```python
import torch

def _softmax(x, axis=-1):
    return torch.softmax(x, dim=axis)

def _gelu(x):
    return torch.nn.functional.gelu(x, approximate='tanh')

def _silu(x):
    return torch.nn.functional.silu(x)

def _sigmoid(x):
    return torch.sigmoid(x)

def _layernorm(x, axis=-1, eps=1e-05):
    m = x.mean(dim=axis, keepdim=True)
    v = x.var(dim=axis, keepdim=True, unbiased=False)
    return (x - m) / torch.sqrt(v + eps)

def _scatter_add(tgt, idx, src, axis=0):
    return tgt.clone().index_add_(axis, idx, src)

def _segment_sum(src, seg, n):
    out = torch.zeros((n,) + src.shape[1:], dtype=src.dtype)
    return out.index_add_(0, seg, src)

def _pad(x, pw):
    flat = tuple((v for pair in reversed(pw) for v in pair))
    return torch.nn.functional.pad(x, flat)
kernel_name = 'sequential_preLN__spectral_gfnet__mixer_gmlp__prompt'

def setup_inputs():

    _w = lambda a: (lambda t: t.to(torch.bfloat16) if t.is_floating_point() else t)(torch.as_tensor(a))

    def _A_setup():
        B, S, D = (1, 2048, 512)
        Df = D // 2 + 1
        return {'x': _w((lambda *s: torch.randn(*s, dtype=torch.bfloat16) * 0.05)(B, S, D)), 'w_r': _w((lambda *s: torch.randn(*s, dtype=torch.bfloat16) * 0.4)(S, Df) * 0.02), 'w_i': _w((lambda *s: torch.randn(*s, dtype=torch.bfloat16) * 0.4)(S, Df) * 0.02)}
    _A_in = _A_setup()

    def _B_setup():
        B, S, D, F = (1, 2048, 512, 1792)
        Fh = F // 2
        return {'x': _w((lambda *s: torch.randn(*s, dtype=torch.bfloat16) * 0.05)(B, S, D)), 'w_in': _w((lambda *s: torch.randn(*s, dtype=torch.bfloat16) * 0.4)(D, 2 * Fh)), 'w_sp': _w(0.01 * (lambda *s: torch.randn(*s, dtype=torch.bfloat16) * 0.4)(S, S)), 'b_sp': _w(1.0 + 0.01 * (lambda *s: torch.randn(*s, dtype=torch.bfloat16) * 0.05)(S)), 'w_out': _w((lambda *s: torch.randn(*s, dtype=torch.bfloat16) * 0.05)(Fh, D))}
    _B_in = _B_setup()
    return {'A_x': _A_in['x'], 'A_w_r': _A_in['w_r'], 'A_w_i': _A_in['w_i'], 'B_x': _B_in['x'], 'B_w_in': _B_in['w_in'], 'B_w_sp': _B_in['w_sp'], 'B_b_sp': _B_in['b_sp'], 'B_w_out': _B_in['w_out']}

def reference(A_x, A_w_r, A_w_i, B_x, B_w_in, B_w_sp, B_b_sp, B_w_out):

    def _A_ref(x, w_r, w_i):
        B, S, D = x.shape
        X = (lambda x, axes=(-2, -1): torch.fft.rfft2(x.float(), dim=axes))(x, axes=(-2, -1))
        W = w_r + 1j * w_i
        X = X * W
        y = (lambda x, s, axes=(-2, -1): torch.fft.irfft2(x, s=s, dim=axes).to(torch.bfloat16))(X, (S, D), axes=(-2, -1))
        return y

    def _B_ref(x, w_in, w_sp, b_sp, w_out):
        B, S, D = x.shape
        F = w_in.shape[-1]
        Fh = F // 2
        z = _gelu(torch.einsum('bsd,df->bsf', x, w_in))
        z1 = z[..., :Fh].clone()
        z2 = _layernorm(z[..., Fh:], axis=-1)
        g = torch.einsum('ts,bsf->btf', w_sp, z2) + b_sp[None, :, None]
        return torch.einsum('bsf,fd->bsd', z1 * g, w_out)
    x = A_x
    h = x + _A_ref(_layernorm(x, axis=-1), A_w_r, A_w_i)
    h2 = h + _B_ref(_layernorm(h, axis=-1), B_w_in, B_w_sp, B_b_sp, B_w_out)
    return h2
```

```asm
; @launch grid=(256,1,1) block=(256,1,1) lds=163840
.amdgcn_target "amdgcn-amd-amdhsa--gfx950"
.text
.globl sequential_preLN__spectral_gfnet__mixer_gmlp__prompt_kernel
.p2align 8
.type sequential_preLN__spectral_gfnet__mixer_gmlp__prompt_kernel,@function
sequential_preLN__spectral_gfnet__mixer_gmlp__prompt_kernel:
    s_cmp_ge_u32 s2, 256
    s_cbranch_scc1 L_exit
    s_load_dwordx2 s[8:9], s[0:1], 0
    s_load_dwordx2 s[12:13], s[0:1], 8
    s_load_dwordx2 s[16:17], s[0:1], 16
    s_load_dwordx2 s[40:41], s[0:1], 80
    s_load_dwordx2 s[20:21], s[0:1], 32
    s_load_dwordx2 s[24:25], s[0:1], 40
    s_load_dwordx2 s[28:29], s[0:1], 48
    s_load_dwordx2 s[32:33], s[0:1], 56
    s_load_dwordx2 s[36:37], s[0:1], 64
    s_getpc_b64 s[64:65]
L_pfbase:
    v_lshrrev_b32 v6, 2, v0
    s_lshr_b32 s50, s2, 3
    s_and_b32 s50, s50, 7
    s_lshl_b32 s50, s50, 13
    v_lshl_add_u32 v6, v6, 7, s50
    v_min_u32 v6, L_code_end-L_pfbase-4, v6
    global_load_dword v215, v6, s[64:65]
    s_add_u32 s100, s64, L_table-L_pfbase
    s_addc_u32 s101, s65, 0
    v_lshrrev_b32 v6, 6, v0
    v_and_b32 v1, 63, v0
    v_readfirstlane_b32 s3, v6
    v_lshlrev_b32 v4, 4, v1
    s_lshr_b32 s61, s2, 6
    s_bfe_u32 s62, s2, 0x20004
    s_lshl_b32 s62, s62, 3
    s_and_b32 s50, s2, 7
    s_or_b32 s62, s62, s50
    s_lshl_b32 s50, s61, 9
    s_lshl_b32 s51, s3, 7
    s_add_u32 s50, s50, s51
    s_add_u32 s50, s50, s62
    s_lshl_b32 s50, s50, 10
    s_lshl_b32 m0, s3, 12
    s_mov_b32 s10, 2097152
    s_mov_b32 s11, 0x20000
    s_waitcnt lgkmcnt(0)
    buffer_load_dwordx4 v4, s[8:11], s50 offen offset:0 nt lds
    s_add_u32 s50, s50, 31744
    buffer_load_dwordx4 v4, s[8:11], s50 offen offset:1024 nt lds
    s_add_u32 s50, s50, 31744
    buffer_load_dwordx4 v4, s[8:11], s50 offen offset:2048 nt lds
    s_add_u32 s50, s50, 31744
    buffer_load_dwordx4 v4, s[8:11], s50 offen offset:3072 nt lds
    s_bfe_u32 s60, s2, 0x10003
    s_lshl_b32 s50, s60, 12
    s_add_u32 s50, s50, 67584
    v_add_u32 v6, s50, v4
    v_add_u32 v7, 66560, v4
    global_load_dwordx4 v[64:67], v6, s[100:101] offset:0
    global_load_dwordx4 v[68:71], v6, s[100:101] offset:1024
    global_load_dwordx4 v[76:79], v6, s[100:101] offset:2048
    global_load_dwordx4 v[80:83], v6, s[100:101] offset:3072
    global_load_dwordx4 v[72:75], v7, s[100:101]
    s_mov_b32 s42, 268435456
    s_mov_b32 s43, 0x20000
    v_mov_b32 v217, 0
    buffer_load_dword v214, v217, s[40:43], 0 offen sc1
    s_mov_b32 s14, 1052672
    s_mov_b32 s15, 0x20000
    s_mov_b32 s18, 1052672
    s_mov_b32 s19, 0x20000
    s_mov_b32 s71, 40000
    s_mov_b32 s70, 200
    s_mov_b32 s22, 1835008
    s_mov_b32 s23, 0x20000
    s_mov_b32 s26, 8388608
    s_mov_b32 s27, 0x20000
    s_mov_b32 s30, 4096
    s_mov_b32 s31, 0x20000
    s_mov_b32 s34, 917504
    s_mov_b32 s35, 0x20000
    s_mov_b32 s38, 2097152
    s_mov_b32 s39, 0x20000
    v_and_b32 v2, 15, v0
    v_bfe_u32 v3, v0, 4, 2
    v_lshrrev_b32 v6, 2, v2
    v_and_b32 v7, 3, v2
    v_lshl_add_u32 v5, v6, 3, v7
    s_and_b32 s45, s2, 7
    s_lshl_b32 s45, s45, 2
    s_bfe_u32 s50, s2, 0x20003
    s_add_u32 s45, s45, s50
    s_lshr_b32 s46, s2, 5
    s_lshl_b32 s49, s46, 5
    s_add_u32 s49, s49, s45
    s_lshl_b32 s48, s3, 14
    s_mul_i32 s98, s3, 16640
    s_lshr_b32 s50, s3, 1
    s_lshl_b32 s50, s50, 5
    s_and_b32 s51, s3, 1
    s_lshl_b32 s51, s51, 2
    s_lshl_b32 s47, s45, 6
    s_add_u32 s47, s47, s50
    s_add_u32 s47, s47, s51
    s_lshr_b32 s68, s2, 6
    s_lshl_b32 s68, s68, 4
    s_lshl_b32 s51, s3, 2
    s_add_u32 s68, s68, s51
    s_and_b32 s51, s2, 7
    s_lshl_b32 s51, s51, 8
    s_add_u32 s68, s68, s51
    s_mul_i32 s68, s68, 514
    s_bfe_u32 s51, s2, 0x30003
    s_lshl_b32 s51, s51, 6
    s_add_u32 s68, s68, s51
    s_add_u32 s68, s68, 2
    v_lshrrev_b32 v216, 5, v1
    v_mul_u32_u24 v216, 1028, v216
    v_and_b32 v217, 31, v1
    v_lshl_add_u32 v216, v217, 1, v216
    v_lshl_add_u32 v222, s60, 4, v2
    v_cmp_eq_u32 vcc, 31, v222
    v_mov_b32 v223, 0xc2000000
    s_nop 0
    v_cndmask_b32 v222, 0, v223, vcc
    v_mov_b32 v223, 0x3f803f80
    buffer_load_ushort v192, v216, s[12:15], s68 offen offset:0 nt
    v_mov_b32 v224, 0xfffcfffc
    s_lshr_b32 s50, s2, 3
    s_lshl_b32 s50, s50, 11
    v_lshrrev_b32 v225, 4, v0
    v_lshl_add_u32 v225, v225, 7, s50
    global_load_dword v225, v225, s[100:101]
    buffer_load_short_d16_hi v200, v216, s[16:19], s68 offen offset:0 nt
    s_lshl_b32 s50, s3, 12
    v_lshl_add_u32 v208, v1, 3, s50
    v_bfe_u32 v210, v2, 1, 2
    v_xor_b32 v210, s3, v210
    v_lshlrev_b32 v210, 4, v210
    v_lshl_add_u32 v210, v2, 6, v210
    buffer_load_ushort v196, v216, s[12:15], s68 offen offset:514 nt
    v_lshl_add_u32 v210, v3, 11, v210
    v_add_u32 v210, 133120, v210
    v_bfe_u32 v211, v0, 3, 2
    v_xor_b32 v211, v211, v0
    v_and_b32 v211, 3, v211
    v_and_b32 v212, 0xfc, v0
    buffer_load_short_d16_hi v204, v216, s[16:19], s68 offen offset:514 nt
    v_or_b32 v211, v211, v212
    v_lshlrev_b32 v211, 4, v211
    v_add_u32 v211, 133120, v211
    s_bfe_u32 s50, s62, 0x20002
    s_sub_u32 s50, 0, s50
    s_and_b32 s50, s50, 3
    s_add_u32 s68, s68, 32896
    buffer_load_ushort v193, v216, s[12:15], s68 offen offset:0 nt
    v_xor_b32 v212, s50, v0
    v_and_b32 v212, 3, v212
    v_lshlrev_b32 v212, 4, v212
    v_bfe_u32 v213, v0, 2, 4
    v_lshl_add_u32 v212, v213, 13, v212
    s_lshl_b32 s58, s3, 18
    buffer_load_short_d16_hi v201, v216, s[16:19], s68 offen offset:0 nt
    s_lshl_b32 s51, s60, 17
    s_add_u32 s58, s58, s51
    s_lshr_b32 s51, s62, 4
    s_lshl_b32 s51, s51, 12
    s_add_u32 s58, s58, s51
    s_lshl_b32 s51, s61, 10
    buffer_load_ushort v197, v216, s[12:15], s68 offen offset:514 nt
    s_add_u32 s58, s58, s51
    s_and_b32 s51, s62, 15
    s_lshl_b32 s51, s51, 6
    s_add_u32 s58, s58, s51
    s_add_u32 s58, s58, 1048576
    s_add_u32 s59, s58, 1048576
    buffer_load_short_d16_hi v205, v216, s[16:19], s68 offen offset:514 nt
    s_mov_b32 s96, 0x3b000000
    s_lshr_b32 s69, s46, 1
    s_lshl_b32 s69, s69, 3
    s_add_u32 s69, s69, s3
    s_lshl_b32 s69, s69, 1
    s_and_b32 s54, s46, 1
    s_add_u32 s68, s68, 32896
    buffer_load_ushort v194, v216, s[12:15], s68 offen offset:0 nt
    s_add_u32 s69, s69, s54
    s_lshl_b32 s69, s69, 11
    s_lshl_b32 s54, s45, 18
    s_add_u32 s69, s69, s54
    buffer_load_short_d16_hi v202, v216, s[16:19], s68 offen offset:0 nt
    buffer_load_ushort v198, v216, s[12:15], s68 offen offset:514 nt
    buffer_load_short_d16_hi v206, v216, s[16:19], s68 offen offset:514 nt
    s_add_u32 s68, s68, 32896
    buffer_load_ushort v195, v216, s[12:15], s68 offen offset:0 nt
    buffer_load_short_d16_hi v203, v216, s[16:19], s68 offen offset:0 nt
    buffer_load_ushort v199, v216, s[12:15], s68 offen offset:514 nt
    buffer_load_short_d16_hi v207, v216, s[16:19], s68 offen offset:514 nt
    s_waitcnt vmcnt(17)
    v_readfirstlane_b32 s44, v214
    s_nop 1
    s_add_u32 s44, s44, 1
    s_max_u32 s44, s44, 1
    s_bfe_u32 s50, s44, 131072
    s_bfe_u32 s51, s44, 131074
    s_pack_ll_b32_b16 s4, s50, s51
    s_bfe_u32 s50, s44, 131076
    s_bfe_u32 s51, s44, 131078
    s_pack_ll_b32_b16 s5, s50, s51
    s_bfe_u32 s50, s44, 131080
    s_bfe_u32 s51, s44, 131082
    s_pack_ll_b32_b16 s6, s50, s51
    s_bfe_u32 s50, s44, 131084
    s_bfe_u32 s51, s44, 131086
    s_pack_ll_b32_b16 s7, s50, s51
    ds_read_b64_tr_b16 v[48:49], v208 offset:0
    ds_read_b64_tr_b16 v[50:51], v208 offset:512
    ds_read_b64_tr_b16 v[52:53], v208 offset:1024
    ds_read_b64_tr_b16 v[54:55], v208 offset:1536
    ds_read_b64_tr_b16 v[56:57], v208 offset:2048
    ds_read_b64_tr_b16 v[58:59], v208 offset:2560
    ds_read_b64_tr_b16 v[60:61], v208 offset:3072
    ds_read_b64_tr_b16 v[62:63], v208 offset:3584
    s_waitcnt lgkmcnt(7)
    v_dot2_f32_bf16 v84, v48, v223, 0
    s_waitcnt lgkmcnt(6)
    v_mfma_f32_16x16x32_bf16 v[20:23], v[48:51], v[68:71], 0
    s_waitcnt lgkmcnt(4)
    v_mfma_f32_16x16x32_bf16 v[28:31], v[52:55], v[68:71], 0
    v_mfma_f32_16x16x32_bf16 v[16:19], v[48:51], v[64:67], 0
    v_mfma_f32_16x16x32_bf16 v[24:27], v[52:55], v[64:67], 0
    s_waitcnt lgkmcnt(2)
    v_mfma_f32_16x16x32_bf16 v[36:39], v[56:59], v[68:71], 0
    s_waitcnt lgkmcnt(0)
    v_mfma_f32_16x16x32_bf16 v[44:47], v[60:63], v[68:71], 0
    v_mfma_f32_16x16x32_bf16 v[32:35], v[56:59], v[64:67], 0
    v_mfma_f32_16x16x32_bf16 v[40:43], v[60:63], v[64:67], 0
    v_dot2_f32_bf16 v86, v52, v223, 0
    v_dot2_f32_bf16 v88, v56, v223, 0
    v_dot2_f32_bf16 v90, v60, v223, 0
    v_dot2_f32_bf16 v84, v49, v223, v84
    v_dot2_f32_bf16 v86, v53, v223, v86
    v_dot2_f32_bf16 v88, v57, v223, v88
    v_dot2_f32_bf16 v90, v61, v223, v90
    v_dot2_f32_bf16 v84, v50, v223, v84
    v_dot2_f32_bf16 v86, v54, v223, v86
    v_dot2_f32_bf16 v88, v58, v223, v88
    v_dot2_f32_bf16 v90, v62, v223, v90
    v_dot2_f32_bf16 v84, v51, v223, v84
    v_dot2_f32_bf16 v86, v55, v223, v86
    v_dot2_f32_bf16 v88, v59, v223, v88
    v_dot2_f32_bf16 v90, v63, v223, v90
    v_dot2_f32_bf16 v92, v48, v48, 0
    v_dot2_f32_bf16 v94, v52, v52, 0
    v_permlane32_swap_b32 v84, v88
    v_permlane32_swap_b32 v86, v90
    v_add_f32 v84, v84, v88
    v_add_f32 v86, v86, v90
    v_dot2_f32_bf16 v96, v56, v56, 0
    v_dot2_f32_bf16 v98, v60, v60, 0
    v_permlane16_swap_b32 v84, v86
    v_add_f32 v84, v84, v86
    v_dot2_f32_bf16 v92, v49, v49, v92
    v_dot2_f32_bf16 v94, v53, v53, v94
    v_add_f32_dpp v84, v84, v84 row_ror:8 row_mask:0xf bank_mask:0xf
    v_dot2_f32_bf16 v96, v57, v57, v96
    v_dot2_f32_bf16 v98, v61, v61, v98
    v_dot2_f32_bf16 v92, v50, v50, v92
    v_dot2_f32_bf16 v94, v54, v54, v94
    v_dot2_f32_bf16 v96, v58, v58, v96
    v_dot2_f32_bf16 v98, v62, v62, v98
    v_add_f32_dpp v84, v84, v84 row_ror:4 row_mask:0xf bank_mask:0xf
    v_dot2_f32_bf16 v92, v51, v51, v92
    v_dot2_f32_bf16 v94, v55, v55, v94
    v_dot2_f32_bf16 v96, v59, v59, v96
    v_dot2_f32_bf16 v98, v63, v63, v98
    v_add_f32_dpp v84, v84, v84 row_ror:2 row_mask:0xf bank_mask:0xf
    v_pk_mul_f32 v[100:101], v[20:21], v[80:81]
    v_permlane32_swap_b32 v92, v96
    v_permlane32_swap_b32 v94, v98
    v_add_f32_dpp v84, v84, v84 row_ror:1 row_mask:0xf bank_mask:0xf
    v_add_f32 v92, v92, v96
    v_add_f32 v94, v94, v98
    v_mul_f32 v84, s96, v84
    v_pk_mul_f32 v[102:103], v[22:23], v[82:83]
    v_readlane_b32 s52, v84, 0
    v_readlane_b32 s53, v84, 16
    v_permlane16_swap_b32 v92, v94
    v_pk_mul_f32 v[104:105], v[28:29], v[80:81]
    v_pk_mul_f32 v[106:107], v[30:31], v[82:83]
    v_add_f32 v92, v92, v94
    v_fmac_f32 v16, s52, v222
    v_fmac_f32 v17, s52, v222
    v_fmac_f32 v18, s52, v222
    v_fmac_f32 v19, s52, v222
    v_fmac_f32 v24, s53, v222
    v_fmac_f32 v25, s53, v222
    v_fmac_f32 v26, s53, v222
    v_fmac_f32 v27, s53, v222
    v_pk_mul_f32 v[20:21], v[20:21], v[76:77]
    v_pk_mul_f32 v[22:23], v[22:23], v[78:79]
    v_pk_mul_f32 v[28:29], v[28:29], v[76:77]
    v_pk_mul_f32 v[30:31], v[30:31], v[78:79]
    v_readlane_b32 s54, v84, 32
    v_readlane_b32 s55, v84, 48
    v_pk_fma_f32 v[20:21], v[16:17], v[80:81], v[20:21]
    v_pk_fma_f32 v[22:23], v[18:19], v[82:83], v[22:23]
    v_pk_fma_f32 v[28:29], v[24:25], v[80:81], v[28:29]
    v_pk_fma_f32 v[30:31], v[26:27], v[82:83], v[30:31]
    v_pk_fma_f32 v[16:17], v[16:17], v[76:77], v[100:101] neg_lo:[0,0,1] neg_hi:[0,0,1]
    v_pk_fma_f32 v[18:19], v[18:19], v[78:79], v[102:103] neg_lo:[0,0,1] neg_hi:[0,0,1]
    v_pk_fma_f32 v[24:25], v[24:25], v[76:77], v[104:105] neg_lo:[0,0,1] neg_hi:[0,0,1]
    v_pk_fma_f32 v[26:27], v[26:27], v[78:79], v[106:107] neg_lo:[0,0,1] neg_hi:[0,0,1]
    v_add_f32_dpp v92, v92, v92 row_ror:8 row_mask:0xf bank_mask:0xf
    v_pk_mul_f32 v[100:101], v[36:37], v[80:81]
    v_pk_mul_f32 v[102:103], v[38:39], v[82:83]
    v_pk_mul_f32 v[104:105], v[44:45], v[80:81]
    v_pk_mul_f32 v[106:107], v[46:47], v[82:83]
    v_fmac_f32 v32, s54, v222
    v_fmac_f32 v33, s54, v222
    v_fmac_f32 v34, s54, v222
    v_fmac_f32 v35, s54, v222
    v_fmac_f32 v40, s55, v222
    v_fmac_f32 v41, s55, v222
    v_fmac_f32 v42, s55, v222
    v_fmac_f32 v43, s55, v222
    v_pk_mul_f32 v[36:37], v[36:37], v[76:77]
    v_pk_mul_f32 v[38:39], v[38:39], v[78:79]
    v_pk_mul_f32 v[44:45], v[44:45], v[76:77]
    v_pk_mul_f32 v[46:47], v[46:47], v[78:79]
    v_pk_fma_f32 v[36:37], v[32:33], v[80:81], v[36:37]
    v_pk_fma_f32 v[38:39], v[34:35], v[82:83], v[38:39]
    v_pk_fma_f32 v[44:45], v[40:41], v[80:81], v[44:45]
    v_pk_fma_f32 v[46:47], v[42:43], v[82:83], v[46:47]
    v_add_f32_dpp v92, v92, v92 row_ror:4 row_mask:0xf bank_mask:0xf
    v_pk_fma_f32 v[32:33], v[32:33], v[76:77], v[100:101] neg_lo:[0,0,1] neg_hi:[0,0,1]
    v_pk_fma_f32 v[34:35], v[34:35], v[78:79], v[102:103] neg_lo:[0,0,1] neg_hi:[0,0,1]
    v_pk_fma_f32 v[40:41], v[40:41], v[76:77], v[104:105] neg_lo:[0,0,1] neg_hi:[0,0,1]
    v_pk_fma_f32 v[42:43], v[42:43], v[78:79], v[106:107] neg_lo:[0,0,1] neg_hi:[0,0,1]
    v_cvt_pk_bf16_f32 v48, v16, v20
    v_cvt_pk_bf16_f32 v49, v17, v21
    v_cvt_pk_bf16_f32 v50, v18, v22
    v_cvt_pk_bf16_f32 v51, v19, v23
    v_cvt_pk_bf16_f32 v52, v24, v28
    v_cvt_pk_bf16_f32 v53, v25, v29
    v_mfma_f32_16x16x32_bf16 v[16:19], v[72:75], v[48:51], 0
    v_cvt_pk_bf16_f32 v54, v26, v30
    v_cvt_pk_bf16_f32 v55, v27, v31
    v_cvt_pk_bf16_f32 v56, v32, v36
    v_cvt_pk_bf16_f32 v57, v33, v37
    v_mfma_f32_16x16x32_bf16 v[20:23], v[72:75], v[52:55], 0
    v_cvt_pk_bf16_f32 v58, v34, v38
    v_cvt_pk_bf16_f32 v59, v35, v39
    v_cvt_pk_bf16_f32 v60, v40, v44
    v_cvt_pk_bf16_f32 v61, v41, v45
    v_mfma_f32_16x16x32_bf16 v[24:27], v[72:75], v[56:59], 0
    v_cvt_pk_bf16_f32 v62, v42, v46
    v_cvt_pk_bf16_f32 v63, v43, v47
    v_add_f32_dpp v92, v92, v92 row_ror:2 row_mask:0xf bank_mask:0xf
    v_mul_f32 v85, v84, v84
    v_mfma_f32_16x16x32_bf16 v[28:31], v[72:75], v[60:63], 0
    v_add_f32_dpp v92, v92, v92 row_ror:1 row_mask:0xf bank_mask:0xf
    v_fma_f32 v92, v92, s96, -v85
    v_max_f32 v92, 0, v92
    v_add_f32 v92, 0x3727c5ac, v92
    v_rsq_f32 v92, v92
    s_nop 0
    v_mul_f32 v92, 0x3e800000, v92
    s_nop 0
    v_readlane_b32 s60, v92, 0
    v_readlane_b32 s62, v92, 16
    v_readlane_b32 s64, v92, 32
    v_readlane_b32 s66, v92, 48
    v_pk_mul_f32 v[16:17], v[16:17], s[60:61] op_sel_hi:[1,0]
    v_pk_mul_f32 v[20:21], v[20:21], s[62:63] op_sel_hi:[1,0]
    v_pk_mul_f32 v[24:25], v[24:25], s[64:65] op_sel_hi:[1,0]
    v_pk_mul_f32 v[28:29], v[28:29], s[66:67] op_sel_hi:[1,0]
    v_pk_mul_f32 v[18:19], v[18:19], s[60:61] op_sel_hi:[1,0]
    v_pk_mul_f32 v[22:23], v[22:23], s[62:63] op_sel_hi:[1,0]
    v_pk_mul_f32 v[26:27], v[26:27], s[64:65] op_sel_hi:[1,0]
    v_pk_mul_f32 v[30:31], v[30:31], s[66:67] op_sel_hi:[1,0]
    v_cvt_pk_f16_f32 v40, v16, v17
    v_cvt_pk_f16_f32 v41, v20, v21
    v_cvt_pk_f16_f32 v42, v24, v25
    v_cvt_pk_f16_f32 v43, v28, v29
    v_add_u32 v40, 0x20002, v40
    v_add_u32 v41, 0x20002, v41
    v_add_u32 v42, 0x20002, v42
    v_add_u32 v43, 0x20002, v43
    v_cvt_pk_f16_f32 v44, v18, v19
    v_cvt_pk_f16_f32 v45, v22, v23
    v_cvt_pk_f16_f32 v46, v26, v27
    v_cvt_pk_f16_f32 v47, v30, v31
    v_bfi_b32 v40, v224, v40, s4
    v_bfi_b32 v41, v224, v41, s5
    v_bfi_b32 v42, v224, v42, s6
    v_bfi_b32 v43, v224, v43, s7
    v_add_u32 v44, 0x20002, v44
    v_add_u32 v45, 0x20002, v45
    v_add_u32 v46, 0x20002, v46
    v_add_u32 v47, 0x20002, v47
    ds_write_b128 v210, v[40:43] offset:0
    v_bfi_b32 v44, v224, v44, s4
    v_bfi_b32 v45, v224, v45, s5
    v_bfi_b32 v46, v224, v46, s6
    v_bfi_b32 v47, v224, v47, s7
    ds_write_b128 v210, v[44:47] offset:1024
    s_waitcnt lgkmcnt(0)
    s_barrier
    ds_read_b128 v[16:19], v211
    ds_read_b128 v[20:23], v211 offset:4096
    s_waitcnt lgkmcnt(1)
    buffer_store_dwordx4 v[16:19], v212, s[40:43], s58 offen sc1
    s_waitcnt lgkmcnt(0)
    buffer_store_dwordx4 v[20:23], v212, s[40:43], s59 offen sc1
    s_lshl_b32 s50, s2, 4
    s_add_u32 s50, s50, 8192
    s_cmp_eq_u32 s3, 3
    s_cselect_b32 s50, s50, 0x20000000
    v_mov_b32 v6, s44
    v_mov_b32 v63, 0
    s_mov_b64 exec, 1
    buffer_store_dword v6, v63, s[40:43], s50 offen sc1
    s_mov_b64 exec, -1
    s_lshl_b32 s50, s3, 2
    v_lshrrev_b32 v219, 5, v1
    v_lshl_add_u32 v219, v219, 1, s50
    v_and_b32 v220, 7, v1
    v_xor_b32 v219, v219, v220
    v_lshlrev_b32 v219, 4, v219
    v_and_b32 v220, 31, v1
    v_lshl_add_u32 v219, v220, 8, v219
    v_add_u32 v219, 141312, v219
    v_xor_b32 v221, 16, v219
    s_waitcnt vmcnt(17)
    v_or_b32 v192, v192, v200
    s_waitcnt vmcnt(13)
    v_or_b32 v193, v193, v201
    s_waitcnt vmcnt(9)
    v_or_b32 v194, v194, v202
    s_waitcnt vmcnt(5)
    v_or_b32 v195, v195, v203
    v_or_b32 v196, v196, v204
    v_or_b32 v197, v197, v205
    v_or_b32 v198, v198, v206
    s_waitcnt vmcnt(3)
    v_or_b32 v199, v199, v207
    ds_write_b128 v219, v[192:195]
    ds_write_b128 v221, v[196:199]
    v_lshrrev_b32 v209, 4, v0
    v_xor_b32 v220, v209, v0
    v_and_b32 v220, 7, v220
    v_and_b32 v218, 0xf8, v0
    v_or_b32 v220, v220, v218
    v_lshlrev_b32 v220, 4, v220
    v_add_u32 v220, 141312, v220
    v_mul_u32_u24 v209, 8704, v209
    v_lshl_add_u32 v209, v2, 4, v209
    s_bfe_u32 s57, s2, 0x30003
    s_mul_i32 s57, s57, 278528
    s_lshr_b32 s51, s2, 6
    s_mul_i32 s51, s51, 2176
    s_add_u32 s57, s57, s51
    s_and_b32 s51, s2, 7
    s_add_u32 s57, s57, 3145728
    s_lshl_b32 s56, s51, 3
    s_add_u32 s56, s56, s57
    s_lshl_b32 s51, s51, 8
    s_add_u32 s57, s57, s51
    s_waitcnt lgkmcnt(0)
    s_barrier
    s_cmp_ge_u32 s3, 2
    s_cbranch_scc1 L_wst_1
    ds_read_b128 v[16:19], v220 offset:0
    ds_read_b128 v[20:23], v220 offset:2048
    ds_read_b128 v[24:27], v220 offset:4096
    ds_read_b128 v[28:31], v220 offset:6144
    s_add_u32 s52, s57, 0
    v_mov_b32 v33, s44
    s_add_u32 s53, s57, 69632
    v_mov_b32 v35, s44
    s_add_u32 s54, s57, 139264
    v_mov_b32 v37, s44
    s_add_u32 s55, s57, 208896
    v_mov_b32 v39, s44
    s_waitcnt lgkmcnt(3)
    buffer_store_dwordx4 v[16:19], v209, s[40:43], s52 offen sc1
    v_add3_u32 v32, v16, v17, v18
    v_add_u32 v32, v32, v19
    s_waitcnt lgkmcnt(2)
    buffer_store_dwordx4 v[20:23], v209, s[40:43], s53 offen sc1
    v_add3_u32 v34, v20, v21, v22
    v_add_u32 v34, v34, v23
    s_waitcnt lgkmcnt(1)
    buffer_store_dwordx4 v[24:27], v209, s[40:43], s54 offen sc1
    v_add3_u32 v36, v24, v25, v26
    v_add_u32 v36, v36, v27
    s_waitcnt lgkmcnt(0)
    buffer_store_dwordx4 v[28:31], v209, s[40:43], s55 offen sc1
    v_add3_u32 v38, v28, v29, v30
    v_add_u32 v38, v38, v31
    v_add_u32_dpp v32, v32, v32 row_ror:8 row_mask:0xf bank_mask:0xf
    v_add_u32_dpp v34, v34, v34 row_ror:8 row_mask:0xf bank_mask:0xf
    v_add_u32_dpp v36, v36, v36 row_ror:8 row_mask:0xf bank_mask:0xf
    v_add_u32_dpp v38, v38, v38 row_ror:8 row_mask:0xf bank_mask:0xf
    v_add_u32_dpp v32, v32, v32 row_ror:4 row_mask:0xf bank_mask:0xf
    v_add_u32_dpp v34, v34, v34 row_ror:4 row_mask:0xf bank_mask:0xf
    v_add_u32_dpp v36, v36, v36 row_ror:4 row_mask:0xf bank_mask:0xf
    v_add_u32_dpp v38, v38, v38 row_ror:4 row_mask:0xf bank_mask:0xf
    v_add_u32_dpp v32, v32, v32 row_ror:2 row_mask:0xf bank_mask:0xf
    v_add_u32_dpp v34, v34, v34 row_ror:2 row_mask:0xf bank_mask:0xf
    v_add_u32_dpp v36, v36, v36 row_ror:2 row_mask:0xf bank_mask:0xf
    v_add_u32_dpp v38, v38, v38 row_ror:2 row_mask:0xf bank_mask:0xf
    v_add_u32_dpp v32, v32, v32 row_ror:1 row_mask:0xf bank_mask:0xf
    v_add_u32_dpp v34, v34, v34 row_ror:1 row_mask:0xf bank_mask:0xf
    v_add_u32_dpp v36, v36, v36 row_ror:1 row_mask:0xf bank_mask:0xf
    v_add_u32_dpp v38, v38, v38 row_ror:1 row_mask:0xf bank_mask:0xf
    s_mov_b32 exec_lo, 0x10001
    s_mov_b32 exec_hi, 0x10001
    buffer_store_dwordx2 v[32:33], v209, s[40:43], s56 offen offset:2048 sc1
    s_add_u32 s56, s56, 69632
    buffer_store_dwordx2 v[34:35], v209, s[40:43], s56 offen offset:2048 sc1
    s_add_u32 s56, s56, 69632
    buffer_store_dwordx2 v[36:37], v209, s[40:43], s56 offen offset:2048 sc1
    s_add_u32 s56, s56, 69632
    buffer_store_dwordx2 v[38:39], v209, s[40:43], s56 offen offset:2048 sc1
    s_mov_b64 exec, -1
    s_lshr_b32 s50, s2, 5
    s_mul_i32 s50, s50, 112
    s_bfe_u32 s51, s2, 0x20003
    s_lshl_b32 s51, s51, 5
    s_add_u32 s50, s50, s51
    s_lshl_b32 s51, s3, 4
    s_add_u32 s50, s50, s51
    s_lshl_b32 s50, s50, 10
    s_and_b32 s51, s2, 7
    s_lshl_b32 s51, s51, 7
    s_add_u32 s50, s50, s51
    v_lshrrev_b32 v122, 3, v1
    v_and_b32 v123, 7, v1
    v_lshlrev_b32 v123, 4, v123
    v_lshl_add_u32 v124, v122, 10, v123
    s_lshl_b32 s52, s3, 11
    s_add_u32 m0, s52, 157696
    s_nop 0
    buffer_load_dwordx4 v124, s[32:35], s50 offen nt lds
    s_add_u32 s50, s50, 8192
    s_add_u32 m0, s52, 158720
    s_nop 0
    buffer_load_dwordx4 v124, s[32:35], s50 offen nt lds
    s_lshl_b32 s50, s3, 8
    s_and_b32 s51, s2, 7
    s_lshl_b32 s51, s51, 4
    s_add_u32 s50, s50, s51
    s_mul_i32 s50, s50, 3584
    s_lshr_b32 s51, s2, 3
    s_lshl_b32 s51, s51, 7
    s_add_u32 s50, s50, s51
    v_mul_u32_u24 v124, 3584, v122
    v_add_u32 v124, v124, v123
    s_lshl_b32 s52, s3, 12
    s_add_u32 m0, s52, 149504
    s_nop 0
    buffer_load_dwordx4 v124, s[20:23], s50 offen nt lds
    s_add_u32 s50, s50, 28672
    s_add_u32 m0, s52, 150528
    s_nop 0
    buffer_load_dwordx4 v124, s[20:23], s50 offen nt lds
    s_add_u32 s50, s50, 430080
    s_add_u32 m0, s52, 151552
    s_nop 0
    buffer_load_dwordx4 v124, s[20:23], s50 offen nt lds
    s_add_u32 s50, s50, 28672
    s_add_u32 m0, s52, 152576
    s_nop 0
    buffer_load_dwordx4 v124, s[20:23], s50 offen nt lds
L_wst_1:
    s_lshl_b32 s58, s47, 10
    v_cvt_f32_u32 v84, v2
    v_lshlrev_b32 v89, 2, v3
    v_cvt_f32_u32 v89, v89
    s_lshl_b32 s50, s3, 4
    v_add_u32 v86, s50, v2
    v_cvt_f32_u32 v86, v86
    v_mul_f32 v87, 0x3c800000, v86
    v_and_b32 v85, 1, v2
    v_mul_u32_u24 v85, 0x8000, v85
    v_lshl_add_u32 v85, v85, 16, v85
    v_mul_f32 v88, v89, v87
    v_mul_f32 v90, 0x41800000, v87
    v_cos_f32 v92, v88
    v_sin_f32 v93, v88
    v_cos_f32 v102, v87
    v_sin_f32 v103, v87
    v_cos_f32 v100, v90
    v_sin_f32 v101, v90
    v_pk_mul_f32 v[94:95], v[92:93], v[102:103] op_sel_hi:[1,0]
    s_add_u32 m0, s48, 0
    v_add_u32 v7, m0, v4
    global_load_lds_dwordx4 v7, s[100:101] offset:0
    v_pk_fma_f32 v[94:95], v[92:93], v[102:103], v[94:95] op_sel:[1,1,0] op_sel_hi:[0,1,1] neg_lo:[1,0,0]
    v_pk_mul_f32 v[96:97], v[94:95], v[102:103] op_sel_hi:[1,0]
    v_pk_fma_f32 v[96:97], v[94:95], v[102:103], v[96:97] op_sel:[1,1,0] op_sel_hi:[0,1,1] neg_lo:[1,0,0]
    v_pk_mul_f32 v[98:99], v[96:97], v[102:103] op_sel_hi:[1,0]
    v_pk_fma_f32 v[98:99], v[96:97], v[102:103], v[98:99] op_sel:[1,1,0] op_sel_hi:[0,1,1] neg_lo:[1,0,0]
    v_cvt_pk_bf16_f32 v160, v92, v93
    v_cvt_pk_bf16_f32 v164, -v93, v92
    v_cvt_pk_bf16_f32 v161, v94, v95
    v_cvt_pk_bf16_f32 v165, -v95, v94
    v_cvt_pk_bf16_f32 v162, v96, v97
    v_cvt_pk_bf16_f32 v166, -v97, v96
    v_cvt_pk_bf16_f32 v163, v98, v99
    v_cvt_pk_bf16_f32 v167, -v99, v98
    v_cvt_pk_f16_f32 v128, v92, v93
    v_cvt_pk_f16_f32 v132, -v93, v92
    v_cvt_pk_f16_f32 v129, v94, v95
    v_cvt_pk_f16_f32 v133, -v95, v94
    v_cvt_pk_f16_f32 v130, v96, v97
    v_cvt_pk_f16_f32 v134, -v97, v96
    v_cvt_pk_f16_f32 v131, v98, v99
    global_load_lds_dwordx4 v7, s[100:101] offset:1024
    v_cvt_pk_f16_f32 v135, -v99, v98
    v_pk_mul_f32 v[104:105], v[92:93], v[100:101] op_sel_hi:[1,0]
    v_pk_fma_f32 v[104:105], v[92:93], v[100:101], v[104:105] op_sel:[1,1,0] op_sel_hi:[0,1,1] neg_lo:[1,0,0]
    v_pk_mul_f32 v[106:107], v[94:95], v[100:101] op_sel_hi:[1,0]
    v_pk_fma_f32 v[106:107], v[94:95], v[100:101], v[106:107] op_sel:[1,1,0] op_sel_hi:[0,1,1] neg_lo:[1,0,0]
    v_pk_mul_f32 v[108:109], v[96:97], v[100:101] op_sel_hi:[1,0]
    v_pk_fma_f32 v[108:109], v[96:97], v[100:101], v[108:109] op_sel:[1,1,0] op_sel_hi:[0,1,1] neg_lo:[1,0,0]
    v_pk_mul_f32 v[110:111], v[98:99], v[100:101] op_sel_hi:[1,0]
    v_pk_fma_f32 v[110:111], v[98:99], v[100:101], v[110:111] op_sel:[1,1,0] op_sel_hi:[0,1,1] neg_lo:[1,0,0]
    v_cvt_pk_bf16_f32 v168, v104, v105
    v_cvt_pk_bf16_f32 v172, -v105, v104
    v_cvt_pk_bf16_f32 v169, v106, v107
    v_cvt_pk_bf16_f32 v173, -v107, v106
    v_cvt_pk_bf16_f32 v170, v108, v109
    v_cvt_pk_bf16_f32 v174, -v109, v108
    v_cvt_pk_bf16_f32 v171, v110, v111
    v_cvt_pk_bf16_f32 v175, -v111, v110
    v_cvt_pk_f16_f32 v136, v104, v105
    v_cvt_pk_f16_f32 v140, -v105, v104
    v_cvt_pk_f16_f32 v137, v106, v107
    global_load_lds_dwordx4 v7, s[100:101] offset:2048
    v_cvt_pk_f16_f32 v141, -v107, v106
    v_cvt_pk_f16_f32 v138, v108, v109
    v_cvt_pk_f16_f32 v142, -v109, v108
    v_cvt_pk_f16_f32 v139, v110, v111
    v_cvt_pk_f16_f32 v143, -v111, v110
    v_xor_b32 v144, v85, v128
    v_xor_b32 v176, v85, v160
    v_xor_b32 v145, v85, v129
    v_xor_b32 v177, v85, v161
    v_xor_b32 v146, v85, v130
    v_xor_b32 v178, v85, v162
    v_xor_b32 v147, v85, v131
    v_xor_b32 v179, v85, v163
    v_xor_b32 v148, v85, v132
    v_xor_b32 v180, v85, v164
    v_xor_b32 v149, v85, v133
    v_xor_b32 v181, v85, v165
    v_xor_b32 v150, v85, v134
    v_xor_b32 v182, v85, v166
    v_xor_b32 v151, v85, v135
    global_load_lds_dwordx4 v7, s[100:101] offset:3072
    v_xor_b32 v183, v85, v167
    v_xor_b32 v152, v85, v136
    v_xor_b32 v184, v85, v168
    v_xor_b32 v153, v85, v137
    v_xor_b32 v185, v85, v169
    v_xor_b32 v154, v85, v138
    v_xor_b32 v186, v85, v170
    v_xor_b32 v155, v85, v139
    v_xor_b32 v187, v85, v171
    v_xor_b32 v156, v85, v140
    v_xor_b32 v188, v85, v172
    v_xor_b32 v157, v85, v141
    v_xor_b32 v189, v85, v173
    v_xor_b32 v158, v85, v142
    v_xor_b32 v190, v85, v174
    v_xor_b32 v159, v85, v143
    v_xor_b32 v191, v85, v175
    s_cmp_lg_u32 s3, 3
    s_cbranch_scc1 L_ack_2
    s_waitcnt vmcnt(5)
L_ack_2:
    s_lshl_b32 s50, s2, 4
    s_add_u32 s50, s50, 12288
    s_cmp_eq_u32 s3, 3
    s_cselect_b32 s50, s50, 0x20000000
    v_mov_b32 v6, s44
    v_mov_b32 v63, 0
    s_mov_b64 exec, 1
    buffer_store_dword v6, v63, s[40:43], s50 offen sc1
    s_mov_b64 exec, -1
    v_mul_f32 v87, 0x3d000000, v84
    v_mul_f32 v88, v89, v87
    v_cos_f32 v92, v88
    s_add_u32 m0, s48, 4096
    v_add_u32 v7, m0, v4
    global_load_lds_dwordx4 v7, s[100:101] offset:0
    v_sin_f32 v93, v88
    v_cos_f32 v102, v87
    v_sin_f32 v103, v87
    s_nop 0
    v_pk_mul_f32 v[94:95], v[92:93], v[102:103] op_sel_hi:[1,0]
    v_pk_fma_f32 v[94:95], v[92:93], v[102:103], v[94:95] op_sel:[1,1,0] op_sel_hi:[0,1,1] neg_lo:[1,0,0]
    v_pk_mul_f32 v[96:97], v[94:95], v[102:103] op_sel_hi:[1,0]
    v_pk_fma_f32 v[96:97], v[94:95], v[102:103], v[96:97] op_sel:[1,1,0] op_sel_hi:[0,1,1] neg_lo:[1,0,0]
    v_pk_mul_f32 v[98:99], v[96:97], v[102:103] op_sel_hi:[1,0]
    v_pk_fma_f32 v[98:99], v[96:97], v[102:103], v[98:99] op_sel:[1,1,0] op_sel_hi:[0,1,1] neg_lo:[1,0,0]
    v_cvt_pk_bf16_f32 v192, v92, v93
    v_cvt_pk_bf16_f32 v196, -v93, v92
    v_cvt_pk_bf16_f32 v193, v94, v95
    v_cvt_pk_bf16_f32 v197, -v95, v94
    v_cvt_pk_bf16_f32 v194, v96, v97
    v_cvt_pk_bf16_f32 v198, -v97, v96
    v_cvt_pk_bf16_f32 v195, v98, v99
    v_cvt_pk_bf16_f32 v199, -v99, v98
    v_xor_b32 v200, v85, v192
    v_xor_b32 v201, v85, v193
    v_xor_b32 v202, v85, v194
    global_load_lds_dwordx4 v7, s[100:101] offset:1024
    v_xor_b32 v203, v85, v195
    v_xor_b32 v204, v85, v196
    v_xor_b32 v205, v85, v197
    v_xor_b32 v206, v85, v198
    v_xor_b32 v207, v85, v199
    v_mov_b32 v208, v192
    v_xor_b32 v209, 0x80008000, v193
    v_mov_b32 v210, v194
    v_xor_b32 v211, 0x80008000, v195
    v_mov_b32 v212, v196
    v_xor_b32 v213, 0x80008000, v197
    v_mov_b32 v214, v198
    v_xor_b32 v215, 0x80008000, v199
    v_mov_b32 v216, v200
    v_xor_b32 v217, 0x80008000, v201
    v_mov_b32 v218, v202
    v_xor_b32 v219, 0x80008000, v203
    v_mov_b32 v220, v204
    v_xor_b32 v221, 0x80008000, v205
    v_mov_b32 v222, v206
    global_load_lds_dwordx4 v7, s[100:101] offset:2048
    v_xor_b32 v223, 0x80008000, v207
    v_mul_f32 v87, 0xba000000, v86
    v_mul_f32 v88, v89, v87
    v_mul_f32 v90, 0x41800000, v87
    v_cos_f32 v92, v88
    v_sin_f32 v93, v88
    v_cos_f32 v102, v87
    v_sin_f32 v103, v87
    v_cos_f32 v100, v90
    v_sin_f32 v101, v90
    v_pk_mul_f32 v[94:95], v[92:93], v[102:103] op_sel_hi:[1,0]
    v_pk_fma_f32 v[94:95], v[92:93], v[102:103], v[94:95] op_sel:[1,1,0] op_sel_hi:[0,1,1] neg_lo:[1,0,0]
    v_pk_mul_f32 v[96:97], v[94:95], v[102:103] op_sel_hi:[1,0]
    v_pk_fma_f32 v[96:97], v[94:95], v[102:103], v[96:97] op_sel:[1,1,0] op_sel_hi:[0,1,1] neg_lo:[1,0,0]
    v_pk_mul_f32 v[98:99], v[96:97], v[102:103] op_sel_hi:[1,0]
    v_pk_fma_f32 v[98:99], v[96:97], v[102:103], v[98:99] op_sel:[1,1,0] op_sel_hi:[0,1,1] neg_lo:[1,0,0]
    s_mov_b32 s51, 0x3d800000
    v_mul_f32 v224, s51, v92
    v_mul_f32 v228, s51, v93
    v_mul_f32 v225, s51, v94
    global_load_lds_dwordx4 v7, s[100:101] offset:3072
    v_mul_f32 v229, s51, v95
    v_mul_f32 v226, s51, v96
    v_mul_f32 v230, s51, v97
    v_mul_f32 v227, s51, v98
    v_mul_f32 v231, s51, v99
    v_pk_mul_f32 v[104:105], v[92:93], v[100:101] op_sel_hi:[1,0]
    v_pk_fma_f32 v[104:105], v[92:93], v[100:101], v[104:105] op_sel:[1,1,0] op_sel_hi:[0,1,1] neg_lo:[1,0,0]
    v_pk_mul_f32 v[106:107], v[94:95], v[100:101] op_sel_hi:[1,0]
    v_pk_fma_f32 v[106:107], v[94:95], v[100:101], v[106:107] op_sel:[1,1,0] op_sel_hi:[0,1,1] neg_lo:[1,0,0]
    v_pk_mul_f32 v[108:109], v[96:97], v[100:101] op_sel_hi:[1,0]
    v_pk_fma_f32 v[108:109], v[96:97], v[100:101], v[108:109] op_sel:[1,1,0] op_sel_hi:[0,1,1] neg_lo:[1,0,0]
    v_pk_mul_f32 v[110:111], v[98:99], v[100:101] op_sel_hi:[1,0]
    v_pk_fma_f32 v[110:111], v[98:99], v[100:101], v[110:111] op_sel:[1,1,0] op_sel_hi:[0,1,1] neg_lo:[1,0,0]
    v_mul_f32 v232, s51, v104
    v_mul_f32 v236, s51, v105
    v_mul_f32 v233, s51, v106
    v_mul_f32 v237, s51, v107
    v_mul_f32 v234, s51, v108
    v_mul_f32 v238, s51, v109
    v_mul_f32 v235, s51, v110
    v_mul_f32 v239, s51, v111
    s_bfe_u32 s65, s2, 0x10004
    s_lshl_b32 s65, s65, 7
    v_and_b32 v63, 7, v1
    v_lshrrev_b32 v53, 3, v1
    v_lshlrev_b32 v63, 4, v63
    v_lshl_add_u32 v53, v53, 8, v63
    s_add_u32 s65, s65, 8192
    s_add_u32 s67, s65, 4096
    s_lshl_b32 s60, s2, 13
    s_lshl_b32 s61, s3, 11
    s_add_u32 s60, s60, s61
    s_mul_i32 s62, s2, 8704
    s_mul_i32 s51, s3, 2176
    s_add_u32 s62, s62, s51
    v_and_b32 v54, 7, v1
    v_lshlrev_b32 v54, 3, v54
    s_lshl_b32 s60, s2, 13
    s_lshl_b32 s66, s3, 12
    s_add_u32 s60, s60, s66
    s_add_u32 s60, s60, 1040384
    s_add_u32 s62, s62, 3145728
    v_lshrrev_b32 v56, 2, v2
    v_sub_u32 v56, 0, v56
    v_and_b32 v56, 3, v56
    v_xor_b32 v56, v56, v3
    v_lshlrev_b32 v56, 4, v56
    v_lshl_add_u32 v57, v2, 6, v56
    v_add_u32 v57, 133120, v57
    v_lshl_add_u32 v58, v5, 6, v56
    s_bfe_u32 s51, s2, 0x10006
    s_lshl_b32 s51, s51, 8
    s_add_u32 s51, s51, 141312
    v_add_u32 v58, s51, v58
    v_xor_b32 v55, 256, v58
    v_lshrrev_b32 v59, 3, v2
    v_sub_u32 v59, 0, v59
    v_and_b32 v59, 3, v59
    v_xor_b32 v59, v59, v3
    v_lshlrev_b32 v59, 4, v59
    v_lshl_add_u32 v59, v2, 6, v59
    s_add_u32 s51, s61, 141312
    v_add_u32 v59, s51, v59
    v_xor_b32 v60, 32, v59
    s_add_u32 s61, s66, 124928
    v_lshrrev_b32 v48, 1, v2
    v_lshlrev_b32 v61, 16, v48
    v_and_b32 v62, 1, v2
    v_lshl_add_u32 v61, v62, 6, v61
    v_lshl_add_u32 v61, v3, 4, v61
    s_lshl_b32 s63, s3, 19
    s_lshl_b32 s51, s2, 8
    s_add_u32 s63, s63, s51
    s_add_u32 s63, s63, 7340032
    v_lshlrev_b32 v48, 11, v48
    s_lshl_b32 s64, s2, 3
    s_add_u32 s64, s64, s48
    s_add_u32 s64, s64, 13107200
    v_mov_b32 v51, s44
    s_lshl_b32 s50, s3, 4
    s_mov_b32 s51, 0x39000000
    s_cmp_eq_u32 s2, 255
    s_cselect_b32 s51, 0x38800000, s51
    v_cvt_f32_u32 v91, s50
    v_add_f32 v87, 0x00000000, v84
    v_mul_f32 v87, 0xba000000, v87
    v_add_f32 v88, v91, v89
    v_mul_f32 v88, v88, v87
    v_cos_f32 v92, v88
    v_sin_f32 v93, v88
    v_cos_f32 v102, v87
    v_sin_f32 v103, v87
    s_nop 0
    v_pk_mul_f32 v[94:95], v[92:93], v[102:103] op_sel_hi:[1,0]
    v_pk_fma_f32 v[94:95], v[92:93], v[102:103], v[94:95] op_sel:[1,1,0] op_sel_hi:[0,1,1] neg_lo:[1,0,0]
    v_pk_mul_f32 v[96:97], v[94:95], v[102:103] op_sel_hi:[1,0]
    v_pk_fma_f32 v[96:97], v[94:95], v[102:103], v[96:97] op_sel:[1,1,0] op_sel_hi:[0,1,1] neg_lo:[1,0,0]
    v_pk_mul_f32 v[98:99], v[96:97], v[102:103] op_sel_hi:[1,0]
    v_pk_fma_f32 v[98:99], v[96:97], v[102:103], v[98:99] op_sel:[1,1,0] op_sel_hi:[0,1,1] neg_lo:[1,0,0]
    v_mul_f32 v240, s51, v92
    v_mul_f32 v244, s51, v93
    v_mul_f32 v241, s51, v94
    v_mul_f32 v245, s51, v95
    v_mul_f32 v242, s51, v96
    v_mul_f32 v246, s51, v97
    v_mul_f32 v243, s51, v98
    v_mul_f32 v247, s51, v99
    v_add_f32 v87, 0x41800000, v84
    v_mul_f32 v87, 0xba000000, v87
    v_add_f32 v88, v91, v89
    v_mul_f32 v88, v88, v87
    v_cos_f32 v92, v88
    v_sin_f32 v93, v88
    v_cos_f32 v102, v87
    v_sin_f32 v103, v87
    s_nop 0
    v_pk_mul_f32 v[94:95], v[92:93], v[102:103] op_sel_hi:[1,0]
    v_pk_fma_f32 v[94:95], v[92:93], v[102:103], v[94:95] op_sel:[1,1,0] op_sel_hi:[0,1,1] neg_lo:[1,0,0]
    v_pk_mul_f32 v[96:97], v[94:95], v[102:103] op_sel_hi:[1,0]
    v_pk_fma_f32 v[96:97], v[94:95], v[102:103], v[96:97] op_sel:[1,1,0] op_sel_hi:[0,1,1] neg_lo:[1,0,0]
    v_pk_mul_f32 v[98:99], v[96:97], v[102:103] op_sel_hi:[1,0]
    v_pk_fma_f32 v[98:99], v[96:97], v[102:103], v[98:99] op_sel:[1,1,0] op_sel_hi:[0,1,1] neg_lo:[1,0,0]
    v_mul_f32 v248, s51, v92
    v_mul_f32 v252, s51, v93
    v_mul_f32 v249, s51, v94
    v_mul_f32 v253, s51, v95
    v_mul_f32 v250, s51, v96
    v_mul_f32 v254, s51, v97
    v_mul_f32 v251, s51, v98
    v_mul_f32 v255, s51, v99
    v_mov_b32 v120, 0
    s_cmp_lt_u32 s3, 2
    s_cbranch_scc1 L_nocol_8
    s_mov_b32 m0, s61
    s_nop 0
    buffer_load_dwordx4 v4, s[40:43], s60 offen offset:0 sc1 nt lds
    buffer_load_dwordx4 v4, s[40:43], s60 offen offset:1024 sc1 nt lds
    buffer_load_dwordx4 v4, s[40:43], s60 offen offset:2048 sc1 nt lds
    buffer_load_dwordx4 v4, s[40:43], s60 offen offset:3072 sc1 nt lds
L_nocol_8:
    buffer_load_dwordx4 v[112:115], v4, s[40:43], s62 offen offset:0 sc1 nt
    buffer_load_dwordx4 v[116:119], v4, s[40:43], s62 offen offset:1024 sc1 nt
    buffer_load_dwordx2 v[126:127], v54, s[40:43], s62 offen offset:2048 sc1 nt
    s_cmp_ge_u32 s3, 2
    s_cbranch_scc1 L_auxw_9
    s_waitcnt vmcnt(8)
L_auxw_9:
    s_barrier
    v_bfe_u32 v84, v1, 2, 2
    v_and_b32 v85, 3, v1
    v_lshl_add_u32 v86, v3, 2, v84
    v_lshlrev_b32 v86, 7, v86
    v_lshl_add_u32 v86, v85, 4, v86
    s_lshr_b32 s50, s3, 1
    s_lshl_b32 s50, s50, 6
    s_and_b32 s51, s3, 1
    s_lshl_b32 s51, s51, 3
    s_add_u32 s50, s50, s51
    s_add_u32 s50, s50, 157696
    v_add_u32 v86, s50, v86
    ds_read_b64_tr_b16 a[200:201], v86
    ds_read_b64_tr_b16 a[202:203], v86 offset:2048
    v_lshlrev_b32 v87, 11, v3
    v_lshl_add_u32 v87, v84, 7, v87
    v_lshl_add_u32 v87, v85, 3, v87
    s_lshl_b32 s50, s3, 5
    s_add_u32 s50, s50, 149504
    v_add_u32 v87, s50, v87
    ds_read_b64_tr_b16 a[192:193], v87 offset:0
    ds_read_b64_tr_b16 a[194:195], v87 offset:512
    ds_read_b64_tr_b16 a[196:197], v87 offset:1024
    ds_read_b64_tr_b16 a[198:199], v87 offset:1536
    s_and_b32 s50, s2, 7
    s_lshl_b32 s50, s50, 17
    s_lshr_b32 s51, s2, 6
    s_mul_i32 s51, s51, 28672
    s_add_u32 s50, s50, s51
    s_lshl_b32 s51, s3, 10
    s_add_u32 s50, s50, s51
    s_add_u32 s50, s50, 11534336
    s_bfe_u32 s51, s2, 0x10005
    s_lshl_b32 s96, s51, 3
    s_add_u32 s96, s96, s50
    s_add_u32 s96, s96, 24576
    s_mul_i32 s51, s51, 3
    s_bfe_u32 s52, s2, 0x20003
    s_add_u32 s51, s51, s52
    s_lshl_b32 s51, s51, 12
    s_add_u32 s66, s50, s51
    s_cmp_eq_u32 s52, 3
    s_cselect_b32 s66, 0x20000000, s66
    s_cselect_b32 s96, s96, 0x20000000
    s_lshr_b32 s50, s2, 3
    s_lshl_b32 s50, s50, 16
    s_add_u32 s50, s50, s48
    s_and_b32 s51, s2, 7
    s_lshl_b32 s51, s51, 11
    s_add_u32 s50, s50, s51
    s_add_u32 s50, s50, 9437184
    s_cmp_ge_u32 s2, 224
    s_cselect_b32 s68, 0x20000000, s50
    s_add_u32 m0, s98, 66560
    s_add_u32 s99, s58, 0
    buffer_load_dwordx4 v4, s[8:11], s99 offen nt lds
    s_add_u32 m0, s98, 67600
    s_add_u32 s99, s58, 1024
    buffer_load_dwordx4 v4, s[8:11], s99 offen nt lds
    s_add_u32 m0, s98, 68640
    s_add_u32 s99, s58, 2048
    buffer_load_dwordx4 v4, s[8:11], s99 offen nt lds
    s_add_u32 m0, s98, 69680
    s_add_u32 s99, s58, 3072
    buffer_load_dwordx4 v4, s[8:11], s99 offen nt lds
    s_add_u32 m0, s98, 70720
    s_add_u32 s99, s58, 8192
    buffer_load_dwordx4 v4, s[8:11], s99 offen nt lds
    s_add_u32 m0, s98, 71760
    s_add_u32 s99, s58, 9216
    buffer_load_dwordx4 v4, s[8:11], s99 offen nt lds
    s_add_u32 m0, s98, 72800
    s_add_u32 s99, s58, 10240
    buffer_load_dwordx4 v4, s[8:11], s99 offen nt lds
    s_add_u32 m0, s98, 73840
    s_add_u32 s99, s58, 11264
    buffer_load_dwordx4 v4, s[8:11], s99 offen nt lds
    s_cmp_lt_u32 s3, 2
    s_cbranch_scc1 L_nocolw_10
    s_waitcnt vmcnt(11)
L_nocolw_10:
    s_waitcnt lgkmcnt(0)
    s_barrier
L_wtry_11:
    ds_read_b128 v[16:19], v57 offset:0
    ds_read_b128 v[20:23], v57 offset:1024
    ds_read_b128 v[24:27], v57 offset:2048
    ds_read_b128 v[28:31], v57 offset:3072
    ds_read_b128 v[32:35], v57 offset:4096
    ds_read_b128 v[36:39], v57 offset:5120
    ds_read_b128 v[40:43], v57 offset:6144
    ds_read_b128 v[44:47], v57 offset:7168
    s_waitcnt lgkmcnt(7)
    v_xor_b32 v16, s4, v16
    v_xor_b32 v17, s5, v17
    v_xor_b32 v18, s6, v18
    v_xor_b32 v19, s7, v19
    s_waitcnt lgkmcnt(3)
    v_xor_b32 v32, s4, v32
    v_xor_b32 v33, s5, v33
    v_mfma_f32_16x16x32_f16 v[64:67], v[16:19], v[128:131], 0
    v_xor_b32 v34, s6, v34
    v_xor_b32 v35, s7, v35
    v_mfma_f32_16x16x32_f16 v[68:71], v[16:19], v[132:135], 0
    v_xor_b32 v20, s4, v20
    v_xor_b32 v21, s5, v21
    v_mfma_f32_16x16x32_f16 v[72:75], v[32:35], v[128:131], 0
    v_xor_b32 v22, s6, v22
    v_xor_b32 v23, s7, v23
    v_mfma_f32_16x16x32_f16 v[76:79], v[32:35], v[132:135], 0
    s_waitcnt lgkmcnt(2)
    v_xor_b32 v36, s4, v36
    v_xor_b32 v37, s5, v37
    v_mfma_f32_16x16x32_f16 v[64:67], v[20:23], v[136:139], v[64:67]
    v_xor_b32 v38, s6, v38
    v_xor_b32 v39, s7, v39
    v_mfma_f32_16x16x32_f16 v[68:71], v[20:23], v[140:143], v[68:71]
    v_or3_b32 v120, v120, v16, v17
    v_or3_b32 v120, v120, v18, v19
    v_mfma_f32_16x16x32_f16 v[72:75], v[36:39], v[136:139], v[72:75]
    v_xor_b32 v24, s4, v24
    v_xor_b32 v25, s5, v25
    v_mfma_f32_16x16x32_f16 v[76:79], v[36:39], v[140:143], v[76:79]
    v_xor_b32 v26, s6, v26
    v_xor_b32 v27, s7, v27
    s_waitcnt lgkmcnt(1)
    v_xor_b32 v40, s4, v40
    v_xor_b32 v41, s5, v41
    v_mfma_f32_16x16x32_f16 v[64:67], v[24:27], v[144:147], v[64:67]
    v_xor_b32 v42, s6, v42
    v_xor_b32 v43, s7, v43
    v_mfma_f32_16x16x32_f16 v[68:71], v[24:27], v[148:151], v[68:71]
    v_or3_b32 v120, v120, v20, v21
    v_or3_b32 v120, v120, v22, v23
    v_mfma_f32_16x16x32_f16 v[72:75], v[40:43], v[144:147], v[72:75]
    v_or3_b32 v120, v120, v24, v25
    v_xor_b32 v28, s4, v28
    v_mfma_f32_16x16x32_f16 v[76:79], v[40:43], v[148:151], v[76:79]
    v_xor_b32 v29, s5, v29
    v_or3_b32 v120, v120, v26, v27
    v_xor_b32 v30, s6, v30
    v_xor_b32 v31, s7, v31
    v_or3_b32 v120, v120, v28, v29
    v_or3_b32 v120, v120, v30, v31
    v_mfma_f32_16x16x32_f16 v[64:67], v[28:31], v[152:155], v[64:67]
    v_or3_b32 v120, v120, v32, v33
    v_or3_b32 v120, v120, v34, v35
    v_mfma_f32_16x16x32_f16 v[68:71], v[28:31], v[156:159], v[68:71]
    s_waitcnt lgkmcnt(0)
    v_xor_b32 v44, s4, v44
    v_xor_b32 v45, s5, v45
    v_xor_b32 v46, s6, v46
    v_xor_b32 v47, s7, v47
    v_or3_b32 v120, v120, v36, v37
    v_or3_b32 v120, v120, v38, v39
    v_mfma_f32_16x16x32_f16 v[72:75], v[44:47], v[152:155], v[72:75]
    v_or3_b32 v120, v120, v40, v41
    v_or3_b32 v120, v120, v42, v43
    v_mfma_f32_16x16x32_f16 v[76:79], v[44:47], v[156:159], v[76:79]
    v_or3_b32 v120, v120, v44, v45
    v_or3_b32 v120, v120, v46, v47
    v_and_b32 v120, 0x30003, v120
    v_cmp_ne_u32 vcc, 0, v120
    s_nop 1
    s_cmp_lg_u64 vcc, 0
    s_cbranch_scc1 L_x1fail_6
L_x1ok_7:
    s_waitcnt vmcnt(8)
    v_cmp_ne_u32 vcc, s44, v127
    s_nop 1
    s_cmp_lg_u64 vcc, 0
    s_cbranch_scc1 L_wtag_15
L_wtagok_16:
    buffer_store_dwordx4 a[192:195], v4, s[40:43], s68 offen sc1
    buffer_store_dwordx4 a[196:199], v4, s[40:43], s68 offen offset:1024 sc1
    buffer_store_dwordx4 a[200:203], v4, s[40:43], s66 offen sc1
    buffer_store_dwordx2 a[200:201], v4, s[40:43], s96 offen sc1
    v_pk_mul_f32 v[122:123], v[68:69], v[228:229]
    v_pk_mul_f32 v[124:125], v[70:71], v[230:231]
    v_pk_mul_f32 v[68:69], v[68:69], v[224:225]
    v_pk_mul_f32 v[70:71], v[70:71], v[226:227]
    v_pk_fma_f32 v[68:69], v[64:65], v[228:229], v[68:69]
    v_pk_fma_f32 v[70:71], v[66:67], v[230:231], v[70:71]
    v_pk_fma_f32 v[64:65], v[64:65], v[224:225], v[122:123] neg_lo:[0,0,1] neg_hi:[0,0,1]
    v_pk_fma_f32 v[66:67], v[66:67], v[226:227], v[124:125] neg_lo:[0,0,1] neg_hi:[0,0,1]
    v_cvt_pk_bf16_f32 v80, v64, v68
    v_cvt_pk_bf16_f32 v81, v65, v69
    v_cvt_pk_bf16_f32 v82, v66, v70
    v_cvt_pk_bf16_f32 v83, v67, v71
    v_pk_mul_f32 v[122:123], v[76:77], v[236:237]
    v_pk_mul_f32 v[124:125], v[78:79], v[238:239]
    v_mfma_f32_16x16x32_bf16 v[92:95], v[196:199], v[80:83], 0
    v_cmp_gt_u32 s[52:53], 8, v1
    v_sub_u32 v62, 0, v126
    s_add_u32 m0, s98, 74880
    s_add_u32 s99, s58, 16384
    buffer_load_dwordx4 v4, s[8:11], s99 offen nt lds
    v_mfma_f32_16x16x32_bf16 v[88:91], v[192:195], v[80:83], 0
    v_cndmask_b32 v62, 0, v62, s[52:53]
    v_add3_u32 v62, v112, v113, v62
    v_mfma_f32_16x16x32_bf16 v[100:103], v[212:215], v[80:83], 0
    v_add3_u32 v62, v114, v115, v62
    v_lshlrev_b32 v104, 16, v112
    v_mfma_f32_16x16x32_bf16 v[96:99], v[208:211], v[80:83], 0
    v_lshlrev_b32 v105, 16, v113
    v_lshlrev_b32 v106, 16, v114
    v_pk_mul_f32 v[76:77], v[76:77], v[232:233]
    v_pk_mul_f32 v[78:79], v[78:79], v[234:235]
    v_pk_fma_f32 v[76:77], v[72:73], v[236:237], v[76:77]
    v_pk_fma_f32 v[78:79], v[74:75], v[238:239], v[78:79]
    v_pk_fma_f32 v[72:73], v[72:73], v[232:233], v[122:123] neg_lo:[0,0,1] neg_hi:[0,0,1]
    v_pk_fma_f32 v[74:75], v[74:75], v[234:235], v[124:125] neg_lo:[0,0,1] neg_hi:[0,0,1]
    v_cvt_pk_bf16_f32 v84, v72, v76
    v_cvt_pk_bf16_f32 v85, v73, v77
    v_cvt_pk_bf16_f32 v86, v74, v78
    s_add_u32 m0, s98, 75920
    s_add_u32 s99, s58, 17408
    buffer_load_dwordx4 v4, s[8:11], s99 offen nt lds
    v_cvt_pk_bf16_f32 v87, v75, v79
    v_lshlrev_b32 v107, 16, v115
    v_and_b32 v112, 0xffff0000, v112
    v_mfma_f32_16x16x32_bf16 v[92:95], v[204:207], v[84:87], v[92:95]
    v_and_b32 v113, 0xffff0000, v113
    v_and_b32 v114, 0xffff0000, v114
    v_mfma_f32_16x16x32_bf16 v[88:91], v[200:203], v[84:87], v[88:91]
    v_and_b32 v115, 0xffff0000, v115
    v_add3_u32 v62, v116, v117, v62
    v_mfma_f32_16x16x32_bf16 v[100:103], v[220:223], v[84:87], v[100:103]
    v_add3_u32 v62, v118, v119, v62
    v_lshlrev_b32 v108, 16, v116
    v_mfma_f32_16x16x32_bf16 v[96:99], v[216:219], v[84:87], v[96:99]
    v_lshlrev_b32 v109, 16, v117
    v_lshlrev_b32 v110, 16, v118
    v_pk_mul_f32 v[122:123], v[92:93], v[112:113]
    v_pk_mul_f32 v[124:125], v[94:95], v[114:115]
    v_pk_mul_f32 v[92:93], v[92:93], v[104:105]
    s_add_u32 m0, s98, 76960
    s_add_u32 s99, s58, 18432
    buffer_load_dwordx4 v4, s[8:11], s99 offen nt lds
    v_pk_mul_f32 v[94:95], v[94:95], v[106:107]
    v_pk_fma_f32 v[92:93], v[88:89], v[112:113], v[92:93]
    v_pk_fma_f32 v[94:95], v[90:91], v[114:115], v[94:95]
    v_pk_fma_f32 v[88:89], v[88:89], v[104:105], v[122:123] neg_lo:[0,0,1] neg_hi:[0,0,1]
    v_pk_fma_f32 v[90:91], v[90:91], v[106:107], v[124:125] neg_lo:[0,0,1] neg_hi:[0,0,1]
    v_cvt_pk_bf16_f32 v80, v92, v88
    v_cvt_pk_bf16_f32 v81, v93, v89
    v_cvt_pk_bf16_f32 v82, v94, v90
    v_cvt_pk_bf16_f32 v83, v95, v91
    v_lshlrev_b32 v111, 16, v119
    v_and_b32 v116, 0xffff0000, v116
    v_mfma_f32_16x16x32_bf16 v[68:71], v[80:83], v[196:199], 0
    v_and_b32 v117, 0xffff0000, v117
    v_and_b32 v118, 0xffff0000, v118
    v_mfma_f32_16x16x32_bf16 v[64:67], v[80:83], v[192:195], 0
    v_and_b32 v119, 0xffff0000, v119
    v_add_u32_dpp v62, v62, v62 row_ror:8 row_mask:0xf bank_mask:0xf
    v_mfma_f32_16x16x32_bf16 v[76:79], v[80:83], v[212:215], 0
    s_add_u32 m0, s98, 78000
    s_add_u32 s99, s58, 19456
    buffer_load_dwordx4 v4, s[8:11], s99 offen nt lds
    v_add_u32_dpp v62, v62, v62 row_ror:4 row_mask:0xf bank_mask:0xf
    v_mfma_f32_16x16x32_bf16 v[72:75], v[80:83], v[208:211], 0
    s_nop 0
    v_add_u32_dpp v62, v62, v62 row_ror:2 row_mask:0xf bank_mask:0xf
    v_pk_mul_f32 v[122:123], v[100:101], v[116:117]
    v_pk_mul_f32 v[124:125], v[102:103], v[118:119]
    v_pk_mul_f32 v[100:101], v[100:101], v[108:109]
    v_pk_mul_f32 v[102:103], v[102:103], v[110:111]
    v_pk_fma_f32 v[100:101], v[96:97], v[116:117], v[100:101]
    v_pk_fma_f32 v[102:103], v[98:99], v[118:119], v[102:103]
    v_pk_fma_f32 v[96:97], v[96:97], v[108:109], v[122:123] neg_lo:[0,0,1] neg_hi:[0,0,1]
    v_pk_fma_f32 v[98:99], v[98:99], v[110:111], v[124:125] neg_lo:[0,0,1] neg_hi:[0,0,1]
    v_cvt_pk_bf16_f32 v84, v100, v96
    v_cvt_pk_bf16_f32 v85, v101, v97
    v_cvt_pk_bf16_f32 v86, v102, v98
    v_cvt_pk_bf16_f32 v87, v103, v99
    v_add_u32_dpp v62, v62, v62 row_ror:1 row_mask:0xf bank_mask:0xf
    s_nop 0
    v_mfma_f32_16x16x32_bf16 v[68:71], v[84:87], v[204:207], v[68:71]
    v_readlane_b32 s54, v62, 0
    s_add_u32 m0, s98, 79040
    s_add_u32 s99, s58, 24576
    buffer_load_dwordx4 v4, s[8:11], s99 offen nt lds
    v_readlane_b32 s55, v62, 16
    v_mfma_f32_16x16x32_bf16 v[64:67], v[84:87], v[200:203], v[64:67]
    v_readlane_b32 s56, v62, 32
    v_readlane_b32 s57, v62, 48
    v_mfma_f32_16x16x32_bf16 v[76:79], v[84:87], v[220:223], v[76:79]
    s_add_u32 s54, s54, s55
    s_add_u32 s56, s56, s57
    s_add_u32 s54, s54, s56
    v_mfma_f32_16x16x32_bf16 v[72:75], v[84:87], v[216:219], v[72:75]
    v_pk_mul_f32 v[122:123], v[68:69], v[244:245]
    v_pk_mul_f32 v[124:125], v[70:71], v[246:247]
    v_pk_mul_f32 v[68:69], v[68:69], v[240:241]
    v_pk_mul_f32 v[70:71], v[70:71], v[242:243]
    v_pk_fma_f32 v[68:69], v[64:65], v[244:245], v[68:69]
    v_pk_fma_f32 v[70:71], v[66:67], v[246:247], v[70:71]
    v_pk_fma_f32 v[64:65], v[64:65], v[240:241], v[122:123] neg_lo:[0,0,1] neg_hi:[0,0,1]
    v_pk_fma_f32 v[66:67], v[66:67], v[242:243], v[124:125] neg_lo:[0,0,1] neg_hi:[0,0,1]
    v_pk_mul_f32 v[122:123], v[76:77], v[252:253]
    s_add_u32 m0, s98, 80080
    s_add_u32 s99, s58, 25600
    buffer_load_dwordx4 v4, s[8:11], s99 offen nt lds
    v_pk_mul_f32 v[124:125], v[78:79], v[254:255]
    v_pk_mul_f32 v[76:77], v[76:77], v[248:249]
    v_pk_mul_f32 v[78:79], v[78:79], v[250:251]
    v_pk_fma_f32 v[76:77], v[72:73], v[252:253], v[76:77]
    v_pk_fma_f32 v[78:79], v[74:75], v[254:255], v[78:79]
    v_pk_fma_f32 v[72:73], v[72:73], v[248:249], v[122:123] neg_lo:[0,0,1] neg_hi:[0,0,1]
    v_pk_fma_f32 v[74:75], v[74:75], v[250:251], v[124:125] neg_lo:[0,0,1] neg_hi:[0,0,1]
    v_cvt_pk_bf16_f32 v88, v64, v68
    v_cvt_pk_bf16_f32 v89, v65, v69
    v_cvt_pk_bf16_f32 v90, v66, v70
    v_cvt_pk_bf16_f32 v91, v67, v71
    v_cvt_pk_bf16_f32 v92, v72, v76
    v_cvt_pk_bf16_f32 v93, v73, v77
    v_cvt_pk_bf16_f32 v94, v74, v78
    v_cvt_pk_bf16_f32 v95, v75, v79
    ds_write_b128 v59, v[88:91] offset:0
    ds_write_b128 v60, v[92:95] offset:1024
    s_cmp_lg_u32 s54, 0
    s_cbranch_scc1 L_wfail_12
L_wok_13:
    s_add_u32 m0, s98, 81120
    s_add_u32 s99, s58, 26624
    buffer_load_dwordx4 v4, s[8:11], s99 offen nt lds
    s_waitcnt lgkmcnt(0)
    s_barrier
    ds_read_b128 v[16:19], v58 offset:0
    ds_read_b128 v[32:35], v55 offset:0
    ds_read_b128 v[20:23], v58 offset:2048
    ds_read_b128 v[36:39], v55 offset:2048
    ds_read_b128 v[24:27], v58 offset:4096
    ds_read_b128 v[40:43], v55 offset:4096
    ds_read_b128 v[28:31], v58 offset:6144
    ds_read_b128 v[44:47], v55 offset:6144
    s_waitcnt lgkmcnt(7)
    v_mfma_f32_16x16x32_bf16 v[68:71], v[16:19], v[164:167], 0
    s_waitcnt lgkmcnt(6)
    v_mfma_f32_16x16x32_bf16 v[76:79], v[32:35], v[164:167], 0
    v_mfma_f32_16x16x32_bf16 v[64:67], v[16:19], v[160:163], 0
    v_mfma_f32_16x16x32_bf16 v[72:75], v[32:35], v[160:163], 0
    s_waitcnt lgkmcnt(5)
    v_mfma_f32_16x16x32_bf16 v[68:71], v[20:23], v[172:175], v[68:71]
    s_waitcnt lgkmcnt(4)
    v_mfma_f32_16x16x32_bf16 v[76:79], v[36:39], v[172:175], v[76:79]
    v_mfma_f32_16x16x32_bf16 v[64:67], v[20:23], v[168:171], v[64:67]
    v_mfma_f32_16x16x32_bf16 v[72:75], v[36:39], v[168:171], v[72:75]
    s_add_u32 m0, s98, 82160
    s_add_u32 s99, s58, 27648
    buffer_load_dwordx4 v4, s[8:11], s99 offen nt lds
    s_waitcnt lgkmcnt(3)
    v_mfma_f32_16x16x32_bf16 v[68:71], v[24:27], v[180:183], v[68:71]
    s_waitcnt lgkmcnt(2)
    v_mfma_f32_16x16x32_bf16 v[76:79], v[40:43], v[180:183], v[76:79]
    v_mfma_f32_16x16x32_bf16 v[64:67], v[24:27], v[176:179], v[64:67]
    v_mfma_f32_16x16x32_bf16 v[72:75], v[40:43], v[176:179], v[72:75]
    s_waitcnt lgkmcnt(1)
    v_mfma_f32_16x16x32_bf16 v[68:71], v[28:31], v[188:191], v[68:71]
    s_waitcnt lgkmcnt(0)
    v_mfma_f32_16x16x32_bf16 v[76:79], v[44:47], v[188:191], v[76:79]
    v_mfma_f32_16x16x32_bf16 v[64:67], v[28:31], v[184:187], v[64:67]
    v_mfma_f32_16x16x32_bf16 v[72:75], v[44:47], v[184:187], v[72:75]
    s_nop 3
    v_cvt_pk_bf16_f32 v80, v68, v69
    v_cvt_pk_bf16_f32 v81, v70, v71
    v_cvt_pk_bf16_f32 v82, v76, v77
    v_cvt_pk_bf16_f32 v83, v78, v79
    buffer_store_dwordx4 v[80:83], v61, s[40:43], s63 offen offset:0 sc1
    v_cvt_pk_bf16_f32 v84, v64, v65
    v_cvt_pk_bf16_f32 v85, v66, v67
    v_cvt_pk_bf16_f32 v86, v72, v73
    v_cvt_pk_bf16_f32 v87, v74, v75
    buffer_store_dwordx4 v[84:87], v61, s[40:43], s63 offen offset:128 sc1
    v_add3_u32 v50, v80, v81, v82
    v_add_u32 v50, v50, v83
    v_add3_u32 v50, v84, v85, v50
    v_add3_u32 v50, v86, v87, v50
    s_nop 1
    v_add_u32_dpp v50, v50, v50 quad_perm:[1,0,3,2] row_mask:0xf bank_mask:0xf
    v_mov_b32 v52, v50
    s_nop 1
    v_permlane16_swap_b32 v50, v52
    v_add_u32 v50, v50, v52
    v_mov_b32 v52, v50
    s_nop 1
    v_permlane32_swap_b32 v50, v52
    v_add_u32 v50, v50, v52
    s_mov_b64 exec, 0x5555
    buffer_store_dwordx2 v[50:51], v48, s[40:43], s64 offen sc1
    s_mov_b64 exec, -1
    v_lshrrev_b32 v121, 2, v1
    s_add_u32 s99, s69, 0
    v_lshlrev_b32 v121, 7, v121
    buffer_load_dword v121, v121, s[24:27], s99 offen
    s_lshl_b32 s50, s45, 7
    v_lshlrev_b32 v84, 1, v5
    buffer_load_short_d16_hi v12, v84, s[28:31], s50 offen offset:0
    buffer_load_short_d16_hi v13, v84, s[28:31], s50 offen offset:8
    buffer_load_short_d16_hi v14, v84, s[28:31], s50 offen offset:64
    buffer_load_short_d16_hi v15, v84, s[28:31], s50 offen offset:72
    s_mul_i32 s50, s46, 7
    s_add_u32 s60, s50, s3
    s_add_u32 s60, s60, 56
    s_add_u32 s61, s60, 4
    s_add_u32 s51, s50, 6
    s_cmp_eq_u32 s3, 3
    s_cselect_b32 s61, s51, s61
    s_lshl_b32 s51, s3, 1
    s_add_u32 s62, s50, s51
    v_mov_b32 v117, s60
    v_mov_b32 v118, s61
    v_cmp_gt_u32 vcc, 8, v1
    s_nop 1
    v_cndmask_b32 v117, v118, v117, vcc
    v_bfe_u32 v118, v1, 3, 1
    v_add_u32 v118, s62, v118
    v_cmp_gt_u32 vcc, 16, v1
    s_nop 1
    v_cndmask_b32 v117, v118, v117, vcc
    v_lshrrev_b32 v117, 2, v117
    v_and_b32 v118, 7, v1
    v_lshl_add_u32 v117, v117, 3, v118
    v_and_b32 v118, 31, v1
    v_lshl_add_u32 v118, v118, 3, s46
    v_cmp_gt_u32 vcc, 32, v1
    s_nop 1
    v_cndmask_b32 v117, v118, v117, vcc
    v_lshlrev_b32 v117, 4, v117
    v_add_u32 v117, 4096, v117
    s_lshl_b32 s60, s60, 14
    s_add_u32 s60, s60, 9437184
    s_lshl_b32 s61, s61, 14
    s_add_u32 s61, s61, 9437184
    s_lshl_b32 s62, s62, 14
    s_add_u32 s62, s62, 9437184
    s_cmp_eq_u32 s3, 3
    s_cselect_b32 s62, 0x20000000, s62
    s_add_u32 s63, s62, 16384
    s_add_u32 s16, s45, 0
    s_and_b32 s16, s16, 3
    s_lshl_b32 s16, s16, 12
    s_add_u32 s17, s45, 1
    s_and_b32 s17, s17, 3
    s_lshl_b32 s17, s17, 12
    s_add_u32 s96, s45, 2
    s_and_b32 s96, s96, 3
    s_lshl_b32 s96, s96, 12
    s_add_u32 s95, s45, 3
    s_and_b32 s95, s95, 3
    s_lshl_b32 s95, s95, 12
    v_add_u32 v84, 65536, v4
    global_load_dwordx4 v[112:115], v84, s[100:101]
    s_add_u32 s50, s46, 0
    s_and_b32 s50, s50, 3
    s_lshl_b32 s51, s50, 6
    v_xor_b32 v88, s51, v4
    s_lshl_b32 s50, s50, 12
    s_add_u32 s52, s50, s48
    s_add_u32 s50, s52, 66560
    v_add_u32 v97, s50, v4
    s_add_u32 s50, s46, 1
    s_and_b32 s50, s50, 3
    s_lshl_b32 s51, s50, 6
    v_xor_b32 v89, s51, v4
    s_lshl_b32 s50, s50, 12
    s_add_u32 s53, s50, s48
    s_add_u32 s50, s53, 66560
    v_add_u32 v98, s50, v4
    s_add_u32 s50, s46, 2
    s_and_b32 s50, s50, 3
    s_lshl_b32 s51, s50, 6
    v_xor_b32 v90, s51, v4
    s_lshl_b32 s50, s50, 12
    s_add_u32 s54, s50, s48
    s_add_u32 s50, s54, 66560
    v_add_u32 v99, s50, v4
    s_add_u32 s50, s46, 3
    s_and_b32 s50, s50, 3
    s_lshl_b32 s51, s50, 6
    v_xor_b32 v91, s51, v4
    s_lshl_b32 s50, s50, 12
    s_add_u32 s55, s50, s48
    s_add_u32 s50, s55, 66560
    v_add_u32 v100, s50, v4
    s_lshl_b32 s64, s45, 16
    s_add_u32 s64, s64, 7340032
    s_lshl_b32 s65, s45, 11
    s_lshl_b32 s50, s3, 9
    s_add_u32 s65, s65, s50
    s_add_u32 s65, s65, 13107200
    v_lshlrev_b32 v92, 3, v1
    v_bfe_u32 v84, v1, 2, 2
    s_lshr_b32 s50, s3, 1
    v_xor_b32 v85, s50, v84
    v_lshlrev_b32 v85, 6, v85
    v_lshrrev_b32 v86, 2, v1
    v_lshl_add_u32 v85, v86, 12, v85
    v_and_b32 v86, 3, v1
    v_lshl_add_u32 v85, v86, 4, v85
    v_xor_b32 v86, s3, v3
    v_and_b32 v86, 1, v86
    v_lshl_add_u32 v85, v86, 3, v85
    v_add_u32 v85, 66560, v85
    v_xor_b32 v86, 128, v85
    s_sub_u32 s51, 0, s45
    s_and_b32 s51, s51, 3
    s_lshl_b32 s51, s51, 12
    s_add_u32 s51, s51, s48
    s_add_u32 s51, s51, 66560
    v_add_u32 v116, s51, v4
    s_sub_u32 s51, 1, s45
    s_and_b32 s51, s51, 3
    s_lshl_b32 s51, s51, 12
    s_add_u32 s51, s51, s48
    s_add_u32 s51, s51, 66560
    v_add_u32 v87, s51, v4
    s_sub_u32 s51, 2, s45
    s_and_b32 s51, s51, 3
    s_lshl_b32 s51, s51, 12
    s_add_u32 s51, s51, s48
    s_add_u32 s51, s51, 66560
    v_add_u32 v84, s51, v4
    s_sub_u32 s51, 3, s45
    s_and_b32 s51, s51, 3
    s_lshl_b32 s51, s51, 12
    s_add_u32 s51, s51, s48
    s_add_u32 s51, s51, 66560
    v_add_u32 v119, s51, v4
    s_waitcnt vmcnt(17)
    s_barrier
    s_lshl_b32 s50, s2, 4
    s_add_u32 s50, s50, 4096
    s_cmp_eq_u32 s3, 0
    s_cselect_b32 s50, s50, 0x20000000
    v_mov_b32 v6, s44
    v_mov_b32 v63, 0
    s_mov_b64 exec, 1
    buffer_store_dword v6, v63, s[40:43], s50 offen sc1
    s_mov_b64 exec, -1
    s_waitcnt vmcnt(10)
    s_add_u32 s50, s98, 66560
    v_mul_u32_u24 v101, 1040, v2
    v_lshl_add_u32 v101, v3, 8, v101
    v_add_u32 v101, s50, v101
    ds_read_b128 v[16:19], v101 offset:0
    ds_read_b128 v[32:35], v101 offset:64
    ds_read_b128 v[20:23], v101 offset:16
    ds_read_b128 v[36:39], v101 offset:80
    ds_read_b128 v[24:27], v101 offset:32
    ds_read_b128 v[40:43], v101 offset:96
    ds_read_b128 v[28:31], v101 offset:48
    ds_read_b128 v[44:47], v101 offset:112
    ds_read_b128 v[48:51], v101 offset:128
    ds_read_b128 v[64:67], v101 offset:192
    ds_read_b128 v[52:55], v101 offset:144
    ds_read_b128 v[68:71], v101 offset:208
    ds_read_b128 v[56:59], v101 offset:160
    ds_read_b128 v[72:75], v101 offset:224
    ds_read_b128 v[60:63], v101 offset:176
    ds_read_b128 v[76:79], v101 offset:240
    s_waitcnt lgkmcnt(0)
    s_add_u32 s97, s3, 0
    s_and_b32 s97, s97, 3
    s_lshl_b32 s59, s97, 10
    s_lshl_b32 s58, s45, 6
    s_add_u32 s58, s58, 0
    s_lshl_b32 s58, s58, 12
    s_add_u32 s58, s58, s59
    v_mov_b32 v104, 0xbb00bb00
    v_mov_b32 v105, v104
    v_mov_b32 v106, v104
    v_mov_b32 v107, v104
    s_add_u32 m0, s98, 66560
    v_xor_b32 v108, 0, v4
    s_add_u32 s99, s58, 0
    buffer_load_dwordx4 v108, s[24:27], s99 offen nt lds
    s_mov_b32 s50, 0x05040100
    s_mov_b32 s51, 0x07060302
    v_mfma_f32_16x16x32_bf16 v[8:11], v[104:107], v[16:19], 0
    v_perm_b32 v130, v32, v16, s50
    v_perm_b32 v134, v32, v16, s51
    s_add_u32 m0, s98, 67584
    v_xor_b32 v108, 16, v4
    s_add_u32 s99, s58, 4096
    buffer_load_dwordx4 v108, s[24:27], s99 offen nt lds
    v_perm_b32 v138, v33, v17, s50
    v_perm_b32 v142, v33, v17, s51
    v_mfma_f32_16x16x32_bf16 v[8:11], v[104:107], v[32:35], v[8:11]
    v_perm_b32 v146, v34, v18, s50
    v_perm_b32 v150, v34, v18, s51
    s_add_u32 m0, s98, 68608
    v_xor_b32 v108, 32, v4
    s_add_u32 s99, s58, 8192
    buffer_load_dwordx4 v108, s[24:27], s99 offen nt lds
    v_perm_b32 v154, v35, v19, s50
    v_perm_b32 v158, v35, v19, s51
    v_mfma_f32_16x16x32_bf16 v[8:11], v[104:107], v[20:23], v[8:11]
    v_perm_b32 v162, v36, v20, s50
    v_perm_b32 v166, v36, v20, s51
    s_add_u32 m0, s98, 69632
    v_xor_b32 v108, 48, v4
    s_add_u32 s99, s58, 12288
    buffer_load_dwordx4 v108, s[24:27], s99 offen nt lds
    v_perm_b32 v170, v37, v21, s50
    v_perm_b32 v174, v37, v21, s51
    v_mfma_f32_16x16x32_bf16 v[8:11], v[104:107], v[36:39], v[8:11]
    v_perm_b32 v178, v38, v22, s50
    v_perm_b32 v182, v38, v22, s51
    s_add_u32 m0, s98, 70656
    v_xor_b32 v108, 64, v4
    s_add_u32 s99, s58, 32768
    buffer_load_dwordx4 v108, s[24:27], s99 offen nt lds
    v_perm_b32 v186, v39, v23, s50
    v_perm_b32 v190, v39, v23, s51
    v_mfma_f32_16x16x32_bf16 v[8:11], v[104:107], v[24:27], v[8:11]
    v_perm_b32 v194, v40, v24, s50
    v_perm_b32 v198, v40, v24, s51
    s_add_u32 m0, s98, 71680
    v_xor_b32 v108, 80, v4
    s_add_u32 s99, s58, 36864
    buffer_load_dwordx4 v108, s[24:27], s99 offen nt lds
    v_perm_b32 v202, v41, v25, s50
    v_perm_b32 v206, v41, v25, s51
    v_mfma_f32_16x16x32_bf16 v[8:11], v[104:107], v[40:43], v[8:11]
    v_perm_b32 v210, v42, v26, s50
    v_perm_b32 v214, v42, v26, s51
    s_add_u32 m0, s98, 72704
    v_xor_b32 v108, 96, v4
    s_add_u32 s99, s58, 40960
    buffer_load_dwordx4 v108, s[24:27], s99 offen nt lds
    v_perm_b32 v218, v43, v27, s50
    v_perm_b32 v222, v43, v27, s51
    v_mfma_f32_16x16x32_bf16 v[8:11], v[104:107], v[28:31], v[8:11]
    v_perm_b32 v226, v44, v28, s50
    v_perm_b32 v230, v44, v28, s51
    s_add_u32 m0, s98, 73728
    v_xor_b32 v108, 112, v4
    s_add_u32 s99, s58, 45056
    buffer_load_dwordx4 v108, s[24:27], s99 offen nt lds
    v_perm_b32 v234, v45, v29, s50
    v_perm_b32 v238, v45, v29, s51
    v_mfma_f32_16x16x32_bf16 v[8:11], v[104:107], v[44:47], v[8:11]
    v_perm_b32 v242, v46, v30, s50
    v_perm_b32 v246, v46, v30, s51
    s_add_u32 m0, s98, 74752
    v_xor_b32 v108, 128, v4
    s_add_u32 s99, s58, 65536
    buffer_load_dwordx4 v108, s[24:27], s99 offen nt lds
    v_perm_b32 v250, v47, v31, s50
    v_perm_b32 v254, v47, v31, s51
    v_mfma_f32_16x16x32_bf16 v[8:11], v[104:107], v[48:51], v[8:11]
    v_perm_b32 v131, v64, v48, s50
    v_perm_b32 v135, v64, v48, s51
    s_add_u32 m0, s98, 75776
    v_xor_b32 v108, 144, v4
    s_add_u32 s99, s58, 69632
    buffer_load_dwordx4 v108, s[24:27], s99 offen nt lds
    v_perm_b32 v139, v65, v49, s50
    v_perm_b32 v143, v65, v49, s51
    v_mfma_f32_16x16x32_bf16 v[8:11], v[104:107], v[64:67], v[8:11]
    v_perm_b32 v147, v66, v50, s50
    v_perm_b32 v151, v66, v50, s51
    s_add_u32 m0, s98, 76800
    v_xor_b32 v108, 160, v4
    s_add_u32 s99, s58, 73728
    buffer_load_dwordx4 v108, s[24:27], s99 offen nt lds
    v_perm_b32 v155, v67, v51, s50
    v_perm_b32 v159, v67, v51, s51
    v_mfma_f32_16x16x32_bf16 v[8:11], v[104:107], v[52:55], v[8:11]
    v_perm_b32 v163, v68, v52, s50
    v_perm_b32 v167, v68, v52, s51
    s_add_u32 m0, s98, 77824
    v_xor_b32 v108, 176, v4
    s_add_u32 s99, s58, 77824
    buffer_load_dwordx4 v108, s[24:27], s99 offen nt lds
    v_perm_b32 v171, v69, v53, s50
    v_perm_b32 v175, v69, v53, s51
    v_mfma_f32_16x16x32_bf16 v[8:11], v[104:107], v[68:71], v[8:11]
    v_perm_b32 v179, v70, v54, s50
    v_perm_b32 v183, v70, v54, s51
    s_add_u32 m0, s98, 78848
    v_xor_b32 v108, 192, v4
    s_add_u32 s99, s58, 98304
    buffer_load_dwordx4 v108, s[24:27], s99 offen nt lds
    v_perm_b32 v187, v71, v55, s50
    v_perm_b32 v191, v71, v55, s51
    v_mfma_f32_16x16x32_bf16 v[8:11], v[104:107], v[56:59], v[8:11]
    v_perm_b32 v195, v72, v56, s50
    v_perm_b32 v199, v72, v56, s51
    s_add_u32 m0, s98, 79872
    v_xor_b32 v108, 208, v4
    s_add_u32 s99, s58, 102400
    buffer_load_dwordx4 v108, s[24:27], s99 offen nt lds
    v_perm_b32 v203, v73, v57, s50
    v_perm_b32 v207, v73, v57, s51
    v_mfma_f32_16x16x32_bf16 v[8:11], v[104:107], v[72:75], v[8:11]
    v_perm_b32 v211, v74, v58, s50
    v_perm_b32 v215, v74, v58, s51
    s_add_u32 m0, s98, 80896
    v_xor_b32 v108, 224, v4
    s_add_u32 s99, s58, 106496
    buffer_load_dwordx4 v108, s[24:27], s99 offen nt lds
    v_perm_b32 v219, v75, v59, s50
    v_perm_b32 v223, v75, v59, s51
    v_mfma_f32_16x16x32_bf16 v[8:11], v[104:107], v[60:63], v[8:11]
    v_perm_b32 v227, v76, v60, s50
    v_perm_b32 v231, v76, v60, s51
    s_add_u32 m0, s98, 81920
    v_xor_b32 v108, 240, v4
    s_add_u32 s99, s58, 110592
    buffer_load_dwordx4 v108, s[24:27], s99 offen nt lds
    v_perm_b32 v235, v77, v61, s50
    v_perm_b32 v239, v77, v61, s51
    v_mfma_f32_16x16x32_bf16 v[8:11], v[104:107], v[76:79], v[8:11]
    v_perm_b32 v243, v78, v62, s50
    v_perm_b32 v247, v78, v62, s51
    s_add_u32 m0, s48, 8192
    v_add_u32 v7, m0, v4
    global_load_lds_dwordx4 v7, s[100:101] offset:0
    v_perm_b32 v251, v79, v63, s50
    v_perm_b32 v255, v79, v63, s51
    global_load_lds_dwordx4 v7, s[100:101] offset:1024
    global_load_lds_dwordx4 v7, s[100:101] offset:2048
    global_load_lds_dwordx4 v7, s[100:101] offset:3072
    s_add_u32 m0, s48, 12288
    v_add_u32 v7, m0, v4
    global_load_lds_dwordx4 v7, s[100:101] offset:0
    global_load_lds_dwordx4 v7, s[100:101] offset:1024
    global_load_lds_dwordx4 v7, s[100:101] offset:2048
    global_load_lds_dwordx4 v7, s[100:101] offset:3072
    s_add_u32 s50, s98, 66560
    v_xor_b32 v104, v3, v2
    v_lshlrev_b32 v104, 4, v104
    v_lshl_add_u32 v104, v2, 10, v104
    v_xor_b32 v105, 64, v104
    v_xor_b32 v106, 128, v104
    v_xor_b32 v107, 192, v104
    v_add_u32 v104, s50, v104
    v_add_u32 v105, s50, v105
    v_add_u32 v106, s50, v106
    v_add_u32 v107, s50, v107
    s_waitcnt vmcnt(8)
    ds_read_b128 a[0:3], v104 offset:0
    ds_read_b128 a[4:7], v105 offset:0
    ds_read_b128 a[8:11], v106 offset:0
    ds_read_b128 a[12:15], v107 offset:0
    ds_read_b128 a[16:19], v104 offset:256
    ds_read_b128 a[20:23], v105 offset:256
    ds_read_b128 a[24:27], v106 offset:256
    ds_read_b128 a[28:31], v107 offset:256
    ds_read_b128 a[32:35], v104 offset:512
    ds_read_b128 a[36:39], v105 offset:512
    ds_read_b128 a[40:43], v106 offset:512
    ds_read_b128 a[44:47], v107 offset:512
    ds_read_b128 a[48:51], v104 offset:768
    ds_read_b128 a[52:55], v105 offset:768
    ds_read_b128 a[56:59], v106 offset:768
    ds_read_b128 a[60:63], v107 offset:768
    s_waitcnt lgkmcnt(0)
    s_waitcnt vmcnt(0)
    s_barrier
    s_mov_b32 s67, 0
L_x2try_19:
    buffer_load_dwordx2 v[94:95], v92, s[40:43], s65 offen sc1
    buffer_load_dword v118, v117, s[40:43], 0 offen sc1
    s_add_u32 m0, s52, 66560
    s_add_u32 s66, s64, s52
    buffer_load_dwordx4 v88, s[40:43], s66 offen offset:0 sc1 lds
    buffer_load_dwordx4 v88, s[40:43], s66 offen offset:1024 sc1 lds
    buffer_load_dwordx4 v88, s[40:43], s66 offen offset:2048 sc1 lds
    buffer_load_dwordx4 v88, s[40:43], s66 offen offset:3072 sc1 lds
    s_add_u32 m0, s53, 66560
    s_add_u32 s66, s64, s53
    buffer_load_dwordx4 v89, s[40:43], s66 offen offset:0 sc1 lds
    buffer_load_dwordx4 v89, s[40:43], s66 offen offset:1024 sc1 lds
    buffer_load_dwordx4 v89, s[40:43], s66 offen offset:2048 sc1 lds
    buffer_load_dwordx4 v89, s[40:43], s66 offen offset:3072 sc1 lds
    s_add_u32 m0, s54, 66560
    s_add_u32 s66, s64, s54
    buffer_load_dwordx4 v90, s[40:43], s66 offen offset:0 sc1 lds
    buffer_load_dwordx4 v90, s[40:43], s66 offen offset:1024 sc1 lds
    buffer_load_dwordx4 v90, s[40:43], s66 offen offset:2048 sc1 lds
    buffer_load_dwordx4 v90, s[40:43], s66 offen offset:3072 sc1 lds
    s_add_u32 m0, s55, 66560
    s_add_u32 s66, s64, s55
    buffer_load_dwordx4 v91, s[40:43], s66 offen offset:0 sc1 lds
    buffer_load_dwordx4 v91, s[40:43], s66 offen offset:1024 sc1 lds
    buffer_load_dwordx4 v91, s[40:43], s66 offen offset:2048 sc1 lds
    buffer_load_dwordx4 v91, s[40:43], s66 offen offset:3072 sc1 lds
    v_lshrrev_b32 v6, 2, v1
    s_add_u32 s99, s69, 16384
    v_lshlrev_b32 v6, 7, v6
    buffer_load_dword v6, v6, s[24:27], s99 offen
    s_waitcnt vmcnt(18)
    v_cmp_ne_u32 vcc, s44, v95
    s_nop 1
    s_cmp_lg_u64 vcc, 0
    s_cbranch_scc1 L_x2tag_20
    s_waitcnt vmcnt(17)
    v_cmp_ne_u32 vcc, s44, v118
    s_nop 1
    s_cmp_lg_u64 vcc, 0
    s_cbranch_scc1 L_auxfail_25
L_auxok_26:
    v_sub_u32 v93, 0, v94
    v_mov_b32 v96, 0
    s_waitcnt vmcnt(13)
    ds_read_b128 v[16:19], v97 offset:0
    ds_read_b128 v[20:23], v97 offset:1024
    ds_read_b128 v[24:27], v97 offset:2048
    ds_read_b128 v[28:31], v97 offset:3072
    s_waitcnt vmcnt(9)
    ds_read_b128 v[32:35], v98 offset:0
    ds_read_b128 v[36:39], v98 offset:1024
    ds_read_b128 v[40:43], v98 offset:2048
    ds_read_b128 v[44:47], v98 offset:3072
    s_waitcnt lgkmcnt(7)
    v_add3_u32 v96, v16, v17, v96
    v_add3_u32 v96, v18, v19, v96
    s_waitcnt lgkmcnt(6)
    v_add3_u32 v93, v20, v21, v93
    v_add3_u32 v93, v22, v23, v93
    s_waitcnt lgkmcnt(5)
    v_add3_u32 v96, v24, v25, v96
    v_add3_u32 v96, v26, v27, v96
    s_waitcnt lgkmcnt(4)
    v_add3_u32 v93, v28, v29, v93
    v_add3_u32 v93, v30, v31, v93
    s_waitcnt vmcnt(5)
    ds_read_b128 v[48:51], v99 offset:0
    ds_read_b128 v[52:55], v99 offset:1024
    ds_read_b128 v[56:59], v99 offset:2048
    ds_read_b128 v[60:63], v99 offset:3072
    s_waitcnt lgkmcnt(7)
    v_add3_u32 v96, v32, v33, v96
    v_add3_u32 v96, v34, v35, v96
    s_waitcnt lgkmcnt(6)
    v_add3_u32 v93, v36, v37, v93
    v_add3_u32 v93, v38, v39, v93
    s_waitcnt lgkmcnt(5)
    v_add3_u32 v96, v40, v41, v96
    v_add3_u32 v96, v42, v43, v96
    s_waitcnt lgkmcnt(4)
    v_add3_u32 v93, v44, v45, v93
    v_add3_u32 v93, v46, v47, v93
    s_waitcnt vmcnt(1)
    ds_read_b128 v[64:67], v100 offset:0
    ds_read_b128 v[68:71], v100 offset:1024
    ds_read_b128 v[72:75], v100 offset:2048
    ds_read_b128 v[76:79], v100 offset:3072
    s_waitcnt lgkmcnt(7)
    v_add3_u32 v96, v48, v49, v96
    v_add3_u32 v96, v50, v51, v96
    s_waitcnt lgkmcnt(6)
    v_add3_u32 v93, v52, v53, v93
    v_add3_u32 v93, v54, v55, v93
    s_waitcnt lgkmcnt(5)
    v_add3_u32 v96, v56, v57, v96
    v_add3_u32 v96, v58, v59, v96
    s_waitcnt lgkmcnt(4)
    v_add3_u32 v93, v60, v61, v93
    v_add3_u32 v93, v62, v63, v93
    s_waitcnt lgkmcnt(3)
    v_add3_u32 v96, v64, v65, v96
    v_add3_u32 v96, v66, v67, v96
    s_waitcnt lgkmcnt(2)
    v_add3_u32 v93, v68, v69, v93
    v_add3_u32 v93, v70, v71, v93
    s_waitcnt lgkmcnt(1)
    v_add3_u32 v96, v72, v73, v96
    v_add3_u32 v96, v74, v75, v96
    s_waitcnt lgkmcnt(0)
    v_add3_u32 v93, v76, v77, v93
    v_add3_u32 v93, v78, v79, v93
    v_add_u32 v93, v93, v96
    s_nop 1
    v_add_u32_dpp v93, v93, v93 row_ror:8 row_mask:0xf bank_mask:0xf
    s_nop 1
    v_add_u32_dpp v93, v93, v93 row_ror:4 row_mask:0xf bank_mask:0xf
    s_nop 1
    v_add_u32_dpp v93, v93, v93 row_ror:2 row_mask:0xf bank_mask:0xf
    s_nop 1
    v_add_u32_dpp v93, v93, v93 row_ror:1 row_mask:0xf bank_mask:0xf
    s_nop 0
    v_readlane_b32 s50, v93, 0
    v_readlane_b32 s51, v93, 16
    v_readlane_b32 s56, v93, 32
    v_readlane_b32 s57, v93, 48
    s_add_u32 s50, s50, s51
    s_nop 0
    s_add_u32 s56, s56, s57
    s_add_u32 s50, s50, s56
    s_cmp_lg_u32 s50, 0
    s_cbranch_scc1 L_x2sum_21
L_x2ok_22:
    s_barrier
    ds_read_b64_tr_b16 a[128:129], v85 offset:0
    ds_read_b64_tr_b16 a[130:131], v86 offset:0
    ds_read_b128 v[16:19], v4 offset:0
    ds_read_b64_tr_b16 a[184:185], v85 offset:3584
    s_add_u32 s12, s60, s16
    buffer_load_dwordx4 a[64:67], v4, s[40:43], s12 offen offset:0 sc1
    ds_read_b64_tr_b16 a[186:187], v86 offset:3584
    ds_read_b128 v[20:23], v4 offset:14336
    ds_read_b64_tr_b16 a[132:133], v85 offset:256
    ds_read_b64_tr_b16 a[134:135], v86 offset:256
    ds_read_b128 v[24:27], v4 offset:1024
    ds_read_b64_tr_b16 a[180:181], v85 offset:3328
    s_add_u32 s13, s61, s16
    buffer_load_dwordx4 a[68:71], v4, s[40:43], s13 offen offset:0 sc1
    ds_read_b64_tr_b16 a[182:183], v86 offset:3328
    ds_read_b128 v[28:31], v4 offset:13312
    ds_read_b64_tr_b16 a[136:137], v85 offset:512
    ds_read_b64_tr_b16 a[138:139], v86 offset:512
    ds_read_b128 v[32:35], v4 offset:2048
    ds_read_b64_tr_b16 a[176:177], v85 offset:3072
    buffer_load_dwordx4 a[72:75], v4, s[40:43], s12 offen offset:1024 sc1
    ds_read_b64_tr_b16 a[178:179], v86 offset:3072
    ds_read_b128 v[36:39], v4 offset:12288
    ds_read_b64_tr_b16 a[140:141], v85 offset:768
    ds_read_b64_tr_b16 a[142:143], v86 offset:768
    ds_read_b128 v[40:43], v4 offset:3072
    s_waitcnt lgkmcnt(15)
    v_mfma_f32_16x16x32_bf16 v[48:51], v[16:19], a[128:131], 0
    buffer_load_dwordx4 a[76:79], v4, s[40:43], s13 offen offset:1024 sc1
    ds_read_b64_tr_b16 a[172:173], v85 offset:2816
    s_waitcnt lgkmcnt(15)
    v_mfma_f32_16x16x32_bf16 v[48:51], v[20:23], a[184:187], v[48:51]
    ds_read_b64_tr_b16 a[174:175], v86 offset:2816
    ds_read_b128 v[44:47], v4 offset:11264
    s_waitcnt lgkmcnt(15)
    v_mfma_f32_16x16x32_bf16 v[52:55], v[24:27], a[132:135], 0
    ds_read_b64_tr_b16 a[144:145], v85 offset:1024
    s_waitcnt lgkmcnt(13)
    v_mfma_f32_16x16x32_bf16 v[52:55], v[28:31], a[180:183], v[52:55]
    ds_read_b64_tr_b16 a[146:147], v86 offset:1024
    ds_read_b128 v[16:19], v4 offset:4096
    s_waitcnt lgkmcnt(12)
    v_mfma_f32_16x16x32_bf16 v[56:59], v[32:35], a[136:139], 0
    ds_read_b64_tr_b16 a[168:169], v85 offset:2560
    ds_read_b64_tr_b16 a[170:171], v86 offset:2560
    ds_read_b128 v[20:23], v4 offset:10240
    s_waitcnt lgkmcnt(12)
    v_mfma_f32_16x16x32_bf16 v[56:59], v[36:39], a[176:179], v[56:59]
    ds_read_b64_tr_b16 a[148:149], v85 offset:1280
    ds_read_b64_tr_b16 a[150:151], v86 offset:1280
    v_cvt_pk_bf16_f32 v128, v48, v52
    ds_read_b128 v[24:27], v4 offset:5120
    v_cvt_pk_bf16_f32 v132, v49, v53
    v_cvt_pk_bf16_f32 v136, v50, v54
    s_waitcnt lgkmcnt(12)
    v_mfma_f32_16x16x32_bf16 v[60:63], v[40:43], a[140:143], 0
    ds_read_b64_tr_b16 a[164:165], v85 offset:2304
    ds_read_b64_tr_b16 a[166:167], v86 offset:2304
    v_cvt_pk_bf16_f32 v140, v51, v55
    ds_read_b128 v[28:31], v4 offset:9216
    s_waitcnt lgkmcnt(12)
    v_mfma_f32_16x16x32_bf16 v[60:63], v[44:47], a[172:175], v[60:63]
    ds_read_b64_tr_b16 a[152:153], v85 offset:1536
    ds_read_b64_tr_b16 a[154:155], v86 offset:1536
    ds_read_b128 v[32:35], v4 offset:6144
    s_waitcnt lgkmcnt(12)
    v_mfma_f32_16x16x32_bf16 v[64:67], v[16:19], a[144:147], 0
    ds_read_b64_tr_b16 a[160:161], v85 offset:2048
    ds_read_b64_tr_b16 a[162:163], v86 offset:2048
    ds_read_b128 v[36:39], v4 offset:8192
    v_cvt_pk_bf16_f32 v129, v56, v60
    s_waitcnt lgkmcnt(12)
    v_mfma_f32_16x16x32_bf16 v[64:67], v[20:23], a[168:171], v[64:67]
    ds_read_b64_tr_b16 a[156:157], v85 offset:1792
    ds_read_b64_tr_b16 a[158:159], v86 offset:1792
    v_cvt_pk_bf16_f32 v133, v57, v61
    ds_read_b128 v[40:43], v4 offset:7168
    v_cvt_pk_bf16_f32 v137, v58, v62
    v_cvt_pk_bf16_f32 v141, v59, v63
    s_waitcnt lgkmcnt(12)
    v_mfma_f32_16x16x32_bf16 v[68:71], v[24:27], a[148:151], 0
    ds_read_b64_tr_b16 a[188:189], v85 offset:3840
    ds_read_b64_tr_b16 a[190:191], v86 offset:3840
    ds_read_b128 v[44:47], v4 offset:15360
    s_waitcnt lgkmcnt(12)
    v_mfma_f32_16x16x32_bf16 v[68:71], v[28:31], a[164:167], v[68:71]
    s_waitcnt lgkmcnt(9)
    v_mfma_f32_16x16x32_bf16 v[72:75], v[32:35], a[152:155], 0
    s_waitcnt lgkmcnt(6)
    v_mfma_f32_16x16x32_bf16 v[72:75], v[36:39], a[160:163], v[72:75]
    s_nop 3
    v_cvt_pk_bf16_f32 v144, v64, v68
    s_waitcnt lgkmcnt(3)
    v_mfma_f32_16x16x32_bf16 v[76:79], v[40:43], a[156:159], 0
    v_cvt_pk_bf16_f32 v148, v65, v69
    s_waitcnt lgkmcnt(0)
    v_mfma_f32_16x16x32_bf16 v[76:79], v[44:47], a[188:191], v[76:79]
    v_cvt_pk_bf16_f32 v152, v66, v70
    v_cvt_pk_bf16_f32 v156, v67, v71
    s_nop 5
    v_cvt_pk_bf16_f32 v145, v72, v76
    v_cvt_pk_bf16_f32 v149, v73, v77
    v_cvt_pk_bf16_f32 v153, v74, v78
    v_cvt_pk_bf16_f32 v157, v75, v79
    s_barrier
    buffer_load_dwordx4 a[80:83], v4, s[40:43], s12 offen offset:2048 sc1
    s_lshr_b32 s59, s46, 1
    s_lshl_b32 s59, s59, 8
    ds_read_b128 v[16:19], v4 offset:16384
    ds_read_b128 v[20:23], v4 offset:30720
    ds_read_b128 v[24:27], v4 offset:17408
    ds_read_b128 v[28:31], v4 offset:29696
    ds_read_b128 v[32:35], v4 offset:18432
    ds_read_b128 v[36:39], v4 offset:28672
    v_permlane32_swap_b32 v128, v144
    ds_read_b128 v[40:43], v4 offset:19456
    v_permlane32_swap_b32 v129, v145
    v_permlane32_swap_b32 v132, v148
    ds_read_b128 v[44:47], v4 offset:27648
    v_mfma_f32_16x16x32_bf16 v[96:99], v[112:115], v[128:131], v[8:11]
    s_add_u32 s59, s59, s48
    v_permlane32_swap_b32 v133, v149
    v_mfma_f32_16x16x32_bf16 v[120:123], v[112:115], v[144:147], v[8:11]
    s_add_u32 s59, s59, 66560
    buffer_load_dwordx4 a[84:87], v4, s[40:43], s13 offen offset:2048 sc1
    v_mfma_f32_16x16x32_bf16 v[100:103], v[112:115], v[132:135], v[8:11]
    s_lshl_b32 s58, s46, 1
    v_permlane32_swap_b32 v136, v152
    v_mfma_f32_16x16x32_bf16 v[124:127], v[112:115], v[148:151], v[8:11]
    s_sub_u32 s58, s58, s45
    v_permlane32_swap_b32 v137, v153
    v_permlane32_swap_b32 v140, v156
    v_lshrrev_b32 v86, 2, v2
    v_mfma_f32_16x16x32_bf16 v[104:107], v[112:115], v[136:139], v[8:11]
    s_lshl_b32 s66, s3, 6
    v_permlane32_swap_b32 v141, v157
    s_waitcnt lgkmcnt(7)
    v_mfma_f32_16x16x32_bf16 v[48:51], v[16:19], a[128:131], 0
    s_add_u32 s66, s66, 161792
    v_cvt_pk_bf16_f32 v128, v96, v100
    v_cvt_pk_bf16_f32 v130, v120, v124
    s_waitcnt lgkmcnt(6)
    v_mfma_f32_16x16x32_bf16 v[48:51], v[20:23], a[184:187], v[48:51]
    buffer_load_dwordx4 a[88:91], v4, s[40:43], s12 offen offset:3072 sc1
    s_waitcnt lgkmcnt(5)
    v_mfma_f32_16x16x32_bf16 v[52:55], v[24:27], a[132:135], 0
    s_add_u32 s12, s60, s17
    ds_read_b128 v[16:19], v4 offset:20480
    ds_read_b128 v[20:23], v4 offset:26624
    s_waitcnt lgkmcnt(6)
    v_mfma_f32_16x16x32_bf16 v[52:55], v[28:31], a[180:183], v[52:55]
    ds_read_b128 v[24:27], v4 offset:21504
    v_cvt_pk_bf16_f32 v132, v97, v101
    s_waitcnt lgkmcnt(6)
    v_mfma_f32_16x16x32_bf16 v[56:59], v[32:35], a[136:139], 0
    ds_read_b128 v[28:31], v4 offset:25600
    v_cvt_pk_bf16_f32 v134, v121, v125
    s_waitcnt lgkmcnt(6)
    v_mfma_f32_16x16x32_bf16 v[56:59], v[36:39], a[176:179], v[56:59]
    ds_read_b128 v[32:35], v4 offset:22528
    v_cvt_pk_bf16_f32 v136, v98, v102
    s_waitcnt lgkmcnt(6)
    v_mfma_f32_16x16x32_bf16 v[60:63], v[40:43], a[140:143], 0
    ds_read_b128 v[36:39], v4 offset:24576
    v_cvt_pk_bf16_f32 v160, v48, v52
    s_waitcnt lgkmcnt(6)
    v_mfma_f32_16x16x32_bf16 v[60:63], v[44:47], a[172:175], v[60:63]
    buffer_load_dwordx4 a[92:95], v4, s[40:43], s13 offen offset:3072 sc1
    v_mfma_f32_16x16x32_bf16 v[108:111], v[112:115], v[140:143], v[8:11]
    s_add_u32 s13, s61, s17
    ds_read_b128 v[40:43], v4 offset:23552
    ds_read_b128 v[44:47], v4 offset:31744
    v_mfma_f32_16x16x32_bf16 v[88:91], v[112:115], v[152:155], v[8:11]
    v_cvt_pk_bf16_f32 v164, v49, v53
    v_cvt_pk_bf16_f32 v168, v50, v54
    v_mfma_f32_16x16x32_bf16 v[92:95], v[112:115], v[156:159], v[8:11]
    v_cvt_pk_bf16_f32 v172, v51, v55
    v_cvt_pk_bf16_f32 v161, v56, v60
    v_cvt_pk_bf16_f32 v165, v57, v61
    s_waitcnt lgkmcnt(7)
    v_mfma_f32_16x16x32_bf16 v[64:67], v[16:19], a[144:147], 0
    v_cvt_pk_bf16_f32 v169, v58, v62
    v_cvt_pk_bf16_f32 v173, v59, v63
    s_waitcnt lgkmcnt(6)
    v_mfma_f32_16x16x32_bf16 v[64:67], v[20:23], a[168:171], v[64:67]
    ds_read_b128 v[16:19], v4 offset:32768
    v_cvt_pk_bf16_f32 v129, v104, v108
    s_waitcnt lgkmcnt(6)
    v_mfma_f32_16x16x32_bf16 v[68:71], v[24:27], a[148:151], 0
    buffer_load_dwordx4 a[96:99], v4, s[40:43], s12 offen offset:0 sc1
    s_waitcnt lgkmcnt(5)
    v_mfma_f32_16x16x32_bf16 v[68:71], v[28:31], a[164:167], v[68:71]
    ds_read_b128 v[20:23], v4 offset:47104
    ds_read_b128 v[24:27], v4 offset:33792
    s_waitcnt lgkmcnt(6)
    v_mfma_f32_16x16x32_bf16 v[72:75], v[32:35], a[152:155], 0
    ds_read_b128 v[28:31], v4 offset:46080
    v_cvt_pk_bf16_f32 v131, v88, v92
    s_waitcnt lgkmcnt(6)
    v_mfma_f32_16x16x32_bf16 v[72:75], v[36:39], a[160:163], v[72:75]
    ds_read_b128 v[32:35], v4 offset:34816
    v_cvt_pk_bf16_f32 v133, v105, v109
    s_waitcnt lgkmcnt(6)
    v_mfma_f32_16x16x32_bf16 v[76:79], v[40:43], a[156:159], 0
    ds_read_b128 v[36:39], v4 offset:45056
    v_cvt_pk_bf16_f32 v176, v64, v68
    s_waitcnt lgkmcnt(6)
    v_mfma_f32_16x16x32_bf16 v[76:79], v[44:47], a[188:191], v[76:79]
    ds_read_b128 v[40:43], v4 offset:35840
    v_cvt_pk_bf16_f32 v180, v65, v69
    v_mfma_f32_16x16x32_bf16 v[80:83], v[128:131], v[128:131], 0
    buffer_load_dwordx4 a[100:103], v4, s[40:43], s13 offen offset:0 sc1
    ds_read_b128 v[44:47], v4 offset:44032
    v_cvt_pk_bf16_f32 v184, v66, v70
    v_cvt_pk_bf16_f32 v188, v67, v71
    s_waitcnt lgkmcnt(7)
    v_mfma_f32_16x16x32_bf16 v[48:51], v[16:19], a[128:131], 0
    v_cvt_pk_bf16_f32 v177, v72, v76
    v_cvt_pk_bf16_f32 v181, v73, v77
    ds_read_b128 v[16:19], v4 offset:36864
    v_cvt_pk_bf16_f32 v185, v74, v78
    v_cvt_pk_bf16_f32 v189, v75, v79
    v_cvt_pk_bf16_f32 v135, v89, v93
    s_waitcnt lgkmcnt(7)
    v_mfma_f32_16x16x32_bf16 v[48:51], v[20:23], a[184:187], v[48:51]
    v_cvt_pk_bf16_f32 v137, v106, v110
    v_cvt_pk_bf16_f32 v138, v122, v126
    s_waitcnt lgkmcnt(6)
    v_mfma_f32_16x16x32_bf16 v[52:55], v[24:27], a[132:135], 0
    ds_read_b128 v[20:23], v4 offset:43008
    v_cvt_pk_bf16_f32 v139, v90, v94
    s_waitcnt lgkmcnt(6)
    v_mfma_f32_16x16x32_bf16 v[52:55], v[28:31], a[180:183], v[52:55]
    buffer_load_dwordx4 a[104:107], v4, s[40:43], s12 offen offset:1024 sc1
    s_waitcnt lgkmcnt(5)
    v_mfma_f32_16x16x32_bf16 v[56:59], v[32:35], a[136:139], 0
    ds_read_b128 v[24:27], v4 offset:37888
    ds_read_b128 v[28:31], v4 offset:41984
    s_waitcnt lgkmcnt(6)
    v_mfma_f32_16x16x32_bf16 v[56:59], v[36:39], a[176:179], v[56:59]
    ds_read_b128 v[32:35], v4 offset:38912
    v_cvt_pk_bf16_f32 v140, v99, v103
    s_waitcnt lgkmcnt(6)
    v_mfma_f32_16x16x32_bf16 v[60:63], v[40:43], a[140:143], 0
    ds_read_b128 v[36:39], v4 offset:40960
    v_cvt_pk_bf16_f32 v192, v48, v52
    s_waitcnt lgkmcnt(6)
    v_mfma_f32_16x16x32_bf16 v[60:63], v[44:47], a[172:175], v[60:63]
    ds_read_b128 v[40:43], v4 offset:39936
    v_cvt_pk_bf16_f32 v196, v49, v53
    v_mfma_f32_16x16x32_bf16 v[80:83], v[132:135], v[132:135], v[80:83]
    ds_read_b128 v[44:47], v4 offset:48128
    v_cvt_pk_bf16_f32 v200, v50, v54
    s_waitcnt lgkmcnt(7)
    v_mfma_f32_16x16x32_bf16 v[64:67], v[16:19], a[144:147], 0
    buffer_load_dwordx4 a[108:111], v4, s[40:43], s13 offen offset:1024 sc1
    v_mfma_f32_16x16x32_bf16 v[80:83], v[136:139], v[136:139], v[80:83]
    ds_read_b128 v[16:19], v4 offset:49152
    v_cvt_pk_bf16_f32 v204, v51, v55
    v_cvt_pk_bf16_f32 v193, v56, v60
    s_waitcnt lgkmcnt(7)
    v_mfma_f32_16x16x32_bf16 v[64:67], v[20:23], a[168:171], v[64:67]
    v_cvt_pk_bf16_f32 v197, v57, v61
    v_cvt_pk_bf16_f32 v201, v58, v62
    ds_read_b128 v[20:23], v4 offset:63488
    v_cvt_pk_bf16_f32 v205, v59, v63
    v_permlane32_swap_b32 v160, v176
    s_waitcnt lgkmcnt(7)
    v_mfma_f32_16x16x32_bf16 v[68:71], v[24:27], a[148:151], 0
    v_permlane32_swap_b32 v161, v177
    s_waitcnt lgkmcnt(6)
    v_mfma_f32_16x16x32_bf16 v[68:71], v[28:31], a[164:167], v[68:71]
    ds_read_b128 v[24:27], v4 offset:50176
    v_cvt_pk_bf16_f32 v141, v107, v111
    s_waitcnt lgkmcnt(6)
    v_mfma_f32_16x16x32_bf16 v[72:75], v[32:35], a[152:155], 0
    buffer_load_dwordx4 a[112:115], v4, s[40:43], s12 offen offset:2048 sc1
    s_waitcnt lgkmcnt(5)
    v_mfma_f32_16x16x32_bf16 v[72:75], v[36:39], a[160:163], v[72:75]
    ds_read_b128 v[28:31], v4 offset:62464
    ds_read_b128 v[32:35], v4 offset:51200
    s_waitcnt lgkmcnt(6)
    v_mfma_f32_16x16x32_bf16 v[76:79], v[40:43], a[156:159], 0
    ds_read_b128 v[36:39], v4 offset:61440
    v_cvt_pk_bf16_f32 v142, v123, v127
    s_waitcnt lgkmcnt(6)
    v_mfma_f32_16x16x32_bf16 v[76:79], v[44:47], a[188:191], v[76:79]
    ds_read_b128 v[40:43], v4 offset:52224
    v_cvt_pk_bf16_f32 v143, v91, v95
    s_waitcnt lgkmcnt(6)
    v_mfma_f32_16x16x32_bf16 v[48:51], v[16:19], a[128:131], 0
    ds_read_b128 v[44:47], v4 offset:60416
    v_cvt_pk_bf16_f32 v208, v64, v68
    v_mfma_f32_16x16x32_bf16 v[96:99], v[112:115], v[160:163], v[8:11]
    ds_read_b128 v[16:19], v4 offset:53248
    v_cvt_pk_bf16_f32 v212, v65, v69
    s_waitcnt lgkmcnt(7)
    v_mfma_f32_16x16x32_bf16 v[48:51], v[20:23], a[184:187], v[48:51]
    buffer_load_dwordx4 a[116:119], v4, s[40:43], s13 offen offset:2048 sc1
    v_mfma_f32_16x16x32_bf16 v[120:123], v[112:115], v[176:179], v[8:11]
    v_permlane32_swap_b32 v164, v180
    v_mfma_f32_16x16x32_bf16 v[80:83], v[140:143], v[140:143], v[80:83]
    v_permlane32_swap_b32 v165, v181
    s_waitcnt lgkmcnt(6)
    v_mfma_f32_16x16x32_bf16 v[52:55], v[24:27], a[132:135], 0
    v_permlane32_swap_b32 v168, v184
    v_mfma_f32_16x16x32_bf16 v[100:103], v[112:115], v[164:167], v[8:11]
    v_permlane32_swap_b32 v169, v185
    s_waitcnt lgkmcnt(4)
    v_mfma_f32_16x16x32_bf16 v[56:59], v[32:35], a[136:139], 0
    v_permlane32_swap_b32 v172, v188
    v_mfma_f32_16x16x32_bf16 v[52:55], v[28:31], a[180:183], v[52:55]
    buffer_load_dwordx4 a[120:123], v4, s[40:43], s12 offen offset:3072 sc1
    s_waitcnt lgkmcnt(3)
    v_mfma_f32_16x16x32_bf16 v[56:59], v[36:39], a[176:179], v[56:59]
    s_add_u32 s12, s60, s96
    v_permlane32_swap_b32 v173, v189
    s_waitcnt lgkmcnt(2)
    v_mfma_f32_16x16x32_bf16 v[60:63], v[40:43], a[140:143], 0
    ds_read_b128 v[20:23], v4 offset:59392
    ds_read_b128 v[24:27], v4 offset:54272
    v_mfma_f32_16x16x32_bf16 v[104:107], v[112:115], v[168:171], v[8:11]
    ds_read_b128 v[28:31], v4 offset:58368
    ds_read_b128 v[32:35], v4 offset:55296
    v_mfma_f32_16x16x32_bf16 v[108:111], v[112:115], v[172:175], v[8:11]
    ds_read_b128 v[36:39], v4 offset:57344
    ds_read_b128 v[40:43], v4 offset:56320
    v_mfma_f32_16x16x32_bf16 v[124:127], v[112:115], v[180:183], v[8:11]
    v_cvt_pk_bf16_f32 v160, v96, v100
    v_cvt_pk_bf16_f32 v164, v97, v101
    v_mfma_f32_16x16x32_bf16 v[88:91], v[112:115], v[184:187], v[8:11]
    buffer_load_dwordx4 a[124:127], v4, s[40:43], s13 offen offset:3072 sc1
    v_mfma_f32_16x16x32_bf16 v[92:95], v[112:115], v[188:191], v[8:11]
    s_add_u32 s13, s61, s96
    v_cvt_pk_bf16_f32 v161, v104, v108
    v_cvt_pk_bf16_f32 v165, v105, v109
    s_waitcnt lgkmcnt(7)
    v_mfma_f32_16x16x32_bf16 v[60:63], v[44:47], a[172:175], v[60:63]
    v_cvt_pk_bf16_f32 v162, v120, v124
    v_cvt_pk_bf16_f32 v166, v121, v125
    ds_read_b128 v[44:47], v4 offset:64512
    v_cvt_pk_bf16_f32 v216, v66, v70
    v_cvt_pk_bf16_f32 v163, v88, v92
    v_cvt_pk_bf16_f32 v167, v89, v93
    v_cvt_pk_bf16_f32 v220, v67, v71
    v_mfma_f32_16x16x32_bf16 v[80:83], v[160:163], v[160:163], v[80:83]
    v_cvt_pk_bf16_f32 v209, v72, v76
    v_cvt_pk_bf16_f32 v213, v73, v77
    v_mfma_f32_16x16x32_bf16 v[80:83], v[164:167], v[164:167], v[80:83]
    v_cvt_pk_bf16_f32 v217, v74, v78
    v_cvt_pk_bf16_f32 v221, v75, v79
    s_waitcnt lgkmcnt(7)
    v_mfma_f32_16x16x32_bf16 v[64:67], v[16:19], a[144:147], 0
    buffer_load_dwordx4 a[192:195], v4, s[40:43], s12 offen offset:0 sc1
    s_waitcnt lgkmcnt(5)
    v_mfma_f32_16x16x32_bf16 v[68:71], v[24:27], a[148:151], 0
    v_cvt_pk_bf16_f32 v168, v98, v102
    v_cvt_pk_bf16_f32 v169, v106, v110
    s_waitcnt lgkmcnt(3)
    v_mfma_f32_16x16x32_bf16 v[72:75], v[32:35], a[152:155], 0
    v_cvt_pk_bf16_f32 v170, v122, v126
    v_cvt_pk_bf16_f32 v171, v90, v94
    s_waitcnt lgkmcnt(1)
    v_mfma_f32_16x16x32_bf16 v[76:79], v[40:43], a[156:159], 0
    v_permlane32_swap_b32 v192, v208
    v_mfma_f32_16x16x32_bf16 v[80:83], v[168:171], v[168:171], v[80:83]
    v_permlane32_swap_b32 v193, v209
    v_mfma_f32_16x16x32_bf16 v[64:67], v[20:23], a[168:171], v[64:67]
    v_permlane32_swap_b32 v196, v212
    v_mfma_f32_16x16x32_bf16 v[68:71], v[28:31], a[164:167], v[68:71]
    buffer_load_dwordx4 a[196:199], v4, s[40:43], s13 offen offset:0 sc1
    v_mfma_f32_16x16x32_bf16 v[72:75], v[36:39], a[160:163], v[72:75]
    v_permlane32_swap_b32 v197, v213
    s_waitcnt lgkmcnt(0)
    v_mfma_f32_16x16x32_bf16 v[76:79], v[44:47], a[188:191], v[76:79]
    v_permlane32_swap_b32 v200, v216
    v_permlane32_swap_b32 v201, v217
    v_permlane32_swap_b32 v204, v220
    v_permlane32_swap_b32 v205, v221
    v_cvt_pk_bf16_f32 v172, v99, v103
    v_mfma_f32_16x16x32_bf16 v[96:99], v[112:115], v[192:195], v[8:11]
    v_cvt_pk_bf16_f32 v173, v107, v111
    v_cvt_pk_bf16_f32 v174, v123, v127
    v_mfma_f32_16x16x32_bf16 v[100:103], v[112:115], v[196:199], v[8:11]
    buffer_load_dwordx4 a[200:203], v4, s[40:43], s12 offen offset:1024 sc1
    v_mfma_f32_16x16x32_bf16 v[104:107], v[112:115], v[200:203], v[8:11]
    v_cvt_pk_bf16_f32 v175, v91, v95
    v_cvt_pk_bf16_f32 v224, v48, v52
    v_mfma_f32_16x16x32_bf16 v[108:111], v[112:115], v[204:207], v[8:11]
    v_cvt_pk_bf16_f32 v228, v49, v53
    v_cvt_pk_bf16_f32 v232, v50, v54
    v_mfma_f32_16x16x32_bf16 v[120:123], v[112:115], v[208:211], v[8:11]
    v_cvt_pk_bf16_f32 v192, v96, v100
    v_cvt_pk_bf16_f32 v196, v97, v101
    v_mfma_f32_16x16x32_bf16 v[124:127], v[112:115], v[212:215], v[8:11]
    v_cvt_pk_bf16_f32 v236, v51, v55
    v_cvt_pk_bf16_f32 v225, v56, v60
    v_mfma_f32_16x16x32_bf16 v[88:91], v[112:115], v[216:219], v[8:11]
    v_cvt_pk_bf16_f32 v193, v104, v108
    v_cvt_pk_bf16_f32 v197, v105, v109
    v_mfma_f32_16x16x32_bf16 v[92:95], v[112:115], v[220:223], v[8:11]
    buffer_load_dwordx4 a[204:207], v4, s[40:43], s13 offen offset:1024 sc1
    v_mfma_f32_16x16x32_bf16 v[80:83], v[172:175], v[172:175], v[80:83]
    v_cvt_pk_bf16_f32 v194, v120, v124
    v_cvt_pk_bf16_f32 v198, v121, v125
    v_cvt_pk_bf16_f32 v229, v57, v61
    v_cvt_pk_bf16_f32 v233, v58, v62
    v_cvt_pk_bf16_f32 v237, v59, v63
    v_cvt_pk_bf16_f32 v240, v64, v68
    v_cvt_pk_bf16_f32 v195, v88, v92
    v_cvt_pk_bf16_f32 v199, v89, v93
    v_cvt_pk_bf16_f32 v244, v65, v69
    v_mfma_f32_16x16x32_bf16 v[80:83], v[192:195], v[192:195], v[80:83]
    v_cvt_pk_bf16_f32 v248, v66, v70
    v_cvt_pk_bf16_f32 v252, v67, v71
    v_mfma_f32_16x16x32_bf16 v[80:83], v[196:199], v[196:199], v[80:83]
    v_cvt_pk_bf16_f32 v241, v72, v76
    v_cvt_pk_bf16_f32 v245, v73, v77
    v_cvt_pk_bf16_f32 v249, v74, v78
    v_cvt_pk_bf16_f32 v253, v75, v79
    buffer_load_dwordx4 a[208:211], v4, s[40:43], s12 offen offset:2048 sc1
    v_cvt_pk_bf16_f32 v200, v98, v102
    v_cvt_pk_bf16_f32 v201, v106, v110
    v_cvt_pk_bf16_f32 v202, v122, v126
    v_cvt_pk_bf16_f32 v203, v90, v94
    v_permlane32_swap_b32 v224, v240
    v_cvt_pk_bf16_f32 v204, v99, v103
    v_mfma_f32_16x16x32_bf16 v[80:83], v[200:203], v[200:203], v[80:83]
    v_permlane32_swap_b32 v225, v241
    v_permlane32_swap_b32 v228, v244
    v_cvt_pk_bf16_f32 v205, v107, v111
    v_mfma_f32_16x16x32_bf16 v[96:99], v[112:115], v[224:227], v[8:11]
    v_permlane32_swap_b32 v229, v245
    v_permlane32_swap_b32 v232, v248
    v_cvt_pk_bf16_f32 v206, v123, v127
    v_mfma_f32_16x16x32_bf16 v[100:103], v[112:115], v[228:231], v[8:11]
    buffer_load_dwordx4 a[212:215], v4, s[40:43], s13 offen offset:2048 sc1
    v_mfma_f32_16x16x32_bf16 v[120:123], v[112:115], v[240:243], v[8:11]
    v_permlane32_swap_b32 v233, v249
    v_mfma_f32_16x16x32_bf16 v[124:127], v[112:115], v[244:247], v[8:11]
    v_permlane32_swap_b32 v236, v252
    v_mfma_f32_16x16x32_bf16 v[104:107], v[112:115], v[232:235], v[8:11]
    v_permlane32_swap_b32 v237, v253
    v_cvt_pk_bf16_f32 v207, v91, v95
    v_mfma_f32_16x16x32_bf16 v[88:91], v[112:115], v[248:251], v[8:11]
    v_cvt_pk_bf16_f32 v224, v96, v100
    v_cvt_pk_bf16_f32 v228, v97, v101
    v_mfma_f32_16x16x32_bf16 v[108:111], v[112:115], v[236:239], v[8:11]
    v_cvt_pk_bf16_f32 v226, v120, v124
    v_cvt_pk_bf16_f32 v230, v121, v125
    v_mfma_f32_16x16x32_bf16 v[92:95], v[112:115], v[252:255], v[8:11]
    buffer_load_dwordx4 a[216:219], v4, s[40:43], s12 offen offset:3072 sc1
    v_mfma_f32_16x16x32_bf16 v[80:83], v[204:207], v[204:207], v[80:83]
    s_add_u32 s12, s60, s95
    v_cvt_pk_bf16_f32 v232, v98, v102
    v_cvt_pk_bf16_f32 v234, v122, v126
    v_cvt_pk_bf16_f32 v225, v104, v108
    v_cvt_pk_bf16_f32 v229, v105, v109
    v_cvt_pk_bf16_f32 v233, v106, v110
    v_cvt_pk_bf16_f32 v227, v88, v92
    v_cvt_pk_bf16_f32 v231, v89, v93
    v_cvt_pk_bf16_f32 v235, v90, v94
    v_mfma_f32_16x16x32_bf16 v[80:83], v[224:227], v[224:227], v[80:83]
    v_cvt_pk_bf16_f32 v236, v99, v103
    v_cvt_pk_bf16_f32 v237, v107, v111
    v_mfma_f32_16x16x32_bf16 v[80:83], v[228:231], v[228:231], v[80:83]
    v_cvt_pk_bf16_f32 v238, v123, v127
    v_cvt_pk_bf16_f32 v239, v91, v95
    v_mfma_f32_16x16x32_bf16 v[80:83], v[232:235], v[232:235], v[80:83]
    v_cmp_eq_u32 s[56:57], v86, v3
    v_and_b32 v86, 3, v2
    v_mfma_f32_16x16x32_bf16 v[80:83], v[236:239], v[236:239], v[80:83]
    buffer_load_dwordx4 a[220:223], v4, s[40:43], s13 offen offset:3072 sc1
    s_add_u32 s13, s61, s95
    ds_write_b128 v116, v[128:131] offset:0
    v_cmp_eq_u32 s[52:53], 1, v86
    v_cmp_eq_u32 s[54:55], 2, v86
    v_cmp_eq_u32 s[64:65], 3, v86
    v_mov_b32 v86, 0x3727c5ac
    v_lshlrev_b32 v118, 2, v2
    v_cndmask_b32 v80, v80, v81, s[52:53]
    ds_write_b128 v116, v[160:163] offset:1024
    s_or_b64 s[54:55], s[54:55], s[64:65]
    buffer_load_dwordx4 a[224:227], v4, s[40:43], s12 offen offset:0 sc1
    v_cndmask_b32 v82, v82, v83, s[64:65]
    v_cndmask_b32 v80, v80, v82, s[54:55]
    v_fmac_f32 v86, 0x3b000000, v80
    ds_write_b128 v116, v[192:195] offset:2048
    v_lshl_add_u32 v85, v2, 2, s66
    v_add_u32 v117, 66560, v4
    v_add_u32 v118, 161792, v118
    v_rsq_f32 v86, v86
    ds_write_b128 v116, v[224:227] offset:3072
    buffer_load_dwordx4 a[228:231], v4, s[40:43], s13 offen offset:0 sc1
    s_waitcnt vmcnt(26)
    v_lshlrev_b32 v6, 10, v3
    v_lshl_add_u32 v6, v2, 4, v6
    v_add_u32 v6, s59, v6
    s_add_u32 s59, s58, 1
    ds_write_b128 v87, v[132:135] offset:0
    s_and_b32 s59, s59, 3
    s_lshl_b32 s59, s59, 12
    s_and_b32 s58, s58, 3
    v_add_u32 v7, s59, v6
    s_lshl_b32 s58, s58, 12
    v_add_u32 v6, s58, v6
    ds_write_b128 v84, v[136:139] offset:0
    buffer_load_dwordx4 a[232:235], v4, s[40:43], s12 offen offset:1024 sc1
    ds_write_b128 v119, v[140:143] offset:0
    ds_write_b128 v87, v[164:167] offset:1024
    buffer_load_dwordx4 a[236:239], v4, s[40:43], s13 offen offset:1024 sc1
    ds_write_b128 v84, v[168:171] offset:1024
    ds_write_b128 v119, v[172:175] offset:1024
    buffer_load_dwordx4 a[240:243], v4, s[40:43], s12 offen offset:2048 sc1
    ds_write_b128 v87, v[196:199] offset:2048
    ds_write_b128 v84, v[200:203] offset:2048
    buffer_load_dwordx4 a[244:247], v4, s[40:43], s13 offen offset:2048 sc1
    ds_write_b128 v119, v[204:207] offset:2048
    ds_write_b128 v87, v[228:231] offset:3072
    buffer_load_dwordx4 a[248:251], v4, s[40:43], s12 offen offset:3072 sc1
    ds_write_b128 v84, v[232:235] offset:3072
    ds_write_b128 v119, v[236:239] offset:3072
    buffer_load_dwordx4 a[252:255], v4, s[40:43], s13 offen offset:3072 sc1
    s_mov_b64 exec, s[56:57]
    ds_write_b32 v85, v86
    s_mov_b64 exec, -1
    s_waitcnt lgkmcnt(0)
    s_barrier
    ds_read_b32 v112, v118 offset:0
    ds_read_b32 v113, v118 offset:64
    ds_read_b32 v114, v118 offset:128
    ds_read_b32 v115, v118 offset:192
    ds_read_b128 v[120:123], v6
    ds_read_b128 v[124:127], v7
    s_add_u32 s30, s62, s16
    buffer_load_dwordx4 v[128:131], v4, s[40:43], s30 offen offset:0 sc1
    s_add_u32 s31, s63, s16
    s_lshl_b32 s6, s3, 3
    ds_read_b128 v[80:83], v117 offset:0
    ds_read_b128 v[84:87], v117 offset:16384
    ds_read_b128 v[88:91], v117 offset:32768
    ds_read_b128 v[92:95], v117 offset:49152
    ds_read_b128 v[96:99], v117 offset:1024
    ds_read_b128 v[100:103], v117 offset:17408
    v_lshrrev_b32 v118, 2, v2
    v_and_b32 v7, 3, v1
    ds_read_b128 v[104:107], v117 offset:33792
    s_mul_i32 s7, s46, 458752
    s_lshl_b32 s19, s97, 14
    s_lshr_b32 s12, 394242, s6
    buffer_load_dwordx4 v[132:135], v4, s[40:43], s31 offen offset:0 sc1
    s_lshr_b32 s13, 16778499, s6
    s_lshr_b32 s14, 33621508, s6
    ds_read_b128 v[108:111], v117 offset:50176
    s_lshr_b32 s15, 50462725, s6
    s_lshr_b32 s16, 67305734, s6
    s_lshr_b32 s18, 100925952, s6
    v_xor_b32 v118, v118, v3
    v_bfe_u32 v119, v1, 2, 2
    v_xor_b32 v7, v7, v3
    s_mul_i32 s20, s46, 7
    s_add_u32 s7, s7, s19
    s_and_b32 s12, s12, 7
    s_and_b32 s13, s13, 7
    s_and_b32 s14, s14, 7
    buffer_load_dwordx4 v[136:139], v4, s[40:43], s30 offen offset:1024 sc1
    s_and_b32 s15, s15, 7
    s_and_b32 s16, s16, 7
    s_and_b32 s18, s18, 7
    v_lshlrev_b32 v118, 3, v118
    s_lshl_b32 s23, s3, 12
    s_waitcnt vmcnt(34)
    s_waitcnt lgkmcnt(7)
    v_mfma_f32_16x16x32_bf16 v[16:19], a[64:67], v[80:83], 0
    s_add_u32 s20, s20, s3
    v_lshl_add_u32 v119, v3, 3, v119
    v_lshlrev_b32 v7, 3, v7
    s_waitcnt vmcnt(33)
    v_mfma_f32_16x16x32_bf16 v[32:35], a[68:71], v[80:83], 0
    s_add_u32 s7, s7, 13631488
    s_lshl_b32 s12, s12, 16
    s_lshl_b32 s13, s13, 16
    s_waitcnt lgkmcnt(6)
    v_mfma_f32_16x16x32_bf16 v[20:23], a[64:67], v[84:87], 0
    s_lshl_b32 s14, s14, 16
    buffer_load_dwordx4 v[140:143], v4, s[40:43], s31 offen offset:1024 sc1
    v_mfma_f32_16x16x32_bf16 v[36:39], a[68:71], v[84:87], 0
    s_lshl_b32 s15, s15, 16
    ds_read_b128 v[80:83], v117 offset:2048
    s_lshl_b32 s16, s16, 16
    s_waitcnt lgkmcnt(6)
    v_mfma_f32_16x16x32_bf16 v[24:27], a[64:67], v[88:91], 0
    s_lshl_b32 s18, s18, 16
    ds_read_b128 v[84:87], v117 offset:18432
    v_lshl_add_u32 v118, v5, 5, v118
    v_mfma_f32_16x16x32_bf16 v[40:43], a[68:71], v[88:91], 0
    s_add_u32 s23, s23, 133120
    v_lshl_add_u32 v119, v119, 5, v7
    s_lshl_b32 s20, s20, 16
    s_waitcnt lgkmcnt(6)
    v_mfma_f32_16x16x32_bf16 v[28:31], a[64:67], v[92:95], 0
    s_lshl_b32 s21, s45, 11
    buffer_load_dwordx4 v[144:147], v4, s[40:43], s30 offen offset:2048 sc1
    v_mfma_f32_16x16x32_bf16 v[44:47], a[68:71], v[92:95], 0
    s_add_u32 s67, s3, 1
    ds_read_b128 v[88:91], v117 offset:34816
    s_add_u32 s12, s12, s7
    s_waitcnt vmcnt(34)
    s_waitcnt lgkmcnt(6)
    v_mfma_f32_16x16x32_bf16 v[16:19], a[72:75], v[96:99], v[16:19]
    s_add_u32 s13, s13, s7
    ds_read_b128 v[92:95], v117 offset:51200
    s_add_u32 s14, s14, s7
    s_waitcnt vmcnt(33)
    v_mfma_f32_16x16x32_bf16 v[32:35], a[76:79], v[96:99], v[32:35]
    s_add_u32 s15, s15, s7
    s_add_u32 s16, s16, s7
    s_add_u32 s18, s18, s7
    s_waitcnt lgkmcnt(6)
    v_mfma_f32_16x16x32_bf16 v[20:23], a[72:75], v[100:103], v[20:23]
    s_add_u32 s20, s20, s21
    buffer_load_dwordx4 v[148:151], v4, s[40:43], s31 offen offset:2048 sc1
    v_mfma_f32_16x16x32_bf16 v[36:39], a[76:79], v[100:103], v[36:39]
    s_lshr_b32 s67, s67, 2
    ds_read_b128 v[96:99], v117 offset:3072
    v_add_u32 v118, s23, v118
    s_waitcnt lgkmcnt(6)
    v_mfma_f32_16x16x32_bf16 v[24:27], a[72:75], v[104:107], v[24:27]
    s_lshr_b32 s32, 34868744, s6
    ds_read_b128 v[100:103], v117 offset:19456
    v_add_u32 v119, s23, v119
    v_mfma_f32_16x16x32_bf16 v[40:43], a[76:79], v[104:107], v[40:43]
    s_lshr_b32 s33, 83955979, s6
    s_lshr_b32 s34, 117707533, s6
    s_lshr_b32 s35, 168165392, s6
    s_waitcnt lgkmcnt(6)
    v_mfma_f32_16x16x32_bf16 v[28:31], a[72:75], v[108:111], v[28:31]
    s_lshr_b32 s28, 201917202, s6
    buffer_load_dwordx4 v[152:155], v4, s[40:43], s30 offen offset:3072 sc1
    v_mfma_f32_16x16x32_bf16 v[44:47], a[76:79], v[108:111], v[44:47]
    s_add_u32 s30, s62, s17
    ds_read_b128 v[104:107], v117 offset:35840
    s_lshr_b32 s29, 253039893, s6
    s_waitcnt vmcnt(34)
    s_waitcnt lgkmcnt(6)
    v_mfma_f32_16x16x32_bf16 v[16:19], a[80:83], v[80:83], v[16:19]
    s_lshl_b32 s68, s46, 11
    ds_read_b128 v[108:111], v117 offset:52224
    s_add_u32 s20, s20, 13631488
    s_waitcnt vmcnt(33)
    v_mfma_f32_16x16x32_bf16 v[32:35], a[84:87], v[80:83], v[32:35]
    s_lshl_b32 s21, s67, 29
    s_lshl_b32 s22, s49, 6
    s_lshl_b32 s23, s3, 3
    s_waitcnt lgkmcnt(6)
    v_mfma_f32_16x16x32_bf16 v[20:23], a[80:83], v[84:87], v[20:23]
    s_and_b32 s32, s32, 31
    buffer_load_dwordx4 v[156:159], v4, s[40:43], s31 offen offset:3072 sc1
    v_mfma_f32_16x16x32_bf16 v[36:39], a[84:87], v[84:87], v[36:39]
    s_add_u32 s31, s63, s17
    ds_read_b128 v[80:83], v117 offset:4096
    s_lshr_b32 s17, 84214529, s6
    s_waitcnt lgkmcnt(6)
    v_mfma_f32_16x16x32_bf16 v[24:27], a[80:83], v[88:91], v[24:27]
    s_and_b32 s17, s17, 7
    ds_read_b128 v[84:87], v117 offset:20480
    s_lshl_b32 s17, s17, 16
    v_mfma_f32_16x16x32_bf16 v[40:43], a[84:87], v[88:91], v[40:43]
    s_add_u32 s17, s17, s7
    s_lshl_b32 s7, s97, 9
    s_and_b32 s33, s33, 31
    s_waitcnt lgkmcnt(6)
    v_mfma_f32_16x16x32_bf16 v[28:31], a[80:83], v[92:95], v[28:31]
    s_and_b32 s34, s34, 31
    buffer_load_dwordx4 v[160:163], v4, s[40:43], s30 offen offset:0 sc1
    v_mfma_f32_16x16x32_bf16 v[44:47], a[84:87], v[92:95], v[44:47]
    s_and_b32 s35, s35, 31
    ds_read_b128 v[88:91], v117 offset:36864
    s_and_b32 s28, s28, 31
    s_waitcnt vmcnt(34)
    s_waitcnt lgkmcnt(6)
    v_mfma_f32_16x16x32_bf16 v[16:19], a[88:91], v[96:99], v[16:19]
    s_and_b32 s29, s29, 31
    ds_read_b128 v[92:95], v117 offset:53248
    s_lshr_b32 s4, 121860124, s6
    s_waitcnt vmcnt(33)
    v_mfma_f32_16x16x32_bf16 v[32:35], a[92:95], v[96:99], v[32:35]
    s_add_u32 s68, s68, s7
    v_lshlrev_b32 v6, 3, v2
    s_add_u32 s21, s21, s20
    s_waitcnt lgkmcnt(6)
    v_mfma_f32_16x16x32_bf16 v[20:23], a[88:91], v[100:103], v[20:23]
    s_add_u32 s22, s22, s23
    buffer_load_dwordx4 v[164:167], v4, s[40:43], s31 offen offset:0 sc1
    v_mfma_f32_16x16x32_bf16 v[36:39], a[92:95], v[100:103], v[36:39]
    s_lshl_b32 s32, s32, 12
    ds_read_b128 v[96:99], v117 offset:5120
    s_lshl_b32 s33, s33, 12
    s_waitcnt lgkmcnt(6)
    v_mfma_f32_16x16x32_bf16 v[24:27], a[88:91], v[104:107], v[24:27]
    s_lshl_b32 s34, s34, 12
    ds_read_b128 v[100:103], v117 offset:21504
    s_lshl_b32 s35, s35, 12
    v_mfma_f32_16x16x32_bf16 v[40:43], a[92:95], v[104:107], v[40:43]
    s_lshl_b32 s28, s28, 12
    s_lshl_b32 s29, s29, 12
    s_and_b32 s4, s4, 255
    s_waitcnt lgkmcnt(6)
    v_mfma_f32_16x16x32_bf16 v[28:31], a[88:91], v[108:111], v[28:31]
    s_mov_b32 s5, 0
    buffer_load_dwordx4 v[168:171], v4, s[40:43], s30 offen offset:1024 sc1
    v_mfma_f32_16x16x32_bf16 v[44:47], a[92:95], v[108:111], v[44:47]
    s_add_u32 s68, s68, 13238272
    ds_read_b128 v[104:107], v117 offset:37888
    s_mul_i32 s19, s3, 24576
    s_waitcnt vmcnt(34)
    s_waitcnt lgkmcnt(6)
    v_mfma_f32_16x16x32_bf16 v[16:19], a[96:99], v[80:83], v[16:19]
    s_add_u32 s21, s21, 262144
    ds_read_b128 v[108:111], v117 offset:54272
    v_add_u32 v6, 162048, v6
    s_waitcnt vmcnt(33)
    v_mfma_f32_16x16x32_bf16 v[32:35], a[100:103], v[80:83], v[32:35]
    s_sub_u32 s67, s67, 1
    s_add_u32 s22, s22, 13238272
    s_waitcnt lgkmcnt(6)
    v_mfma_f32_16x16x32_bf16 v[20:23], a[96:99], v[84:87], v[20:23]
    buffer_load_dwordx4 v[172:175], v4, s[40:43], s31 offen offset:1024 sc1
    v_mfma_f32_16x16x32_bf16 v[36:39], a[100:103], v[84:87], v[36:39]
    ds_read_b128 v[80:83], v117 offset:6144
    s_waitcnt lgkmcnt(6)
    v_mfma_f32_16x16x32_bf16 v[24:27], a[96:99], v[88:91], v[24:27]
    ds_read_b128 v[84:87], v117 offset:22528
    v_mfma_f32_16x16x32_bf16 v[40:43], a[100:103], v[88:91], v[40:43]
    s_waitcnt lgkmcnt(6)
    v_mfma_f32_16x16x32_bf16 v[28:31], a[96:99], v[92:95], v[28:31]
    buffer_load_dwordx4 v[176:179], v4, s[40:43], s30 offen offset:2048 sc1
    v_mfma_f32_16x16x32_bf16 v[44:47], a[100:103], v[92:95], v[44:47]
    ds_read_b128 v[88:91], v117 offset:38912
    s_waitcnt vmcnt(34)
    s_waitcnt lgkmcnt(6)
    v_mfma_f32_16x16x32_bf16 v[16:19], a[104:107], v[96:99], v[16:19]
    ds_read_b128 v[92:95], v117 offset:55296
    s_waitcnt vmcnt(33)
    v_mfma_f32_16x16x32_bf16 v[32:35], a[108:111], v[96:99], v[32:35]
    s_waitcnt lgkmcnt(6)
    v_mfma_f32_16x16x32_bf16 v[20:23], a[104:107], v[100:103], v[20:23]
    buffer_load_dwordx4 v[180:183], v4, s[40:43], s31 offen offset:2048 sc1
    v_mfma_f32_16x16x32_bf16 v[36:39], a[108:111], v[100:103], v[36:39]
    ds_read_b128 v[96:99], v117 offset:7168
    s_waitcnt lgkmcnt(6)
    v_mfma_f32_16x16x32_bf16 v[24:27], a[104:107], v[104:107], v[24:27]
    ds_read_b128 v[100:103], v117 offset:23552
    v_mfma_f32_16x16x32_bf16 v[40:43], a[108:111], v[104:107], v[40:43]
    s_waitcnt lgkmcnt(6)
    v_mfma_f32_16x16x32_bf16 v[28:31], a[104:107], v[108:111], v[28:31]
    buffer_load_dwordx4 v[184:187], v4, s[40:43], s30 offen offset:3072 sc1
    v_mfma_f32_16x16x32_bf16 v[44:47], a[108:111], v[108:111], v[44:47]
    s_add_u32 s30, s62, s96
    ds_read_b128 v[104:107], v117 offset:39936
    s_waitcnt vmcnt(34)
    s_waitcnt lgkmcnt(6)
    v_mfma_f32_16x16x32_bf16 v[16:19], a[112:115], v[80:83], v[16:19]
    ds_read_b128 v[108:111], v117 offset:56320
    s_waitcnt vmcnt(33)
    v_mfma_f32_16x16x32_bf16 v[32:35], a[116:119], v[80:83], v[32:35]
    s_waitcnt lgkmcnt(6)
    v_mfma_f32_16x16x32_bf16 v[20:23], a[112:115], v[84:87], v[20:23]
    buffer_load_dwordx4 v[188:191], v4, s[40:43], s31 offen offset:3072 sc1
    v_mfma_f32_16x16x32_bf16 v[36:39], a[116:119], v[84:87], v[36:39]
    s_add_u32 s31, s63, s96
    ds_read_b128 v[80:83], v117 offset:8192
    s_waitcnt lgkmcnt(6)
    v_mfma_f32_16x16x32_bf16 v[24:27], a[112:115], v[88:91], v[24:27]
    ds_read_b128 v[84:87], v117 offset:24576
    v_mfma_f32_16x16x32_bf16 v[40:43], a[116:119], v[88:91], v[40:43]
    s_waitcnt lgkmcnt(6)
    v_mfma_f32_16x16x32_bf16 v[28:31], a[112:115], v[92:95], v[28:31]
    buffer_load_dwordx4 v[192:195], v4, s[40:43], s30 offen offset:0 sc1
    v_mfma_f32_16x16x32_bf16 v[44:47], a[116:119], v[92:95], v[44:47]
    ds_read_b128 v[88:91], v117 offset:40960
    s_waitcnt vmcnt(34)
    s_waitcnt lgkmcnt(6)
    v_mfma_f32_16x16x32_bf16 v[16:19], a[120:123], v[96:99], v[16:19]
    ds_read_b128 v[92:95], v117 offset:57344
    s_waitcnt vmcnt(33)
    v_mfma_f32_16x16x32_bf16 v[32:35], a[124:127], v[96:99], v[32:35]
    s_waitcnt lgkmcnt(6)
    v_mfma_f32_16x16x32_bf16 v[20:23], a[120:123], v[100:103], v[20:23]
    buffer_load_dwordx4 v[196:199], v4, s[40:43], s31 offen offset:0 sc1
    v_mfma_f32_16x16x32_bf16 v[36:39], a[124:127], v[100:103], v[36:39]
    ds_read_b128 v[96:99], v117 offset:9216
    s_waitcnt lgkmcnt(6)
    v_mfma_f32_16x16x32_bf16 v[24:27], a[120:123], v[104:107], v[24:27]
    ds_read_b128 v[100:103], v117 offset:25600
    v_mfma_f32_16x16x32_bf16 v[40:43], a[124:127], v[104:107], v[40:43]
    s_waitcnt lgkmcnt(6)
    v_mfma_f32_16x16x32_bf16 v[28:31], a[120:123], v[108:111], v[28:31]
    buffer_load_dwordx4 v[200:203], v4, s[40:43], s30 offen offset:1024 sc1
    v_mfma_f32_16x16x32_bf16 v[44:47], a[124:127], v[108:111], v[44:47]
    ds_read_b128 v[104:107], v117 offset:41984
    s_waitcnt vmcnt(34)
    s_waitcnt lgkmcnt(6)
    v_mfma_f32_16x16x32_bf16 v[16:19], a[192:195], v[80:83], v[16:19]
    ds_read_b128 v[108:111], v117 offset:58368
    s_waitcnt vmcnt(33)
    v_mfma_f32_16x16x32_bf16 v[32:35], a[196:199], v[80:83], v[32:35]
    s_waitcnt lgkmcnt(6)
    v_mfma_f32_16x16x32_bf16 v[20:23], a[192:195], v[84:87], v[20:23]
    buffer_load_dwordx4 v[204:207], v4, s[40:43], s31 offen offset:1024 sc1
    v_mfma_f32_16x16x32_bf16 v[36:39], a[196:199], v[84:87], v[36:39]
    ds_read_b128 v[80:83], v117 offset:10240
    s_waitcnt lgkmcnt(6)
    v_mfma_f32_16x16x32_bf16 v[24:27], a[192:195], v[88:91], v[24:27]
    ds_read_b128 v[84:87], v117 offset:26624
    v_mfma_f32_16x16x32_bf16 v[40:43], a[196:199], v[88:91], v[40:43]
    s_waitcnt lgkmcnt(6)
    v_mfma_f32_16x16x32_bf16 v[28:31], a[192:195], v[92:95], v[28:31]
    buffer_load_dwordx4 v[208:211], v4, s[40:43], s30 offen offset:2048 sc1
    v_mfma_f32_16x16x32_bf16 v[44:47], a[196:199], v[92:95], v[44:47]
    ds_read_b128 v[88:91], v117 offset:43008
    s_waitcnt vmcnt(34)
    s_waitcnt lgkmcnt(6)
    v_mfma_f32_16x16x32_bf16 v[16:19], a[200:203], v[96:99], v[16:19]
    ds_read_b128 v[92:95], v117 offset:59392
    s_waitcnt vmcnt(33)
    v_mfma_f32_16x16x32_bf16 v[32:35], a[204:207], v[96:99], v[32:35]
    s_waitcnt lgkmcnt(6)
    v_mfma_f32_16x16x32_bf16 v[20:23], a[200:203], v[100:103], v[20:23]
    buffer_load_dwordx4 v[212:215], v4, s[40:43], s31 offen offset:2048 sc1
    v_mfma_f32_16x16x32_bf16 v[36:39], a[204:207], v[100:103], v[36:39]
    ds_read_b128 v[96:99], v117 offset:11264
    s_waitcnt lgkmcnt(6)
    v_mfma_f32_16x16x32_bf16 v[24:27], a[200:203], v[104:107], v[24:27]
    ds_read_b128 v[100:103], v117 offset:27648
    v_mfma_f32_16x16x32_bf16 v[40:43], a[204:207], v[104:107], v[40:43]
    s_waitcnt lgkmcnt(6)
    v_mfma_f32_16x16x32_bf16 v[28:31], a[200:203], v[108:111], v[28:31]
    buffer_load_dwordx4 v[216:219], v4, s[40:43], s30 offen offset:3072 sc1
    v_mfma_f32_16x16x32_bf16 v[44:47], a[204:207], v[108:111], v[44:47]
    s_add_u32 s30, s62, s95
    ds_read_b128 v[104:107], v117 offset:44032
    s_waitcnt vmcnt(34)
    s_waitcnt lgkmcnt(6)
    v_mfma_f32_16x16x32_bf16 v[16:19], a[208:211], v[80:83], v[16:19]
    ds_read_b128 v[108:111], v117 offset:60416
    s_waitcnt vmcnt(33)
    v_mfma_f32_16x16x32_bf16 v[32:35], a[212:215], v[80:83], v[32:35]
    s_waitcnt lgkmcnt(6)
    v_mfma_f32_16x16x32_bf16 v[20:23], a[208:211], v[84:87], v[20:23]
    buffer_load_dwordx4 v[220:223], v4, s[40:43], s31 offen offset:3072 sc1
    v_mfma_f32_16x16x32_bf16 v[36:39], a[212:215], v[84:87], v[36:39]
    s_add_u32 s31, s63, s95
    ds_read_b128 v[80:83], v117 offset:12288
    s_waitcnt lgkmcnt(6)
    v_mfma_f32_16x16x32_bf16 v[24:27], a[208:211], v[88:91], v[24:27]
    ds_read_b128 v[84:87], v117 offset:28672
    v_mfma_f32_16x16x32_bf16 v[40:43], a[212:215], v[88:91], v[40:43]
    s_waitcnt lgkmcnt(6)
    v_mfma_f32_16x16x32_bf16 v[28:31], a[208:211], v[92:95], v[28:31]
    buffer_load_dwordx4 v[224:227], v4, s[40:43], s30 offen offset:0 sc1
    v_mfma_f32_16x16x32_bf16 v[44:47], a[212:215], v[92:95], v[44:47]
    ds_read_b128 v[88:91], v117 offset:45056
    s_waitcnt vmcnt(34)
    s_waitcnt lgkmcnt(6)
    v_mfma_f32_16x16x32_bf16 v[16:19], a[216:219], v[96:99], v[16:19]
    ds_read_b128 v[92:95], v117 offset:61440
    s_waitcnt vmcnt(33)
    v_mfma_f32_16x16x32_bf16 v[32:35], a[220:223], v[96:99], v[32:35]
    s_waitcnt lgkmcnt(6)
    v_mfma_f32_16x16x32_bf16 v[20:23], a[216:219], v[100:103], v[20:23]
    buffer_load_dwordx4 v[228:231], v4, s[40:43], s31 offen offset:0 sc1
    v_mfma_f32_16x16x32_bf16 v[36:39], a[220:223], v[100:103], v[36:39]
    ds_read_b128 v[96:99], v117 offset:13312
    s_waitcnt lgkmcnt(6)
    v_mfma_f32_16x16x32_bf16 v[24:27], a[216:219], v[104:107], v[24:27]
    ds_read_b128 v[100:103], v117 offset:29696
    v_mfma_f32_16x16x32_bf16 v[40:43], a[220:223], v[104:107], v[40:43]
    s_waitcnt lgkmcnt(6)
    v_mfma_f32_16x16x32_bf16 v[28:31], a[216:219], v[108:111], v[28:31]
    buffer_load_dwordx4 v[232:235], v4, s[40:43], s30 offen offset:1024 sc1
    v_mfma_f32_16x16x32_bf16 v[44:47], a[220:223], v[108:111], v[44:47]
    ds_read_b128 v[104:107], v117 offset:46080
    s_waitcnt vmcnt(34)
    s_waitcnt lgkmcnt(6)
    v_mfma_f32_16x16x32_bf16 v[16:19], a[224:227], v[80:83], v[16:19]
    ds_read_b128 v[108:111], v117 offset:62464
    s_waitcnt vmcnt(33)
    v_mfma_f32_16x16x32_bf16 v[32:35], a[228:231], v[80:83], v[32:35]
    s_waitcnt lgkmcnt(6)
    v_mfma_f32_16x16x32_bf16 v[20:23], a[224:227], v[84:87], v[20:23]
    buffer_load_dwordx4 v[236:239], v4, s[40:43], s31 offen offset:1024 sc1
    v_mfma_f32_16x16x32_bf16 v[36:39], a[228:231], v[84:87], v[36:39]
    ds_read_b128 v[80:83], v117 offset:14336
    s_waitcnt lgkmcnt(6)
    v_mfma_f32_16x16x32_bf16 v[24:27], a[224:227], v[88:91], v[24:27]
    ds_read_b128 v[84:87], v117 offset:30720
    v_mfma_f32_16x16x32_bf16 v[40:43], a[228:231], v[88:91], v[40:43]
    s_waitcnt lgkmcnt(6)
    v_mfma_f32_16x16x32_bf16 v[28:31], a[224:227], v[92:95], v[28:31]
    buffer_load_dwordx4 v[240:243], v4, s[40:43], s30 offen offset:2048 sc1
    v_mfma_f32_16x16x32_bf16 v[44:47], a[228:231], v[92:95], v[44:47]
    ds_read_b128 v[88:91], v117 offset:47104
    s_waitcnt vmcnt(34)
    s_waitcnt lgkmcnt(6)
    v_mfma_f32_16x16x32_bf16 v[16:19], a[232:235], v[96:99], v[16:19]
    ds_read_b128 v[92:95], v117 offset:63488
    s_waitcnt vmcnt(33)
    v_mfma_f32_16x16x32_bf16 v[32:35], a[236:239], v[96:99], v[32:35]
    s_waitcnt lgkmcnt(6)
    v_mfma_f32_16x16x32_bf16 v[20:23], a[232:235], v[100:103], v[20:23]
    buffer_load_dwordx4 v[244:247], v4, s[40:43], s31 offen offset:2048 sc1
    v_mfma_f32_16x16x32_bf16 v[36:39], a[236:239], v[100:103], v[36:39]
    ds_read_b128 v[96:99], v117 offset:15360
    s_waitcnt lgkmcnt(6)
    v_mfma_f32_16x16x32_bf16 v[24:27], a[232:235], v[104:107], v[24:27]
    ds_read_b128 v[100:103], v117 offset:31744
    v_mfma_f32_16x16x32_bf16 v[40:43], a[236:239], v[104:107], v[40:43]
    s_waitcnt lgkmcnt(6)
    v_mfma_f32_16x16x32_bf16 v[28:31], a[232:235], v[108:111], v[28:31]
    buffer_load_dwordx4 v[248:251], v4, s[40:43], s30 offen offset:3072 sc1
    v_mfma_f32_16x16x32_bf16 v[44:47], a[236:239], v[108:111], v[44:47]
    ds_read_b128 v[104:107], v117 offset:48128
    s_waitcnt vmcnt(34)
    s_waitcnt lgkmcnt(6)
    v_mfma_f32_16x16x32_bf16 v[16:19], a[240:243], v[80:83], v[16:19]
    ds_read_b128 v[108:111], v117 offset:64512
    s_waitcnt lgkmcnt(6)
    v_mfma_f32_16x16x32_bf16 v[20:23], a[240:243], v[84:87], v[20:23]
    s_waitcnt lgkmcnt(5)
    v_mfma_f32_16x16x32_bf16 v[24:27], a[240:243], v[88:91], v[24:27]
    buffer_load_dwordx4 v[252:255], v4, s[40:43], s31 offen offset:3072 sc1
    s_waitcnt lgkmcnt(4)
    v_mfma_f32_16x16x32_bf16 v[28:31], a[240:243], v[92:95], v[28:31]
    s_waitcnt vmcnt(34)
    v_mfma_f32_16x16x32_bf16 v[32:35], a[244:247], v[80:83], v[32:35]
    v_mfma_f32_16x16x32_bf16 v[36:39], a[244:247], v[84:87], v[36:39]
    v_mfma_f32_16x16x32_bf16 v[40:43], a[244:247], v[88:91], v[40:43]
    v_mfma_f32_16x16x32_bf16 v[44:47], a[244:247], v[92:95], v[44:47]
    s_waitcnt vmcnt(33)
    s_waitcnt lgkmcnt(3)
    v_mfma_f32_16x16x32_bf16 v[16:19], a[248:251], v[96:99], v[16:19]
    s_waitcnt lgkmcnt(2)
    v_mfma_f32_16x16x32_bf16 v[20:23], a[248:251], v[100:103], v[20:23]
    s_waitcnt lgkmcnt(1)
    v_mfma_f32_16x16x32_bf16 v[24:27], a[248:251], v[104:107], v[24:27]
    s_waitcnt lgkmcnt(0)
    v_mfma_f32_16x16x32_bf16 v[28:31], a[248:251], v[108:111], v[28:31]
    s_waitcnt vmcnt(32)
    v_mfma_f32_16x16x32_bf16 v[32:35], a[252:255], v[96:99], v[32:35]
    v_mfma_f32_16x16x32_bf16 v[36:39], a[252:255], v[100:103], v[36:39]
    v_mfma_f32_16x16x32_bf16 v[40:43], a[252:255], v[104:107], v[40:43]
    v_mfma_f32_16x16x32_bf16 v[44:47], a[252:255], v[108:111], v[44:47]
    s_cmp_lg_u32 s3, 3
    s_cbranch_scc1 L_w3mv_29
    s_nop 5
    v_pk_mov_b32 v[48:49], v[32:33], v[32:33] op_sel:[0,1]
    v_pk_mov_b32 v[50:51], v[34:35], v[34:35] op_sel:[0,1]
    v_pk_mov_b32 v[52:53], v[36:37], v[36:37] op_sel:[0,1]
    v_pk_mov_b32 v[54:55], v[38:39], v[38:39] op_sel:[0,1]
    v_pk_mov_b32 v[56:57], v[40:41], v[40:41] op_sel:[0,1]
    v_pk_mov_b32 v[58:59], v[42:43], v[42:43] op_sel:[0,1]
    v_pk_mov_b32 v[60:61], v[44:45], v[44:45] op_sel:[0,1]
    v_pk_mov_b32 v[62:63], v[46:47], v[46:47] op_sel:[0,1]
L_w3mv_29:
    v_and_b32 v92, s67, v112
    v_and_b32 v93, s67, v113
    v_and_b32 v94, s67, v114
    v_and_b32 v95, s67, v115
    v_lshlrev_b32 v116, 12, v3
    v_lshl_add_u32 v116, v2, 7, v116
    s_sub_u32 s57, s69, 12288
    s_cmp_eq_u32 s3, 3
    s_cselect_b32 s57, s57, 0x20000000
    s_add_u32 s99, s57, 131072
    buffer_load_dword a196, v116, s[24:27], s99 offen
    s_add_u32 s99, s57, 147456
    buffer_load_dword a198, v116, s[24:27], s99 offen
    v_pk_mul_f32 v[16:17], v[16:17], v[112:113] op_sel_hi:[1,0]
    v_pk_mul_f32 v[20:21], v[20:21], v[112:113] op_sel:[0,1] op_sel_hi:[1,1]
    s_mov_b32 s64, 0xbdd2d3e8
    v_mov_b32 v88, 0xc0135761
    v_pk_mul_f32 v[18:19], v[18:19], v[112:113] op_sel_hi:[1,0]
    v_pk_mul_f32 v[80:81], v[16:17], v[16:17]
    v_pk_mul_f32 v[22:23], v[22:23], v[112:113] op_sel:[0,1] op_sel_hi:[1,1]
    v_pk_mul_f32 v[84:85], v[20:21], v[20:21]
    v_pk_mul_f32 v[82:83], v[18:19], v[18:19]
    v_pk_fma_f32 v[80:81], v[80:81], s[64:65], v[88:89] op_sel_hi:[1,0,0]
    v_pk_mul_f32 v[86:87], v[22:23], v[22:23]
    v_pk_fma_f32 v[84:85], v[84:85], s[64:65], v[88:89] op_sel_hi:[1,0,0]
    v_pk_fma_f32 v[82:83], v[82:83], s[64:65], v[88:89] op_sel_hi:[1,0,0]
    v_pk_mul_f32 v[80:81], v[80:81], v[16:17]
    v_pk_fma_f32 v[86:87], v[86:87], s[64:65], v[88:89] op_sel_hi:[1,0,0]
    v_pk_mul_f32 v[84:85], v[84:85], v[20:21]
    v_pk_mul_f32 v[82:83], v[82:83], v[18:19]
    v_exp_f32 v80, v80
    v_exp_f32 v81, v81
    v_pk_mul_f32 v[86:87], v[86:87], v[22:23]
    v_exp_f32 v84, v84
    v_exp_f32 v85, v85
    v_exp_f32 v82, v82
    v_exp_f32 v83, v83
    v_exp_f32 v86, v86
    v_exp_f32 v87, v87
    v_pk_add_f32 v[80:81], v[80:81], 1.0 op_sel_hi:[1,0]
    v_pk_add_f32 v[84:85], v[84:85], 1.0 op_sel_hi:[1,0]
    v_pk_add_f32 v[82:83], v[82:83], 1.0 op_sel_hi:[1,0]
    v_rcp_f32 v80, v80
    v_rcp_f32 v81, v81
    v_pk_add_f32 v[86:87], v[86:87], 1.0 op_sel_hi:[1,0]
    v_rcp_f32 v84, v84
    v_rcp_f32 v85, v85
    v_rcp_f32 v82, v82
    v_rcp_f32 v83, v83
    v_rcp_f32 v86, v86
    v_rcp_f32 v87, v87
    v_pk_mul_f32 v[16:17], v[16:17], v[80:81]
    v_pk_mul_f32 v[20:21], v[20:21], v[84:85]
    v_pk_mul_f32 v[24:25], v[24:25], v[114:115] op_sel_hi:[1,0]
    v_pk_mul_f32 v[28:29], v[28:29], v[114:115] op_sel:[0,1] op_sel_hi:[1,1]
    v_pk_mul_f32 v[18:19], v[18:19], v[82:83]
    v_pk_mul_f32 v[22:23], v[22:23], v[86:87]
    v_pk_mul_f32 v[26:27], v[26:27], v[114:115] op_sel_hi:[1,0]
    v_pk_mul_f32 v[80:81], v[24:25], v[24:25]
    v_pk_mul_f32 v[30:31], v[30:31], v[114:115] op_sel:[0,1] op_sel_hi:[1,1]
    v_pk_mul_f32 v[84:85], v[28:29], v[28:29]
    v_pk_mul_f32 v[82:83], v[26:27], v[26:27]
    v_pk_fma_f32 v[80:81], v[80:81], s[64:65], v[88:89] op_sel_hi:[1,0,0]
    v_pk_mul_f32 v[86:87], v[30:31], v[30:31]
    v_pk_fma_f32 v[84:85], v[84:85], s[64:65], v[88:89] op_sel_hi:[1,0,0]
    v_pk_fma_f32 v[82:83], v[82:83], s[64:65], v[88:89] op_sel_hi:[1,0,0]
    v_pk_mul_f32 v[80:81], v[80:81], v[24:25]
    v_pk_fma_f32 v[86:87], v[86:87], s[64:65], v[88:89] op_sel_hi:[1,0,0]
    v_pk_mul_f32 v[84:85], v[84:85], v[28:29]
    v_pk_mul_f32 v[82:83], v[82:83], v[26:27]
    v_exp_f32 v80, v80
    v_exp_f32 v81, v81
    v_pk_mul_f32 v[86:87], v[86:87], v[30:31]
    v_exp_f32 v84, v84
    v_exp_f32 v85, v85
    v_exp_f32 v82, v82
    v_exp_f32 v83, v83
    v_exp_f32 v86, v86
    v_exp_f32 v87, v87
    v_pk_add_f32 v[80:81], v[80:81], 1.0 op_sel_hi:[1,0]
    v_pk_add_f32 v[84:85], v[84:85], 1.0 op_sel_hi:[1,0]
    v_pk_add_f32 v[82:83], v[82:83], 1.0 op_sel_hi:[1,0]
    v_rcp_f32 v80, v80
    v_rcp_f32 v81, v81
    v_pk_add_f32 v[86:87], v[86:87], 1.0 op_sel_hi:[1,0]
    v_rcp_f32 v84, v84
    v_rcp_f32 v85, v85
    v_rcp_f32 v82, v82
    v_rcp_f32 v83, v83
    v_rcp_f32 v86, v86
    v_rcp_f32 v87, v87
    v_pk_mul_f32 v[24:25], v[24:25], v[80:81]
    v_pk_mul_f32 v[28:29], v[28:29], v[84:85]
    v_pk_mul_f32 v[32:33], v[32:33], v[92:93] op_sel_hi:[1,0]
    v_pk_mul_f32 v[36:37], v[36:37], v[92:93] op_sel:[0,1] op_sel_hi:[1,1]
    v_pk_mul_f32 v[26:27], v[26:27], v[82:83]
    v_pk_mul_f32 v[30:31], v[30:31], v[86:87]
    s_mov_b32 s64, 0xbdd2d3e8
    v_mov_b32 v88, 0xc0135761
    v_pk_mul_f32 v[34:35], v[34:35], v[92:93] op_sel_hi:[1,0]
    v_pk_mul_f32 v[80:81], v[32:33], v[32:33]
    v_pk_mul_f32 v[38:39], v[38:39], v[92:93] op_sel:[0,1] op_sel_hi:[1,1]
    v_pk_mul_f32 v[84:85], v[36:37], v[36:37]
    v_pk_mul_f32 v[82:83], v[34:35], v[34:35]
    v_pk_fma_f32 v[80:81], v[80:81], s[64:65], v[88:89] op_sel_hi:[1,0,0]
    v_pk_mul_f32 v[86:87], v[38:39], v[38:39]
    v_pk_fma_f32 v[84:85], v[84:85], s[64:65], v[88:89] op_sel_hi:[1,0,0]
    v_pk_fma_f32 v[82:83], v[82:83], s[64:65], v[88:89] op_sel_hi:[1,0,0]
    v_pk_mul_f32 v[80:81], v[80:81], v[32:33]
    v_pk_fma_f32 v[86:87], v[86:87], s[64:65], v[88:89] op_sel_hi:[1,0,0]
    v_pk_mul_f32 v[84:85], v[84:85], v[36:37]
    v_pk_mul_f32 v[82:83], v[82:83], v[34:35]
    v_exp_f32 v80, v80
    v_exp_f32 v81, v81
    v_pk_mul_f32 v[86:87], v[86:87], v[38:39]
    v_exp_f32 v84, v84
    v_exp_f32 v85, v85
    v_exp_f32 v82, v82
    v_exp_f32 v83, v83
    v_exp_f32 v86, v86
    v_exp_f32 v87, v87
    v_pk_add_f32 v[80:81], v[80:81], 1.0 op_sel_hi:[1,0]
    v_pk_add_f32 v[84:85], v[84:85], 1.0 op_sel_hi:[1,0]
    v_pk_add_f32 v[82:83], v[82:83], 1.0 op_sel_hi:[1,0]
    v_rcp_f32 v80, v80
    v_rcp_f32 v81, v81
    v_pk_add_f32 v[86:87], v[86:87], 1.0 op_sel_hi:[1,0]
    v_rcp_f32 v84, v84
    v_rcp_f32 v85, v85
    v_rcp_f32 v82, v82
    v_rcp_f32 v83, v83
    v_rcp_f32 v86, v86
    v_rcp_f32 v87, v87
    v_pk_mul_f32 v[32:33], v[32:33], v[80:81]
    v_pk_mul_f32 v[36:37], v[36:37], v[84:85]
    v_pk_mul_f32 v[40:41], v[40:41], v[94:95] op_sel_hi:[1,0]
    v_pk_mul_f32 v[44:45], v[44:45], v[94:95] op_sel:[0,1] op_sel_hi:[1,1]
    v_pk_mul_f32 v[34:35], v[34:35], v[82:83]
    v_pk_mul_f32 v[38:39], v[38:39], v[86:87]
    v_pk_mul_f32 v[42:43], v[42:43], v[94:95] op_sel_hi:[1,0]
    v_pk_mul_f32 v[80:81], v[40:41], v[40:41]
    v_pk_mul_f32 v[46:47], v[46:47], v[94:95] op_sel:[0,1] op_sel_hi:[1,1]
    v_pk_mul_f32 v[84:85], v[44:45], v[44:45]
    v_pk_mul_f32 v[82:83], v[42:43], v[42:43]
    v_pk_fma_f32 v[80:81], v[80:81], s[64:65], v[88:89] op_sel_hi:[1,0,0]
    v_pk_mul_f32 v[86:87], v[46:47], v[46:47]
    v_pk_fma_f32 v[84:85], v[84:85], s[64:65], v[88:89] op_sel_hi:[1,0,0]
    v_pk_fma_f32 v[82:83], v[82:83], s[64:65], v[88:89] op_sel_hi:[1,0,0]
    v_pk_mul_f32 v[80:81], v[80:81], v[40:41]
    v_pk_fma_f32 v[86:87], v[86:87], s[64:65], v[88:89] op_sel_hi:[1,0,0]
    v_pk_mul_f32 v[84:85], v[84:85], v[44:45]
    v_pk_mul_f32 v[82:83], v[82:83], v[42:43]
    v_exp_f32 v80, v80
    v_exp_f32 v81, v81
    v_pk_mul_f32 v[86:87], v[86:87], v[46:47]
    v_exp_f32 v84, v84
    v_exp_f32 v85, v85
    v_exp_f32 v82, v82
    v_exp_f32 v83, v83
    v_exp_f32 v86, v86
    v_exp_f32 v87, v87
    v_pk_add_f32 v[80:81], v[80:81], 1.0 op_sel_hi:[1,0]
    v_pk_add_f32 v[84:85], v[84:85], 1.0 op_sel_hi:[1,0]
    v_pk_add_f32 v[82:83], v[82:83], 1.0 op_sel_hi:[1,0]
    v_rcp_f32 v80, v80
    v_rcp_f32 v81, v81
    v_pk_add_f32 v[86:87], v[86:87], 1.0 op_sel_hi:[1,0]
    v_rcp_f32 v84, v84
    v_rcp_f32 v85, v85
    v_rcp_f32 v82, v82
    v_rcp_f32 v83, v83
    v_rcp_f32 v86, v86
    v_rcp_f32 v87, v87
    v_pk_mul_f32 v[104:105], v[16:17], v[16:17]
    v_pk_mul_f32 v[106:107], v[20:21], v[20:21]
    v_pk_mul_f32 v[108:109], v[24:25], v[24:25]
    v_pk_mul_f32 v[110:111], v[28:29], v[28:29]
    v_pk_mul_f32 v[40:41], v[40:41], v[80:81]
    v_pk_mul_f32 v[44:45], v[44:45], v[84:85]
    v_pk_add_f32 v[96:97], v[16:17], v[18:19]
    v_pk_add_f32 v[98:99], v[20:21], v[22:23]
    v_pk_add_f32 v[100:101], v[24:25], v[26:27]
    v_pk_add_f32 v[102:103], v[28:29], v[30:31]
    v_pk_fma_f32 v[104:105], v[18:19], v[18:19], v[104:105]
    v_pk_fma_f32 v[106:107], v[22:23], v[22:23], v[106:107]
    v_pk_fma_f32 v[108:109], v[26:27], v[26:27], v[108:109]
    v_pk_fma_f32 v[110:111], v[30:31], v[30:31], v[110:111]
    v_pk_mul_f32 v[42:43], v[42:43], v[82:83]
    v_pk_mul_f32 v[46:47], v[46:47], v[86:87]
    v_pk_add_f32 v[96:97], v[96:97], v[32:33]
    v_pk_fma_f32 v[104:105], v[32:33], v[32:33], v[104:105]
    v_pk_add_f32 v[98:99], v[98:99], v[36:37]
    v_pk_fma_f32 v[106:107], v[36:37], v[36:37], v[106:107]
    v_pk_add_f32 v[100:101], v[100:101], v[40:41]
    v_pk_fma_f32 v[108:109], v[40:41], v[40:41], v[108:109]
    v_pk_add_f32 v[102:103], v[102:103], v[44:45]
    v_pk_fma_f32 v[110:111], v[44:45], v[44:45], v[110:111]
    v_pk_add_f32 v[96:97], v[96:97], v[34:35]
    v_pk_fma_f32 v[104:105], v[34:35], v[34:35], v[104:105]
    v_pk_add_f32 v[98:99], v[98:99], v[38:39]
    v_pk_fma_f32 v[106:107], v[38:39], v[38:39], v[106:107]
    v_pk_add_f32 v[100:101], v[100:101], v[42:43]
    v_pk_fma_f32 v[108:109], v[42:43], v[42:43], v[108:109]
    v_pk_add_f32 v[102:103], v[102:103], v[46:47]
    v_pk_fma_f32 v[110:111], v[46:47], v[46:47], v[110:111]
    v_add_f32 v96, v96, v97
    v_add_f32 v104, v104, v105
    v_add_f32 v98, v98, v99
    v_add_f32 v106, v106, v107
    v_add_f32 v100, v100, v101
    v_add_f32 v108, v108, v109
    v_add_f32 v102, v102, v103
    v_add_f32 v110, v110, v111
    v_permlane32_swap_b32 v96, v100
    v_permlane32_swap_b32 v98, v102
    v_permlane32_swap_b32 v104, v108
    v_permlane32_swap_b32 v106, v110
    v_add_f32 v96, v96, v100
    v_add_f32 v98, v98, v102
    v_add_f32 v104, v104, v108
    v_add_f32 v106, v106, v110
    v_permlane16_swap_b32 v96, v98
    s_lshl_b32 s50, s3, 9
    v_permlane16_swap_b32 v104, v106
    s_add_u32 s50, s50, 149504
    v_add_f32 v96, v96, v98
    v_add_f32 v97, v104, v106
    v_lshl_add_u32 v116, v1, 3, s50
    ds_write_b64 v116, v[96:97]
    s_waitcnt lgkmcnt(0)
    s_barrier
    s_cmp_eq_u32 s3, 3
    s_cbranch_scc1 L_w3_30
    ds_read_b128 v[80:83], v117 offset:0
    ds_read_b128 v[84:87], v117 offset:16384
    ds_read_b128 v[88:91], v117 offset:32768
    ds_read_b128 v[92:95], v117 offset:49152
    ds_read_b128 v[96:99], v117 offset:1024
    ds_read_b128 v[100:103], v117 offset:17408
    ds_read_b128 v[104:107], v117 offset:33792
    ds_read_b128 v[108:111], v117 offset:50176
    s_waitcnt vmcnt(33)
    s_waitcnt lgkmcnt(7)
    v_mfma_f32_16x16x32_bf16 v[48:51], v[128:131], v[80:83], 0
    s_waitcnt vmcnt(32)
    v_mfma_f32_16x16x32_bf16 v[64:67], v[132:135], v[80:83], 0
    s_waitcnt lgkmcnt(6)
    v_mfma_f32_16x16x32_bf16 v[52:55], v[128:131], v[84:87], 0
    ds_read_b128 v[80:83], v117 offset:2048
    v_mfma_f32_16x16x32_bf16 v[68:71], v[132:135], v[84:87], 0
    s_waitcnt lgkmcnt(6)
    v_mfma_f32_16x16x32_bf16 v[56:59], v[128:131], v[88:91], 0
    ds_read_b128 v[84:87], v117 offset:18432
    v_mfma_f32_16x16x32_bf16 v[72:75], v[132:135], v[88:91], 0
    s_waitcnt lgkmcnt(6)
    v_mfma_f32_16x16x32_bf16 v[60:63], v[128:131], v[92:95], 0
    ds_read_b128 v[88:91], v117 offset:34816
    v_mfma_f32_16x16x32_bf16 v[76:79], v[132:135], v[92:95], 0
    s_waitcnt vmcnt(31)
    s_waitcnt lgkmcnt(6)
    v_mfma_f32_16x16x32_bf16 v[48:51], v[136:139], v[96:99], v[48:51]
    ds_read_b128 v[92:95], v117 offset:51200
    s_waitcnt vmcnt(30)
    v_mfma_f32_16x16x32_bf16 v[64:67], v[140:143], v[96:99], v[64:67]
    s_waitcnt lgkmcnt(6)
    v_mfma_f32_16x16x32_bf16 v[52:55], v[136:139], v[100:103], v[52:55]
    ds_read_b128 v[96:99], v117 offset:3072
    v_mfma_f32_16x16x32_bf16 v[68:71], v[140:143], v[100:103], v[68:71]
    s_waitcnt lgkmcnt(6)
    v_mfma_f32_16x16x32_bf16 v[56:59], v[136:139], v[104:107], v[56:59]
    ds_read_b128 v[100:103], v117 offset:19456
    v_mfma_f32_16x16x32_bf16 v[72:75], v[140:143], v[104:107], v[72:75]
    s_waitcnt lgkmcnt(6)
    v_mfma_f32_16x16x32_bf16 v[60:63], v[136:139], v[108:111], v[60:63]
    ds_read_b128 v[104:107], v117 offset:35840
    v_mfma_f32_16x16x32_bf16 v[76:79], v[140:143], v[108:111], v[76:79]
    s_waitcnt vmcnt(29)
    s_waitcnt lgkmcnt(6)
    v_mfma_f32_16x16x32_bf16 v[48:51], v[144:147], v[80:83], v[48:51]
    ds_read_b128 v[108:111], v117 offset:52224
    s_waitcnt vmcnt(28)
    v_mfma_f32_16x16x32_bf16 v[64:67], v[148:151], v[80:83], v[64:67]
    s_waitcnt lgkmcnt(6)
    v_mfma_f32_16x16x32_bf16 v[52:55], v[144:147], v[84:87], v[52:55]
    ds_read_b128 v[80:83], v117 offset:4096
    v_mfma_f32_16x16x32_bf16 v[68:71], v[148:151], v[84:87], v[68:71]
    s_waitcnt lgkmcnt(6)
    v_mfma_f32_16x16x32_bf16 v[56:59], v[144:147], v[88:91], v[56:59]
    ds_read_b128 v[84:87], v117 offset:20480
    v_mfma_f32_16x16x32_bf16 v[72:75], v[148:151], v[88:91], v[72:75]
    s_waitcnt lgkmcnt(6)
    v_mfma_f32_16x16x32_bf16 v[60:63], v[144:147], v[92:95], v[60:63]
    ds_read_b128 v[88:91], v117 offset:36864
    v_mfma_f32_16x16x32_bf16 v[76:79], v[148:151], v[92:95], v[76:79]
    s_waitcnt vmcnt(27)
    s_waitcnt lgkmcnt(6)
    v_mfma_f32_16x16x32_bf16 v[48:51], v[152:155], v[96:99], v[48:51]
    ds_read_b128 v[92:95], v117 offset:53248
    s_waitcnt vmcnt(26)
    v_mfma_f32_16x16x32_bf16 v[64:67], v[156:159], v[96:99], v[64:67]
    s_waitcnt lgkmcnt(6)
    v_mfma_f32_16x16x32_bf16 v[52:55], v[152:155], v[100:103], v[52:55]
    ds_read_b128 v[96:99], v117 offset:5120
    v_mfma_f32_16x16x32_bf16 v[68:71], v[156:159], v[100:103], v[68:71]
    s_waitcnt lgkmcnt(6)
    v_mfma_f32_16x16x32_bf16 v[56:59], v[152:155], v[104:107], v[56:59]
    ds_read_b128 v[100:103], v117 offset:21504
    v_mfma_f32_16x16x32_bf16 v[72:75], v[156:159], v[104:107], v[72:75]
    s_waitcnt lgkmcnt(6)
    v_mfma_f32_16x16x32_bf16 v[60:63], v[152:155], v[108:111], v[60:63]
    ds_read_b128 v[104:107], v117 offset:37888
    v_mfma_f32_16x16x32_bf16 v[76:79], v[156:159], v[108:111], v[76:79]
    s_waitcnt vmcnt(25)
    s_waitcnt lgkmcnt(6)
    v_mfma_f32_16x16x32_bf16 v[48:51], v[160:163], v[80:83], v[48:51]
    ds_read_b128 v[108:111], v117 offset:54272
    s_waitcnt vmcnt(24)
    v_mfma_f32_16x16x32_bf16 v[64:67], v[164:167], v[80:83], v[64:67]
    s_waitcnt lgkmcnt(6)
    v_mfma_f32_16x16x32_bf16 v[52:55], v[160:163], v[84:87], v[52:55]
    ds_read_b128 v[80:83], v117 offset:6144
    v_mfma_f32_16x16x32_bf16 v[68:71], v[164:167], v[84:87], v[68:71]
    s_waitcnt lgkmcnt(6)
    v_mfma_f32_16x16x32_bf16 v[56:59], v[160:163], v[88:91], v[56:59]
    ds_read_b128 v[84:87], v117 offset:22528
    v_mfma_f32_16x16x32_bf16 v[72:75], v[164:167], v[88:91], v[72:75]
    s_waitcnt lgkmcnt(6)
    v_mfma_f32_16x16x32_bf16 v[60:63], v[160:163], v[92:95], v[60:63]
    ds_read_b128 v[88:91], v117 offset:38912
    v_mfma_f32_16x16x32_bf16 v[76:79], v[164:167], v[92:95], v[76:79]
    s_waitcnt vmcnt(23)
    s_waitcnt lgkmcnt(6)
    v_mfma_f32_16x16x32_bf16 v[48:51], v[168:171], v[96:99], v[48:51]
    ds_read_b128 v[92:95], v117 offset:55296
    s_waitcnt vmcnt(22)
    v_mfma_f32_16x16x32_bf16 v[64:67], v[172:175], v[96:99], v[64:67]
    s_waitcnt lgkmcnt(6)
    v_mfma_f32_16x16x32_bf16 v[52:55], v[168:171], v[100:103], v[52:55]
    ds_read_b128 v[96:99], v117 offset:7168
    v_mfma_f32_16x16x32_bf16 v[68:71], v[172:175], v[100:103], v[68:71]
    s_waitcnt lgkmcnt(6)
    v_mfma_f32_16x16x32_bf16 v[56:59], v[168:171], v[104:107], v[56:59]
    ds_read_b128 v[100:103], v117 offset:23552
    v_mfma_f32_16x16x32_bf16 v[72:75], v[172:175], v[104:107], v[72:75]
    s_waitcnt lgkmcnt(6)
    v_mfma_f32_16x16x32_bf16 v[60:63], v[168:171], v[108:111], v[60:63]
    ds_read_b128 v[104:107], v117 offset:39936
    v_mfma_f32_16x16x32_bf16 v[76:79], v[172:175], v[108:111], v[76:79]
    s_waitcnt vmcnt(21)
    s_waitcnt lgkmcnt(6)
    v_mfma_f32_16x16x32_bf16 v[48:51], v[176:179], v[80:83], v[48:51]
    ds_read_b128 v[108:111], v117 offset:56320
    s_waitcnt vmcnt(20)
    v_mfma_f32_16x16x32_bf16 v[64:67], v[180:183], v[80:83], v[64:67]
    s_waitcnt lgkmcnt(6)
    v_mfma_f32_16x16x32_bf16 v[52:55], v[176:179], v[84:87], v[52:55]
    ds_read_b128 v[80:83], v117 offset:8192
    v_mfma_f32_16x16x32_bf16 v[68:71], v[180:183], v[84:87], v[68:71]
    s_waitcnt lgkmcnt(6)
    v_mfma_f32_16x16x32_bf16 v[56:59], v[176:179], v[88:91], v[56:59]
    ds_read_b128 v[84:87], v117 offset:24576
    v_mfma_f32_16x16x32_bf16 v[72:75], v[180:183], v[88:91], v[72:75]
    s_waitcnt lgkmcnt(6)
    v_mfma_f32_16x16x32_bf16 v[60:63], v[176:179], v[92:95], v[60:63]
    ds_read_b128 v[88:91], v117 offset:40960
    v_mfma_f32_16x16x32_bf16 v[76:79], v[180:183], v[92:95], v[76:79]
    s_waitcnt vmcnt(19)
    s_waitcnt lgkmcnt(6)
    v_mfma_f32_16x16x32_bf16 v[48:51], v[184:187], v[96:99], v[48:51]
    ds_read_b128 v[92:95], v117 offset:57344
    s_waitcnt vmcnt(18)
    v_mfma_f32_16x16x32_bf16 v[64:67], v[188:191], v[96:99], v[64:67]
    s_waitcnt lgkmcnt(6)
    v_mfma_f32_16x16x32_bf16 v[52:55], v[184:187], v[100:103], v[52:55]
    ds_read_b128 v[96:99], v117 offset:9216
    v_mfma_f32_16x16x32_bf16 v[68:71], v[188:191], v[100:103], v[68:71]
    s_waitcnt lgkmcnt(6)
    v_mfma_f32_16x16x32_bf16 v[56:59], v[184:187], v[104:107], v[56:59]
    ds_read_b128 v[100:103], v117 offset:25600
    v_mfma_f32_16x16x32_bf16 v[72:75], v[188:191], v[104:107], v[72:75]
    s_waitcnt lgkmcnt(6)
    v_mfma_f32_16x16x32_bf16 v[60:63], v[184:187], v[108:111], v[60:63]
    ds_read_b128 v[104:107], v117 offset:41984
    v_mfma_f32_16x16x32_bf16 v[76:79], v[188:191], v[108:111], v[76:79]
    s_waitcnt vmcnt(17)
    s_waitcnt lgkmcnt(6)
    v_mfma_f32_16x16x32_bf16 v[48:51], v[192:195], v[80:83], v[48:51]
    ds_read_b128 v[108:111], v117 offset:58368
    s_waitcnt vmcnt(16)
    v_mfma_f32_16x16x32_bf16 v[64:67], v[196:199], v[80:83], v[64:67]
    s_waitcnt lgkmcnt(6)
    v_mfma_f32_16x16x32_bf16 v[52:55], v[192:195], v[84:87], v[52:55]
    ds_read_b128 v[80:83], v117 offset:10240
    v_mfma_f32_16x16x32_bf16 v[68:71], v[196:199], v[84:87], v[68:71]
    s_waitcnt lgkmcnt(6)
    v_mfma_f32_16x16x32_bf16 v[56:59], v[192:195], v[88:91], v[56:59]
    ds_read_b128 v[84:87], v117 offset:26624
    v_mfma_f32_16x16x32_bf16 v[72:75], v[196:199], v[88:91], v[72:75]
    s_waitcnt lgkmcnt(6)
    v_mfma_f32_16x16x32_bf16 v[60:63], v[192:195], v[92:95], v[60:63]
    ds_read_b128 v[88:91], v117 offset:43008
    v_mfma_f32_16x16x32_bf16 v[76:79], v[196:199], v[92:95], v[76:79]
    s_waitcnt vmcnt(15)
    s_waitcnt lgkmcnt(6)
    v_mfma_f32_16x16x32_bf16 v[48:51], v[200:203], v[96:99], v[48:51]
    ds_read_b128 v[92:95], v117 offset:59392
    s_waitcnt vmcnt(14)
    v_mfma_f32_16x16x32_bf16 v[64:67], v[204:207], v[96:99], v[64:67]
    s_waitcnt lgkmcnt(6)
    v_mfma_f32_16x16x32_bf16 v[52:55], v[200:203], v[100:103], v[52:55]
    ds_read_b128 v[96:99], v117 offset:11264
    v_mfma_f32_16x16x32_bf16 v[68:71], v[204:207], v[100:103], v[68:71]
    s_waitcnt lgkmcnt(6)
    v_mfma_f32_16x16x32_bf16 v[56:59], v[200:203], v[104:107], v[56:59]
    ds_read_b128 v[100:103], v117 offset:27648
    v_mfma_f32_16x16x32_bf16 v[72:75], v[204:207], v[104:107], v[72:75]
    s_waitcnt lgkmcnt(6)
    v_mfma_f32_16x16x32_bf16 v[60:63], v[200:203], v[108:111], v[60:63]
    ds_read_b128 v[104:107], v117 offset:44032
    v_mfma_f32_16x16x32_bf16 v[76:79], v[204:207], v[108:111], v[76:79]
    s_waitcnt vmcnt(13)
    s_waitcnt lgkmcnt(6)
    v_mfma_f32_16x16x32_bf16 v[48:51], v[208:211], v[80:83], v[48:51]
    ds_read_b128 v[108:111], v117 offset:60416
    s_waitcnt vmcnt(12)
    v_mfma_f32_16x16x32_bf16 v[64:67], v[212:215], v[80:83], v[64:67]
    s_waitcnt lgkmcnt(6)
    v_mfma_f32_16x16x32_bf16 v[52:55], v[208:211], v[84:87], v[52:55]
    ds_read_b128 v[80:83], v117 offset:12288
    v_mfma_f32_16x16x32_bf16 v[68:71], v[212:215], v[84:87], v[68:71]
    s_waitcnt lgkmcnt(6)
    v_mfma_f32_16x16x32_bf16 v[56:59], v[208:211], v[88:91], v[56:59]
    ds_read_b128 v[84:87], v117 offset:28672
    v_mfma_f32_16x16x32_bf16 v[72:75], v[212:215], v[88:91], v[72:75]
    s_waitcnt lgkmcnt(6)
    v_mfma_f32_16x16x32_bf16 v[60:63], v[208:211], v[92:95], v[60:63]
    ds_read_b128 v[88:91], v117 offset:45056
    v_mfma_f32_16x16x32_bf16 v[76:79], v[212:215], v[92:95], v[76:79]
    s_waitcnt vmcnt(11)
    s_waitcnt lgkmcnt(6)
    v_mfma_f32_16x16x32_bf16 v[48:51], v[216:219], v[96:99], v[48:51]
    ds_read_b128 v[92:95], v117 offset:61440
    s_waitcnt vmcnt(10)
    v_mfma_f32_16x16x32_bf16 v[64:67], v[220:223], v[96:99], v[64:67]
    s_waitcnt lgkmcnt(6)
    v_mfma_f32_16x16x32_bf16 v[52:55], v[216:219], v[100:103], v[52:55]
    ds_read_b128 v[96:99], v117 offset:13312
    v_mfma_f32_16x16x32_bf16 v[68:71], v[220:223], v[100:103], v[68:71]
    s_waitcnt lgkmcnt(6)
    v_mfma_f32_16x16x32_bf16 v[56:59], v[216:219], v[104:107], v[56:59]
    ds_read_b128 v[100:103], v117 offset:29696
    v_mfma_f32_16x16x32_bf16 v[72:75], v[220:223], v[104:107], v[72:75]
    s_waitcnt lgkmcnt(6)
    v_mfma_f32_16x16x32_bf16 v[60:63], v[216:219], v[108:111], v[60:63]
    ds_read_b128 v[104:107], v117 offset:46080
    v_mfma_f32_16x16x32_bf16 v[76:79], v[220:223], v[108:111], v[76:79]
    s_waitcnt vmcnt(9)
    s_waitcnt lgkmcnt(6)
    v_mfma_f32_16x16x32_bf16 v[48:51], v[224:227], v[80:83], v[48:51]
    ds_read_b128 v[108:111], v117 offset:62464
    s_waitcnt vmcnt(8)
    v_mfma_f32_16x16x32_bf16 v[64:67], v[228:231], v[80:83], v[64:67]
    s_waitcnt lgkmcnt(6)
    v_mfma_f32_16x16x32_bf16 v[52:55], v[224:227], v[84:87], v[52:55]
    ds_read_b128 v[80:83], v117 offset:14336
    v_mfma_f32_16x16x32_bf16 v[68:71], v[228:231], v[84:87], v[68:71]
    s_waitcnt lgkmcnt(6)
    v_mfma_f32_16x16x32_bf16 v[56:59], v[224:227], v[88:91], v[56:59]
    ds_read_b128 v[84:87], v117 offset:30720
    v_mfma_f32_16x16x32_bf16 v[72:75], v[228:231], v[88:91], v[72:75]
    s_waitcnt lgkmcnt(6)
    v_mfma_f32_16x16x32_bf16 v[60:63], v[224:227], v[92:95], v[60:63]
    ds_read_b128 v[88:91], v117 offset:47104
    v_mfma_f32_16x16x32_bf16 v[76:79], v[228:231], v[92:95], v[76:79]
    s_waitcnt vmcnt(7)
    s_waitcnt lgkmcnt(6)
    v_mfma_f32_16x16x32_bf16 v[48:51], v[232:235], v[96:99], v[48:51]
    ds_read_b128 v[92:95], v117 offset:63488
    s_waitcnt vmcnt(6)
    v_mfma_f32_16x16x32_bf16 v[64:67], v[236:239], v[96:99], v[64:67]
    s_waitcnt lgkmcnt(6)
    v_mfma_f32_16x16x32_bf16 v[52:55], v[232:235], v[100:103], v[52:55]
    ds_read_b128 v[96:99], v117 offset:15360
    v_mfma_f32_16x16x32_bf16 v[68:71], v[236:239], v[100:103], v[68:71]
    s_waitcnt lgkmcnt(6)
    v_mfma_f32_16x16x32_bf16 v[56:59], v[232:235], v[104:107], v[56:59]
    ds_read_b128 v[100:103], v117 offset:31744
    v_mfma_f32_16x16x32_bf16 v[72:75], v[236:239], v[104:107], v[72:75]
    s_waitcnt lgkmcnt(6)
    v_mfma_f32_16x16x32_bf16 v[60:63], v[232:235], v[108:111], v[60:63]
    ds_read_b128 v[104:107], v117 offset:48128
    v_mfma_f32_16x16x32_bf16 v[76:79], v[236:239], v[108:111], v[76:79]
    s_waitcnt vmcnt(5)
    s_waitcnt lgkmcnt(6)
    v_mfma_f32_16x16x32_bf16 v[48:51], v[240:243], v[80:83], v[48:51]
    ds_read_b128 v[108:111], v117 offset:64512
    s_waitcnt lgkmcnt(6)
    v_mfma_f32_16x16x32_bf16 v[52:55], v[240:243], v[84:87], v[52:55]
    s_waitcnt lgkmcnt(5)
    v_mfma_f32_16x16x32_bf16 v[56:59], v[240:243], v[88:91], v[56:59]
    s_waitcnt lgkmcnt(4)
    v_mfma_f32_16x16x32_bf16 v[60:63], v[240:243], v[92:95], v[60:63]
    s_waitcnt vmcnt(4)
    v_mfma_f32_16x16x32_bf16 v[64:67], v[244:247], v[80:83], v[64:67]
    v_mfma_f32_16x16x32_bf16 v[68:71], v[244:247], v[84:87], v[68:71]
    v_mfma_f32_16x16x32_bf16 v[72:75], v[244:247], v[88:91], v[72:75]
    v_mfma_f32_16x16x32_bf16 v[76:79], v[244:247], v[92:95], v[76:79]
    s_waitcnt vmcnt(3)
    s_waitcnt lgkmcnt(3)
    v_mfma_f32_16x16x32_bf16 v[48:51], v[248:251], v[96:99], v[48:51]
    s_waitcnt lgkmcnt(2)
    v_mfma_f32_16x16x32_bf16 v[52:55], v[248:251], v[100:103], v[52:55]
    s_waitcnt lgkmcnt(1)
    v_mfma_f32_16x16x32_bf16 v[56:59], v[248:251], v[104:107], v[56:59]
    s_waitcnt lgkmcnt(0)
    v_mfma_f32_16x16x32_bf16 v[60:63], v[248:251], v[108:111], v[60:63]
    s_waitcnt vmcnt(2)
    v_mfma_f32_16x16x32_bf16 v[64:67], v[252:255], v[96:99], v[64:67]
    v_mfma_f32_16x16x32_bf16 v[68:71], v[252:255], v[100:103], v[68:71]
    v_mfma_f32_16x16x32_bf16 v[72:75], v[252:255], v[104:107], v[72:75]
    v_mfma_f32_16x16x32_bf16 v[76:79], v[252:255], v[108:111], v[76:79]
    s_branch L_join_31
    s_nop 11
L_w3_30:
    v_lshlrev_b32 v82, 3, v1
    v_add_u32 v83, 149504, v82
    ds_read_b64 v[84:85], v83 offset:0
    ds_read_b64 v[86:87], v83 offset:512
    ds_read_b64 v[88:89], v83 offset:1024
    ds_read_b64 v[90:91], v83 offset:1536
    s_lshl_b32 s52, s45, 13
    s_add_u32 s52, s52, 12582912
    s_lshl_b32 s53, s46, 10
    s_add_u32 s53, s53, s52
    s_add_u32 s54, s52, 4096
    s_waitcnt lgkmcnt(2)
    v_pk_add_f32 v[84:85], v[84:85], v[86:87]
    s_waitcnt lgkmcnt(0)
    v_pk_add_f32 v[88:89], v[88:89], v[90:91]
    v_mov_b32 v86, s44
    v_mov_b32 v87, s44
    v_pk_add_f32 v[84:85], v[84:85], v[88:89]
    buffer_store_dwordx4 v[84:87], v4, s[40:43], s53 offen sc1
    v_mov_b32 v64, 0
    v_mov_b32 v65, 0
    v_mov_b32 v66, 0
    v_mov_b32 v67, 0
    v_mov_b32 v68, 0
    v_mov_b32 v69, 0
    v_mov_b32 v70, 0
    v_mov_b32 v71, 0
    v_mov_b32 v72, 0
    v_mov_b32 v73, 0
    v_mov_b32 v74, 0
    v_mov_b32 v75, 0
    v_mov_b32 v76, 0
    v_mov_b32 v77, 0
    v_mov_b32 v78, 0
    v_mov_b32 v79, 0
    s_lshl_b32 s58, s45, 18
    s_add_u32 s58, s58, 16384
    s_add_u32 s57, s97, 1
    s_and_b32 s57, s57, 3
    s_lshl_b32 s57, s57, 10
    s_add_u32 s57, s57, s58
    s_mov_b32 m0, 0
    v_xor_b32 v83, 0, v4
    s_add_u32 s59, s57, 0
    buffer_load_dwordx4 v83, s[24:27], s59 offen nt lds
    s_mov_b32 m0, 1024
    v_xor_b32 v83, 16, v4
    s_add_u32 s59, s57, 4096
    buffer_load_dwordx4 v83, s[24:27], s59 offen nt lds
    s_mov_b32 m0, 2048
    v_xor_b32 v83, 32, v4
    s_add_u32 s59, s57, 8192
    buffer_load_dwordx4 v83, s[24:27], s59 offen nt lds
    s_mov_b32 m0, 3072
    v_xor_b32 v83, 48, v4
    s_add_u32 s59, s57, 12288
    buffer_load_dwordx4 v83, s[24:27], s59 offen nt lds
    s_mov_b32 m0, 4096
    v_xor_b32 v83, 64, v4
    s_add_u32 s59, s57, 32768
    buffer_load_dwordx4 v83, s[24:27], s59 offen nt lds
    s_mov_b32 m0, 5120
    v_xor_b32 v83, 80, v4
    s_add_u32 s59, s57, 36864
    buffer_load_dwordx4 v83, s[24:27], s59 offen nt lds
    s_mov_b32 m0, 6144
    v_xor_b32 v83, 96, v4
    s_add_u32 s59, s57, 40960
    buffer_load_dwordx4 v83, s[24:27], s59 offen nt lds
    s_mov_b32 m0, 7168
    v_xor_b32 v83, 112, v4
    s_add_u32 s59, s57, 45056
    buffer_load_dwordx4 v83, s[24:27], s59 offen nt lds
    s_mov_b32 m0, 8192
    v_xor_b32 v83, 128, v4
    s_add_u32 s59, s57, 65536
    buffer_load_dwordx4 v83, s[24:27], s59 offen nt lds
    s_mov_b32 m0, 9216
    v_xor_b32 v83, 144, v4
    s_add_u32 s59, s57, 69632
    buffer_load_dwordx4 v83, s[24:27], s59 offen nt lds
    s_mov_b32 m0, 10240
    v_xor_b32 v83, 160, v4
    s_add_u32 s59, s57, 73728
    buffer_load_dwordx4 v83, s[24:27], s59 offen nt lds
    s_mov_b32 m0, 11264
    v_xor_b32 v83, 176, v4
    s_add_u32 s59, s57, 77824
    buffer_load_dwordx4 v83, s[24:27], s59 offen nt lds
    s_mov_b32 m0, 12288
    v_xor_b32 v83, 192, v4
    s_add_u32 s59, s57, 98304
    buffer_load_dwordx4 v83, s[24:27], s59 offen nt lds
    s_mov_b32 m0, 13312
    v_xor_b32 v83, 208, v4
    s_add_u32 s59, s57, 102400
    buffer_load_dwordx4 v83, s[24:27], s59 offen nt lds
    s_mov_b32 m0, 14336
    v_xor_b32 v83, 224, v4
    s_add_u32 s59, s57, 106496
    buffer_load_dwordx4 v83, s[24:27], s59 offen nt lds
    s_mov_b32 m0, 15360
    v_xor_b32 v83, 240, v4
    s_add_u32 s59, s57, 110592
    buffer_load_dwordx4 v83, s[24:27], s59 offen nt lds
    s_add_u32 s57, s97, 2
    s_and_b32 s57, s57, 3
    s_lshl_b32 s57, s57, 10
    s_add_u32 s57, s57, s58
    s_mov_b32 m0, 16640
    v_xor_b32 v83, 0, v4
    s_add_u32 s59, s57, 0
    buffer_load_dwordx4 v83, s[24:27], s59 offen nt lds
    s_mov_b32 m0, 17664
    v_xor_b32 v83, 16, v4
    s_add_u32 s59, s57, 4096
    buffer_load_dwordx4 v83, s[24:27], s59 offen nt lds
    s_mov_b32 m0, 18688
    v_xor_b32 v83, 32, v4
    s_add_u32 s59, s57, 8192
    buffer_load_dwordx4 v83, s[24:27], s59 offen nt lds
    s_mov_b32 m0, 19712
    v_xor_b32 v83, 48, v4
    s_add_u32 s59, s57, 12288
    buffer_load_dwordx4 v83, s[24:27], s59 offen nt lds
    s_mov_b32 m0, 20736
    v_xor_b32 v83, 64, v4
    s_add_u32 s59, s57, 32768
    buffer_load_dwordx4 v83, s[24:27], s59 offen nt lds
    s_mov_b32 m0, 21760
    v_xor_b32 v83, 80, v4
    s_add_u32 s59, s57, 36864
    buffer_load_dwordx4 v83, s[24:27], s59 offen nt lds
    s_mov_b32 m0, 22784
    v_xor_b32 v83, 96, v4
    s_add_u32 s59, s57, 40960
    buffer_load_dwordx4 v83, s[24:27], s59 offen nt lds
    s_mov_b32 m0, 23808
    v_xor_b32 v83, 112, v4
    s_add_u32 s59, s57, 45056
    buffer_load_dwordx4 v83, s[24:27], s59 offen nt lds
    s_mov_b32 m0, 24832
    v_xor_b32 v83, 128, v4
    s_add_u32 s59, s57, 65536
    buffer_load_dwordx4 v83, s[24:27], s59 offen nt lds
    s_mov_b32 m0, 25856
    v_xor_b32 v83, 144, v4
    s_add_u32 s59, s57, 69632
    buffer_load_dwordx4 v83, s[24:27], s59 offen nt lds
    s_mov_b32 m0, 26880
    v_xor_b32 v83, 160, v4
    s_add_u32 s59, s57, 73728
    buffer_load_dwordx4 v83, s[24:27], s59 offen nt lds
    s_mov_b32 m0, 27904
    v_xor_b32 v83, 176, v4
    s_add_u32 s59, s57, 77824
    buffer_load_dwordx4 v83, s[24:27], s59 offen nt lds
    s_mov_b32 m0, 28928
    v_xor_b32 v83, 192, v4
    s_add_u32 s59, s57, 98304
    buffer_load_dwordx4 v83, s[24:27], s59 offen nt lds
    s_mov_b32 m0, 29952
    v_xor_b32 v83, 208, v4
    s_add_u32 s59, s57, 102400
    buffer_load_dwordx4 v83, s[24:27], s59 offen nt lds
    s_mov_b32 m0, 30976
    v_xor_b32 v83, 224, v4
    s_add_u32 s59, s57, 106496
    buffer_load_dwordx4 v83, s[24:27], s59 offen nt lds
    s_mov_b32 m0, 32000
    v_xor_b32 v83, 240, v4
    s_add_u32 s59, s57, 110592
    buffer_load_dwordx4 v83, s[24:27], s59 offen nt lds
    s_add_u32 s57, s97, 3
    s_and_b32 s57, s57, 3
    s_lshl_b32 s57, s57, 10
    s_add_u32 s57, s57, s58
    s_mov_b32 m0, 33280
    v_xor_b32 v83, 0, v4
    s_add_u32 s59, s57, 0
    buffer_load_dwordx4 v83, s[24:27], s59 offen nt lds
    s_mov_b32 m0, 34304
    v_xor_b32 v83, 16, v4
    s_add_u32 s59, s57, 4096
    buffer_load_dwordx4 v83, s[24:27], s59 offen nt lds
    s_mov_b32 m0, 35328
    v_xor_b32 v83, 32, v4
    s_add_u32 s59, s57, 8192
    buffer_load_dwordx4 v83, s[24:27], s59 offen nt lds
    s_mov_b32 m0, 36352
    v_xor_b32 v83, 48, v4
    s_add_u32 s59, s57, 12288
    buffer_load_dwordx4 v83, s[24:27], s59 offen nt lds
    s_mov_b32 m0, 37376
    v_xor_b32 v83, 64, v4
    s_add_u32 s59, s57, 32768
    buffer_load_dwordx4 v83, s[24:27], s59 offen nt lds
    s_mov_b32 m0, 38400
    v_xor_b32 v83, 80, v4
    s_add_u32 s59, s57, 36864
    buffer_load_dwordx4 v83, s[24:27], s59 offen nt lds
    s_mov_b32 m0, 39424
    v_xor_b32 v83, 96, v4
    s_add_u32 s59, s57, 40960
    buffer_load_dwordx4 v83, s[24:27], s59 offen nt lds
    s_mov_b32 m0, 40448
    v_xor_b32 v83, 112, v4
    s_add_u32 s59, s57, 45056
    buffer_load_dwordx4 v83, s[24:27], s59 offen nt lds
    s_mov_b32 m0, 41472
    v_xor_b32 v83, 128, v4
    s_add_u32 s59, s57, 65536
    buffer_load_dwordx4 v83, s[24:27], s59 offen nt lds
    s_mov_b32 m0, 42496
    v_xor_b32 v83, 144, v4
    s_add_u32 s59, s57, 69632
    buffer_load_dwordx4 v83, s[24:27], s59 offen nt lds
    s_mov_b32 m0, 43520
    v_xor_b32 v83, 160, v4
    s_add_u32 s59, s57, 73728
    buffer_load_dwordx4 v83, s[24:27], s59 offen nt lds
    s_mov_b32 m0, 44544
    v_xor_b32 v83, 176, v4
    s_add_u32 s59, s57, 77824
    buffer_load_dwordx4 v83, s[24:27], s59 offen nt lds
    s_mov_b32 m0, 45568
    v_xor_b32 v83, 192, v4
    s_add_u32 s59, s57, 98304
    buffer_load_dwordx4 v83, s[24:27], s59 offen nt lds
    s_mov_b32 m0, 46592
    v_xor_b32 v83, 208, v4
    s_add_u32 s59, s57, 102400
    buffer_load_dwordx4 v83, s[24:27], s59 offen nt lds
    s_mov_b32 m0, 47616
    v_xor_b32 v83, 224, v4
    s_add_u32 s59, s57, 106496
    buffer_load_dwordx4 v83, s[24:27], s59 offen nt lds
    s_mov_b32 m0, 48640
    v_xor_b32 v83, 240, v4
    s_add_u32 s59, s57, 110592
    buffer_load_dwordx4 v83, s[24:27], s59 offen nt lds
    s_add_u32 s57, s97, 4
    s_and_b32 s57, s57, 3
    s_lshl_b32 s57, s57, 10
    s_add_u32 s57, s57, s58
    s_mov_b32 m0, 49920
    v_xor_b32 v83, 0, v4
    s_add_u32 s59, s57, 0
    buffer_load_dwordx4 v83, s[24:27], s59 offen nt lds
    s_mov_b32 m0, 50944
    v_xor_b32 v83, 16, v4
    s_add_u32 s59, s57, 4096
    buffer_load_dwordx4 v83, s[24:27], s59 offen nt lds
    s_mov_b32 m0, 51968
    v_xor_b32 v83, 32, v4
    s_add_u32 s59, s57, 8192
    buffer_load_dwordx4 v83, s[24:27], s59 offen nt lds
    s_mov_b32 m0, 52992
    v_xor_b32 v83, 48, v4
    s_add_u32 s59, s57, 12288
    buffer_load_dwordx4 v83, s[24:27], s59 offen nt lds
    s_mov_b32 m0, 54016
    v_xor_b32 v83, 64, v4
    s_add_u32 s59, s57, 32768
    buffer_load_dwordx4 v83, s[24:27], s59 offen nt lds
    s_mov_b32 m0, 55040
    v_xor_b32 v83, 80, v4
    s_add_u32 s59, s57, 36864
    buffer_load_dwordx4 v83, s[24:27], s59 offen nt lds
    s_mov_b32 m0, 56064
    v_xor_b32 v83, 96, v4
    s_add_u32 s59, s57, 40960
    buffer_load_dwordx4 v83, s[24:27], s59 offen nt lds
    s_mov_b32 m0, 57088
    v_xor_b32 v83, 112, v4
    s_add_u32 s59, s57, 45056
    buffer_load_dwordx4 v83, s[24:27], s59 offen nt lds
    s_mov_b32 m0, 58112
    v_xor_b32 v83, 128, v4
    s_add_u32 s59, s57, 65536
    buffer_load_dwordx4 v83, s[24:27], s59 offen nt lds
    s_mov_b32 m0, 59136
    v_xor_b32 v83, 144, v4
    s_add_u32 s59, s57, 69632
    buffer_load_dwordx4 v83, s[24:27], s59 offen nt lds
    s_mov_b32 m0, 60160
    v_xor_b32 v83, 160, v4
    s_add_u32 s59, s57, 73728
    buffer_load_dwordx4 v83, s[24:27], s59 offen nt lds
    s_mov_b32 m0, 61184
    v_xor_b32 v83, 176, v4
    s_add_u32 s59, s57, 77824
    buffer_load_dwordx4 v83, s[24:27], s59 offen nt lds
    s_mov_b32 m0, 62208
    v_xor_b32 v83, 192, v4
    s_add_u32 s59, s57, 98304
    buffer_load_dwordx4 v83, s[24:27], s59 offen nt lds
    s_mov_b32 m0, 63232
    v_xor_b32 v83, 208, v4
    s_add_u32 s59, s57, 102400
    buffer_load_dwordx4 v83, s[24:27], s59 offen nt lds
    s_mov_b32 m0, 64256
    v_xor_b32 v83, 224, v4
    s_add_u32 s59, s57, 106496
    buffer_load_dwordx4 v83, s[24:27], s59 offen nt lds
    s_mov_b32 m0, 65280
    v_xor_b32 v83, 240, v4
    s_add_u32 s59, s57, 110592
    buffer_load_dwordx4 v83, s[24:27], s59 offen nt lds
L_sttry_32:
    buffer_load_dwordx4 v[80:83], v4, s[40:43], s52 offen offset:0 sc1
    buffer_load_dwordx4 v[84:87], v4, s[40:43], s52 offen offset:1024 sc1
    buffer_load_dwordx4 v[88:91], v4, s[40:43], s52 offen offset:2048 sc1
    buffer_load_dwordx4 v[92:95], v4, s[40:43], s52 offen offset:3072 sc1
    buffer_load_dwordx4 v[96:99], v4, s[40:43], s54 offen offset:0 sc1
    buffer_load_dwordx4 v[100:103], v4, s[40:43], s54 offen offset:1024 sc1
    buffer_load_dwordx4 v[104:107], v4, s[40:43], s54 offen offset:2048 sc1
    buffer_load_dwordx4 v[108:111], v4, s[40:43], s54 offen offset:3072 sc1
    s_waitcnt vmcnt(7)
    v_xor_b32 v7, s44, v82
    s_waitcnt vmcnt(6)
    v_bitop3_b32 v7, v7, v86, s44 bitop3:0xf6
    s_waitcnt vmcnt(5)
    v_bitop3_b32 v7, v7, v90, s44 bitop3:0xf6
    s_waitcnt vmcnt(4)
    v_bitop3_b32 v7, v7, v94, s44 bitop3:0xf6
    s_waitcnt vmcnt(3)
    v_bitop3_b32 v7, v7, v98, s44 bitop3:0xf6
    s_waitcnt vmcnt(2)
    v_bitop3_b32 v7, v7, v102, s44 bitop3:0xf6
    s_waitcnt vmcnt(1)
    v_bitop3_b32 v7, v7, v106, s44 bitop3:0xf6
    s_waitcnt vmcnt(0)
    v_bitop3_b32 v7, v7, v110, s44 bitop3:0xf6
    v_cmp_ne_u32 vcc, 0, v7
    s_nop 1
    s_cmp_lg_u64 vcc, 0
    s_cbranch_scc1 L_stfail_33
L_stok_34:
    v_pk_add_f32 v[80:81], v[80:81], v[84:85]
    v_pk_add_f32 v[88:89], v[88:89], v[92:93]
    v_pk_add_f32 v[96:97], v[96:97], v[100:101]
    v_pk_add_f32 v[104:105], v[104:105], v[108:109]
    v_pk_add_f32 v[80:81], v[80:81], v[88:89]
    v_pk_add_f32 v[96:97], v[96:97], v[104:105]
    v_pk_add_f32 v[84:85], v[80:81], v[96:97]
    v_mul_f32 v84, 0x3a924925, v84
    v_mul_f32 v86, v84, v84
    s_mov_b32 s56, 0x3a924925
    v_fma_f32 v85, v85, s56, -v86
    v_max_f32 v85, 0, v85
    v_add_f32 v85, 0x3727c5ac, v85
    v_rsq_f32 v86, v85
    v_lshlrev_b32 v83, 3, v1
    v_mul_f32 v87, v84, v86
    v_add_u32 v83, 162048, v83
    ds_write_b64 v83, v[86:87]
    s_waitcnt lgkmcnt(0)
L_join_31:
    s_nop 11
    s_barrier
    s_lshl_b32 s59, s97, 10
    s_lshl_b32 s58, s45, 6
    s_add_u32 s58, s58, 36
    s_lshl_b32 s58, s58, 12
    s_add_u32 s58, s58, s59
    ds_read_b64 v[84:85], v6 offset:0
    ds_read_b64 v[86:87], v6 offset:128
    ds_read_b64 v[88:89], v6 offset:256
    ds_read_b64 v[90:91], v6 offset:384
    v_mov_b32 v93, s44
    v_and_b32 v95, 32, v1
    s_waitcnt lgkmcnt(3)
    v_pk_fma_f32 v[16:17], v[16:17], v[84:85], v[84:85] op_sel:[0,0,1] op_sel_hi:[1,0,1] neg_lo:[0,0,1] neg_hi:[0,0,1]
    v_pk_fma_f32 v[18:19], v[18:19], v[84:85], v[84:85] op_sel:[0,0,1] op_sel_hi:[1,0,1] neg_lo:[0,0,1] neg_hi:[0,0,1]
    v_cvt_pk_bf16_f32 v16, v16, v17
    s_waitcnt lgkmcnt(2)
    v_pk_fma_f32 v[20:21], v[20:21], v[86:87], v[86:87] op_sel:[0,0,1] op_sel_hi:[1,0,1] neg_lo:[0,0,1] neg_hi:[0,0,1]
    v_cvt_pk_bf16_f32 v17, v18, v19
    v_pk_fma_f32 v[22:23], v[22:23], v[86:87], v[86:87] op_sel:[0,0,1] op_sel_hi:[1,0,1] neg_lo:[0,0,1] neg_hi:[0,0,1]
    v_cvt_pk_bf16_f32 v20, v20, v21
    ds_write_b64 v118, v[16:17] offset:0
    v_cvt_pk_bf16_f32 v21, v22, v23
    s_waitcnt lgkmcnt(2)
    v_pk_fma_f32 v[24:25], v[24:25], v[88:89], v[88:89] op_sel:[0,0,1] op_sel_hi:[1,0,1] neg_lo:[0,0,1] neg_hi:[0,0,1]
    ds_write_b64 v118, v[20:21] offset:128
    ds_read_b64_tr_b16 v[96:97], v119 offset:0
    ds_read_b64_tr_b16 v[98:99], v119 offset:128
    v_pk_fma_f32 v[26:27], v[26:27], v[88:89], v[88:89] op_sel:[0,0,1] op_sel_hi:[1,0,1] neg_lo:[0,0,1] neg_hi:[0,0,1]
    v_cvt_pk_bf16_f32 v24, v24, v25
    s_waitcnt lgkmcnt(4)
    v_pk_fma_f32 v[28:29], v[28:29], v[90:91], v[90:91] op_sel:[0,0,1] op_sel_hi:[1,0,1] neg_lo:[0,0,1] neg_hi:[0,0,1]
    v_cvt_pk_bf16_f32 v25, v26, v27
    v_pk_fma_f32 v[30:31], v[30:31], v[90:91], v[90:91] op_sel:[0,0,1] op_sel_hi:[1,0,1] neg_lo:[0,0,1] neg_hi:[0,0,1]
    v_cvt_pk_bf16_f32 v28, v28, v29
    ds_write_b64 v118, v[24:25] offset:1024
    v_cvt_pk_bf16_f32 v29, v30, v31
    v_pk_fma_f32 v[32:33], v[32:33], v[84:85], v[84:85] op_sel:[0,0,1] op_sel_hi:[1,0,1] neg_lo:[0,0,1] neg_hi:[0,0,1]
    ds_write_b64 v118, v[28:29] offset:1152
    ds_read_b64_tr_b16 v[100:101], v119 offset:1024
    ds_read_b64_tr_b16 v[102:103], v119 offset:1152
    v_pk_fma_f32 v[34:35], v[34:35], v[84:85], v[84:85] op_sel:[0,0,1] op_sel_hi:[1,0,1] neg_lo:[0,0,1] neg_hi:[0,0,1]
    v_cvt_pk_bf16_f32 v32, v32, v33
    v_pk_fma_f32 v[36:37], v[36:37], v[86:87], v[86:87] op_sel:[0,0,1] op_sel_hi:[1,0,1] neg_lo:[0,0,1] neg_hi:[0,0,1]
    v_cvt_pk_bf16_f32 v33, v34, v35
    v_pk_fma_f32 v[38:39], v[38:39], v[86:87], v[86:87] op_sel:[0,0,1] op_sel_hi:[1,0,1] neg_lo:[0,0,1] neg_hi:[0,0,1]
    v_cvt_pk_bf16_f32 v36, v36, v37
    ds_write_b64 v118, v[32:33] offset:2048
    v_cvt_pk_bf16_f32 v37, v38, v39
    v_pk_fma_f32 v[40:41], v[40:41], v[88:89], v[88:89] op_sel:[0,0,1] op_sel_hi:[1,0,1] neg_lo:[0,0,1] neg_hi:[0,0,1]
    ds_write_b64 v118, v[36:37] offset:2176
    ds_read_b64_tr_b16 v[104:105], v119 offset:2048
    ds_read_b64_tr_b16 v[106:107], v119 offset:2176
    v_pk_fma_f32 v[42:43], v[42:43], v[88:89], v[88:89] op_sel:[0,0,1] op_sel_hi:[1,0,1] neg_lo:[0,0,1] neg_hi:[0,0,1]
    v_cvt_pk_bf16_f32 v40, v40, v41
    v_pk_fma_f32 v[44:45], v[44:45], v[90:91], v[90:91] op_sel:[0,0,1] op_sel_hi:[1,0,1] neg_lo:[0,0,1] neg_hi:[0,0,1]
    v_cvt_pk_bf16_f32 v41, v42, v43
    v_pk_fma_f32 v[46:47], v[46:47], v[90:91], v[90:91] op_sel:[0,0,1] op_sel_hi:[1,0,1] neg_lo:[0,0,1] neg_hi:[0,0,1]
    v_cvt_pk_bf16_f32 v44, v44, v45
    ds_write_b64 v118, v[40:41] offset:3072
    v_cvt_pk_bf16_f32 v45, v46, v47
    s_waitcnt lgkmcnt(9)
    buffer_store_dwordx4 v[96:99], v4, s[40:43], s20 offen offset:0 sc1
    ds_write_b64 v118, v[44:45] offset:3200
    ds_read_b64_tr_b16 v[108:109], v119 offset:3072
    ds_read_b64_tr_b16 v[110:111], v119 offset:3200
    s_waitcnt lgkmcnt(8)
    buffer_store_dwordx4 v[100:103], v4, s[40:43], s20 offen offset:1024 sc1
    v_add3_u32 v92, v96, v97, v98
    v_add_u32 v92, v92, v99
    v_add3_u32 v92, v100, v101, v92
    v_add3_u32 v92, v102, v103, v92
    s_waitcnt lgkmcnt(4)
    buffer_store_dwordx4 v[104:107], v4, s[40:43], s21 offen offset:0 sc1
    v_add3_u32 v94, v104, v105, v106
    v_add_u32 v94, v94, v107
    s_waitcnt lgkmcnt(1)
    v_add3_u32 v94, v108, v109, v94
    s_waitcnt lgkmcnt(0)
    buffer_store_dwordx4 v[108:111], v4, s[40:43], s21 offen offset:1024 sc1
    v_add3_u32 v94, v110, v111, v94
    v_and_b32 v94, s67, v94
    s_nop 1
    v_permlane32_swap_b32 v92, v94
    v_add_u32 v92, v92, v94
    v_mov_b32 v94, v92
    s_nop 1
    v_permlane16_swap_b32 v92, v94
    v_add_u32 v92, v92, v94
    s_nop 1
    v_add_u32_dpp v92, v92, v92 row_ror:8 row_mask:0xf bank_mask:0xf
    s_nop 1
    v_add_u32_dpp v92, v92, v92 row_ror:4 row_mask:0xf bank_mask:0xf
    s_nop 1
    v_add_u32_dpp v92, v92, v92 row_ror:2 row_mask:0xf bank_mask:0xf
    s_nop 1
    v_add_u32_dpp v92, v92, v92 row_ror:1 row_mask:0xf bank_mask:0xf
    s_mov_b32 exec_lo, 1
    s_mov_b32 exec_hi, 1
    buffer_store_dwordx2 v[92:93], v95, s[40:43], s22 offen sc1
    s_mov_b64 exec, -1
    s_cmp_eq_u32 s2, 0
    s_cselect_b32 s50, 0, 0x20000000
    v_mov_b32 v16, s44
    v_mov_b32 v17, 0
    buffer_store_dword v16, v17, s[40:43], s50 offen sc1
    s_add_u32 s50, s98, 0
    v_xor_b32 v20, v3, v2
    v_lshlrev_b32 v20, 4, v20
    v_lshl_add_u32 v20, v2, 10, v20
    v_xor_b32 v21, 64, v20
    v_xor_b32 v22, 128, v20
    v_xor_b32 v23, 192, v20
    v_add_u32 v20, s50, v20
    v_add_u32 v21, s50, v21
    v_add_u32 v22, s50, v22
    v_add_u32 v23, s50, v23
    ds_read_b128 a[64:67], v20 offset:0
    ds_read_b128 a[68:71], v21 offset:0
    ds_read_b128 a[72:75], v22 offset:0
    ds_read_b128 a[76:79], v23 offset:0
    ds_read_b128 a[80:83], v20 offset:256
    ds_read_b128 a[84:87], v21 offset:256
    ds_read_b128 a[88:91], v22 offset:256
    ds_read_b128 a[92:95], v23 offset:256
    ds_read_b128 a[96:99], v20 offset:512
    ds_read_b128 a[100:103], v21 offset:512
    ds_read_b128 a[104:107], v22 offset:512
    ds_read_b128 a[108:111], v23 offset:512
    ds_read_b128 a[112:115], v20 offset:768
    ds_read_b128 a[116:119], v21 offset:768
    ds_read_b128 a[120:123], v22 offset:768
    ds_read_b128 a[124:127], v23 offset:768
    s_mov_b32 s64, 0xbdd2d3e8
    v_mov_b32 v88, 0xc0135761
    v_pk_mul_f32 v[48:49], v[48:49], v[112:113] op_sel_hi:[1,0]
    v_pk_mul_f32 v[50:51], v[50:51], v[112:113] op_sel_hi:[1,0]
    v_pk_mul_f32 v[80:81], v[48:49], v[48:49]
    v_pk_mul_f32 v[82:83], v[50:51], v[50:51]
    s_add_u32 m0, s98, 66560
    v_xor_b32 v142, 0, v4
    s_add_u32 s99, s58, 0
    buffer_load_dwordx4 v142, s[24:27], s99 offen nt lds
    v_pk_fma_f32 v[80:81], v[80:81], s[64:65], v[88:89] op_sel_hi:[1,0,0]
    v_pk_fma_f32 v[82:83], v[82:83], s[64:65], v[88:89] op_sel_hi:[1,0,0]
    v_pk_mul_f32 v[80:81], v[80:81], v[48:49]
    v_pk_mul_f32 v[82:83], v[82:83], v[50:51]
    v_exp_f32 v80, v80
    v_exp_f32 v81, v81
    v_exp_f32 v82, v82
    s_add_u32 m0, s98, 67584
    v_xor_b32 v142, 16, v4
    s_add_u32 s99, s58, 4096
    buffer_load_dwordx4 v142, s[24:27], s99 offen nt lds
    v_exp_f32 v83, v83
    v_pk_add_f32 v[80:81], v[80:81], 1.0 op_sel_hi:[1,0]
    v_pk_add_f32 v[82:83], v[82:83], 1.0 op_sel_hi:[1,0]
    v_rcp_f32 v80, v80
    v_rcp_f32 v81, v81
    v_rcp_f32 v82, v82
    v_rcp_f32 v83, v83
    s_add_u32 m0, s98, 68608
    v_xor_b32 v142, 32, v4
    s_add_u32 s99, s58, 8192
    buffer_load_dwordx4 v142, s[24:27], s99 offen nt lds
    v_pk_mul_f32 v[48:49], v[48:49], v[80:81]
    v_pk_mul_f32 v[50:51], v[50:51], v[82:83]
    v_pk_mul_f32 v[52:53], v[52:53], v[112:113] op_sel:[0,1] op_sel_hi:[1,1]
    v_pk_mul_f32 v[54:55], v[54:55], v[112:113] op_sel:[0,1] op_sel_hi:[1,1]
    v_pk_mul_f32 v[84:85], v[52:53], v[52:53]
    v_pk_mul_f32 v[86:87], v[54:55], v[54:55]
    v_pk_fma_f32 v[84:85], v[84:85], s[64:65], v[88:89] op_sel_hi:[1,0,0]
    s_add_u32 m0, s98, 69632
    v_xor_b32 v142, 48, v4
    s_add_u32 s99, s58, 12288
    buffer_load_dwordx4 v142, s[24:27], s99 offen nt lds
    v_pk_fma_f32 v[86:87], v[86:87], s[64:65], v[88:89] op_sel_hi:[1,0,0]
    v_pk_mul_f32 v[84:85], v[84:85], v[52:53]
    v_pk_mul_f32 v[86:87], v[86:87], v[54:55]
    v_exp_f32 v84, v84
    v_exp_f32 v85, v85
    v_exp_f32 v86, v86
    v_exp_f32 v87, v87
    s_add_u32 m0, s98, 70656
    v_xor_b32 v142, 64, v4
    s_add_u32 s99, s58, 32768
    buffer_load_dwordx4 v142, s[24:27], s99 offen nt lds
    v_pk_add_f32 v[84:85], v[84:85], 1.0 op_sel_hi:[1,0]
    v_pk_add_f32 v[86:87], v[86:87], 1.0 op_sel_hi:[1,0]
    v_rcp_f32 v84, v84
    v_rcp_f32 v85, v85
    v_rcp_f32 v86, v86
    v_rcp_f32 v87, v87
    v_pk_mul_f32 v[52:53], v[52:53], v[84:85]
    s_add_u32 m0, s98, 71680
    v_xor_b32 v142, 80, v4
    s_add_u32 s99, s58, 36864
    buffer_load_dwordx4 v142, s[24:27], s99 offen nt lds
    v_pk_mul_f32 v[54:55], v[54:55], v[86:87]
    v_pk_mul_f32 v[56:57], v[56:57], v[114:115] op_sel_hi:[1,0]
    v_pk_mul_f32 v[58:59], v[58:59], v[114:115] op_sel_hi:[1,0]
    v_pk_mul_f32 v[80:81], v[56:57], v[56:57]
    v_pk_mul_f32 v[82:83], v[58:59], v[58:59]
    v_pk_fma_f32 v[80:81], v[80:81], s[64:65], v[88:89] op_sel_hi:[1,0,0]
    v_pk_fma_f32 v[82:83], v[82:83], s[64:65], v[88:89] op_sel_hi:[1,0,0]
    s_add_u32 m0, s98, 72704
    v_xor_b32 v142, 96, v4
    s_add_u32 s99, s58, 40960
    buffer_load_dwordx4 v142, s[24:27], s99 offen nt lds
    v_pk_mul_f32 v[80:81], v[80:81], v[56:57]
    v_pk_mul_f32 v[82:83], v[82:83], v[58:59]
    v_exp_f32 v80, v80
    v_exp_f32 v81, v81
    v_exp_f32 v82, v82
    v_exp_f32 v83, v83
    v_pk_add_f32 v[80:81], v[80:81], 1.0 op_sel_hi:[1,0]
    s_add_u32 m0, s98, 73728
    v_xor_b32 v142, 112, v4
    s_add_u32 s99, s58, 45056
    buffer_load_dwordx4 v142, s[24:27], s99 offen nt lds
    v_pk_add_f32 v[82:83], v[82:83], 1.0 op_sel_hi:[1,0]
    v_rcp_f32 v80, v80
    v_rcp_f32 v81, v81
    v_rcp_f32 v82, v82
    v_rcp_f32 v83, v83
    v_pk_mul_f32 v[56:57], v[56:57], v[80:81]
    v_pk_mul_f32 v[58:59], v[58:59], v[82:83]
    s_add_u32 m0, s98, 74752
    v_xor_b32 v142, 128, v4
    s_add_u32 s99, s58, 65536
    buffer_load_dwordx4 v142, s[24:27], s99 offen nt lds
    v_pk_mul_f32 v[60:61], v[60:61], v[114:115] op_sel:[0,1] op_sel_hi:[1,1]
    v_pk_mul_f32 v[62:63], v[62:63], v[114:115] op_sel:[0,1] op_sel_hi:[1,1]
    v_pk_mul_f32 v[84:85], v[60:61], v[60:61]
    v_pk_mul_f32 v[86:87], v[62:63], v[62:63]
    v_pk_fma_f32 v[84:85], v[84:85], s[64:65], v[88:89] op_sel_hi:[1,0,0]
    v_pk_fma_f32 v[86:87], v[86:87], s[64:65], v[88:89] op_sel_hi:[1,0,0]
    v_pk_mul_f32 v[84:85], v[84:85], v[60:61]
    s_add_u32 m0, s98, 75776
    v_xor_b32 v142, 144, v4
    s_add_u32 s99, s58, 69632
    buffer_load_dwordx4 v142, s[24:27], s99 offen nt lds
    v_pk_mul_f32 v[86:87], v[86:87], v[62:63]
    v_exp_f32 v84, v84
    v_exp_f32 v85, v85
    v_exp_f32 v86, v86
    v_exp_f32 v87, v87
    v_pk_add_f32 v[84:85], v[84:85], 1.0 op_sel_hi:[1,0]
    v_pk_add_f32 v[86:87], v[86:87], 1.0 op_sel_hi:[1,0]
    s_add_u32 m0, s98, 76800
    v_xor_b32 v142, 160, v4
    s_add_u32 s99, s58, 73728
    buffer_load_dwordx4 v142, s[24:27], s99 offen nt lds
    v_rcp_f32 v84, v84
    v_rcp_f32 v85, v85
    v_rcp_f32 v86, v86
    v_rcp_f32 v87, v87
    v_pk_mul_f32 v[60:61], v[60:61], v[84:85]
    v_pk_mul_f32 v[62:63], v[62:63], v[86:87]
    s_add_u32 m0, s98, 77824
    v_xor_b32 v142, 176, v4
    s_add_u32 s99, s58, 77824
    buffer_load_dwordx4 v142, s[24:27], s99 offen nt lds
    s_add_u32 m0, s98, 78848
    v_xor_b32 v142, 192, v4
    s_add_u32 s99, s58, 98304
    buffer_load_dwordx4 v142, s[24:27], s99 offen nt lds
    s_add_u32 m0, s98, 79872
    v_xor_b32 v142, 208, v4
    s_add_u32 s99, s58, 102400
    buffer_load_dwordx4 v142, s[24:27], s99 offen nt lds
    s_add_u32 m0, s98, 80896
    v_xor_b32 v142, 224, v4
    s_add_u32 s99, s58, 106496
    buffer_load_dwordx4 v142, s[24:27], s99 offen nt lds
    s_add_u32 m0, s98, 81920
    v_xor_b32 v142, 240, v4
    s_add_u32 s99, s58, 110592
    buffer_load_dwordx4 v142, s[24:27], s99 offen nt lds
    s_waitcnt lgkmcnt(0)
    s_lshl_b32 s59, s97, 10
    s_lshl_b32 s58, s45, 6
    s_add_u32 s58, s58, 32
    s_lshl_b32 s58, s58, 12
    s_add_u32 s58, s58, s59
    s_mov_b32 s64, 0xbdd2d3e8
    v_mov_b32 v88, 0xc0135761
    v_pk_mul_f32 v[64:65], v[64:65], v[112:113] op_sel_hi:[1,0]
    v_pk_mul_f32 v[66:67], v[66:67], v[112:113] op_sel_hi:[1,0]
    v_pk_mul_f32 v[80:81], v[64:65], v[64:65]
    v_pk_mul_f32 v[82:83], v[66:67], v[66:67]
    s_add_u32 m0, s98, 0
    v_xor_b32 v142, 0, v4
    s_add_u32 s99, s58, 0
    buffer_load_dwordx4 v142, s[24:27], s99 offen nt lds
    v_pk_fma_f32 v[80:81], v[80:81], s[64:65], v[88:89] op_sel_hi:[1,0,0]
    v_pk_fma_f32 v[82:83], v[82:83], s[64:65], v[88:89] op_sel_hi:[1,0,0]
    v_pk_mul_f32 v[80:81], v[80:81], v[64:65]
    v_pk_mul_f32 v[82:83], v[82:83], v[66:67]
    v_exp_f32 v80, v80
    v_exp_f32 v81, v81
    v_exp_f32 v82, v82
    s_add_u32 m0, s98, 1024
    v_xor_b32 v142, 16, v4
    s_add_u32 s99, s58, 4096
    buffer_load_dwordx4 v142, s[24:27], s99 offen nt lds
    v_exp_f32 v83, v83
    v_pk_add_f32 v[80:81], v[80:81], 1.0 op_sel_hi:[1,0]
    v_pk_add_f32 v[82:83], v[82:83], 1.0 op_sel_hi:[1,0]
    v_rcp_f32 v80, v80
    v_rcp_f32 v81, v81
    v_rcp_f32 v82, v82
    v_rcp_f32 v83, v83
    s_add_u32 m0, s98, 2048
    v_xor_b32 v142, 32, v4
    s_add_u32 s99, s58, 8192
    buffer_load_dwordx4 v142, s[24:27], s99 offen nt lds
    v_pk_mul_f32 v[64:65], v[64:65], v[80:81]
    v_pk_mul_f32 v[66:67], v[66:67], v[82:83]
    v_pk_mul_f32 v[68:69], v[68:69], v[112:113] op_sel:[0,1] op_sel_hi:[1,1]
    v_pk_mul_f32 v[70:71], v[70:71], v[112:113] op_sel:[0,1] op_sel_hi:[1,1]
    v_pk_mul_f32 v[84:85], v[68:69], v[68:69]
    v_pk_mul_f32 v[86:87], v[70:71], v[70:71]
    v_pk_fma_f32 v[84:85], v[84:85], s[64:65], v[88:89] op_sel_hi:[1,0,0]
    s_add_u32 m0, s98, 3072
    v_xor_b32 v142, 48, v4
    s_add_u32 s99, s58, 12288
    buffer_load_dwordx4 v142, s[24:27], s99 offen nt lds
    v_pk_fma_f32 v[86:87], v[86:87], s[64:65], v[88:89] op_sel_hi:[1,0,0]
    v_pk_mul_f32 v[84:85], v[84:85], v[68:69]
    v_pk_mul_f32 v[86:87], v[86:87], v[70:71]
    v_exp_f32 v84, v84
    v_exp_f32 v85, v85
    v_exp_f32 v86, v86
    v_exp_f32 v87, v87
    s_add_u32 m0, s98, 4096
    v_xor_b32 v142, 64, v4
    s_add_u32 s99, s58, 32768
    buffer_load_dwordx4 v142, s[24:27], s99 offen nt lds
    v_pk_add_f32 v[84:85], v[84:85], 1.0 op_sel_hi:[1,0]
    v_pk_add_f32 v[86:87], v[86:87], 1.0 op_sel_hi:[1,0]
    v_rcp_f32 v84, v84
    v_rcp_f32 v85, v85
    v_rcp_f32 v86, v86
    v_rcp_f32 v87, v87
    v_pk_mul_f32 v[68:69], v[68:69], v[84:85]
    s_add_u32 m0, s98, 5120
    v_xor_b32 v142, 80, v4
    s_add_u32 s99, s58, 36864
    buffer_load_dwordx4 v142, s[24:27], s99 offen nt lds
    v_pk_mul_f32 v[70:71], v[70:71], v[86:87]
    v_pk_mul_f32 v[72:73], v[72:73], v[114:115] op_sel_hi:[1,0]
    v_pk_mul_f32 v[74:75], v[74:75], v[114:115] op_sel_hi:[1,0]
    v_pk_mul_f32 v[80:81], v[72:73], v[72:73]
    v_pk_mul_f32 v[82:83], v[74:75], v[74:75]
    v_pk_fma_f32 v[80:81], v[80:81], s[64:65], v[88:89] op_sel_hi:[1,0,0]
    v_pk_fma_f32 v[82:83], v[82:83], s[64:65], v[88:89] op_sel_hi:[1,0,0]
    s_add_u32 m0, s98, 6144
    v_xor_b32 v142, 96, v4
    s_add_u32 s99, s58, 40960
    buffer_load_dwordx4 v142, s[24:27], s99 offen nt lds
    v_pk_mul_f32 v[80:81], v[80:81], v[72:73]
    v_pk_mul_f32 v[82:83], v[82:83], v[74:75]
    v_exp_f32 v80, v80
    v_exp_f32 v81, v81
    v_exp_f32 v82, v82
    v_exp_f32 v83, v83
    v_pk_add_f32 v[80:81], v[80:81], 1.0 op_sel_hi:[1,0]
    s_add_u32 m0, s98, 7168
    v_xor_b32 v142, 112, v4
    s_add_u32 s99, s58, 45056
    buffer_load_dwordx4 v142, s[24:27], s99 offen nt lds
    v_pk_add_f32 v[82:83], v[82:83], 1.0 op_sel_hi:[1,0]
    v_rcp_f32 v80, v80
    v_rcp_f32 v81, v81
    v_rcp_f32 v82, v82
    v_rcp_f32 v83, v83
    v_pk_mul_f32 v[72:73], v[72:73], v[80:81]
    v_pk_mul_f32 v[74:75], v[74:75], v[82:83]
    s_add_u32 m0, s98, 8192
    v_xor_b32 v142, 128, v4
    s_add_u32 s99, s58, 65536
    buffer_load_dwordx4 v142, s[24:27], s99 offen nt lds
    v_pk_mul_f32 v[76:77], v[76:77], v[114:115] op_sel:[0,1] op_sel_hi:[1,1]
    v_pk_mul_f32 v[78:79], v[78:79], v[114:115] op_sel:[0,1] op_sel_hi:[1,1]
    v_pk_mul_f32 v[84:85], v[76:77], v[76:77]
    v_pk_mul_f32 v[86:87], v[78:79], v[78:79]
    v_pk_fma_f32 v[84:85], v[84:85], s[64:65], v[88:89] op_sel_hi:[1,0,0]
    v_pk_fma_f32 v[86:87], v[86:87], s[64:65], v[88:89] op_sel_hi:[1,0,0]
    v_pk_mul_f32 v[84:85], v[84:85], v[76:77]
    s_add_u32 m0, s98, 9216
    v_xor_b32 v142, 144, v4
    s_add_u32 s99, s58, 69632
    buffer_load_dwordx4 v142, s[24:27], s99 offen nt lds
    v_pk_mul_f32 v[86:87], v[86:87], v[78:79]
    v_exp_f32 v84, v84
    v_exp_f32 v85, v85
    v_exp_f32 v86, v86
    v_exp_f32 v87, v87
    v_pk_add_f32 v[84:85], v[84:85], 1.0 op_sel_hi:[1,0]
    v_pk_add_f32 v[86:87], v[86:87], 1.0 op_sel_hi:[1,0]
    s_add_u32 m0, s98, 10240
    v_xor_b32 v142, 160, v4
    s_add_u32 s99, s58, 73728
    buffer_load_dwordx4 v142, s[24:27], s99 offen nt lds
    v_rcp_f32 v84, v84
    v_rcp_f32 v85, v85
    v_rcp_f32 v86, v86
    v_rcp_f32 v87, v87
    v_pk_mul_f32 v[76:77], v[76:77], v[84:85]
    v_pk_mul_f32 v[78:79], v[78:79], v[86:87]
    v_add_u32 v116, s32, v4
    s_add_u32 m0, s98, 11264
    v_xor_b32 v142, 176, v4
    s_add_u32 s99, s58, 77824
    buffer_load_dwordx4 v142, s[24:27], s99 offen nt lds
    v_add_u32 v117, s33, v4
    v_add_u32 v118, s34, v4
    v_add_u32 v119, s35, v4
    v_add_u32 v6, s28, v4
    v_add_u32 v7, s29, v4
    v_add_u32 v140, s19, v4
    v_lshlrev_b32 v141, 3, v1
    s_add_u32 m0, s98, 12288
    v_xor_b32 v142, 192, v4
    s_add_u32 s99, s58, 98304
    buffer_load_dwordx4 v142, s[24:27], s99 offen nt lds
    s_add_u32 s50, s98, 0
    v_xor_b32 v44, v3, v2
    v_lshlrev_b32 v44, 4, v44
    v_lshl_add_u32 v44, v2, 10, v44
    v_xor_b32 v45, 64, v44
    v_xor_b32 v46, 128, v44
    v_xor_b32 v47, 192, v44
    s_add_u32 m0, s98, 13312
    v_xor_b32 v142, 208, v4
    s_add_u32 s99, s58, 102400
    buffer_load_dwordx4 v142, s[24:27], s99 offen nt lds
    v_add_u32 v44, s50, v44
    v_add_u32 v45, s50, v45
    v_add_u32 v46, s50, v46
    v_add_u32 v47, s50, v47
    s_add_u32 s50, s98, 66560
    v_xor_b32 v24, v3, v2
    v_lshlrev_b32 v24, 4, v24
    s_add_u32 m0, s98, 14336
    v_xor_b32 v142, 224, v4
    s_add_u32 s99, s58, 106496
    buffer_load_dwordx4 v142, s[24:27], s99 offen nt lds
    v_lshl_add_u32 v24, v2, 10, v24
    v_xor_b32 v25, 64, v24
    v_xor_b32 v26, 128, v24
    v_xor_b32 v27, 192, v24
    v_add_u32 v24, s50, v24
    v_add_u32 v25, s50, v25
    v_add_u32 v26, s50, v26
    s_add_u32 m0, s98, 15360
    v_xor_b32 v142, 240, v4
    s_add_u32 s99, s58, 110592
    buffer_load_dwordx4 v142, s[24:27], s99 offen nt lds
    v_add_u32 v27, s50, v27
    s_waitcnt vmcnt(16)
    ds_read_b128 a[192:195], v24 offset:0
    ds_read_b128 a[196:199], v25 offset:0
    ds_read_b128 a[200:203], v26 offset:0
    ds_read_b128 a[204:207], v27 offset:0
    ds_read_b128 a[208:211], v24 offset:256
    ds_read_b128 a[212:215], v25 offset:256
    ds_read_b128 a[216:219], v26 offset:256
    ds_read_b128 a[220:223], v27 offset:256
    ds_read_b128 a[224:227], v24 offset:512
    ds_read_b128 a[228:231], v25 offset:512
    ds_read_b128 a[232:235], v26 offset:512
    ds_read_b128 a[236:239], v27 offset:512
    ds_read_b128 a[240:243], v24 offset:768
    ds_read_b128 a[244:247], v25 offset:768
    ds_read_b128 a[248:251], v26 offset:768
    ds_read_b128 a[252:255], v27 offset:768
    buffer_load_dwordx2 v[10:11], v141, s[40:43], s68 offen sc1
    buffer_load_dwordx4 v[16:19], v4, s[40:43], s12 offen offset:0 sc1
    buffer_load_dwordx4 v[20:23], v4, s[40:43], s13 offen offset:0 sc1
    buffer_load_dwordx4 v[24:27], v4, s[40:43], s14 offen offset:0 sc1
    buffer_load_dwordx4 v[28:31], v4, s[40:43], s12 offen offset:1024 sc1
    buffer_load_dwordx4 v[32:35], v4, s[40:43], s13 offen offset:1024 sc1
    buffer_load_dwordx4 v[36:39], v4, s[40:43], s14 offen offset:1024 sc1
    v_mov_b32 v240, v12
    v_and_b32 v224, s67, v12
    v_mov_b32 v241, v12
    v_and_b32 v225, s67, v12
    v_mov_b32 v242, v12
    v_and_b32 v226, s67, v12
    v_mov_b32 v243, v12
    v_and_b32 v227, s67, v12
    v_mov_b32 v244, v13
    v_and_b32 v228, s67, v13
    v_mov_b32 v245, v13
    v_and_b32 v229, s67, v13
    v_mov_b32 v246, v13
    v_and_b32 v230, s67, v13
    v_mov_b32 v247, v13
    v_and_b32 v231, s67, v13
    v_mov_b32 v248, v14
    v_and_b32 v232, s67, v14
    v_mov_b32 v249, v14
    v_and_b32 v233, s67, v14
    v_mov_b32 v250, v14
    v_and_b32 v234, s67, v14
    v_mov_b32 v251, v14
    v_and_b32 v235, s67, v14
    v_mov_b32 v252, v15
    v_and_b32 v236, s67, v15
    v_mov_b32 v253, v15
    v_and_b32 v237, s67, v15
    v_mov_b32 v254, v15
    v_and_b32 v238, s67, v15
    v_mov_b32 v255, v15
    v_and_b32 v239, s67, v15
    s_waitcnt vmcnt(7)
    ds_read_b128 a[128:131], v44 offset:0
    ds_read_b128 a[132:135], v45 offset:0
    ds_read_b128 a[136:139], v46 offset:0
    ds_read_b128 a[140:143], v47 offset:0
    ds_read_b128 a[144:147], v44 offset:256
    ds_read_b128 a[148:151], v45 offset:256
    ds_read_b128 a[152:155], v46 offset:256
    ds_read_b128 a[156:159], v47 offset:256
    ds_read_b128 a[160:163], v44 offset:512
    ds_read_b128 a[164:167], v45 offset:512
    ds_read_b128 a[168:171], v46 offset:512
    ds_read_b128 a[172:175], v47 offset:512
    ds_read_b128 a[176:179], v44 offset:768
    ds_read_b128 a[180:183], v45 offset:768
    ds_read_b128 a[184:187], v46 offset:768
    ds_read_b128 a[188:191], v47 offset:768
    s_waitcnt vmcnt(6)
    v_cmp_ne_u32 vcc, s44, v11
    s_nop 1
    s_cmp_lg_u64 vcc, 0
    s_cbranch_scc1 L_ztag_38
    buffer_load_dwordx4 v[40:43], v4, s[40:43], s12 offen offset:2048 sc1
    buffer_load_dwordx4 v[44:47], v4, s[40:43], s13 offen offset:2048 sc1
    buffer_load_dwordx4 v[128:131], v4, s[40:43], s14 offen offset:2048 sc1
    buffer_load_dwordx4 v[132:135], v4, s[40:43], s12 offen offset:3072 sc1
    buffer_load_dwordx4 v[136:139], v4, s[40:43], s13 offen offset:3072 sc1
    buffer_load_dwordx4 v[80:83], v4, s[40:43], s14 offen offset:3072 sc1
    s_add_u32 s12, s12, 4096
    buffer_load_dwordx4 v[84:87], v4, s[40:43], s12 offen offset:0 sc1
    s_add_u32 s13, s13, 4096
    buffer_load_dwordx4 v[88:91], v4, s[40:43], s13 offen offset:0 sc1
    s_add_u32 s14, s14, 4096
    buffer_load_dwordx4 v[92:95], v4, s[40:43], s14 offen offset:0 sc1
    buffer_load_dwordx4 v[96:99], v4, s[40:43], s12 offen offset:1024 sc1
    buffer_load_dwordx4 v[100:103], v4, s[40:43], s13 offen offset:1024 sc1
    buffer_load_dwordx4 v[104:107], v4, s[40:43], s14 offen offset:1024 sc1
    buffer_load_dwordx4 v[108:111], v4, s[40:43], s12 offen offset:2048 sc1
    buffer_load_dwordx4 v[112:115], v4, s[40:43], s13 offen offset:2048 sc1
L_ztagok_39:
    s_waitcnt lgkmcnt(0)
    s_barrier
L_ztry_35:
    v_sub_u32 v9, 0, v10
    v_cndmask_b32 v141, 0, v9, s[4:5]
    v_sub_u32 v9, v9, v141
    s_lshl_b32 s58, s46, 17
    s_lshl_b32 s59, s3, 10
    s_add_u32 s58, s58, s59
    s_add_u32 s58, s58, 11534336
    s_waitcnt vmcnt(19)
    v_mfma_f32_16x16x32_bf16 v[144:147], v[16:19], a[0:3], 0
    v_mfma_f32_16x16x32_bf16 v[148:151], v[16:19], a[64:67], 0
    v_add3_u32 v141, v16, v17, v141
    v_add3_u32 v141, v18, v19, v141
    v_mfma_f32_16x16x32_bf16 v[152:155], v[16:19], a[128:131], 0
    v_mfma_f32_16x16x32_bf16 v[156:159], v[16:19], a[192:195], 0
    s_waitcnt vmcnt(18)
    v_mfma_f32_16x16x32_bf16 v[160:163], v[20:23], a[0:3], 0
    buffer_load_dwordx4 v[16:19], v4, s[40:43], s14 offen offset:2048 sc1
    v_mfma_f32_16x16x32_bf16 v[164:167], v[20:23], a[64:67], 0
    v_add3_u32 v141, v20, v21, v141
    v_add3_u32 v141, v22, v23, v141
    v_mfma_f32_16x16x32_bf16 v[168:171], v[20:23], a[128:131], 0
    v_mfma_f32_16x16x32_bf16 v[172:175], v[20:23], a[192:195], 0
    s_waitcnt vmcnt(18)
    v_mfma_f32_16x16x32_bf16 v[176:179], v[24:27], a[0:3], 0
    buffer_load_dwordx4 v[20:23], v4, s[40:43], s12 offen offset:3072 sc1
    v_mfma_f32_16x16x32_bf16 v[180:183], v[24:27], a[64:67], 0
    s_add_u32 s12, s12, 4096
    v_add3_u32 v141, v24, v25, v141
    v_add3_u32 v141, v26, v27, v141
    v_mfma_f32_16x16x32_bf16 v[184:187], v[24:27], a[128:131], 0
    v_mfma_f32_16x16x32_bf16 v[188:191], v[24:27], a[192:195], 0
    s_waitcnt vmcnt(18)
    v_mfma_f32_16x16x32_bf16 v[144:147], v[28:31], a[4:7], v[144:147]
    buffer_load_dwordx4 v[24:27], v4, s[40:43], s13 offen offset:3072 sc1
    v_mfma_f32_16x16x32_bf16 v[148:151], v[28:31], a[68:71], v[148:151]
    s_add_u32 s13, s13, 4096
    v_add3_u32 v141, v28, v29, v141
    v_add3_u32 v141, v30, v31, v141
    v_mfma_f32_16x16x32_bf16 v[152:155], v[28:31], a[132:135], v[152:155]
    v_mfma_f32_16x16x32_bf16 v[156:159], v[28:31], a[196:199], v[156:159]
    s_waitcnt vmcnt(18)
    v_mfma_f32_16x16x32_bf16 v[160:163], v[32:35], a[4:7], v[160:163]
    buffer_load_dwordx4 v[28:31], v4, s[40:43], s14 offen offset:3072 sc1
    v_mfma_f32_16x16x32_bf16 v[164:167], v[32:35], a[68:71], v[164:167]
    s_add_u32 s14, s14, 4096
    v_add3_u32 v141, v32, v33, v141
    v_add3_u32 v141, v34, v35, v141
    v_mfma_f32_16x16x32_bf16 v[168:171], v[32:35], a[132:135], v[168:171]
    v_mfma_f32_16x16x32_bf16 v[172:175], v[32:35], a[196:199], v[172:175]
    s_waitcnt vmcnt(18)
    v_mfma_f32_16x16x32_bf16 v[176:179], v[36:39], a[4:7], v[176:179]
    buffer_load_dwordx4 v[32:35], v4, s[40:43], s12 offen offset:0 sc1
    v_mfma_f32_16x16x32_bf16 v[180:183], v[36:39], a[68:71], v[180:183]
    v_add3_u32 v141, v36, v37, v141
    v_add3_u32 v141, v38, v39, v141
    v_mfma_f32_16x16x32_bf16 v[184:187], v[36:39], a[132:135], v[184:187]
    s_nop 0
    v_add_u32_dpp v141, v141, v141 row_ror:8 row_mask:0xf bank_mask:0xf
    v_mfma_f32_16x16x32_bf16 v[188:191], v[36:39], a[196:199], v[188:191]
    s_nop 0
    v_add_u32_dpp v141, v141, v141 row_ror:4 row_mask:0xf bank_mask:0xf
    s_waitcnt vmcnt(18)
    v_mfma_f32_16x16x32_bf16 v[144:147], v[40:43], a[8:11], v[144:147]
    buffer_load_dwordx4 v[36:39], v4, s[40:43], s13 offen offset:0 sc1
    v_mfma_f32_16x16x32_bf16 v[148:151], v[40:43], a[72:75], v[148:151]
    v_add3_u32 v9, v40, v41, v9
    v_add3_u32 v9, v42, v43, v9
    v_mfma_f32_16x16x32_bf16 v[152:155], v[40:43], a[136:139], v[152:155]
    v_add_u32_dpp v141, v141, v141 row_ror:2 row_mask:0xf bank_mask:0xf
    v_mfma_f32_16x16x32_bf16 v[156:159], v[40:43], a[200:203], v[156:159]
    s_nop 0
    v_add_u32_dpp v141, v141, v141 row_ror:1 row_mask:0xf bank_mask:0xf
    buffer_load_dwordx4 v[40:43], v4, s[40:43], s14 offen offset:0 sc1
    v_readlane_b32 s50, v141, 0
    v_readlane_b32 s51, v141, 16
    v_readlane_b32 s56, v141, 32
    v_readlane_b32 s57, v141, 48
    s_add_u32 s50, s50, s51
    s_nop 0
    s_add_u32 s56, s56, s57
    s_add_u32 s50, s50, s56
    s_cmp_lg_u32 s50, 0
    s_cbranch_scc1 L_zearly_42
L_zearlyok_43:
    s_waitcnt vmcnt(19)
    v_mfma_f32_16x16x32_bf16 v[160:163], v[44:47], a[8:11], v[160:163]
    s_lshl_b32 s60, s45, 17
    s_lshr_b32 s20, s46, 1
    s_add_u32 s60, s60, 17825792
    v_mfma_f32_16x16x32_bf16 v[164:167], v[44:47], a[72:75], v[164:167]
    s_mul_i32 s20, s20, 7168
    v_add3_u32 v9, v44, v45, v9
    v_add3_u32 v9, v46, v47, v9
    v_mfma_f32_16x16x32_bf16 v[168:171], v[44:47], a[136:139], v[168:171]
    s_and_b32 s22, s46, 1
    s_add_u32 s20, s20, s60
    s_lshl_b32 s23, s22, 3
    v_mfma_f32_16x16x32_bf16 v[172:175], v[44:47], a[200:203], v[172:175]
    s_add_u32 s23, s23, s20
    s_mul_i32 s22, s22, 3072
    s_add_u32 s20, s20, s22
    s_waitcnt vmcnt(18)
    v_mfma_f32_16x16x32_bf16 v[176:179], v[128:131], a[8:11], v[176:179]
    s_lshl_b32 s22, s3, 10
    buffer_load_dwordx4 v[44:47], v4, s[40:43], s12 offen offset:1024 sc1
    v_mfma_f32_16x16x32_bf16 v[180:183], v[128:131], a[72:75], v[180:183]
    s_add_u32 s20, s20, s22
    v_add3_u32 v9, v128, v129, v9
    v_add3_u32 v9, v130, v131, v9
    v_mfma_f32_16x16x32_bf16 v[184:187], v[128:131], a[136:139], v[184:187]
    s_lshl_b32 s22, s3, 15
    s_lshl_b32 s61, s45, 10
    s_add_u32 s60, s60, s22
    v_mfma_f32_16x16x32_bf16 v[188:191], v[128:131], a[200:203], v[188:191]
    s_add_u32 s61, s61, 13303808
    s_lshl_b32 s21, s46, 5
    s_add_u32 s23, s23, 6144
    s_waitcnt vmcnt(18)
    v_mfma_f32_16x16x32_bf16 v[144:147], v[132:135], a[12:15], v[144:147]
    s_and_b32 s31, s67, 0x20000000
    buffer_load_dwordx4 v[128:131], v4, s[40:43], s13 offen offset:1024 sc1
    v_mfma_f32_16x16x32_bf16 v[148:151], v[132:135], a[76:79], v[148:151]
    s_add_u32 s21, s21, s61
    v_add3_u32 v9, v132, v133, v9
    v_add3_u32 v9, v134, v135, v9
    v_mfma_f32_16x16x32_bf16 v[152:155], v[132:135], a[140:143], v[152:155]
    s_lshl_b32 s22, s3, 3
    s_or_b32 s23, s23, s31
    s_add_u32 s21, s21, s22
    v_mfma_f32_16x16x32_bf16 v[156:159], v[132:135], a[204:207], v[156:159]
    s_xor_b32 s31, s31, 0x20000000
    s_lshl_b32 s22, s3, 8
    s_or_b32 s20, s20, s31
    s_waitcnt vmcnt(18)
    v_mfma_f32_16x16x32_bf16 v[160:163], v[136:139], a[12:15], v[160:163]
    s_add_u32 s61, s61, s22
    buffer_load_dwordx4 v[132:135], v4, s[40:43], s14 offen offset:1024 sc1
    v_mfma_f32_16x16x32_bf16 v[164:167], v[136:139], a[76:79], v[164:167]
    s_lshl_b32 s63, s46, 7
    v_add3_u32 v9, v136, v137, v9
    v_add3_u32 v9, v138, v139, v9
    v_mfma_f32_16x16x32_bf16 v[168:171], v[136:139], a[140:143], v[168:171]
    v_mfma_f32_16x16x32_bf16 v[172:175], v[136:139], a[204:207], v[172:175]
    s_waitcnt vmcnt(18)
    v_mfma_f32_16x16x32_bf16 v[176:179], v[80:83], a[12:15], v[176:179]
    buffer_load_dwordx4 v[136:139], v4, s[40:43], s12 offen offset:2048 sc1
    v_mfma_f32_16x16x32_bf16 v[180:183], v[80:83], a[76:79], v[180:183]
    v_add3_u32 v9, v80, v81, v9
    v_add3_u32 v9, v82, v83, v9
    v_mfma_f32_16x16x32_bf16 v[184:187], v[80:83], a[140:143], v[184:187]
    v_mfma_f32_16x16x32_bf16 v[188:191], v[80:83], a[204:207], v[188:191]
    s_waitcnt vmcnt(18)
    v_mfma_f32_16x16x32_bf16 v[144:147], v[84:87], a[16:19], v[144:147]
    buffer_load_dwordx4 v[80:83], v4, s[40:43], s13 offen offset:2048 sc1
    v_mfma_f32_16x16x32_bf16 v[148:151], v[84:87], a[80:83], v[148:151]
    v_add3_u32 v9, v84, v85, v9
    v_add3_u32 v9, v86, v87, v9
    v_mfma_f32_16x16x32_bf16 v[152:155], v[84:87], a[144:147], v[152:155]
    v_mfma_f32_16x16x32_bf16 v[156:159], v[84:87], a[208:211], v[156:159]
    s_waitcnt vmcnt(18)
    v_mfma_f32_16x16x32_bf16 v[160:163], v[88:91], a[16:19], v[160:163]
    buffer_load_dwordx4 v[84:87], v4, s[40:43], s14 offen offset:2048 sc1
    v_mfma_f32_16x16x32_bf16 v[164:167], v[88:91], a[80:83], v[164:167]
    v_add3_u32 v9, v88, v89, v9
    v_add3_u32 v9, v90, v91, v9
    v_mfma_f32_16x16x32_bf16 v[168:171], v[88:91], a[144:147], v[168:171]
    v_mfma_f32_16x16x32_bf16 v[172:175], v[88:91], a[208:211], v[172:175]
    s_waitcnt vmcnt(18)
    v_mfma_f32_16x16x32_bf16 v[176:179], v[92:95], a[16:19], v[176:179]
    buffer_load_dwordx4 v[88:91], v4, s[40:43], s12 offen offset:3072 sc1
    v_mfma_f32_16x16x32_bf16 v[180:183], v[92:95], a[80:83], v[180:183]
    s_add_u32 s12, s12, 4096
    v_add3_u32 v9, v92, v93, v9
    v_add3_u32 v9, v94, v95, v9
    v_mfma_f32_16x16x32_bf16 v[184:187], v[92:95], a[144:147], v[184:187]
    v_mfma_f32_16x16x32_bf16 v[188:191], v[92:95], a[208:211], v[188:191]
    s_waitcnt vmcnt(18)
    v_mfma_f32_16x16x32_bf16 v[144:147], v[96:99], a[20:23], v[144:147]
    buffer_load_dwordx4 v[92:95], v4, s[40:43], s13 offen offset:3072 sc1
    v_mfma_f32_16x16x32_bf16 v[148:151], v[96:99], a[84:87], v[148:151]
    s_add_u32 s13, s13, 4096
    v_add3_u32 v9, v96, v97, v9
    v_add3_u32 v9, v98, v99, v9
    v_mfma_f32_16x16x32_bf16 v[152:155], v[96:99], a[148:151], v[152:155]
    v_mfma_f32_16x16x32_bf16 v[156:159], v[96:99], a[212:215], v[156:159]
    s_waitcnt vmcnt(18)
    v_mfma_f32_16x16x32_bf16 v[160:163], v[100:103], a[20:23], v[160:163]
    buffer_load_dwordx4 v[96:99], v4, s[40:43], s14 offen offset:3072 sc1
    v_mfma_f32_16x16x32_bf16 v[164:167], v[100:103], a[84:87], v[164:167]
    s_add_u32 s14, s14, 4096
    v_add3_u32 v9, v100, v101, v9
    v_add3_u32 v9, v102, v103, v9
    v_mfma_f32_16x16x32_bf16 v[168:171], v[100:103], a[148:151], v[168:171]
    v_mfma_f32_16x16x32_bf16 v[172:175], v[100:103], a[212:215], v[172:175]
    s_waitcnt vmcnt(18)
    v_mfma_f32_16x16x32_bf16 v[176:179], v[104:107], a[20:23], v[176:179]
    buffer_load_dwordx4 v[100:103], v4, s[40:43], s12 offen offset:0 sc1
    v_mfma_f32_16x16x32_bf16 v[180:183], v[104:107], a[84:87], v[180:183]
    v_add3_u32 v9, v104, v105, v9
    v_add3_u32 v9, v106, v107, v9
    v_mfma_f32_16x16x32_bf16 v[184:187], v[104:107], a[148:151], v[184:187]
    v_mfma_f32_16x16x32_bf16 v[188:191], v[104:107], a[212:215], v[188:191]
    s_waitcnt vmcnt(18)
    v_mfma_f32_16x16x32_bf16 v[144:147], v[108:111], a[24:27], v[144:147]
    buffer_load_dwordx4 v[104:107], v4, s[40:43], s13 offen offset:0 sc1
    v_mfma_f32_16x16x32_bf16 v[148:151], v[108:111], a[88:91], v[148:151]
    v_add3_u32 v9, v108, v109, v9
    v_add3_u32 v9, v110, v111, v9
    v_mfma_f32_16x16x32_bf16 v[152:155], v[108:111], a[152:155], v[152:155]
    v_mfma_f32_16x16x32_bf16 v[156:159], v[108:111], a[216:219], v[156:159]
    s_waitcnt vmcnt(18)
    v_mfma_f32_16x16x32_bf16 v[160:163], v[112:115], a[24:27], v[160:163]
    buffer_load_dwordx4 v[108:111], v4, s[40:43], s14 offen offset:0 sc1
    v_mfma_f32_16x16x32_bf16 v[164:167], v[112:115], a[88:91], v[164:167]
    v_add3_u32 v9, v112, v113, v9
    v_add3_u32 v9, v114, v115, v9
    v_mfma_f32_16x16x32_bf16 v[168:171], v[112:115], a[152:155], v[168:171]
    v_mfma_f32_16x16x32_bf16 v[172:175], v[112:115], a[216:219], v[172:175]
    s_waitcnt vmcnt(18)
    v_mfma_f32_16x16x32_bf16 v[176:179], v[16:19], a[24:27], v[176:179]
    buffer_load_dwordx4 v[112:115], v4, s[40:43], s12 offen offset:1024 sc1
    v_mfma_f32_16x16x32_bf16 v[180:183], v[16:19], a[88:91], v[180:183]
    v_add3_u32 v9, v16, v17, v9
    v_add3_u32 v9, v18, v19, v9
    v_mfma_f32_16x16x32_bf16 v[184:187], v[16:19], a[152:155], v[184:187]
    v_mfma_f32_16x16x32_bf16 v[188:191], v[16:19], a[216:219], v[188:191]
    s_waitcnt vmcnt(18)
    v_mfma_f32_16x16x32_bf16 v[144:147], v[20:23], a[28:31], v[144:147]
    buffer_load_dwordx4 v[16:19], v4, s[40:43], s13 offen offset:1024 sc1
    v_mfma_f32_16x16x32_bf16 v[148:151], v[20:23], a[92:95], v[148:151]
    v_add3_u32 v9, v20, v21, v9
    v_add3_u32 v9, v22, v23, v9
    v_mfma_f32_16x16x32_bf16 v[152:155], v[20:23], a[156:159], v[152:155]
    v_mfma_f32_16x16x32_bf16 v[156:159], v[20:23], a[220:223], v[156:159]
    s_waitcnt vmcnt(18)
    v_mfma_f32_16x16x32_bf16 v[160:163], v[24:27], a[28:31], v[160:163]
    buffer_load_dwordx4 v[20:23], v4, s[40:43], s14 offen offset:1024 sc1
    v_mfma_f32_16x16x32_bf16 v[164:167], v[24:27], a[92:95], v[164:167]
    v_add3_u32 v9, v24, v25, v9
    v_add3_u32 v9, v26, v27, v9
    v_mfma_f32_16x16x32_bf16 v[168:171], v[24:27], a[156:159], v[168:171]
    v_mfma_f32_16x16x32_bf16 v[172:175], v[24:27], a[220:223], v[172:175]
    s_waitcnt vmcnt(18)
    v_mfma_f32_16x16x32_bf16 v[176:179], v[28:31], a[28:31], v[176:179]
    buffer_load_dwordx4 v[24:27], v4, s[40:43], s12 offen offset:2048 sc1
    v_mfma_f32_16x16x32_bf16 v[180:183], v[28:31], a[92:95], v[180:183]
    v_add3_u32 v9, v28, v29, v9
    v_add3_u32 v9, v30, v31, v9
    v_mfma_f32_16x16x32_bf16 v[184:187], v[28:31], a[156:159], v[184:187]
    v_mfma_f32_16x16x32_bf16 v[188:191], v[28:31], a[220:223], v[188:191]
    s_waitcnt vmcnt(18)
    v_mfma_f32_16x16x32_bf16 v[144:147], v[32:35], a[32:35], v[144:147]
    buffer_load_dwordx4 v[28:31], v4, s[40:43], s13 offen offset:2048 sc1
    v_mfma_f32_16x16x32_bf16 v[148:151], v[32:35], a[96:99], v[148:151]
    v_add3_u32 v9, v32, v33, v9
    v_add3_u32 v9, v34, v35, v9
    v_mfma_f32_16x16x32_bf16 v[152:155], v[32:35], a[160:163], v[152:155]
    v_mfma_f32_16x16x32_bf16 v[156:159], v[32:35], a[224:227], v[156:159]
    s_waitcnt vmcnt(18)
    v_mfma_f32_16x16x32_bf16 v[160:163], v[36:39], a[32:35], v[160:163]
    buffer_load_dwordx4 v[32:35], v4, s[40:43], s14 offen offset:2048 sc1
    v_mfma_f32_16x16x32_bf16 v[164:167], v[36:39], a[96:99], v[164:167]
    v_add3_u32 v9, v36, v37, v9
    v_add3_u32 v9, v38, v39, v9
    v_mfma_f32_16x16x32_bf16 v[168:171], v[36:39], a[160:163], v[168:171]
    v_mfma_f32_16x16x32_bf16 v[172:175], v[36:39], a[224:227], v[172:175]
    s_waitcnt vmcnt(18)
    v_mfma_f32_16x16x32_bf16 v[176:179], v[40:43], a[32:35], v[176:179]
    buffer_load_dwordx4 v[36:39], v4, s[40:43], s12 offen offset:3072 sc1
    v_mfma_f32_16x16x32_bf16 v[180:183], v[40:43], a[96:99], v[180:183]
    v_add3_u32 v9, v40, v41, v9
    v_add3_u32 v9, v42, v43, v9
    v_mfma_f32_16x16x32_bf16 v[184:187], v[40:43], a[160:163], v[184:187]
    v_mfma_f32_16x16x32_bf16 v[188:191], v[40:43], a[224:227], v[188:191]
    s_waitcnt vmcnt(18)
    v_mfma_f32_16x16x32_bf16 v[144:147], v[44:47], a[36:39], v[144:147]
    buffer_load_dwordx4 v[40:43], v4, s[40:43], s13 offen offset:3072 sc1
    v_mfma_f32_16x16x32_bf16 v[148:151], v[44:47], a[100:103], v[148:151]
    v_add3_u32 v9, v44, v45, v9
    v_add3_u32 v9, v46, v47, v9
    v_mfma_f32_16x16x32_bf16 v[152:155], v[44:47], a[164:167], v[152:155]
    v_mfma_f32_16x16x32_bf16 v[156:159], v[44:47], a[228:231], v[156:159]
    s_waitcnt vmcnt(18)
    v_mfma_f32_16x16x32_bf16 v[160:163], v[128:131], a[36:39], v[160:163]
    buffer_load_dwordx4 v[44:47], v4, s[40:43], s14 offen offset:3072 sc1
    v_mfma_f32_16x16x32_bf16 v[164:167], v[128:131], a[100:103], v[164:167]
    v_add3_u32 v9, v128, v129, v9
    v_add3_u32 v9, v130, v131, v9
    v_mfma_f32_16x16x32_bf16 v[168:171], v[128:131], a[164:167], v[168:171]
    v_mfma_f32_16x16x32_bf16 v[172:175], v[128:131], a[228:231], v[172:175]
    s_waitcnt vmcnt(18)
    v_mfma_f32_16x16x32_bf16 v[176:179], v[132:135], a[36:39], v[176:179]
    buffer_load_dwordx4 v[128:131], v4, s[40:43], s15 offen offset:0 sc1
    v_mfma_f32_16x16x32_bf16 v[180:183], v[132:135], a[100:103], v[180:183]
    v_add3_u32 v9, v132, v133, v9
    v_add3_u32 v9, v134, v135, v9
    v_mfma_f32_16x16x32_bf16 v[184:187], v[132:135], a[164:167], v[184:187]
    v_mfma_f32_16x16x32_bf16 v[188:191], v[132:135], a[228:231], v[188:191]
    s_waitcnt vmcnt(18)
    v_mfma_f32_16x16x32_bf16 v[144:147], v[136:139], a[40:43], v[144:147]
    buffer_load_dwordx4 v[132:135], v4, s[40:43], s16 offen offset:0 sc1
    v_mfma_f32_16x16x32_bf16 v[148:151], v[136:139], a[104:107], v[148:151]
    v_add3_u32 v9, v136, v137, v9
    v_add3_u32 v9, v138, v139, v9
    v_mfma_f32_16x16x32_bf16 v[152:155], v[136:139], a[168:171], v[152:155]
    v_mfma_f32_16x16x32_bf16 v[156:159], v[136:139], a[232:235], v[156:159]
    s_waitcnt vmcnt(18)
    v_mfma_f32_16x16x32_bf16 v[160:163], v[80:83], a[40:43], v[160:163]
    buffer_load_dwordx4 v[136:139], v4, s[40:43], s17 offen offset:0 sc1
    v_mfma_f32_16x16x32_bf16 v[164:167], v[80:83], a[104:107], v[164:167]
    v_add3_u32 v9, v80, v81, v9
    v_add3_u32 v9, v82, v83, v9
    v_mfma_f32_16x16x32_bf16 v[168:171], v[80:83], a[168:171], v[168:171]
    v_mfma_f32_16x16x32_bf16 v[172:175], v[80:83], a[232:235], v[172:175]
    s_waitcnt vmcnt(18)
    v_mfma_f32_16x16x32_bf16 v[176:179], v[84:87], a[40:43], v[176:179]
    buffer_load_dwordx4 v[80:83], v4, s[40:43], s15 offen offset:1024 sc1
    v_mfma_f32_16x16x32_bf16 v[180:183], v[84:87], a[104:107], v[180:183]
    v_add3_u32 v9, v84, v85, v9
    v_add3_u32 v9, v86, v87, v9
    v_mfma_f32_16x16x32_bf16 v[184:187], v[84:87], a[168:171], v[184:187]
    v_mfma_f32_16x16x32_bf16 v[188:191], v[84:87], a[232:235], v[188:191]
    s_waitcnt vmcnt(18)
    v_mfma_f32_16x16x32_bf16 v[144:147], v[88:91], a[44:47], v[144:147]
    buffer_load_dwordx4 v[84:87], v4, s[40:43], s16 offen offset:1024 sc1
    v_mfma_f32_16x16x32_bf16 v[148:151], v[88:91], a[108:111], v[148:151]
    v_add3_u32 v9, v88, v89, v9
    v_add3_u32 v9, v90, v91, v9
    v_mfma_f32_16x16x32_bf16 v[152:155], v[88:91], a[172:175], v[152:155]
    v_mfma_f32_16x16x32_bf16 v[156:159], v[88:91], a[236:239], v[156:159]
    s_waitcnt vmcnt(18)
    v_mfma_f32_16x16x32_bf16 v[160:163], v[92:95], a[44:47], v[160:163]
    buffer_load_dwordx4 v[88:91], v4, s[40:43], s17 offen offset:1024 sc1
    v_mfma_f32_16x16x32_bf16 v[164:167], v[92:95], a[108:111], v[164:167]
    v_add3_u32 v9, v92, v93, v9
    v_add3_u32 v9, v94, v95, v9
    v_mfma_f32_16x16x32_bf16 v[168:171], v[92:95], a[172:175], v[168:171]
    v_mfma_f32_16x16x32_bf16 v[172:175], v[92:95], a[236:239], v[172:175]
    s_waitcnt vmcnt(18)
    v_mfma_f32_16x16x32_bf16 v[176:179], v[96:99], a[44:47], v[176:179]
    buffer_load_dwordx4 v[92:95], v4, s[40:43], s15 offen offset:2048 sc1
    v_mfma_f32_16x16x32_bf16 v[180:183], v[96:99], a[108:111], v[180:183]
    v_add3_u32 v9, v96, v97, v9
    v_add3_u32 v9, v98, v99, v9
    v_mfma_f32_16x16x32_bf16 v[184:187], v[96:99], a[172:175], v[184:187]
    v_mfma_f32_16x16x32_bf16 v[188:191], v[96:99], a[236:239], v[188:191]
    s_waitcnt vmcnt(18)
    v_mfma_f32_16x16x32_bf16 v[144:147], v[100:103], a[48:51], v[144:147]
    buffer_load_dwordx4 v[96:99], v4, s[40:43], s16 offen offset:2048 sc1
    v_mfma_f32_16x16x32_bf16 v[148:151], v[100:103], a[112:115], v[148:151]
    v_add3_u32 v9, v100, v101, v9
    v_add3_u32 v9, v102, v103, v9
    v_mfma_f32_16x16x32_bf16 v[152:155], v[100:103], a[176:179], v[152:155]
    v_mfma_f32_16x16x32_bf16 v[156:159], v[100:103], a[240:243], v[156:159]
    s_waitcnt vmcnt(18)
    v_mfma_f32_16x16x32_bf16 v[160:163], v[104:107], a[48:51], v[160:163]
    buffer_load_dwordx4 v[100:103], v4, s[40:43], s17 offen offset:2048 sc1
    v_mfma_f32_16x16x32_bf16 v[164:167], v[104:107], a[112:115], v[164:167]
    v_add3_u32 v9, v104, v105, v9
    v_add3_u32 v9, v106, v107, v9
    v_mfma_f32_16x16x32_bf16 v[168:171], v[104:107], a[176:179], v[168:171]
    v_mfma_f32_16x16x32_bf16 v[172:175], v[104:107], a[240:243], v[172:175]
    s_waitcnt vmcnt(18)
    v_mfma_f32_16x16x32_bf16 v[176:179], v[108:111], a[48:51], v[176:179]
    buffer_load_dwordx4 v[104:107], v4, s[40:43], s15 offen offset:3072 sc1
    v_mfma_f32_16x16x32_bf16 v[180:183], v[108:111], a[112:115], v[180:183]
    s_add_u32 s15, s15, 4096
    v_add3_u32 v9, v108, v109, v9
    v_add3_u32 v9, v110, v111, v9
    v_mfma_f32_16x16x32_bf16 v[184:187], v[108:111], a[176:179], v[184:187]
    v_mfma_f32_16x16x32_bf16 v[188:191], v[108:111], a[240:243], v[188:191]
    s_waitcnt vmcnt(18)
    v_mfma_f32_16x16x32_bf16 v[144:147], v[112:115], a[52:55], v[144:147]
    buffer_load_dwordx4 v[108:111], v4, s[40:43], s16 offen offset:3072 sc1
    v_mfma_f32_16x16x32_bf16 v[148:151], v[112:115], a[116:119], v[148:151]
    s_add_u32 s16, s16, 4096
    v_add3_u32 v9, v112, v113, v9
    v_add3_u32 v9, v114, v115, v9
    v_mfma_f32_16x16x32_bf16 v[152:155], v[112:115], a[180:183], v[152:155]
    v_mfma_f32_16x16x32_bf16 v[156:159], v[112:115], a[244:247], v[156:159]
    s_waitcnt vmcnt(18)
    v_mfma_f32_16x16x32_bf16 v[160:163], v[16:19], a[52:55], v[160:163]
    buffer_load_dwordx4 v[112:115], v4, s[40:43], s17 offen offset:3072 sc1
    v_mfma_f32_16x16x32_bf16 v[164:167], v[16:19], a[116:119], v[164:167]
    s_add_u32 s17, s17, 4096
    v_add3_u32 v9, v16, v17, v9
    v_add3_u32 v9, v18, v19, v9
    v_mfma_f32_16x16x32_bf16 v[168:171], v[16:19], a[180:183], v[168:171]
    v_mfma_f32_16x16x32_bf16 v[172:175], v[16:19], a[244:247], v[172:175]
    s_waitcnt vmcnt(18)
    v_mfma_f32_16x16x32_bf16 v[176:179], v[20:23], a[52:55], v[176:179]
    buffer_load_dwordx4 v[16:19], v4, s[40:43], s15 offen offset:0 sc1
    v_mfma_f32_16x16x32_bf16 v[180:183], v[20:23], a[116:119], v[180:183]
    v_add3_u32 v9, v20, v21, v9
    v_add3_u32 v9, v22, v23, v9
    v_mfma_f32_16x16x32_bf16 v[184:187], v[20:23], a[180:183], v[184:187]
    v_mfma_f32_16x16x32_bf16 v[188:191], v[20:23], a[244:247], v[188:191]
    s_waitcnt vmcnt(18)
    v_mfma_f32_16x16x32_bf16 v[144:147], v[24:27], a[56:59], v[144:147]
    buffer_load_dwordx4 v[20:23], v4, s[40:43], s16 offen offset:0 sc1
    v_mfma_f32_16x16x32_bf16 v[148:151], v[24:27], a[120:123], v[148:151]
    v_add3_u32 v9, v24, v25, v9
    v_add3_u32 v9, v26, v27, v9
    v_mfma_f32_16x16x32_bf16 v[152:155], v[24:27], a[184:187], v[152:155]
    v_mfma_f32_16x16x32_bf16 v[156:159], v[24:27], a[248:251], v[156:159]
    s_waitcnt vmcnt(18)
    v_mfma_f32_16x16x32_bf16 v[160:163], v[28:31], a[56:59], v[160:163]
    buffer_load_dwordx4 v[24:27], v4, s[40:43], s17 offen offset:0 sc1
    v_mfma_f32_16x16x32_bf16 v[164:167], v[28:31], a[120:123], v[164:167]
    v_add3_u32 v9, v28, v29, v9
    v_add3_u32 v9, v30, v31, v9
    v_mfma_f32_16x16x32_bf16 v[168:171], v[28:31], a[184:187], v[168:171]
    v_mfma_f32_16x16x32_bf16 v[172:175], v[28:31], a[248:251], v[172:175]
    s_waitcnt vmcnt(18)
    v_mfma_f32_16x16x32_bf16 v[176:179], v[32:35], a[56:59], v[176:179]
    buffer_load_dwordx4 v[28:31], v4, s[40:43], s15 offen offset:1024 sc1
    v_mfma_f32_16x16x32_bf16 v[180:183], v[32:35], a[120:123], v[180:183]
    v_add3_u32 v9, v32, v33, v9
    v_add3_u32 v9, v34, v35, v9
    v_mfma_f32_16x16x32_bf16 v[184:187], v[32:35], a[184:187], v[184:187]
    v_mfma_f32_16x16x32_bf16 v[188:191], v[32:35], a[248:251], v[188:191]
    s_waitcnt vmcnt(18)
    v_mfma_f32_16x16x32_bf16 v[144:147], v[36:39], a[60:63], v[144:147]
    buffer_load_dwordx4 v[32:35], v4, s[40:43], s16 offen offset:1024 sc1
    v_mfma_f32_16x16x32_bf16 v[148:151], v[36:39], a[124:127], v[148:151]
    v_add3_u32 v9, v36, v37, v9
    v_add3_u32 v9, v38, v39, v9
    v_mfma_f32_16x16x32_bf16 v[152:155], v[36:39], a[188:191], v[152:155]
    v_mfma_f32_16x16x32_bf16 v[156:159], v[36:39], a[252:255], v[156:159]
    s_nop 1
    ds_write_b128 v116, v[144:147] offset:0
    s_waitcnt vmcnt(18)
    v_mfma_f32_16x16x32_bf16 v[160:163], v[40:43], a[60:63], v[160:163]
    buffer_load_dwordx4 v[36:39], v4, s[40:43], s17 offen offset:1024 sc1
    v_mfma_f32_16x16x32_bf16 v[164:167], v[40:43], a[124:127], v[164:167]
    v_add3_u32 v9, v40, v41, v9
    v_add3_u32 v9, v42, v43, v9
    v_mfma_f32_16x16x32_bf16 v[168:171], v[40:43], a[188:191], v[168:171]
    ds_write_b128 v116, v[148:151] offset:1024
    v_mfma_f32_16x16x32_bf16 v[172:175], v[40:43], a[252:255], v[172:175]
    s_waitcnt vmcnt(18)
    v_mfma_f32_16x16x32_bf16 v[176:179], v[44:47], a[60:63], v[176:179]
    buffer_load_dwordx4 v[40:43], v4, s[40:43], s15 offen offset:2048 sc1
    v_mfma_f32_16x16x32_bf16 v[180:183], v[44:47], a[124:127], v[180:183]
    v_add3_u32 v9, v44, v45, v9
    v_add3_u32 v9, v46, v47, v9
    v_mfma_f32_16x16x32_bf16 v[184:187], v[44:47], a[188:191], v[184:187]
    ds_write_b128 v117, v[160:163] offset:0
    v_mfma_f32_16x16x32_bf16 v[188:191], v[44:47], a[252:255], v[188:191]
    s_waitcnt vmcnt(18)
    v_mfma_f32_16x16x32_bf16 v[192:195], v[128:131], a[0:3], 0
    buffer_load_dwordx4 v[44:47], v4, s[40:43], s16 offen offset:2048 sc1
    v_mfma_f32_16x16x32_bf16 v[196:199], v[128:131], a[64:67], 0
    v_add3_u32 v9, v128, v129, v9
    v_add3_u32 v9, v130, v131, v9
    v_mfma_f32_16x16x32_bf16 v[200:203], v[128:131], a[128:131], 0
    ds_write_b128 v118, v[176:179] offset:0
    v_mfma_f32_16x16x32_bf16 v[204:207], v[128:131], a[192:195], 0
    s_waitcnt vmcnt(18)
    v_mfma_f32_16x16x32_bf16 v[208:211], v[132:135], a[0:3], 0
    buffer_load_dwordx4 v[128:131], v4, s[40:43], s17 offen offset:2048 sc1
    v_mfma_f32_16x16x32_bf16 v[212:215], v[132:135], a[64:67], 0
    v_add3_u32 v9, v132, v133, v9
    v_add3_u32 v9, v134, v135, v9
    v_mfma_f32_16x16x32_bf16 v[216:219], v[132:135], a[128:131], 0
    ds_write_b128 v117, v[164:167] offset:1024
    v_mfma_f32_16x16x32_bf16 v[220:223], v[132:135], a[192:195], 0
    s_waitcnt vmcnt(18)
    v_mfma_f32_16x16x32_bf16 v[224:227], v[136:139], a[0:3], v[224:227]
    buffer_load_dwordx4 v[132:135], v4, s[40:43], s15 offen offset:3072 sc1
    v_mfma_f32_16x16x32_bf16 v[228:231], v[136:139], a[64:67], v[228:231]
    s_add_u32 s15, s15, 4096
    v_add3_u32 v9, v136, v137, v9
    v_add3_u32 v9, v138, v139, v9
    v_mfma_f32_16x16x32_bf16 v[232:235], v[136:139], a[128:131], v[232:235]
    ds_write_b128 v118, v[180:183] offset:1024
    v_mfma_f32_16x16x32_bf16 v[236:239], v[136:139], a[192:195], v[236:239]
    s_waitcnt vmcnt(18)
    v_mfma_f32_16x16x32_bf16 v[192:195], v[80:83], a[4:7], v[192:195]
    buffer_load_dwordx4 v[136:139], v4, s[40:43], s16 offen offset:3072 sc1
    v_mfma_f32_16x16x32_bf16 v[196:199], v[80:83], a[68:71], v[196:199]
    s_add_u32 s16, s16, 4096
    v_add3_u32 v9, v80, v81, v9
    v_add3_u32 v9, v82, v83, v9
    v_mfma_f32_16x16x32_bf16 v[200:203], v[80:83], a[132:135], v[200:203]
    ds_write_b128 v116, v[152:155] offset:2048
    v_mfma_f32_16x16x32_bf16 v[204:207], v[80:83], a[196:199], v[204:207]
    s_waitcnt vmcnt(18)
    v_mfma_f32_16x16x32_bf16 v[208:211], v[84:87], a[4:7], v[208:211]
    buffer_load_dwordx4 v[80:83], v4, s[40:43], s17 offen offset:3072 sc1
    v_mfma_f32_16x16x32_bf16 v[212:215], v[84:87], a[68:71], v[212:215]
    s_add_u32 s17, s17, 4096
    v_add3_u32 v9, v84, v85, v9
    v_add3_u32 v9, v86, v87, v9
    v_mfma_f32_16x16x32_bf16 v[216:219], v[84:87], a[132:135], v[216:219]
    ds_write_b128 v117, v[168:171] offset:2048
    v_mfma_f32_16x16x32_bf16 v[220:223], v[84:87], a[196:199], v[220:223]
    s_waitcnt vmcnt(18)
    v_mfma_f32_16x16x32_bf16 v[224:227], v[88:91], a[4:7], v[224:227]
    buffer_load_dwordx4 v[84:87], v4, s[40:43], s15 offen offset:0 sc1
    v_mfma_f32_16x16x32_bf16 v[228:231], v[88:91], a[68:71], v[228:231]
    v_add3_u32 v9, v88, v89, v9
    v_add3_u32 v9, v90, v91, v9
    v_mfma_f32_16x16x32_bf16 v[232:235], v[88:91], a[132:135], v[232:235]
    ds_write_b128 v118, v[184:187] offset:2048
    v_mfma_f32_16x16x32_bf16 v[236:239], v[88:91], a[196:199], v[236:239]
    s_waitcnt vmcnt(18)
    v_mfma_f32_16x16x32_bf16 v[192:195], v[92:95], a[8:11], v[192:195]
    buffer_load_dwordx4 v[88:91], v4, s[40:43], s16 offen offset:0 sc1
    v_mfma_f32_16x16x32_bf16 v[196:199], v[92:95], a[72:75], v[196:199]
    v_add3_u32 v9, v92, v93, v9
    v_add3_u32 v9, v94, v95, v9
    v_mfma_f32_16x16x32_bf16 v[200:203], v[92:95], a[136:139], v[200:203]
    ds_write_b128 v116, v[156:159] offset:3072
    v_mfma_f32_16x16x32_bf16 v[204:207], v[92:95], a[200:203], v[204:207]
    s_waitcnt vmcnt(18)
    v_mfma_f32_16x16x32_bf16 v[208:211], v[96:99], a[8:11], v[208:211]
    buffer_load_dwordx4 v[92:95], v4, s[40:43], s17 offen offset:0 sc1
    v_mfma_f32_16x16x32_bf16 v[212:215], v[96:99], a[72:75], v[212:215]
    v_add3_u32 v9, v96, v97, v9
    v_add3_u32 v9, v98, v99, v9
    v_mfma_f32_16x16x32_bf16 v[216:219], v[96:99], a[136:139], v[216:219]
    ds_write_b128 v117, v[172:175] offset:3072
    v_mfma_f32_16x16x32_bf16 v[220:223], v[96:99], a[200:203], v[220:223]
    s_waitcnt vmcnt(18)
    v_mfma_f32_16x16x32_bf16 v[224:227], v[100:103], a[8:11], v[224:227]
    buffer_load_dwordx4 v[96:99], v4, s[40:43], s15 offen offset:1024 sc1
    v_mfma_f32_16x16x32_bf16 v[228:231], v[100:103], a[72:75], v[228:231]
    v_add3_u32 v9, v100, v101, v9
    v_add3_u32 v9, v102, v103, v9
    v_mfma_f32_16x16x32_bf16 v[232:235], v[100:103], a[136:139], v[232:235]
    ds_write_b128 v118, v[188:191] offset:3072
    v_mfma_f32_16x16x32_bf16 v[236:239], v[100:103], a[200:203], v[236:239]
    s_waitcnt vmcnt(18)
    v_mfma_f32_16x16x32_bf16 v[192:195], v[104:107], a[12:15], v[192:195]
    buffer_load_dwordx4 v[100:103], v4, s[40:43], s16 offen offset:1024 sc1
    v_mfma_f32_16x16x32_bf16 v[196:199], v[104:107], a[76:79], v[196:199]
    v_add3_u32 v9, v104, v105, v9
    v_add3_u32 v9, v106, v107, v9
    v_mfma_f32_16x16x32_bf16 v[200:203], v[104:107], a[140:143], v[200:203]
    v_mfma_f32_16x16x32_bf16 v[204:207], v[104:107], a[204:207], v[204:207]
    s_waitcnt vmcnt(18)
    v_mfma_f32_16x16x32_bf16 v[208:211], v[108:111], a[12:15], v[208:211]
    buffer_load_dwordx4 v[104:107], v4, s[40:43], s17 offen offset:1024 sc1
    v_mfma_f32_16x16x32_bf16 v[212:215], v[108:111], a[76:79], v[212:215]
    v_add3_u32 v9, v108, v109, v9
    v_add3_u32 v9, v110, v111, v9
    v_mfma_f32_16x16x32_bf16 v[216:219], v[108:111], a[140:143], v[216:219]
    v_mfma_f32_16x16x32_bf16 v[220:223], v[108:111], a[204:207], v[220:223]
    s_waitcnt vmcnt(18)
    v_mfma_f32_16x16x32_bf16 v[224:227], v[112:115], a[12:15], v[224:227]
    buffer_load_dwordx4 v[108:111], v4, s[40:43], s15 offen offset:2048 sc1
    v_mfma_f32_16x16x32_bf16 v[228:231], v[112:115], a[76:79], v[228:231]
    v_add3_u32 v9, v112, v113, v9
    v_add3_u32 v9, v114, v115, v9
    v_mfma_f32_16x16x32_bf16 v[232:235], v[112:115], a[140:143], v[232:235]
    v_mfma_f32_16x16x32_bf16 v[236:239], v[112:115], a[204:207], v[236:239]
    s_waitcnt vmcnt(18)
    v_mfma_f32_16x16x32_bf16 v[192:195], v[16:19], a[16:19], v[192:195]
    buffer_load_dwordx4 v[112:115], v4, s[40:43], s16 offen offset:2048 sc1
    v_mfma_f32_16x16x32_bf16 v[196:199], v[16:19], a[80:83], v[196:199]
    v_add3_u32 v9, v16, v17, v9
    v_add3_u32 v9, v18, v19, v9
    v_mfma_f32_16x16x32_bf16 v[200:203], v[16:19], a[144:147], v[200:203]
    v_mfma_f32_16x16x32_bf16 v[204:207], v[16:19], a[208:211], v[204:207]
    s_waitcnt vmcnt(18)
    v_mfma_f32_16x16x32_bf16 v[208:211], v[20:23], a[16:19], v[208:211]
    buffer_load_dwordx4 v[16:19], v4, s[40:43], s17 offen offset:2048 sc1
    v_mfma_f32_16x16x32_bf16 v[212:215], v[20:23], a[80:83], v[212:215]
    v_add3_u32 v9, v20, v21, v9
    v_add3_u32 v9, v22, v23, v9
    v_mfma_f32_16x16x32_bf16 v[216:219], v[20:23], a[144:147], v[216:219]
    v_mfma_f32_16x16x32_bf16 v[220:223], v[20:23], a[208:211], v[220:223]
    s_waitcnt vmcnt(18)
    v_mfma_f32_16x16x32_bf16 v[224:227], v[24:27], a[16:19], v[224:227]
    buffer_load_dwordx4 v[20:23], v4, s[40:43], s15 offen offset:3072 sc1
    v_mfma_f32_16x16x32_bf16 v[228:231], v[24:27], a[80:83], v[228:231]
    s_add_u32 s15, s15, 4096
    v_add3_u32 v9, v24, v25, v9
    v_add3_u32 v9, v26, v27, v9
    v_mfma_f32_16x16x32_bf16 v[232:235], v[24:27], a[144:147], v[232:235]
    v_mfma_f32_16x16x32_bf16 v[236:239], v[24:27], a[208:211], v[236:239]
    s_waitcnt vmcnt(18)
    v_mfma_f32_16x16x32_bf16 v[192:195], v[28:31], a[20:23], v[192:195]
    buffer_load_dwordx4 v[24:27], v4, s[40:43], s16 offen offset:3072 sc1
    v_mfma_f32_16x16x32_bf16 v[196:199], v[28:31], a[84:87], v[196:199]
    s_add_u32 s16, s16, 4096
    v_add3_u32 v9, v28, v29, v9
    v_add3_u32 v9, v30, v31, v9
    v_mfma_f32_16x16x32_bf16 v[200:203], v[28:31], a[148:151], v[200:203]
    v_mfma_f32_16x16x32_bf16 v[204:207], v[28:31], a[212:215], v[204:207]
    s_waitcnt vmcnt(18)
    v_mfma_f32_16x16x32_bf16 v[208:211], v[32:35], a[20:23], v[208:211]
    buffer_load_dwordx4 v[28:31], v4, s[40:43], s17 offen offset:3072 sc1
    v_mfma_f32_16x16x32_bf16 v[212:215], v[32:35], a[84:87], v[212:215]
    s_add_u32 s17, s17, 4096
    v_add3_u32 v9, v32, v33, v9
    v_add3_u32 v9, v34, v35, v9
    v_mfma_f32_16x16x32_bf16 v[216:219], v[32:35], a[148:151], v[216:219]
    v_mfma_f32_16x16x32_bf16 v[220:223], v[32:35], a[212:215], v[220:223]
    s_waitcnt vmcnt(18)
    v_mfma_f32_16x16x32_bf16 v[224:227], v[36:39], a[20:23], v[224:227]
    buffer_load_dwordx4 v[32:35], v4, s[40:43], s15 offen offset:0 sc1
    v_mfma_f32_16x16x32_bf16 v[228:231], v[36:39], a[84:87], v[228:231]
    v_add3_u32 v9, v36, v37, v9
    v_add3_u32 v9, v38, v39, v9
    v_mfma_f32_16x16x32_bf16 v[232:235], v[36:39], a[148:151], v[232:235]
    v_mfma_f32_16x16x32_bf16 v[236:239], v[36:39], a[212:215], v[236:239]
    s_waitcnt vmcnt(18)
    v_mfma_f32_16x16x32_bf16 v[192:195], v[40:43], a[24:27], v[192:195]
    buffer_load_dwordx4 v[36:39], v4, s[40:43], s16 offen offset:0 sc1
    v_mfma_f32_16x16x32_bf16 v[196:199], v[40:43], a[88:91], v[196:199]
    v_add3_u32 v9, v40, v41, v9
    v_add3_u32 v9, v42, v43, v9
    v_mfma_f32_16x16x32_bf16 v[200:203], v[40:43], a[152:155], v[200:203]
    v_mfma_f32_16x16x32_bf16 v[204:207], v[40:43], a[216:219], v[204:207]
    s_waitcnt vmcnt(18)
    v_mfma_f32_16x16x32_bf16 v[208:211], v[44:47], a[24:27], v[208:211]
    buffer_load_dwordx4 v[40:43], v4, s[40:43], s17 offen offset:0 sc1
    v_mfma_f32_16x16x32_bf16 v[212:215], v[44:47], a[88:91], v[212:215]
    v_add3_u32 v9, v44, v45, v9
    v_add3_u32 v9, v46, v47, v9
    v_mfma_f32_16x16x32_bf16 v[216:219], v[44:47], a[152:155], v[216:219]
    v_mfma_f32_16x16x32_bf16 v[220:223], v[44:47], a[216:219], v[220:223]
    s_waitcnt vmcnt(18)
    v_mfma_f32_16x16x32_bf16 v[224:227], v[128:131], a[24:27], v[224:227]
    buffer_load_dwordx4 v[44:47], v4, s[40:43], s15 offen offset:1024 sc1
    v_mfma_f32_16x16x32_bf16 v[228:231], v[128:131], a[88:91], v[228:231]
    v_add3_u32 v9, v128, v129, v9
    v_add3_u32 v9, v130, v131, v9
    v_mfma_f32_16x16x32_bf16 v[232:235], v[128:131], a[152:155], v[232:235]
    v_mfma_f32_16x16x32_bf16 v[236:239], v[128:131], a[216:219], v[236:239]
    s_waitcnt vmcnt(18)
    v_mfma_f32_16x16x32_bf16 v[192:195], v[132:135], a[28:31], v[192:195]
    buffer_load_dwordx4 v[128:131], v4, s[40:43], s16 offen offset:1024 sc1
    v_mfma_f32_16x16x32_bf16 v[196:199], v[132:135], a[92:95], v[196:199]
    v_add3_u32 v9, v132, v133, v9
    v_add3_u32 v9, v134, v135, v9
    v_mfma_f32_16x16x32_bf16 v[200:203], v[132:135], a[156:159], v[200:203]
    v_mfma_f32_16x16x32_bf16 v[204:207], v[132:135], a[220:223], v[204:207]
    s_waitcnt vmcnt(18)
    v_mfma_f32_16x16x32_bf16 v[208:211], v[136:139], a[28:31], v[208:211]
    buffer_load_dwordx4 v[132:135], v4, s[40:43], s17 offen offset:1024 sc1
    v_mfma_f32_16x16x32_bf16 v[212:215], v[136:139], a[92:95], v[212:215]
    v_add3_u32 v9, v136, v137, v9
    v_add3_u32 v9, v138, v139, v9
    v_mfma_f32_16x16x32_bf16 v[216:219], v[136:139], a[156:159], v[216:219]
    v_mfma_f32_16x16x32_bf16 v[220:223], v[136:139], a[220:223], v[220:223]
    s_waitcnt vmcnt(18)
    v_mfma_f32_16x16x32_bf16 v[224:227], v[80:83], a[28:31], v[224:227]
    buffer_load_dwordx4 v[136:139], v4, s[40:43], s15 offen offset:2048 sc1
    v_mfma_f32_16x16x32_bf16 v[228:231], v[80:83], a[92:95], v[228:231]
    v_add3_u32 v9, v80, v81, v9
    v_add3_u32 v9, v82, v83, v9
    v_mfma_f32_16x16x32_bf16 v[232:235], v[80:83], a[156:159], v[232:235]
    v_mfma_f32_16x16x32_bf16 v[236:239], v[80:83], a[220:223], v[236:239]
    s_waitcnt vmcnt(18)
    v_mfma_f32_16x16x32_bf16 v[192:195], v[84:87], a[32:35], v[192:195]
    buffer_load_dwordx4 v[80:83], v4, s[40:43], s16 offen offset:2048 sc1
    v_mfma_f32_16x16x32_bf16 v[196:199], v[84:87], a[96:99], v[196:199]
    v_add3_u32 v9, v84, v85, v9
    v_add3_u32 v9, v86, v87, v9
    v_mfma_f32_16x16x32_bf16 v[200:203], v[84:87], a[160:163], v[200:203]
    v_mfma_f32_16x16x32_bf16 v[204:207], v[84:87], a[224:227], v[204:207]
    s_waitcnt vmcnt(18)
    v_mfma_f32_16x16x32_bf16 v[208:211], v[88:91], a[32:35], v[208:211]
    buffer_load_dwordx4 v[84:87], v4, s[40:43], s17 offen offset:2048 sc1
    v_mfma_f32_16x16x32_bf16 v[212:215], v[88:91], a[96:99], v[212:215]
    v_add3_u32 v9, v88, v89, v9
    v_add3_u32 v9, v90, v91, v9
    v_mfma_f32_16x16x32_bf16 v[216:219], v[88:91], a[160:163], v[216:219]
    v_mfma_f32_16x16x32_bf16 v[220:223], v[88:91], a[224:227], v[220:223]
    s_waitcnt vmcnt(18)
    v_mfma_f32_16x16x32_bf16 v[224:227], v[92:95], a[32:35], v[224:227]
    buffer_load_dwordx4 v[88:91], v4, s[40:43], s15 offen offset:3072 sc1
    v_mfma_f32_16x16x32_bf16 v[228:231], v[92:95], a[96:99], v[228:231]
    v_add3_u32 v9, v92, v93, v9
    v_add3_u32 v9, v94, v95, v9
    v_mfma_f32_16x16x32_bf16 v[232:235], v[92:95], a[160:163], v[232:235]
    v_mfma_f32_16x16x32_bf16 v[236:239], v[92:95], a[224:227], v[236:239]
    s_waitcnt vmcnt(18)
    v_mfma_f32_16x16x32_bf16 v[192:195], v[96:99], a[36:39], v[192:195]
    buffer_load_dwordx4 v[92:95], v4, s[40:43], s16 offen offset:3072 sc1
    v_mfma_f32_16x16x32_bf16 v[196:199], v[96:99], a[100:103], v[196:199]
    v_add3_u32 v9, v96, v97, v9
    v_add3_u32 v9, v98, v99, v9
    v_mfma_f32_16x16x32_bf16 v[200:203], v[96:99], a[164:167], v[200:203]
    v_mfma_f32_16x16x32_bf16 v[204:207], v[96:99], a[228:231], v[204:207]
    s_waitcnt vmcnt(18)
    v_mfma_f32_16x16x32_bf16 v[208:211], v[100:103], a[36:39], v[208:211]
    buffer_load_dwordx4 v[96:99], v4, s[40:43], s17 offen offset:3072 sc1
    v_mfma_f32_16x16x32_bf16 v[212:215], v[100:103], a[100:103], v[212:215]
    v_add3_u32 v9, v100, v101, v9
    v_add3_u32 v9, v102, v103, v9
    v_mfma_f32_16x16x32_bf16 v[216:219], v[100:103], a[164:167], v[216:219]
    v_mfma_f32_16x16x32_bf16 v[220:223], v[100:103], a[228:231], v[220:223]
    s_waitcnt vmcnt(18)
    v_mfma_f32_16x16x32_bf16 v[224:227], v[104:107], a[36:39], v[224:227]
    buffer_load_dwordx4 v[100:103], v4, s[40:43], s18 offen offset:0 sc1
    v_mfma_f32_16x16x32_bf16 v[228:231], v[104:107], a[100:103], v[228:231]
    v_add3_u32 v9, v104, v105, v9
    v_add3_u32 v9, v106, v107, v9
    v_mfma_f32_16x16x32_bf16 v[232:235], v[104:107], a[164:167], v[232:235]
    v_mfma_f32_16x16x32_bf16 v[236:239], v[104:107], a[228:231], v[236:239]
    s_waitcnt vmcnt(18)
    v_mfma_f32_16x16x32_bf16 v[192:195], v[108:111], a[40:43], v[192:195]
    buffer_load_dwordx4 v[104:107], v4, s[40:43], s18 offen offset:1024 sc1
    v_mfma_f32_16x16x32_bf16 v[196:199], v[108:111], a[104:107], v[196:199]
    v_add3_u32 v9, v108, v109, v9
    v_add3_u32 v9, v110, v111, v9
    v_mfma_f32_16x16x32_bf16 v[200:203], v[108:111], a[168:171], v[200:203]
    v_mfma_f32_16x16x32_bf16 v[204:207], v[108:111], a[232:235], v[204:207]
    s_waitcnt vmcnt(18)
    v_mfma_f32_16x16x32_bf16 v[208:211], v[112:115], a[40:43], v[208:211]
    buffer_load_dwordx4 v[108:111], v4, s[40:43], s18 offen offset:2048 sc1
    v_mfma_f32_16x16x32_bf16 v[212:215], v[112:115], a[104:107], v[212:215]
    v_add3_u32 v9, v112, v113, v9
    v_add3_u32 v9, v114, v115, v9
    v_mfma_f32_16x16x32_bf16 v[216:219], v[112:115], a[168:171], v[216:219]
    v_mfma_f32_16x16x32_bf16 v[220:223], v[112:115], a[232:235], v[220:223]
    s_waitcnt vmcnt(18)
    v_mfma_f32_16x16x32_bf16 v[224:227], v[16:19], a[40:43], v[224:227]
    buffer_load_dwordx4 v[112:115], v4, s[40:43], s18 offen offset:3072 sc1
    v_mfma_f32_16x16x32_bf16 v[228:231], v[16:19], a[104:107], v[228:231]
    s_add_u32 s18, s18, 4096
    v_add3_u32 v9, v16, v17, v9
    v_add3_u32 v9, v18, v19, v9
    v_mfma_f32_16x16x32_bf16 v[232:235], v[16:19], a[168:171], v[232:235]
    v_mfma_f32_16x16x32_bf16 v[236:239], v[16:19], a[232:235], v[236:239]
    s_waitcnt vmcnt(18)
    v_mfma_f32_16x16x32_bf16 v[192:195], v[20:23], a[44:47], v[192:195]
    buffer_load_dwordx4 v[16:19], v4, s[40:43], s18 offen offset:0 sc1
    v_mfma_f32_16x16x32_bf16 v[196:199], v[20:23], a[108:111], v[196:199]
    v_add3_u32 v9, v20, v21, v9
    v_add3_u32 v9, v22, v23, v9
    v_mfma_f32_16x16x32_bf16 v[200:203], v[20:23], a[172:175], v[200:203]
    v_mfma_f32_16x16x32_bf16 v[204:207], v[20:23], a[236:239], v[204:207]
    s_waitcnt vmcnt(18)
    v_mfma_f32_16x16x32_bf16 v[208:211], v[24:27], a[44:47], v[208:211]
    buffer_load_dwordx4 v[20:23], v4, s[40:43], s18 offen offset:1024 sc1
    v_mfma_f32_16x16x32_bf16 v[212:215], v[24:27], a[108:111], v[212:215]
    v_add3_u32 v9, v24, v25, v9
    v_add3_u32 v9, v26, v27, v9
    v_mfma_f32_16x16x32_bf16 v[216:219], v[24:27], a[172:175], v[216:219]
    v_mfma_f32_16x16x32_bf16 v[220:223], v[24:27], a[236:239], v[220:223]
    s_waitcnt vmcnt(18)
    v_mfma_f32_16x16x32_bf16 v[224:227], v[28:31], a[44:47], v[224:227]
    buffer_load_dwordx4 v[24:27], v4, s[40:43], s18 offen offset:2048 sc1
    v_mfma_f32_16x16x32_bf16 v[228:231], v[28:31], a[108:111], v[228:231]
    v_add3_u32 v9, v28, v29, v9
    v_add3_u32 v9, v30, v31, v9
    v_mfma_f32_16x16x32_bf16 v[232:235], v[28:31], a[172:175], v[232:235]
    v_mfma_f32_16x16x32_bf16 v[236:239], v[28:31], a[236:239], v[236:239]
    s_waitcnt vmcnt(18)
    v_mfma_f32_16x16x32_bf16 v[192:195], v[32:35], a[48:51], v[192:195]
    buffer_load_dwordx4 v[28:31], v4, s[40:43], s18 offen offset:3072 sc1
    v_mfma_f32_16x16x32_bf16 v[196:199], v[32:35], a[112:115], v[196:199]
    s_add_u32 s18, s18, 4096
    v_add3_u32 v9, v32, v33, v9
    v_add3_u32 v9, v34, v35, v9
    v_mfma_f32_16x16x32_bf16 v[200:203], v[32:35], a[176:179], v[200:203]
    v_mfma_f32_16x16x32_bf16 v[204:207], v[32:35], a[240:243], v[204:207]
    s_waitcnt vmcnt(18)
    v_mfma_f32_16x16x32_bf16 v[208:211], v[36:39], a[48:51], v[208:211]
    buffer_load_dwordx4 v[32:35], v4, s[40:43], s18 offen offset:0 sc1
    v_mfma_f32_16x16x32_bf16 v[212:215], v[36:39], a[112:115], v[212:215]
    v_add3_u32 v9, v36, v37, v9
    v_add3_u32 v9, v38, v39, v9
    v_mfma_f32_16x16x32_bf16 v[216:219], v[36:39], a[176:179], v[216:219]
    v_mfma_f32_16x16x32_bf16 v[220:223], v[36:39], a[240:243], v[220:223]
    s_waitcnt vmcnt(18)
    v_mfma_f32_16x16x32_bf16 v[224:227], v[40:43], a[48:51], v[224:227]
    buffer_load_dwordx4 v[36:39], v4, s[40:43], s18 offen offset:1024 sc1
    v_mfma_f32_16x16x32_bf16 v[228:231], v[40:43], a[112:115], v[228:231]
    v_add3_u32 v9, v40, v41, v9
    v_add3_u32 v9, v42, v43, v9
    v_mfma_f32_16x16x32_bf16 v[232:235], v[40:43], a[176:179], v[232:235]
    v_mfma_f32_16x16x32_bf16 v[236:239], v[40:43], a[240:243], v[236:239]
    s_waitcnt vmcnt(18)
    v_mfma_f32_16x16x32_bf16 v[192:195], v[44:47], a[52:55], v[192:195]
    buffer_load_dwordx4 v[40:43], v4, s[40:43], s18 offen offset:2048 sc1
    v_mfma_f32_16x16x32_bf16 v[196:199], v[44:47], a[116:119], v[196:199]
    v_add3_u32 v9, v44, v45, v9
    v_add3_u32 v9, v46, v47, v9
    v_mfma_f32_16x16x32_bf16 v[200:203], v[44:47], a[180:183], v[200:203]
    v_mfma_f32_16x16x32_bf16 v[204:207], v[44:47], a[244:247], v[204:207]
    s_waitcnt vmcnt(18)
    v_mfma_f32_16x16x32_bf16 v[208:211], v[128:131], a[52:55], v[208:211]
    buffer_load_dwordx4 v[44:47], v4, s[40:43], s18 offen offset:3072 sc1
    v_mfma_f32_16x16x32_bf16 v[212:215], v[128:131], a[116:119], v[212:215]
    s_add_u32 s18, s18, 4096
    v_add3_u32 v9, v128, v129, v9
    v_add3_u32 v9, v130, v131, v9
    v_mfma_f32_16x16x32_bf16 v[216:219], v[128:131], a[180:183], v[216:219]
    v_mfma_f32_16x16x32_bf16 v[220:223], v[128:131], a[244:247], v[220:223]
    s_waitcnt vmcnt(18)
    v_mfma_f32_16x16x32_bf16 v[224:227], v[132:135], a[52:55], v[224:227]
    buffer_load_dwordx4 v[128:131], v4, s[40:43], s18 offen offset:0 sc1
    v_mfma_f32_16x16x32_bf16 v[228:231], v[132:135], a[116:119], v[228:231]
    v_add3_u32 v9, v132, v133, v9
    v_add3_u32 v9, v134, v135, v9
    v_mfma_f32_16x16x32_bf16 v[232:235], v[132:135], a[180:183], v[232:235]
    v_mfma_f32_16x16x32_bf16 v[236:239], v[132:135], a[244:247], v[236:239]
    s_waitcnt vmcnt(18)
    v_mfma_f32_16x16x32_bf16 v[192:195], v[136:139], a[56:59], v[192:195]
    buffer_load_dwordx4 v[132:135], v4, s[40:43], s18 offen offset:1024 sc1
    v_mfma_f32_16x16x32_bf16 v[196:199], v[136:139], a[120:123], v[196:199]
    v_add3_u32 v9, v136, v137, v9
    v_add3_u32 v9, v138, v139, v9
    v_mfma_f32_16x16x32_bf16 v[200:203], v[136:139], a[184:187], v[200:203]
    v_mfma_f32_16x16x32_bf16 v[204:207], v[136:139], a[248:251], v[204:207]
    s_waitcnt vmcnt(18)
    v_mfma_f32_16x16x32_bf16 v[208:211], v[80:83], a[56:59], v[208:211]
    buffer_load_dwordx4 v[136:139], v4, s[40:43], s18 offen offset:2048 sc1
    v_mfma_f32_16x16x32_bf16 v[212:215], v[80:83], a[120:123], v[212:215]
    v_add3_u32 v9, v80, v81, v9
    v_add3_u32 v9, v82, v83, v9
    v_mfma_f32_16x16x32_bf16 v[216:219], v[80:83], a[184:187], v[216:219]
    v_mfma_f32_16x16x32_bf16 v[220:223], v[80:83], a[248:251], v[220:223]
    s_waitcnt vmcnt(14)
    v_mfma_f32_16x16x32_bf16 v[244:247], v[100:103], a[64:67], v[244:247]
    buffer_load_dwordx4 v[80:83], v4, s[40:43], s18 offen offset:3072 sc1
    v_mfma_f32_16x16x32_bf16 v[240:243], v[100:103], a[0:3], v[240:243]
    v_mfma_f32_16x16x32_bf16 v[248:251], v[100:103], a[128:131], v[248:251]
    v_mfma_f32_16x16x32_bf16 v[252:255], v[100:103], a[192:195], v[252:255]
    s_waitcnt vmcnt(14)
    v_mfma_f32_16x16x32_bf16 v[244:247], v[104:107], a[68:71], v[244:247]
    v_mfma_f32_16x16x32_bf16 v[240:243], v[104:107], a[4:7], v[240:243]
    v_mfma_f32_16x16x32_bf16 v[248:251], v[104:107], a[132:135], v[248:251]
    v_mfma_f32_16x16x32_bf16 v[252:255], v[104:107], a[196:199], v[252:255]
    s_waitcnt vmcnt(13)
    v_mfma_f32_16x16x32_bf16 v[244:247], v[108:111], a[72:75], v[244:247]
    v_mfma_f32_16x16x32_bf16 v[240:243], v[108:111], a[8:11], v[240:243]
    v_mfma_f32_16x16x32_bf16 v[248:251], v[108:111], a[136:139], v[248:251]
    v_mfma_f32_16x16x32_bf16 v[252:255], v[108:111], a[200:203], v[252:255]
    s_waitcnt vmcnt(12)
    v_mfma_f32_16x16x32_bf16 v[244:247], v[112:115], a[76:79], v[244:247]
    v_mfma_f32_16x16x32_bf16 v[228:231], v[84:87], a[120:123], v[228:231]
    v_add3_u32 v9, v84, v85, v9
    v_add3_u32 v9, v86, v87, v9
    v_mfma_f32_16x16x32_bf16 v[240:243], v[112:115], a[12:15], v[240:243]
    v_mfma_f32_16x16x32_bf16 v[248:251], v[112:115], a[140:143], v[248:251]
    v_mfma_f32_16x16x32_bf16 v[252:255], v[112:115], a[204:207], v[252:255]
    v_mfma_f32_16x16x32_bf16 v[224:227], v[84:87], a[56:59], v[224:227]
    v_mfma_f32_16x16x32_bf16 v[196:199], v[88:91], a[124:127], v[196:199]
    v_add3_u32 v9, v88, v89, v9
    v_add3_u32 v9, v90, v91, v9
    v_mfma_f32_16x16x32_bf16 v[232:235], v[84:87], a[184:187], v[232:235]
    v_mfma_f32_16x16x32_bf16 v[212:215], v[92:95], a[124:127], v[212:215]
    v_add3_u32 v9, v92, v93, v9
    v_add3_u32 v9, v94, v95, v9
    s_waitcnt vmcnt(11)
    v_mfma_f32_16x16x32_bf16 v[244:247], v[16:19], a[80:83], v[244:247]
    v_mfma_f32_16x16x32_bf16 v[236:239], v[84:87], a[248:251], v[236:239]
    v_mfma_f32_16x16x32_bf16 v[228:231], v[96:99], a[124:127], v[228:231]
    v_add3_u32 v9, v96, v97, v9
    v_add3_u32 v9, v98, v99, v9
    v_mfma_f32_16x16x32_bf16 v[240:243], v[16:19], a[16:19], v[240:243]
    v_add3_u32 v9, v100, v101, v9
    v_add3_u32 v9, v102, v103, v9
    v_mfma_f32_16x16x32_bf16 v[248:251], v[16:19], a[144:147], v[248:251]
    v_add3_u32 v9, v104, v105, v9
    v_add3_u32 v9, v106, v107, v9
    v_mfma_f32_16x16x32_bf16 v[252:255], v[16:19], a[208:211], v[252:255]
    v_add3_u32 v9, v108, v109, v9
    v_add3_u32 v9, v110, v111, v9
    v_mfma_f32_16x16x32_bf16 v[192:195], v[88:91], a[60:63], v[192:195]
    v_add3_u32 v9, v112, v113, v9
    v_add3_u32 v9, v114, v115, v9
    v_mfma_f32_16x16x32_bf16 v[208:211], v[92:95], a[60:63], v[208:211]
    v_add3_u32 v9, v16, v17, v9
    v_add3_u32 v9, v18, v19, v9
    v_mfma_f32_16x16x32_bf16 v[224:227], v[96:99], a[60:63], v[224:227]
    s_nop 1
    ds_write_b128 v119, v[192:195] offset:0
    v_mfma_f32_16x16x32_bf16 v[200:203], v[88:91], a[188:191], v[200:203]
    v_mfma_f32_16x16x32_bf16 v[216:219], v[92:95], a[188:191], v[216:219]
    v_mfma_f32_16x16x32_bf16 v[232:235], v[96:99], a[188:191], v[232:235]
    ds_write_b128 v6, v[208:211] offset:0
    s_waitcnt vmcnt(10)
    v_mfma_f32_16x16x32_bf16 v[244:247], v[20:23], a[84:87], v[244:247]
    v_add3_u32 v9, v20, v21, v9
    v_add3_u32 v9, v22, v23, v9
    v_mfma_f32_16x16x32_bf16 v[204:207], v[88:91], a[252:255], v[204:207]
    v_mfma_f32_16x16x32_bf16 v[220:223], v[92:95], a[252:255], v[220:223]
    ds_write_b128 v7, v[224:227] offset:0
    v_mfma_f32_16x16x32_bf16 v[236:239], v[96:99], a[252:255], v[236:239]
    v_mfma_f32_16x16x32_bf16 v[240:243], v[20:23], a[20:23], v[240:243]
    v_mfma_f32_16x16x32_bf16 v[248:251], v[20:23], a[148:151], v[248:251]
    ds_write_b128 v119, v[196:199] offset:1024
    v_mfma_f32_16x16x32_bf16 v[252:255], v[20:23], a[212:215], v[252:255]
    s_waitcnt vmcnt(9)
    v_mfma_f32_16x16x32_bf16 v[244:247], v[24:27], a[88:91], v[244:247]
    v_add3_u32 v9, v24, v25, v9
    v_add3_u32 v9, v26, v27, v9
    v_mfma_f32_16x16x32_bf16 v[240:243], v[24:27], a[24:27], v[240:243]
    ds_write_b128 v6, v[212:215] offset:1024
    v_mfma_f32_16x16x32_bf16 v[248:251], v[24:27], a[152:155], v[248:251]
    v_mfma_f32_16x16x32_bf16 v[252:255], v[24:27], a[216:219], v[252:255]
    ds_write_b128 v7, v[228:231] offset:1024
    ds_write_b128 v119, v[200:203] offset:2048
    ds_write_b128 v6, v[216:219] offset:2048
    ds_write_b128 v7, v[232:235] offset:2048
    ds_write_b128 v119, v[204:207] offset:3072
    ds_write_b128 v6, v[220:223] offset:3072
    ds_write_b128 v7, v[236:239] offset:3072
    s_waitcnt vmcnt(8)
    v_mfma_f32_16x16x32_bf16 v[244:247], v[28:31], a[92:95], v[244:247]
    s_lshr_b32 s53, s46, 1
    s_add_u32 s53, s53, 0
    s_and_b32 s53, s53, 3
    v_mfma_f32_16x16x32_bf16 v[240:243], v[28:31], a[28:31], v[240:243]
    s_mul_i32 s53, s53, 28672
    s_add_u32 s53, s53, s58
    s_add_u32 m0, s59, 90112
    v_mfma_f32_16x16x32_bf16 v[248:251], v[28:31], a[156:159], v[248:251]
    s_add_u32 s52, s53, 0
    buffer_load_dwordx4 v4, s[40:43], s52 offen sc1 lds
    v_mfma_f32_16x16x32_bf16 v[252:255], v[28:31], a[220:223], v[252:255]
    s_add_u32 m0, s59, 94208
    s_add_u32 s52, s53, 4096
    v_add3_u32 v9, v28, v29, v9
    s_waitcnt vmcnt(8)
    v_mfma_f32_16x16x32_bf16 v[244:247], v[32:35], a[96:99], v[244:247]
    v_add3_u32 v9, v30, v31, v9
    v_add3_u32 v9, v32, v33, v9
    v_mfma_f32_16x16x32_bf16 v[240:243], v[32:35], a[32:35], v[240:243]
    v_add3_u32 v9, v34, v35, v9
    v_mfma_f32_16x16x32_bf16 v[248:251], v[32:35], a[160:163], v[248:251]
    buffer_load_dwordx4 v4, s[40:43], s52 offen sc1 lds
    v_mfma_f32_16x16x32_bf16 v[252:255], v[32:35], a[224:227], v[252:255]
    s_add_u32 m0, s59, 98304
    s_add_u32 s52, s53, 8192
    s_waitcnt vmcnt(8)
    v_mfma_f32_16x16x32_bf16 v[244:247], v[36:39], a[100:103], v[244:247]
    v_add3_u32 v9, v36, v37, v9
    v_add3_u32 v9, v38, v39, v9
    v_mfma_f32_16x16x32_bf16 v[240:243], v[36:39], a[36:39], v[240:243]
    v_mfma_f32_16x16x32_bf16 v[248:251], v[36:39], a[164:167], v[248:251]
    buffer_load_dwordx4 v4, s[40:43], s52 offen sc1 lds
    v_mfma_f32_16x16x32_bf16 v[252:255], v[36:39], a[228:231], v[252:255]
    s_add_u32 m0, s59, 102400
    s_add_u32 s52, s53, 12288
    s_waitcnt vmcnt(8)
    v_mfma_f32_16x16x32_bf16 v[244:247], v[40:43], a[104:107], v[244:247]
    v_add3_u32 v9, v40, v41, v9
    v_add3_u32 v9, v42, v43, v9
    v_mfma_f32_16x16x32_bf16 v[240:243], v[40:43], a[40:43], v[240:243]
    v_mfma_f32_16x16x32_bf16 v[248:251], v[40:43], a[168:171], v[248:251]
    buffer_load_dwordx4 v4, s[40:43], s52 offen sc1 lds
    v_mfma_f32_16x16x32_bf16 v[252:255], v[40:43], a[232:235], v[252:255]
    s_add_u32 m0, s59, 106496
    s_add_u32 s52, s53, 16384
    s_waitcnt vmcnt(8)
    v_mfma_f32_16x16x32_bf16 v[244:247], v[44:47], a[108:111], v[244:247]
    v_add3_u32 v9, v44, v45, v9
    v_add3_u32 v9, v46, v47, v9
    v_mfma_f32_16x16x32_bf16 v[240:243], v[44:47], a[44:47], v[240:243]
    v_mfma_f32_16x16x32_bf16 v[248:251], v[44:47], a[172:175], v[248:251]
    buffer_load_dwordx4 v4, s[40:43], s52 offen sc1 lds
    v_mfma_f32_16x16x32_bf16 v[252:255], v[44:47], a[236:239], v[252:255]
    s_add_u32 m0, s59, 110592
    s_add_u32 s52, s53, 20480
    s_waitcnt vmcnt(8)
    v_mfma_f32_16x16x32_bf16 v[244:247], v[128:131], a[112:115], v[244:247]
    v_add3_u32 v9, v128, v129, v9
    v_add3_u32 v9, v130, v131, v9
    v_mfma_f32_16x16x32_bf16 v[240:243], v[128:131], a[48:51], v[240:243]
    v_mfma_f32_16x16x32_bf16 v[248:251], v[128:131], a[176:179], v[248:251]
    buffer_load_dwordx4 v4, s[40:43], s52 offen sc1 lds
    v_mfma_f32_16x16x32_bf16 v[252:255], v[128:131], a[240:243], v[252:255]
    s_add_u32 m0, s59, 114688
    s_add_u32 s52, s53, 24576
    s_lshr_b32 s53, s46, 1
    s_waitcnt vmcnt(8)
    v_mfma_f32_16x16x32_bf16 v[244:247], v[132:135], a[116:119], v[244:247]
    s_add_u32 s53, s53, 1
    s_and_b32 s53, s53, 3
    s_mul_i32 s53, s53, 28672
    v_mfma_f32_16x16x32_bf16 v[240:243], v[132:135], a[52:55], v[240:243]
    s_add_u32 s53, s53, s58
    v_add3_u32 v9, v132, v133, v9
    v_add3_u32 v9, v134, v135, v9
    v_mfma_f32_16x16x32_bf16 v[248:251], v[132:135], a[180:183], v[248:251]
    buffer_load_dwordx4 v4, s[40:43], s52 offen sc1 lds
    v_mfma_f32_16x16x32_bf16 v[252:255], v[132:135], a[244:247], v[252:255]
    s_add_u32 m0, s59, 118784
    s_add_u32 s52, s53, 0
    s_waitcnt vmcnt(8)
    v_mfma_f32_16x16x32_bf16 v[244:247], v[136:139], a[120:123], v[244:247]
    v_add3_u32 v9, v136, v137, v9
    v_add3_u32 v9, v138, v139, v9
    v_mfma_f32_16x16x32_bf16 v[240:243], v[136:139], a[56:59], v[240:243]
    v_mfma_f32_16x16x32_bf16 v[248:251], v[136:139], a[184:187], v[248:251]
    buffer_load_dwordx4 v4, s[40:43], s52 offen sc1 lds
    v_mfma_f32_16x16x32_bf16 v[252:255], v[136:139], a[248:251], v[252:255]
    s_add_u32 m0, s59, 122880
    s_add_u32 s52, s53, 4096
    s_waitcnt vmcnt(8)
    v_mfma_f32_16x16x32_bf16 v[244:247], v[80:83], a[124:127], v[244:247]
    v_add3_u32 v9, v80, v81, v9
    v_add3_u32 v9, v82, v83, v9
    v_mfma_f32_16x16x32_bf16 v[240:243], v[80:83], a[60:63], v[240:243]
    v_mfma_f32_16x16x32_bf16 v[248:251], v[80:83], a[188:191], v[248:251]
    buffer_load_dwordx4 v4, s[40:43], s52 offen sc1 lds
    v_mfma_f32_16x16x32_bf16 v[252:255], v[80:83], a[252:255], v[252:255]
    s_add_u32 m0, s59, 126976
    s_add_u32 s52, s53, 8192
    buffer_load_dwordx4 v4, s[40:43], s52 offen sc1 lds
    s_add_u32 m0, s59, 131072
    s_add_u32 s52, s53, 12288
    buffer_load_dwordx4 v4, s[40:43], s52 offen sc1 lds
    s_add_u32 m0, s59, 135168
    s_add_u32 s52, s53, 16384
    buffer_load_dwordx4 v4, s[40:43], s52 offen sc1 lds
    s_add_u32 m0, s59, 139264
    s_add_u32 s52, s53, 20480
    buffer_load_dwordx4 v4, s[40:43], s52 offen sc1 lds
    s_add_u32 m0, s59, 143360
    s_add_u32 s52, s53, 24576
    s_lshr_b32 s53, s46, 1
    s_add_u32 s53, s53, 2
    s_and_b32 s53, s53, 3
    s_mul_i32 s53, s53, 28672
    s_add_u32 s53, s53, s58
    buffer_load_dwordx4 v4, s[40:43], s52 offen sc1 lds
    s_add_u32 m0, s59, 147456
    s_add_u32 s52, s53, 0
    buffer_load_dwordx4 v4, s[40:43], s52 offen sc1 lds
    s_add_u32 m0, s59, 151552
    s_add_u32 s52, s53, 4096
    buffer_load_dwordx4 v4, s[40:43], s52 offen sc1 lds
    s_add_u32 m0, s59, 155648
    s_add_u32 s52, s53, 8192
    buffer_load_dwordx4 v4, s[40:43], s52 offen sc1 lds
    s_add_u32 m0, s59, 159744
    s_add_u32 s52, s53, 12288
    buffer_load_dwordx4 v4, s[40:43], s52 offen sc1 lds
    v_add_u32_dpp v9, v9, v9 row_ror:8 row_mask:0xf bank_mask:0xf
    s_nop 1
    v_add_u32_dpp v9, v9, v9 row_ror:4 row_mask:0xf bank_mask:0xf
    s_nop 1
    v_add_u32_dpp v9, v9, v9 row_ror:2 row_mask:0xf bank_mask:0xf
    s_nop 1
    v_add_u32_dpp v9, v9, v9 row_ror:1 row_mask:0xf bank_mask:0xf
    s_nop 0
    v_readlane_b32 s50, v9, 0
    v_readlane_b32 s51, v9, 16
    v_readlane_b32 s56, v9, 32
    v_readlane_b32 s57, v9, 48
    s_add_u32 s50, s50, s51
    s_nop 0
    s_add_u32 s56, s56, s57
    s_add_u32 s50, s50, s56
    s_cmp_lg_u32 s50, 0
    s_cbranch_scc1 L_zsum_36
L_zok_37:
    s_waitcnt lgkmcnt(0)
    s_barrier
    ds_read_b128 v[144:147], v140 offset:0
    ds_read_b128 v[148:151], v140 offset:4096
    ds_read_b128 v[152:155], v140 offset:8192
    ds_read_b128 v[156:159], v140 offset:12288
    ds_read_b128 v[160:163], v140 offset:16384
    ds_read_b128 v[164:167], v140 offset:20480
    v_mov_b32 v33, s44
    v_lshlrev_b32 v35, 8, v3
    ds_read_b128 v[168:171], v140 offset:1024
    ds_read_b128 v[172:175], v140 offset:5120
    ds_read_b128 v[176:179], v140 offset:9216
    ds_read_b128 v[180:183], v140 offset:13312
    ds_read_b128 v[184:187], v140 offset:17408
    ds_read_b128 v[188:191], v140 offset:21504
    ds_read_b128 v[192:195], v140 offset:2048
    s_waitcnt lgkmcnt(12)
    v_pk_add_f32 v[240:241], v[240:241], v[144:145]
    ds_read_b128 v[196:199], v140 offset:6144
    v_pk_add_f32 v[242:243], v[242:243], v[146:147]
    s_waitcnt lgkmcnt(12)
    v_pk_add_f32 v[240:241], v[240:241], v[148:149]
    v_pk_add_f32 v[242:243], v[242:243], v[150:151]
    ds_read_b128 v[200:203], v140 offset:10240
    s_waitcnt lgkmcnt(12)
    v_pk_add_f32 v[240:241], v[240:241], v[152:153]
    v_pk_add_f32 v[242:243], v[242:243], v[154:155]
    s_waitcnt lgkmcnt(11)
    v_pk_add_f32 v[224:225], v[224:225], v[156:157]
    ds_read_b128 v[204:207], v140 offset:14336
    v_pk_add_f32 v[226:227], v[226:227], v[158:159]
    s_waitcnt lgkmcnt(11)
    v_pk_add_f32 v[224:225], v[224:225], v[160:161]
    v_pk_add_f32 v[226:227], v[226:227], v[162:163]
    ds_read_b128 v[208:211], v140 offset:18432
    s_waitcnt lgkmcnt(11)
    v_pk_add_f32 v[224:225], v[224:225], v[164:165]
    v_pk_add_f32 v[226:227], v[226:227], v[166:167]
    v_pk_mul_f32 v[224:225], v[224:225], v[64:65]
    ds_read_b128 v[212:215], v140 offset:22528
    v_pk_mul_f32 v[226:227], v[226:227], v[66:67]
    v_pk_mul_f32 v[240:241], v[240:241], v[48:49]
    v_pk_mul_f32 v[242:243], v[242:243], v[50:51]
    ds_read_b128 v[144:147], v140 offset:3072
    v_cvt_pk_bf16_f32 v18, v224, v225
    v_cvt_pk_bf16_f32 v19, v226, v227
    v_cvt_pk_bf16_f32 v16, v240, v241
    ds_read_b128 v[148:151], v140 offset:7168
    v_cvt_pk_bf16_f32 v17, v242, v243
    v_and_b32 v18, s67, v18
    v_and_b32 v19, s67, v19
    ds_read_b128 v[152:155], v140 offset:11264
    buffer_store_dwordx4 v[16:19], v4, s[40:43], s20 offen sc1
    s_add_u32 s20, s20, 32768
    ds_read_b128 v[156:159], v140 offset:15360
    s_waitcnt lgkmcnt(12)
    v_pk_add_f32 v[228:229], v[228:229], v[180:181]
    v_pk_add_f32 v[230:231], v[230:231], v[182:183]
    buffer_store_dwordx2 v[16:17], v4, s[40:43], s23 offen sc1
    s_add_u32 s23, s23, 32768
    ds_read_b128 v[160:163], v140 offset:19456
    v_pk_add_f32 v[244:245], v[244:245], v[168:169]
    ds_read_b128 v[164:167], v140 offset:23552
    v_pk_add_f32 v[246:247], v[246:247], v[170:171]
    s_waitcnt lgkmcnt(13)
    v_pk_add_f32 v[228:229], v[228:229], v[184:185]
    v_pk_add_f32 v[230:231], v[230:231], v[186:187]
    v_pk_add_f32 v[244:245], v[244:245], v[172:173]
    v_pk_add_f32 v[246:247], v[246:247], v[174:175]
    s_waitcnt lgkmcnt(12)
    v_pk_add_f32 v[228:229], v[228:229], v[188:189]
    v_pk_add_f32 v[230:231], v[230:231], v[190:191]
    v_pk_add_f32 v[244:245], v[244:245], v[176:177]
    v_pk_add_f32 v[246:247], v[246:247], v[178:179]
    v_pk_mul_f32 v[228:229], v[228:229], v[68:69]
    v_pk_mul_f32 v[230:231], v[230:231], v[70:71]
    v_pk_mul_f32 v[244:245], v[244:245], v[52:53]
    v_pk_mul_f32 v[246:247], v[246:247], v[54:55]
    v_cvt_pk_bf16_f32 v22, v228, v229
    v_cvt_pk_bf16_f32 v23, v230, v231
    v_cvt_pk_bf16_f32 v20, v244, v245
    v_cvt_pk_bf16_f32 v21, v246, v247
    v_and_b32 v22, s67, v22
    v_and_b32 v23, s67, v23
    buffer_store_dwordx4 v[20:23], v4, s[40:43], s20 offen sc1
    s_add_u32 s20, s20, 32768
    s_waitcnt lgkmcnt(8)
    v_pk_add_f32 v[232:233], v[232:233], v[204:205]
    v_pk_add_f32 v[234:235], v[234:235], v[206:207]
    v_pk_add_f32 v[248:249], v[248:249], v[192:193]
    buffer_store_dwordx2 v[20:21], v4, s[40:43], s23 offen sc1
    s_add_u32 s23, s23, 32768
    v_pk_add_f32 v[250:251], v[250:251], v[194:195]
    s_waitcnt lgkmcnt(7)
    v_pk_add_f32 v[232:233], v[232:233], v[208:209]
    v_pk_add_f32 v[234:235], v[234:235], v[210:211]
    v_pk_add_f32 v[248:249], v[248:249], v[196:197]
    v_pk_add_f32 v[250:251], v[250:251], v[198:199]
    s_waitcnt lgkmcnt(6)
    v_pk_add_f32 v[232:233], v[232:233], v[212:213]
    v_pk_add_f32 v[234:235], v[234:235], v[214:215]
    v_pk_add_f32 v[248:249], v[248:249], v[200:201]
    v_pk_add_f32 v[250:251], v[250:251], v[202:203]
    v_pk_mul_f32 v[232:233], v[232:233], v[72:73]
    v_pk_mul_f32 v[234:235], v[234:235], v[74:75]
    v_pk_mul_f32 v[248:249], v[248:249], v[56:57]
    v_pk_mul_f32 v[250:251], v[250:251], v[58:59]
    v_cvt_pk_bf16_f32 v26, v232, v233
    v_cvt_pk_bf16_f32 v27, v234, v235
    v_cvt_pk_bf16_f32 v24, v248, v249
    v_cvt_pk_bf16_f32 v25, v250, v251
    v_and_b32 v26, s67, v26
    v_and_b32 v27, s67, v27
    buffer_store_dwordx4 v[24:27], v4, s[40:43], s20 offen sc1
    s_add_u32 s20, s20, 32768
    s_waitcnt lgkmcnt(2)
    v_pk_add_f32 v[236:237], v[236:237], v[156:157]
    v_pk_add_f32 v[238:239], v[238:239], v[158:159]
    v_pk_add_f32 v[252:253], v[252:253], v[144:145]
    buffer_store_dwordx2 v[24:25], v4, s[40:43], s23 offen sc1
    s_add_u32 s23, s23, 32768
    v_pk_add_f32 v[254:255], v[254:255], v[146:147]
    s_waitcnt lgkmcnt(1)
    v_pk_add_f32 v[236:237], v[236:237], v[160:161]
    v_pk_add_f32 v[238:239], v[238:239], v[162:163]
    v_pk_add_f32 v[252:253], v[252:253], v[148:149]
    v_pk_add_f32 v[254:255], v[254:255], v[150:151]
    s_waitcnt lgkmcnt(0)
    v_pk_add_f32 v[236:237], v[236:237], v[164:165]
    v_pk_add_f32 v[238:239], v[238:239], v[166:167]
    v_pk_add_f32 v[252:253], v[252:253], v[152:153]
    v_pk_add_f32 v[254:255], v[254:255], v[154:155]
    v_pk_mul_f32 v[236:237], v[236:237], v[76:77]
    v_pk_mul_f32 v[238:239], v[238:239], v[78:79]
    v_pk_mul_f32 v[252:253], v[252:253], v[60:61]
    v_pk_mul_f32 v[254:255], v[254:255], v[62:63]
    v_cvt_pk_bf16_f32 v30, v236, v237
    v_cvt_pk_bf16_f32 v31, v238, v239
    v_cvt_pk_bf16_f32 v28, v252, v253
    v_cvt_pk_bf16_f32 v29, v254, v255
    v_and_b32 v30, s67, v30
    v_and_b32 v31, s67, v31
    buffer_store_dwordx4 v[28:31], v4, s[40:43], s20 offen sc1
    v_add3_u32 v32, v16, v17, v18
    v_add3_u32 v34, v20, v21, v22
    v_add3_u32 v36, v24, v25, v26
    buffer_store_dwordx2 v[28:29], v4, s[40:43], s23 offen sc1
    v_add3_u32 v38, v28, v29, v30
    v_add_u32 v32, v32, v19
    v_add_u32 v34, v34, v23
    v_add_u32 v36, v36, v27
    v_add_u32 v38, v38, v31
    s_nop 0
    v_permlane32_swap_b32 v32, v36
    v_add_u32 v32, v32, v36
    v_permlane32_swap_b32 v34, v38
    v_add_u32 v34, v34, v38
    s_nop 1
    v_permlane16_swap_b32 v32, v34
    v_add_u32 v32, v32, v34
    s_nop 1
    v_add_u32_dpp v32, v32, v32 row_ror:8 row_mask:0xf bank_mask:0xf
    s_nop 1
    v_add_u32_dpp v32, v32, v32 row_ror:4 row_mask:0xf bank_mask:0xf
    s_nop 1
    v_add_u32_dpp v32, v32, v32 row_ror:2 row_mask:0xf bank_mask:0xf
    s_nop 1
    v_add_u32_dpp v32, v32, v32 row_ror:1 row_mask:0xf bank_mask:0xf
    s_mov_b32 exec_lo, 0x10001
    s_mov_b32 exec_hi, 0x10001
    buffer_store_dwordx2 v[32:33], v35, s[40:43], s21 offen sc1
    s_mov_b64 exec, -1
    v_and_b32 v114, 31, v1
    v_lshlrev_b32 v114, 3, v114
    v_add_u32 v112, 90112, v4
    v_add_u32 v115, 155648, v4
    v_add_u32 v113, s47, v5
    v_lshlrev_b32 v113, 10, v113
    v_lshl_add_u32 v113, v3, 4, v113
    s_waitcnt vmcnt(9)
    s_barrier
    s_lshl_b32 s58, s46, 17
    s_lshl_b32 s59, s3, 10
    s_add_u32 s58, s58, s59
    s_add_u32 s58, s58, 11534336
    ds_read_b128 a[0:3], v112 offset:0
    ds_read_b128 a[4:7], v112 offset:1024
    ds_read_b128 a[8:11], v112 offset:2048
    ds_read_b128 a[12:15], v112 offset:3072
    ds_read_b128 a[16:19], v112 offset:4096
    s_lshr_b32 s53, s46, 1
    s_add_u32 s53, s53, 2
    s_and_b32 s53, s53, 3
    s_mul_i32 s53, s53, 28672
    s_add_u32 s53, s53, s58
    s_add_u32 m0, s59, 0
    s_add_u32 s52, s53, 16384
    buffer_load_dwordx4 v4, s[40:43], s52 offen sc1 lds
    ds_read_b128 a[20:23], v112 offset:5120
    ds_read_b128 a[24:27], v112 offset:6144
    ds_read_b128 a[28:31], v112 offset:7168
    ds_read_b128 a[32:35], v112 offset:8192
    ds_read_b128 a[36:39], v112 offset:9216
    ds_read_b128 a[40:43], v112 offset:10240
    s_add_u32 m0, s59, 4096
    s_add_u32 s52, s53, 20480
    buffer_load_dwordx4 v4, s[40:43], s52 offen sc1 lds
    ds_read_b128 a[44:47], v112 offset:11264
    ds_read_b128 a[48:51], v112 offset:12288
    ds_read_b128 a[52:55], v112 offset:13312
    ds_read_b128 a[56:59], v112 offset:14336
    ds_read_b128 a[60:63], v112 offset:15360
    ds_read_b128 a[64:67], v112 offset:16384
    s_add_u32 m0, s59, 8192
    s_add_u32 s52, s53, 24576
    buffer_load_dwordx4 v4, s[40:43], s52 offen sc1 lds
    ds_read_b128 a[68:71], v112 offset:17408
    ds_read_b128 a[72:75], v112 offset:18432
    ds_read_b128 a[76:79], v112 offset:19456
    ds_read_b128 a[80:83], v112 offset:20480
    ds_read_b128 a[84:87], v112 offset:21504
    ds_read_b128 a[88:91], v112 offset:22528
    s_lshr_b32 s53, s46, 1
    s_add_u32 s53, s53, 3
    s_and_b32 s53, s53, 3
    s_mul_i32 s53, s53, 28672
    s_add_u32 s53, s53, s58
    s_add_u32 m0, s59, 12288
    s_add_u32 s52, s53, 0
    buffer_load_dwordx4 v4, s[40:43], s52 offen sc1 lds
    ds_read_b128 a[92:95], v112 offset:23552
    ds_read_b128 a[96:99], v112 offset:24576
    ds_read_b128 a[100:103], v112 offset:25600
    ds_read_b128 a[104:107], v112 offset:26624
    ds_read_b128 a[108:111], v112 offset:27648
    ds_read_b128 a[112:115], v112 offset:28672
    s_add_u32 m0, s59, 16384
    s_add_u32 s52, s53, 4096
    buffer_load_dwordx4 v4, s[40:43], s52 offen sc1 lds
    ds_read_b128 a[116:119], v112 offset:29696
    ds_read_b128 a[120:123], v112 offset:30720
    ds_read_b128 a[124:127], v112 offset:31744
    ds_read_b128 a[128:131], v112 offset:32768
    ds_read_b128 a[132:135], v112 offset:33792
    ds_read_b128 a[136:139], v112 offset:34816
    s_add_u32 m0, s59, 20480
    s_add_u32 s52, s53, 8192
    buffer_load_dwordx4 v4, s[40:43], s52 offen sc1 lds
    ds_read_b128 a[140:143], v112 offset:35840
    ds_read_b128 a[144:147], v112 offset:36864
    ds_read_b128 a[148:151], v112 offset:37888
    ds_read_b128 a[152:155], v112 offset:38912
    ds_read_b128 a[156:159], v112 offset:39936
    ds_read_b128 a[160:163], v112 offset:40960
    s_add_u32 m0, s59, 24576
    s_add_u32 s52, s53, 12288
    buffer_load_dwordx4 v4, s[40:43], s52 offen sc1 lds
    ds_read_b128 a[164:167], v112 offset:41984
    ds_read_b128 a[168:171], v112 offset:43008
    ds_read_b128 a[172:175], v112 offset:44032
    ds_read_b128 a[176:179], v112 offset:45056
    ds_read_b128 a[180:183], v112 offset:46080
    ds_read_b128 a[184:187], v112 offset:47104
    s_add_u32 m0, s59, 28672
    s_add_u32 s52, s53, 16384
    buffer_load_dwordx4 v4, s[40:43], s52 offen sc1 lds
    ds_read_b128 a[188:191], v112 offset:48128
    ds_read_b128 a[192:195], v112 offset:49152
    ds_read_b128 a[196:199], v112 offset:50176
    ds_read_b128 a[200:203], v112 offset:51200
    ds_read_b128 a[204:207], v112 offset:52224
    ds_read_b128 a[208:211], v112 offset:53248
    s_add_u32 m0, s59, 32768
    s_add_u32 s52, s53, 20480
    buffer_load_dwordx4 v4, s[40:43], s52 offen sc1 lds
    ds_read_b128 a[212:215], v112 offset:54272
    ds_read_b128 a[216:219], v112 offset:55296
    ds_read_b128 a[220:223], v112 offset:56320
    ds_read_b128 a[224:227], v112 offset:57344
    ds_read_b128 a[228:231], v112 offset:58368
    ds_read_b128 a[232:235], v112 offset:59392
    s_add_u32 m0, s59, 36864
    s_add_u32 s52, s53, 24576
    buffer_load_dwordx4 v4, s[40:43], s52 offen sc1 lds
    ds_read_b128 a[236:239], v112 offset:60416
    ds_read_b128 a[240:243], v112 offset:61440
    ds_read_b128 a[244:247], v112 offset:62464
    ds_read_b128 a[248:251], v112 offset:63488
    ds_read_b128 a[252:255], v112 offset:64512
    v_lshlrev_b32 v96, 16, v120
    v_and_b32 v97, 0xffff0000, v120
    v_lshlrev_b32 v98, 16, v121
    v_and_b32 v99, 0xffff0000, v121
    v_lshlrev_b32 v100, 16, v122
    v_and_b32 v101, 0xffff0000, v122
    v_lshlrev_b32 v102, 16, v123
    v_and_b32 v103, 0xffff0000, v123
    v_lshlrev_b32 v104, 16, v124
    v_and_b32 v105, 0xffff0000, v124
    v_lshlrev_b32 v106, 16, v125
    v_and_b32 v107, 0xffff0000, v125
    v_lshlrev_b32 v108, 16, v126
    v_and_b32 v109, 0xffff0000, v126
    v_lshlrev_b32 v110, 16, v127
    v_and_b32 v111, 0xffff0000, v127
    v_sub_f32 v96, v96, v8
    v_sub_f32 v97, v97, v8
    v_sub_f32 v98, v98, v8
    v_sub_f32 v99, v99, v8
    v_sub_f32 v100, v100, v8
    v_sub_f32 v101, v101, v8
    v_sub_f32 v102, v102, v8
    v_sub_f32 v103, v103, v8
    v_sub_f32 v104, v104, v8
    v_sub_f32 v105, v105, v8
    v_sub_f32 v106, v106, v8
    v_sub_f32 v107, v107, v8
    v_sub_f32 v108, v108, v8
    v_sub_f32 v109, v109, v8
    v_sub_f32 v110, v110, v8
    v_sub_f32 v111, v111, v8
    buffer_load_dwordx2 v[10:11], v114, s[40:43], s61 offen sc1
    s_lshr_b32 s62, s46, 1
    s_add_u32 s62, s62, 0
    s_and_b32 s62, s62, 3
    s_mul_i32 s62, s62, 7168
    s_add_u32 s62, s62, s60
    buffer_load_dwordx4 v[128:131], v4, s[40:43], s62 offen offset:0 sc1
    buffer_load_dwordx4 v[132:135], v4, s[40:43], s62 offen offset:1024 sc1
    buffer_load_dwordx4 v[136:139], v4, s[40:43], s62 offen offset:2048 sc1
    buffer_load_dwordx4 v[140:143], v4, s[40:43], s62 offen offset:3072 sc1
    s_add_u32 s62, s62, 4096
    buffer_load_dwordx4 v[144:147], v4, s[40:43], s62 offen offset:0 sc1
    buffer_load_dwordx4 v[148:151], v4, s[40:43], s62 offen offset:1024 sc1
    buffer_load_dwordx4 v[152:155], v4, s[40:43], s62 offen offset:2048 sc1
    s_lshr_b32 s62, s46, 1
    s_add_u32 s62, s62, 1
    s_and_b32 s62, s62, 3
    s_mul_i32 s62, s62, 7168
    s_add_u32 s62, s62, s60
    buffer_load_dwordx4 v[156:159], v4, s[40:43], s62 offen offset:0 sc1
    buffer_load_dwordx4 v[160:163], v4, s[40:43], s62 offen offset:1024 sc1
    buffer_load_dwordx4 v[164:167], v4, s[40:43], s62 offen offset:2048 sc1
    buffer_load_dwordx4 v[168:171], v4, s[40:43], s62 offen offset:3072 sc1
    s_add_u32 s62, s62, 4096
    buffer_load_dwordx4 v[172:175], v4, s[40:43], s62 offen offset:0 sc1
    s_waitcnt vmcnt(12)
    v_cmp_ne_u32 vcc, s44, v11
    s_nop 1
    s_cmp_lg_u64 vcc, 0
    s_cbranch_scc1 L_vtag_47
L_vtagok_48:
    s_barrier
L_vtry_44:
    v_sub_u32 v9, 0, v10
    v_cmp_gt_u32 vcc, 32, v1
    s_nop 1
    v_cndmask_b32 v9, 0, v9, vcc
    s_waitcnt vmcnt(11)
    s_waitcnt lgkmcnt(15)
    v_mfma_f32_16x16x32_bf16 v[76:79], a[12:15], v[128:131], v[108:111]
    buffer_load_dwordx4 v[176:179], v4, s[40:43], s62 offen offset:1024 sc1
    v_mfma_f32_16x16x32_bf16 v[64:67], a[0:3], v[128:131], v[96:99]
    v_add3_u32 v9, v128, v129, v9
    v_add3_u32 v9, v130, v131, v9
    v_mfma_f32_16x16x32_bf16 v[68:71], a[4:7], v[128:131], v[100:103]
    ds_read_b128 a[0:3], v115 offset:0
    v_mfma_f32_16x16x32_bf16 v[72:75], a[8:11], v[128:131], v[104:107]
    ds_read_b128 a[4:7], v115 offset:1024
    s_waitcnt vmcnt(11)
    s_waitcnt lgkmcnt(15)
    v_mfma_f32_16x16x32_bf16 v[76:79], a[28:31], v[132:135], v[76:79]
    buffer_load_dwordx4 v[180:183], v4, s[40:43], s62 offen offset:2048 sc1
    v_mfma_f32_16x16x32_bf16 v[64:67], a[16:19], v[132:135], v[64:67]
    s_lshr_b32 s62, s46, 1
    s_add_u32 s62, s62, 2
    s_and_b32 s62, s62, 3
    v_mfma_f32_16x16x32_bf16 v[68:71], a[20:23], v[132:135], v[68:71]
    s_mul_i32 s62, s62, 7168
    s_add_u32 s62, s62, s60
    ds_read_b128 a[8:11], v115 offset:2048
    v_mfma_f32_16x16x32_bf16 v[72:75], a[24:27], v[132:135], v[72:75]
    ds_read_b128 a[12:15], v115 offset:3072
    ds_read_b128 a[16:19], v115 offset:4096
    s_waitcnt vmcnt(11)
    s_waitcnt lgkmcnt(15)
    v_mfma_f32_16x16x32_bf16 v[76:79], a[44:47], v[136:139], v[76:79]
    buffer_load_dwordx4 v[184:187], v4, s[40:43], s62 offen offset:0 sc1
    v_mfma_f32_16x16x32_bf16 v[64:67], a[32:35], v[136:139], v[64:67]
    ds_read_b128 a[20:23], v115 offset:5120
    ds_read_b128 a[24:27], v115 offset:6144
    v_mfma_f32_16x16x32_bf16 v[68:71], a[36:39], v[136:139], v[68:71]
    ds_read_b128 a[28:31], v115 offset:7168
    ds_read_b128 a[32:35], v4 offset:0
    v_mfma_f32_16x16x32_bf16 v[72:75], a[40:43], v[136:139], v[72:75]
    ds_read_b128 a[36:39], v4 offset:1024
    v_add3_u32 v9, v132, v133, v9
    s_waitcnt vmcnt(11)
    s_waitcnt lgkmcnt(15)
    v_mfma_f32_16x16x32_bf16 v[76:79], a[60:63], v[140:143], v[76:79]
    buffer_load_dwordx4 v[188:191], v4, s[40:43], s62 offen offset:1024 sc1
    v_mfma_f32_16x16x32_bf16 v[64:67], a[48:51], v[140:143], v[64:67]
    ds_read_b128 a[40:43], v4 offset:2048
    ds_read_b128 a[44:47], v4 offset:3072
    v_mfma_f32_16x16x32_bf16 v[68:71], a[52:55], v[140:143], v[68:71]
    ds_read_b128 a[48:51], v4 offset:4096
    v_add3_u32 v9, v134, v135, v9
    v_mfma_f32_16x16x32_bf16 v[72:75], a[56:59], v[140:143], v[72:75]
    ds_read_b128 a[52:55], v4 offset:5120
    v_add3_u32 v9, v136, v137, v9
    s_waitcnt vmcnt(11)
    s_waitcnt lgkmcnt(15)
    v_mfma_f32_16x16x32_bf16 v[76:79], a[76:79], v[144:147], v[76:79]
    buffer_load_dwordx4 v[192:195], v4, s[40:43], s62 offen offset:2048 sc1
    v_mfma_f32_16x16x32_bf16 v[64:67], a[64:67], v[144:147], v[64:67]
    ds_read_b128 a[56:59], v4 offset:6144
    ds_read_b128 a[60:63], v4 offset:7168
    v_mfma_f32_16x16x32_bf16 v[68:71], a[68:71], v[144:147], v[68:71]
    ds_read_b128 a[64:67], v4 offset:8192
    v_add3_u32 v9, v138, v139, v9
    v_mfma_f32_16x16x32_bf16 v[72:75], a[72:75], v[144:147], v[72:75]
    ds_read_b128 a[68:71], v4 offset:9216
    v_add3_u32 v9, v140, v141, v9
    s_waitcnt vmcnt(11)
    s_waitcnt lgkmcnt(15)
    v_mfma_f32_16x16x32_bf16 v[76:79], a[92:95], v[148:151], v[76:79]
    buffer_load_dwordx4 v[196:199], v4, s[40:43], s62 offen offset:3072 sc1
    v_mfma_f32_16x16x32_bf16 v[64:67], a[80:83], v[148:151], v[64:67]
    s_add_u32 s62, s62, 4096
    ds_read_b128 a[72:75], v4 offset:10240
    ds_read_b128 a[76:79], v4 offset:11264
    v_mfma_f32_16x16x32_bf16 v[68:71], a[84:87], v[148:151], v[68:71]
    ds_read_b128 a[80:83], v4 offset:12288
    v_add3_u32 v9, v142, v143, v9
    v_mfma_f32_16x16x32_bf16 v[72:75], a[88:91], v[148:151], v[72:75]
    ds_read_b128 a[84:87], v4 offset:13312
    v_add3_u32 v9, v144, v145, v9
    s_waitcnt vmcnt(11)
    s_waitcnt lgkmcnt(15)
    v_mfma_f32_16x16x32_bf16 v[76:79], a[108:111], v[152:155], v[76:79]
    buffer_load_dwordx4 v[200:203], v4, s[40:43], s62 offen offset:0 sc1
    v_mfma_f32_16x16x32_bf16 v[64:67], a[96:99], v[152:155], v[64:67]
    ds_read_b128 a[88:91], v4 offset:14336
    ds_read_b128 a[92:95], v4 offset:15360
    v_mfma_f32_16x16x32_bf16 v[68:71], a[100:103], v[152:155], v[68:71]
    ds_read_b128 a[96:99], v4 offset:16384
    v_add3_u32 v9, v146, v147, v9
    v_mfma_f32_16x16x32_bf16 v[72:75], a[104:107], v[152:155], v[72:75]
    ds_read_b128 a[100:103], v4 offset:17408
    v_add3_u32 v9, v148, v149, v9
    s_waitcnt vmcnt(11)
    s_waitcnt lgkmcnt(15)
    v_mfma_f32_16x16x32_bf16 v[76:79], a[124:127], v[156:159], v[76:79]
    buffer_load_dwordx4 v[204:207], v4, s[40:43], s62 offen offset:1024 sc1
    v_mfma_f32_16x16x32_bf16 v[64:67], a[112:115], v[156:159], v[64:67]
    ds_read_b128 a[104:107], v4 offset:18432
    ds_read_b128 a[108:111], v4 offset:19456
    v_mfma_f32_16x16x32_bf16 v[68:71], a[116:119], v[156:159], v[68:71]
    ds_read_b128 a[112:115], v4 offset:20480
    v_add3_u32 v9, v150, v151, v9
    v_mfma_f32_16x16x32_bf16 v[72:75], a[120:123], v[156:159], v[72:75]
    ds_read_b128 a[116:119], v4 offset:21504
    v_add3_u32 v9, v152, v153, v9
    s_waitcnt vmcnt(11)
    s_waitcnt lgkmcnt(15)
    v_mfma_f32_16x16x32_bf16 v[76:79], a[140:143], v[160:163], v[76:79]
    buffer_load_dwordx4 v[208:211], v4, s[40:43], s62 offen offset:2048 sc1
    v_mfma_f32_16x16x32_bf16 v[64:67], a[128:131], v[160:163], v[64:67]
    s_lshr_b32 s62, s46, 1
    s_add_u32 s62, s62, 3
    s_and_b32 s62, s62, 3
    v_mfma_f32_16x16x32_bf16 v[68:71], a[132:135], v[160:163], v[68:71]
    s_mul_i32 s62, s62, 7168
    s_add_u32 s62, s62, s60
    ds_read_b128 a[120:123], v4 offset:22528
    v_mfma_f32_16x16x32_bf16 v[72:75], a[136:139], v[160:163], v[72:75]
    ds_read_b128 a[124:127], v4 offset:23552
    ds_read_b128 a[128:131], v4 offset:24576
    s_waitcnt vmcnt(11)
    s_waitcnt lgkmcnt(15)
    v_mfma_f32_16x16x32_bf16 v[76:79], a[156:159], v[164:167], v[76:79]
    buffer_load_dwordx4 v[212:215], v4, s[40:43], s62 offen offset:0 sc1
    v_mfma_f32_16x16x32_bf16 v[64:67], a[144:147], v[164:167], v[64:67]
    ds_read_b128 a[132:135], v4 offset:25600
    ds_read_b128 a[136:139], v4 offset:26624
    v_mfma_f32_16x16x32_bf16 v[68:71], a[148:151], v[164:167], v[68:71]
    ds_read_b128 a[140:143], v4 offset:27648
    ds_read_b128 a[144:147], v4 offset:28672
    v_mfma_f32_16x16x32_bf16 v[72:75], a[152:155], v[164:167], v[72:75]
    ds_read_b128 a[148:151], v4 offset:29696
    v_add3_u32 v9, v154, v155, v9
    s_waitcnt vmcnt(11)
    s_waitcnt lgkmcnt(15)
    v_mfma_f32_16x16x32_bf16 v[76:79], a[172:175], v[168:171], v[76:79]
    buffer_load_dwordx4 v[216:219], v4, s[40:43], s62 offen offset:1024 sc1
    v_mfma_f32_16x16x32_bf16 v[64:67], a[160:163], v[168:171], v[64:67]
    ds_read_b128 a[152:155], v4 offset:30720
    ds_read_b128 a[156:159], v4 offset:31744
    v_mfma_f32_16x16x32_bf16 v[68:71], a[164:167], v[168:171], v[68:71]
    ds_read_b128 a[160:163], v4 offset:32768
    v_add3_u32 v9, v156, v157, v9
    v_mfma_f32_16x16x32_bf16 v[72:75], a[168:171], v[168:171], v[72:75]
    ds_read_b128 a[164:167], v4 offset:33792
    v_add3_u32 v9, v158, v159, v9
    s_waitcnt vmcnt(11)
    s_waitcnt lgkmcnt(15)
    v_mfma_f32_16x16x32_bf16 v[76:79], a[188:191], v[172:175], v[76:79]
    buffer_load_dwordx4 v[220:223], v4, s[40:43], s62 offen offset:2048 sc1
    v_mfma_f32_16x16x32_bf16 v[64:67], a[176:179], v[172:175], v[64:67]
    ds_read_b128 a[168:171], v4 offset:34816
    ds_read_b128 a[172:175], v4 offset:35840
    v_mfma_f32_16x16x32_bf16 v[68:71], a[180:183], v[172:175], v[68:71]
    ds_read_b128 a[176:179], v4 offset:36864
    v_add3_u32 v9, v160, v161, v9
    v_mfma_f32_16x16x32_bf16 v[72:75], a[184:187], v[172:175], v[72:75]
    ds_read_b128 a[180:183], v4 offset:37888
    v_add3_u32 v9, v162, v163, v9
    s_waitcnt vmcnt(11)
    s_waitcnt lgkmcnt(15)
    v_mfma_f32_16x16x32_bf16 v[76:79], a[204:207], v[176:179], v[76:79]
    buffer_load_dwordx4 v[224:227], v4, s[40:43], s62 offen offset:3072 sc1
    v_mfma_f32_16x16x32_bf16 v[64:67], a[192:195], v[176:179], v[64:67]
    s_add_u32 s62, s62, 4096
    ds_read_b128 a[184:187], v4 offset:38912
    ds_read_b128 a[188:191], v4 offset:39936
    v_mfma_f32_16x16x32_bf16 v[68:71], a[196:199], v[176:179], v[68:71]
    v_add3_u32 v9, v164, v165, v9
    v_add3_u32 v9, v166, v167, v9
    v_mfma_f32_16x16x32_bf16 v[72:75], a[200:203], v[176:179], v[72:75]
    v_add3_u32 v9, v168, v169, v9
    v_add3_u32 v9, v170, v171, v9
    s_waitcnt vmcnt(11)
    s_waitcnt lgkmcnt(15)
    v_mfma_f32_16x16x32_bf16 v[76:79], a[220:223], v[180:183], v[76:79]
    buffer_load_dwordx4 v[228:231], v4, s[40:43], s62 offen offset:0 sc1
    v_mfma_f32_16x16x32_bf16 v[64:67], a[208:211], v[180:183], v[64:67]
    v_add3_u32 v9, v172, v173, v9
    v_add3_u32 v9, v174, v175, v9
    v_mfma_f32_16x16x32_bf16 v[68:71], a[212:215], v[180:183], v[68:71]
    v_add3_u32 v9, v176, v177, v9
    v_add3_u32 v9, v178, v179, v9
    v_mfma_f32_16x16x32_bf16 v[72:75], a[216:219], v[180:183], v[72:75]
    v_add3_u32 v9, v180, v181, v9
    v_add3_u32 v9, v182, v183, v9
    s_waitcnt vmcnt(11)
    s_waitcnt lgkmcnt(15)
    v_mfma_f32_16x16x32_bf16 v[76:79], a[236:239], v[184:187], v[76:79]
    buffer_load_dwordx4 v[232:235], v4, s[40:43], s62 offen offset:1024 sc1
    v_mfma_f32_16x16x32_bf16 v[64:67], a[224:227], v[184:187], v[64:67]
    v_add3_u32 v9, v184, v185, v9
    v_add3_u32 v9, v186, v187, v9
    v_mfma_f32_16x16x32_bf16 v[68:71], a[228:231], v[184:187], v[68:71]
    v_mfma_f32_16x16x32_bf16 v[72:75], a[232:235], v[184:187], v[72:75]
    s_waitcnt vmcnt(11)
    s_waitcnt lgkmcnt(15)
    v_mfma_f32_16x16x32_bf16 v[76:79], a[252:255], v[188:191], v[76:79]
    buffer_load_dwordx4 v[236:239], v4, s[40:43], s62 offen offset:2048 sc1
    v_mfma_f32_16x16x32_bf16 v[64:67], a[240:243], v[188:191], v[64:67]
    v_add3_u32 v9, v188, v189, v9
    v_add3_u32 v9, v190, v191, v9
    v_mfma_f32_16x16x32_bf16 v[68:71], a[244:247], v[188:191], v[68:71]
    v_mfma_f32_16x16x32_bf16 v[72:75], a[248:251], v[188:191], v[72:75]
    s_waitcnt vmcnt(11)
    s_waitcnt lgkmcnt(15)
    v_mfma_f32_16x16x32_bf16 v[76:79], a[12:15], v[192:195], v[76:79]
    v_add3_u32 v9, v192, v193, v9
    v_add3_u32 v9, v194, v195, v9
    v_mfma_f32_16x16x32_bf16 v[64:67], a[0:3], v[192:195], v[64:67]
    v_mfma_f32_16x16x32_bf16 v[68:71], a[4:7], v[192:195], v[68:71]
    v_mfma_f32_16x16x32_bf16 v[72:75], a[8:11], v[192:195], v[72:75]
    s_waitcnt vmcnt(10)
    s_waitcnt lgkmcnt(15)
    v_mfma_f32_16x16x32_bf16 v[76:79], a[28:31], v[196:199], v[76:79]
    v_add3_u32 v9, v196, v197, v9
    v_add3_u32 v9, v198, v199, v9
    v_mfma_f32_16x16x32_bf16 v[64:67], a[16:19], v[196:199], v[64:67]
    v_mfma_f32_16x16x32_bf16 v[68:71], a[20:23], v[196:199], v[68:71]
    v_mfma_f32_16x16x32_bf16 v[72:75], a[24:27], v[196:199], v[72:75]
    s_waitcnt vmcnt(9)
    s_waitcnt lgkmcnt(15)
    v_mfma_f32_16x16x32_bf16 v[76:79], a[44:47], v[200:203], v[76:79]
    v_add3_u32 v9, v200, v201, v9
    v_add3_u32 v9, v202, v203, v9
    v_mfma_f32_16x16x32_bf16 v[64:67], a[32:35], v[200:203], v[64:67]
    v_mfma_f32_16x16x32_bf16 v[68:71], a[36:39], v[200:203], v[68:71]
    v_mfma_f32_16x16x32_bf16 v[72:75], a[40:43], v[200:203], v[72:75]
    s_waitcnt vmcnt(8)
    s_waitcnt lgkmcnt(15)
    v_mfma_f32_16x16x32_bf16 v[76:79], a[60:63], v[204:207], v[76:79]
    v_add3_u32 v9, v204, v205, v9
    v_add3_u32 v9, v206, v207, v9
    v_mfma_f32_16x16x32_bf16 v[64:67], a[48:51], v[204:207], v[64:67]
    v_mfma_f32_16x16x32_bf16 v[68:71], a[52:55], v[204:207], v[68:71]
    v_mfma_f32_16x16x32_bf16 v[72:75], a[56:59], v[204:207], v[72:75]
    s_waitcnt vmcnt(7)
    s_waitcnt lgkmcnt(15)
    v_mfma_f32_16x16x32_bf16 v[76:79], a[76:79], v[208:211], v[76:79]
    v_add3_u32 v9, v208, v209, v9
    v_add3_u32 v9, v210, v211, v9
    v_mfma_f32_16x16x32_bf16 v[64:67], a[64:67], v[208:211], v[64:67]
    v_mfma_f32_16x16x32_bf16 v[68:71], a[68:71], v[208:211], v[68:71]
    v_mfma_f32_16x16x32_bf16 v[72:75], a[72:75], v[208:211], v[72:75]
    s_waitcnt vmcnt(6)
    s_waitcnt lgkmcnt(15)
    v_mfma_f32_16x16x32_bf16 v[76:79], a[92:95], v[212:215], v[76:79]
    v_add3_u32 v9, v212, v213, v9
    v_add3_u32 v9, v214, v215, v9
    v_mfma_f32_16x16x32_bf16 v[64:67], a[80:83], v[212:215], v[64:67]
    v_mfma_f32_16x16x32_bf16 v[68:71], a[84:87], v[212:215], v[68:71]
    v_mfma_f32_16x16x32_bf16 v[72:75], a[88:91], v[212:215], v[72:75]
    s_waitcnt vmcnt(5)
    s_waitcnt lgkmcnt(15)
    v_mfma_f32_16x16x32_bf16 v[76:79], a[108:111], v[216:219], v[76:79]
    v_add3_u32 v9, v216, v217, v9
    v_add3_u32 v9, v218, v219, v9
    v_mfma_f32_16x16x32_bf16 v[64:67], a[96:99], v[216:219], v[64:67]
    v_mfma_f32_16x16x32_bf16 v[68:71], a[100:103], v[216:219], v[68:71]
    v_mfma_f32_16x16x32_bf16 v[72:75], a[104:107], v[216:219], v[72:75]
    s_waitcnt vmcnt(4)
    s_waitcnt lgkmcnt(15)
    v_mfma_f32_16x16x32_bf16 v[76:79], a[124:127], v[220:223], v[76:79]
    v_add3_u32 v9, v220, v221, v9
    v_add3_u32 v9, v222, v223, v9
    v_mfma_f32_16x16x32_bf16 v[64:67], a[112:115], v[220:223], v[64:67]
    v_mfma_f32_16x16x32_bf16 v[68:71], a[116:119], v[220:223], v[68:71]
    v_mfma_f32_16x16x32_bf16 v[72:75], a[120:123], v[220:223], v[72:75]
    s_waitcnt vmcnt(3)
    s_waitcnt lgkmcnt(12)
    v_mfma_f32_16x16x32_bf16 v[76:79], a[140:143], v[224:227], v[76:79]
    v_add3_u32 v9, v224, v225, v9
    v_add3_u32 v9, v226, v227, v9
    v_mfma_f32_16x16x32_bf16 v[64:67], a[128:131], v[224:227], v[64:67]
    v_mfma_f32_16x16x32_bf16 v[68:71], a[132:135], v[224:227], v[68:71]
    v_mfma_f32_16x16x32_bf16 v[72:75], a[136:139], v[224:227], v[72:75]
    s_waitcnt vmcnt(2)
    s_waitcnt lgkmcnt(8)
    v_mfma_f32_16x16x32_bf16 v[76:79], a[156:159], v[228:231], v[76:79]
    v_add3_u32 v9, v228, v229, v9
    v_add3_u32 v9, v230, v231, v9
    v_mfma_f32_16x16x32_bf16 v[64:67], a[144:147], v[228:231], v[64:67]
    v_mfma_f32_16x16x32_bf16 v[68:71], a[148:151], v[228:231], v[68:71]
    v_mfma_f32_16x16x32_bf16 v[72:75], a[152:155], v[228:231], v[72:75]
    s_waitcnt vmcnt(1)
    s_waitcnt lgkmcnt(4)
    v_mfma_f32_16x16x32_bf16 v[76:79], a[172:175], v[232:235], v[76:79]
    v_add3_u32 v9, v232, v233, v9
    v_add3_u32 v9, v234, v235, v9
    v_mfma_f32_16x16x32_bf16 v[64:67], a[160:163], v[232:235], v[64:67]
    v_mfma_f32_16x16x32_bf16 v[68:71], a[164:167], v[232:235], v[68:71]
    v_mfma_f32_16x16x32_bf16 v[72:75], a[168:171], v[232:235], v[72:75]
    s_waitcnt vmcnt(0)
    s_waitcnt lgkmcnt(0)
    v_mfma_f32_16x16x32_bf16 v[76:79], a[188:191], v[236:239], v[76:79]
    v_add3_u32 v9, v236, v237, v9
    v_add3_u32 v9, v238, v239, v9
    v_mfma_f32_16x16x32_bf16 v[64:67], a[176:179], v[236:239], v[64:67]
    v_mfma_f32_16x16x32_bf16 v[68:71], a[180:183], v[236:239], v[68:71]
    v_mfma_f32_16x16x32_bf16 v[72:75], a[184:187], v[236:239], v[72:75]
    v_add_u32_dpp v9, v9, v9 row_ror:8 row_mask:0xf bank_mask:0xf
    s_nop 1
    v_add_u32_dpp v9, v9, v9 row_ror:4 row_mask:0xf bank_mask:0xf
    s_nop 1
    v_add_u32_dpp v9, v9, v9 row_ror:2 row_mask:0xf bank_mask:0xf
    s_nop 1
    v_add_u32_dpp v9, v9, v9 row_ror:1 row_mask:0xf bank_mask:0xf
    s_nop 0
    v_readlane_b32 s50, v9, 0
    v_readlane_b32 s51, v9, 16
    v_readlane_b32 s56, v9, 32
    v_readlane_b32 s57, v9, 48
    s_add_u32 s50, s50, s51
    s_nop 0
    s_add_u32 s56, s56, s57
    s_add_u32 s50, s50, s56
    s_cmp_lg_u32 s50, 0
    s_cbranch_scc1 L_vsum_45
L_vok_46:
    v_cvt_pk_bf16_f32 v16, v64, v65
    v_cvt_pk_bf16_f32 v17, v66, v67
    v_cvt_pk_bf16_f32 v18, v68, v69
    v_cvt_pk_bf16_f32 v19, v70, v71
    buffer_store_dwordx4 v[16:19], v113, s[36:39], s63 offen offset:0
    v_cvt_pk_bf16_f32 v20, v72, v73
    v_cvt_pk_bf16_f32 v21, v74, v75
    v_cvt_pk_bf16_f32 v22, v76, v77
    v_cvt_pk_bf16_f32 v23, v78, v79
    buffer_store_dwordx4 v[20:23], v113, s[36:39], s63 offen offset:64
L_finish:
L_exit:
    s_endpgm
L_x1fail_6:
    s_waitcnt vmcnt(0) lgkmcnt(0)
L_spin_3:
    s_sleep 1
    buffer_load_dword v16, v53, s[40:43], s67 offen sc1
    buffer_load_dword v17, v53, s[40:43], s67 offen offset:2048 sc1
    s_waitcnt vmcnt(0)
    v_cmp_eq_u32 vcc, s44, v16
    s_nop 1
    v_cndmask_b32 v16, v16, v17, vcc
    s_waitcnt vmcnt(0)
    v_cmp_ne_u32 vcc, s44, v16
    s_sub_u32 s71, s71, 1
    s_cmp_le_i32 s71, 0
    s_cbranch_scc1 L_spun_4
    s_cmp_lg_u64 vcc, 0
    s_cbranch_scc1 L_spin_3
L_spun_4:
    s_barrier
    s_cmp_lt_u32 s3, 2
    s_cbranch_scc1 L_recol_14
    s_mov_b32 m0, s61
    s_nop 0
    buffer_load_dwordx4 v4, s[40:43], s60 offen offset:0 sc1 lds
    buffer_load_dwordx4 v4, s[40:43], s60 offen offset:1024 sc1 lds
    buffer_load_dwordx4 v4, s[40:43], s60 offen offset:2048 sc1 lds
    buffer_load_dwordx4 v4, s[40:43], s60 offen offset:3072 sc1 lds
L_recol_14:
    buffer_load_dwordx4 v[112:115], v4, s[40:43], s62 offen offset:0 sc1
    buffer_load_dwordx4 v[116:119], v4, s[40:43], s62 offen offset:1024 sc1
    buffer_load_dwordx2 v[126:127], v54, s[40:43], s62 offen offset:2048 sc1
    v_mov_b32 v120, 0
    s_waitcnt vmcnt(0)
    s_barrier
    s_sub_u32 s70, s70, 1
    s_cmp_gt_i32 s70, 0
    s_nop 11
    s_cbranch_scc1 L_wtry_11
    s_branch L_x1ok_7

L_wtag_15:
    s_waitcnt vmcnt(0) lgkmcnt(0)
L_spin_17:
    s_sleep 1
    buffer_load_dwordx2 v[126:127], v54, s[40:43], s62 offen offset:2048 sc1
    s_waitcnt vmcnt(0)
    v_cmp_ne_u32 vcc, s44, v127
    s_sub_u32 s71, s71, 1
    s_cmp_le_i32 s71, 0
    s_cbranch_scc1 L_spun_18
    s_cmp_lg_u64 vcc, 0
    s_cbranch_scc1 L_spin_17
L_spun_18:
    buffer_load_dwordx4 v[112:115], v4, s[40:43], s62 offen offset:0 sc1
    buffer_load_dwordx4 v[116:119], v4, s[40:43], s62 offen offset:1024 sc1
    s_waitcnt vmcnt(0)
    s_sub_u32 s71, s71, 1
    s_cmp_gt_i32 s71, 0
    s_nop 11
    s_cbranch_scc1 L_wtagok_16
    s_branch L_wtagok_16

L_wfail_12:
    s_waitcnt vmcnt(0) lgkmcnt(0)
    buffer_load_dwordx4 v[112:115], v4, s[40:43], s62 offen offset:0 sc1
    buffer_load_dwordx4 v[116:119], v4, s[40:43], s62 offen offset:1024 sc1
    buffer_load_dwordx2 v[126:127], v54, s[40:43], s62 offen offset:2048 sc1
    v_mov_b32 v120, 0
    s_waitcnt vmcnt(0)
    s_sub_u32 s71, s71, 1
    s_cmp_gt_i32 s71, 0
    s_nop 11
    s_cbranch_scc1 L_wtry_11
    s_branch L_wok_13

L_x2tag_20:
    s_waitcnt vmcnt(0) lgkmcnt(0)
L_spin_23:
    s_sleep 1
    buffer_load_dwordx2 v[94:95], v92, s[40:43], s65 offen sc1
    s_waitcnt vmcnt(0)
    v_cmp_ne_u32 vcc, s44, v95
    s_sub_u32 s71, s71, 1
    s_cmp_le_i32 s71, 0
    s_cbranch_scc1 L_spun_24
    s_cmp_lg_u64 vcc, 0
    s_cbranch_scc1 L_spin_23
L_spun_24:
    s_sub_u32 s71, s71, 1
    s_cmp_gt_i32 s71, 0
    s_nop 11
    s_cbranch_scc1 L_x2try_19
    s_branch L_x2ok_22

L_auxfail_25:
    s_waitcnt vmcnt(0) lgkmcnt(0)
L_spin_27:
    s_sleep 1
    buffer_load_dword v118, v117, s[40:43], 0 offen sc1
    s_waitcnt vmcnt(0)
    v_cmp_ne_u32 vcc, s44, v118
    s_sub_u32 s71, s71, 1
    s_cmp_le_i32 s71, 0
    s_cbranch_scc1 L_spun_28
    s_cmp_lg_u64 vcc, 0
    s_cbranch_scc1 L_spin_27
L_spun_28:
    s_sub_u32 s71, s71, 1
    s_cmp_gt_i32 s71, 0
    s_nop 11
    s_cbranch_scc1 L_auxok_26
    s_branch L_auxok_26

L_x2sum_21:
    s_waitcnt vmcnt(0) lgkmcnt(0)
    s_sub_u32 s71, s71, 200
    s_cmp_gt_i32 s71, 0
    s_nop 11
    s_cbranch_scc1 L_x2try_19
    s_branch L_x2ok_22

L_stfail_33:
    s_waitcnt vmcnt(0) lgkmcnt(0)
    s_sleep 1
    s_sub_u32 s71, s71, 1
    s_cmp_gt_i32 s71, 0
    s_nop 11
    s_cbranch_scc1 L_sttry_32
    s_branch L_stok_34

L_ztag_38:
    s_waitcnt vmcnt(0) lgkmcnt(0)
L_spin_40:
    s_sleep 1
    buffer_load_dwordx2 v[10:11], v141, s[40:43], s68 offen sc1
    s_waitcnt vmcnt(0)
    v_cmp_ne_u32 vcc, s44, v11
    s_sub_u32 s71, s71, 1
    s_cmp_le_i32 s71, 0
    s_cbranch_scc1 L_spun_41
    s_cmp_lg_u64 vcc, 0
    s_cbranch_scc1 L_spin_40
L_spun_41:
    buffer_load_dwordx4 v[16:19], v4, s[40:43], s12 offen offset:0 sc1
    buffer_load_dwordx4 v[20:23], v4, s[40:43], s13 offen offset:0 sc1
    buffer_load_dwordx4 v[24:27], v4, s[40:43], s14 offen offset:0 sc1
    buffer_load_dwordx4 v[28:31], v4, s[40:43], s12 offen offset:1024 sc1
    buffer_load_dwordx4 v[32:35], v4, s[40:43], s13 offen offset:1024 sc1
    buffer_load_dwordx4 v[36:39], v4, s[40:43], s14 offen offset:1024 sc1
    buffer_load_dwordx4 v[40:43], v4, s[40:43], s12 offen offset:2048 sc1
    buffer_load_dwordx4 v[44:47], v4, s[40:43], s13 offen offset:2048 sc1
    buffer_load_dwordx4 v[128:131], v4, s[40:43], s14 offen offset:2048 sc1
    buffer_load_dwordx4 v[132:135], v4, s[40:43], s12 offen offset:3072 sc1
    buffer_load_dwordx4 v[136:139], v4, s[40:43], s13 offen offset:3072 sc1
    buffer_load_dwordx4 v[80:83], v4, s[40:43], s14 offen offset:3072 sc1
    s_add_u32 s12, s12, 4096
    buffer_load_dwordx4 v[84:87], v4, s[40:43], s12 offen offset:0 sc1
    s_add_u32 s13, s13, 4096
    buffer_load_dwordx4 v[88:91], v4, s[40:43], s13 offen offset:0 sc1
    s_add_u32 s14, s14, 4096
    buffer_load_dwordx4 v[92:95], v4, s[40:43], s14 offen offset:0 sc1
    buffer_load_dwordx4 v[96:99], v4, s[40:43], s12 offen offset:1024 sc1
    buffer_load_dwordx4 v[100:103], v4, s[40:43], s13 offen offset:1024 sc1
    buffer_load_dwordx4 v[104:107], v4, s[40:43], s14 offen offset:1024 sc1
    buffer_load_dwordx4 v[108:111], v4, s[40:43], s12 offen offset:2048 sc1
    buffer_load_dwordx4 v[112:115], v4, s[40:43], s13 offen offset:2048 sc1
    v_mov_b32 v240, v12
    v_and_b32 v224, s67, v12
    v_mov_b32 v241, v12
    v_and_b32 v225, s67, v12
    v_mov_b32 v242, v12
    v_and_b32 v226, s67, v12
    v_mov_b32 v243, v12
    v_and_b32 v227, s67, v12
    v_mov_b32 v244, v13
    v_and_b32 v228, s67, v13
    v_mov_b32 v245, v13
    v_and_b32 v229, s67, v13
    v_mov_b32 v246, v13
    v_and_b32 v230, s67, v13
    v_mov_b32 v247, v13
    v_and_b32 v231, s67, v13
    v_mov_b32 v248, v14
    v_and_b32 v232, s67, v14
    v_mov_b32 v249, v14
    v_and_b32 v233, s67, v14
    v_mov_b32 v250, v14
    v_and_b32 v234, s67, v14
    v_mov_b32 v251, v14
    v_and_b32 v235, s67, v14
    v_mov_b32 v252, v15
    v_and_b32 v236, s67, v15
    v_mov_b32 v253, v15
    v_and_b32 v237, s67, v15
    v_mov_b32 v254, v15
    v_and_b32 v238, s67, v15
    v_mov_b32 v255, v15
    v_and_b32 v239, s67, v15
    s_sub_u32 s71, s71, 1
    s_cmp_gt_i32 s71, 0
    s_nop 11
    s_cbranch_scc1 L_ztagok_39
    s_branch L_ztagok_39

L_zearly_42:
    s_waitcnt vmcnt(0) lgkmcnt(0)
    s_sub_u32 s12, s12, 4096
    s_sub_u32 s13, s13, 4096
    s_sub_u32 s14, s14, 4096
    s_sub_u32 s12, s12, 4096
    s_sub_u32 s13, s13, 4096
    s_sub_u32 s14, s14, 4096
    buffer_load_dwordx4 v[16:19], v4, s[40:43], s12 offen offset:0 sc1
    buffer_load_dwordx4 v[20:23], v4, s[40:43], s13 offen offset:0 sc1
    buffer_load_dwordx4 v[24:27], v4, s[40:43], s14 offen offset:0 sc1
    buffer_load_dwordx4 v[28:31], v4, s[40:43], s12 offen offset:1024 sc1
    buffer_load_dwordx4 v[32:35], v4, s[40:43], s13 offen offset:1024 sc1
    buffer_load_dwordx4 v[36:39], v4, s[40:43], s14 offen offset:1024 sc1
    buffer_load_dwordx4 v[40:43], v4, s[40:43], s12 offen offset:2048 sc1
    buffer_load_dwordx4 v[44:47], v4, s[40:43], s13 offen offset:2048 sc1
    buffer_load_dwordx4 v[128:131], v4, s[40:43], s14 offen offset:2048 sc1
    buffer_load_dwordx4 v[132:135], v4, s[40:43], s12 offen offset:3072 sc1
    buffer_load_dwordx4 v[136:139], v4, s[40:43], s13 offen offset:3072 sc1
    buffer_load_dwordx4 v[80:83], v4, s[40:43], s14 offen offset:3072 sc1
    s_add_u32 s12, s12, 4096
    buffer_load_dwordx4 v[84:87], v4, s[40:43], s12 offen offset:0 sc1
    s_add_u32 s13, s13, 4096
    buffer_load_dwordx4 v[88:91], v4, s[40:43], s13 offen offset:0 sc1
    s_add_u32 s14, s14, 4096
    buffer_load_dwordx4 v[92:95], v4, s[40:43], s14 offen offset:0 sc1
    buffer_load_dwordx4 v[96:99], v4, s[40:43], s12 offen offset:1024 sc1
    buffer_load_dwordx4 v[100:103], v4, s[40:43], s13 offen offset:1024 sc1
    buffer_load_dwordx4 v[104:107], v4, s[40:43], s14 offen offset:1024 sc1
    buffer_load_dwordx4 v[108:111], v4, s[40:43], s12 offen offset:2048 sc1
    buffer_load_dwordx4 v[112:115], v4, s[40:43], s13 offen offset:2048 sc1
    v_mov_b32 v240, v12
    v_and_b32 v224, s67, v12
    v_mov_b32 v241, v12
    v_and_b32 v225, s67, v12
    v_mov_b32 v242, v12
    v_and_b32 v226, s67, v12
    v_mov_b32 v243, v12
    v_and_b32 v227, s67, v12
    v_mov_b32 v244, v13
    v_and_b32 v228, s67, v13
    v_mov_b32 v245, v13
    v_and_b32 v229, s67, v13
    v_mov_b32 v246, v13
    v_and_b32 v230, s67, v13
    v_mov_b32 v247, v13
    v_and_b32 v231, s67, v13
    v_mov_b32 v248, v14
    v_and_b32 v232, s67, v14
    v_mov_b32 v249, v14
    v_and_b32 v233, s67, v14
    v_mov_b32 v250, v14
    v_and_b32 v234, s67, v14
    v_mov_b32 v251, v14
    v_and_b32 v235, s67, v14
    v_mov_b32 v252, v15
    v_and_b32 v236, s67, v15
    v_mov_b32 v253, v15
    v_and_b32 v237, s67, v15
    v_mov_b32 v254, v15
    v_and_b32 v238, s67, v15
    v_mov_b32 v255, v15
    v_and_b32 v239, s67, v15
    s_sub_u32 s71, s71, 50
    s_cmp_gt_i32 s71, 0
    s_nop 11
    s_cbranch_scc1 L_ztry_35
    s_branch L_zearlyok_43

L_zsum_36:
    s_waitcnt vmcnt(0) lgkmcnt(0)
    s_sub_u32 s12, s12, 12288
    s_sub_u32 s13, s13, 12288
    s_sub_u32 s14, s14, 12288
    s_sub_u32 s15, s15, 12288
    s_sub_u32 s16, s16, 12288
    s_sub_u32 s17, s17, 12288
    s_sub_u32 s18, s18, 12288
    buffer_load_dwordx4 v[16:19], v4, s[40:43], s12 offen offset:0 sc1
    buffer_load_dwordx4 v[20:23], v4, s[40:43], s13 offen offset:0 sc1
    buffer_load_dwordx4 v[24:27], v4, s[40:43], s14 offen offset:0 sc1
    buffer_load_dwordx4 v[28:31], v4, s[40:43], s12 offen offset:1024 sc1
    buffer_load_dwordx4 v[32:35], v4, s[40:43], s13 offen offset:1024 sc1
    buffer_load_dwordx4 v[36:39], v4, s[40:43], s14 offen offset:1024 sc1
    buffer_load_dwordx4 v[40:43], v4, s[40:43], s12 offen offset:2048 sc1
    buffer_load_dwordx4 v[44:47], v4, s[40:43], s13 offen offset:2048 sc1
    buffer_load_dwordx4 v[128:131], v4, s[40:43], s14 offen offset:2048 sc1
    buffer_load_dwordx4 v[132:135], v4, s[40:43], s12 offen offset:3072 sc1
    buffer_load_dwordx4 v[136:139], v4, s[40:43], s13 offen offset:3072 sc1
    buffer_load_dwordx4 v[80:83], v4, s[40:43], s14 offen offset:3072 sc1
    s_add_u32 s12, s12, 4096
    buffer_load_dwordx4 v[84:87], v4, s[40:43], s12 offen offset:0 sc1
    s_add_u32 s13, s13, 4096
    buffer_load_dwordx4 v[88:91], v4, s[40:43], s13 offen offset:0 sc1
    s_add_u32 s14, s14, 4096
    buffer_load_dwordx4 v[92:95], v4, s[40:43], s14 offen offset:0 sc1
    buffer_load_dwordx4 v[96:99], v4, s[40:43], s12 offen offset:1024 sc1
    buffer_load_dwordx4 v[100:103], v4, s[40:43], s13 offen offset:1024 sc1
    buffer_load_dwordx4 v[104:107], v4, s[40:43], s14 offen offset:1024 sc1
    buffer_load_dwordx4 v[108:111], v4, s[40:43], s12 offen offset:2048 sc1
    buffer_load_dwordx4 v[112:115], v4, s[40:43], s13 offen offset:2048 sc1
    v_mov_b32 v240, v12
    v_and_b32 v224, s67, v12
    v_mov_b32 v241, v12
    v_and_b32 v225, s67, v12
    v_mov_b32 v242, v12
    v_and_b32 v226, s67, v12
    v_mov_b32 v243, v12
    v_and_b32 v227, s67, v12
    v_mov_b32 v244, v13
    v_and_b32 v228, s67, v13
    v_mov_b32 v245, v13
    v_and_b32 v229, s67, v13
    v_mov_b32 v246, v13
    v_and_b32 v230, s67, v13
    v_mov_b32 v247, v13
    v_and_b32 v231, s67, v13
    v_mov_b32 v248, v14
    v_and_b32 v232, s67, v14
    v_mov_b32 v249, v14
    v_and_b32 v233, s67, v14
    v_mov_b32 v250, v14
    v_and_b32 v234, s67, v14
    v_mov_b32 v251, v14
    v_and_b32 v235, s67, v14
    v_mov_b32 v252, v15
    v_and_b32 v236, s67, v15
    v_mov_b32 v253, v15
    v_and_b32 v237, s67, v15
    v_mov_b32 v254, v15
    v_and_b32 v238, s67, v15
    v_mov_b32 v255, v15
    v_and_b32 v239, s67, v15
    s_sub_u32 s71, s71, 2000
    s_cmp_gt_i32 s71, 0
    s_nop 11
    s_cbranch_scc1 L_ztry_35
    s_branch L_zok_37

L_vtag_47:
    s_waitcnt vmcnt(0) lgkmcnt(0)
L_spin_49:
    s_sleep 1
    buffer_load_dwordx2 v[10:11], v114, s[40:43], s61 offen sc1
    s_waitcnt vmcnt(0)
    v_cmp_ne_u32 vcc, s44, v11
    s_sub_u32 s71, s71, 1
    s_cmp_le_i32 s71, 0
    s_cbranch_scc1 L_spun_50
    s_cmp_lg_u64 vcc, 0
    s_cbranch_scc1 L_spin_49
L_spun_50:
    s_lshr_b32 s62, s46, 1
    s_add_u32 s62, s62, 0
    s_and_b32 s62, s62, 3
    s_mul_i32 s62, s62, 7168
    s_add_u32 s62, s62, s60
    buffer_load_dwordx4 v[128:131], v4, s[40:43], s62 offen offset:0 sc1
    buffer_load_dwordx4 v[132:135], v4, s[40:43], s62 offen offset:1024 sc1
    buffer_load_dwordx4 v[136:139], v4, s[40:43], s62 offen offset:2048 sc1
    buffer_load_dwordx4 v[140:143], v4, s[40:43], s62 offen offset:3072 sc1
    s_add_u32 s62, s62, 4096
    buffer_load_dwordx4 v[144:147], v4, s[40:43], s62 offen offset:0 sc1
    buffer_load_dwordx4 v[148:151], v4, s[40:43], s62 offen offset:1024 sc1
    buffer_load_dwordx4 v[152:155], v4, s[40:43], s62 offen offset:2048 sc1
    s_lshr_b32 s62, s46, 1
    s_add_u32 s62, s62, 1
    s_and_b32 s62, s62, 3
    s_mul_i32 s62, s62, 7168
    s_add_u32 s62, s62, s60
    buffer_load_dwordx4 v[156:159], v4, s[40:43], s62 offen offset:0 sc1
    buffer_load_dwordx4 v[160:163], v4, s[40:43], s62 offen offset:1024 sc1
    buffer_load_dwordx4 v[164:167], v4, s[40:43], s62 offen offset:2048 sc1
    buffer_load_dwordx4 v[168:171], v4, s[40:43], s62 offen offset:3072 sc1
    s_add_u32 s62, s62, 4096
    buffer_load_dwordx4 v[172:175], v4, s[40:43], s62 offen offset:0 sc1
    s_sub_u32 s71, s71, 1
    s_cmp_gt_i32 s71, 0
    s_nop 11
    s_cbranch_scc1 L_vtagok_48
    s_branch L_vtagok_48

L_vsum_45:
    s_waitcnt vmcnt(0) lgkmcnt(0)
    s_lshr_b32 s62, s46, 1
    s_add_u32 s62, s62, 0
    s_and_b32 s62, s62, 3
    s_mul_i32 s62, s62, 7168
    s_add_u32 s62, s62, s60
    buffer_load_dwordx4 v[128:131], v4, s[40:43], s62 offen offset:0 sc1
    buffer_load_dwordx4 v[132:135], v4, s[40:43], s62 offen offset:1024 sc1
    buffer_load_dwordx4 v[136:139], v4, s[40:43], s62 offen offset:2048 sc1
    buffer_load_dwordx4 v[140:143], v4, s[40:43], s62 offen offset:3072 sc1
    s_add_u32 s62, s62, 4096
    buffer_load_dwordx4 v[144:147], v4, s[40:43], s62 offen offset:0 sc1
    buffer_load_dwordx4 v[148:151], v4, s[40:43], s62 offen offset:1024 sc1
    buffer_load_dwordx4 v[152:155], v4, s[40:43], s62 offen offset:2048 sc1
    s_lshr_b32 s62, s46, 1
    s_add_u32 s62, s62, 1
    s_and_b32 s62, s62, 3
    s_mul_i32 s62, s62, 7168
    s_add_u32 s62, s62, s60
    buffer_load_dwordx4 v[156:159], v4, s[40:43], s62 offen offset:0 sc1
    buffer_load_dwordx4 v[160:163], v4, s[40:43], s62 offen offset:1024 sc1
    buffer_load_dwordx4 v[164:167], v4, s[40:43], s62 offen offset:2048 sc1
    buffer_load_dwordx4 v[168:171], v4, s[40:43], s62 offen offset:3072 sc1
    s_add_u32 s62, s62, 4096
    buffer_load_dwordx4 v[172:175], v4, s[40:43], s62 offen offset:0 sc1
    ds_read_b128 a[0:3], v112 offset:0
    ds_read_b128 a[4:7], v112 offset:1024
    ds_read_b128 a[8:11], v112 offset:2048
    ds_read_b128 a[12:15], v112 offset:3072
    ds_read_b128 a[16:19], v112 offset:4096
    ds_read_b128 a[20:23], v112 offset:5120
    ds_read_b128 a[24:27], v112 offset:6144
    ds_read_b128 a[28:31], v112 offset:7168
    ds_read_b128 a[32:35], v112 offset:8192
    ds_read_b128 a[36:39], v112 offset:9216
    ds_read_b128 a[40:43], v112 offset:10240
    ds_read_b128 a[44:47], v112 offset:11264
    ds_read_b128 a[48:51], v112 offset:12288
    ds_read_b128 a[52:55], v112 offset:13312
    ds_read_b128 a[56:59], v112 offset:14336
    ds_read_b128 a[60:63], v112 offset:15360
    ds_read_b128 a[64:67], v112 offset:16384
    ds_read_b128 a[68:71], v112 offset:17408
    ds_read_b128 a[72:75], v112 offset:18432
    ds_read_b128 a[76:79], v112 offset:19456
    ds_read_b128 a[80:83], v112 offset:20480
    ds_read_b128 a[84:87], v112 offset:21504
    ds_read_b128 a[88:91], v112 offset:22528
    ds_read_b128 a[92:95], v112 offset:23552
    ds_read_b128 a[96:99], v112 offset:24576
    ds_read_b128 a[100:103], v112 offset:25600
    ds_read_b128 a[104:107], v112 offset:26624
    ds_read_b128 a[108:111], v112 offset:27648
    ds_read_b128 a[112:115], v112 offset:28672
    ds_read_b128 a[116:119], v112 offset:29696
    ds_read_b128 a[120:123], v112 offset:30720
    ds_read_b128 a[124:127], v112 offset:31744
    ds_read_b128 a[128:131], v112 offset:32768
    ds_read_b128 a[132:135], v112 offset:33792
    ds_read_b128 a[136:139], v112 offset:34816
    ds_read_b128 a[140:143], v112 offset:35840
    ds_read_b128 a[144:147], v112 offset:36864
    ds_read_b128 a[148:151], v112 offset:37888
    ds_read_b128 a[152:155], v112 offset:38912
    ds_read_b128 a[156:159], v112 offset:39936
    ds_read_b128 a[160:163], v112 offset:40960
    ds_read_b128 a[164:167], v112 offset:41984
    ds_read_b128 a[168:171], v112 offset:43008
    ds_read_b128 a[172:175], v112 offset:44032
    ds_read_b128 a[176:179], v112 offset:45056
    ds_read_b128 a[180:183], v112 offset:46080
    ds_read_b128 a[184:187], v112 offset:47104
    ds_read_b128 a[188:191], v112 offset:48128
    ds_read_b128 a[192:195], v112 offset:49152
    ds_read_b128 a[196:199], v112 offset:50176
    ds_read_b128 a[200:203], v112 offset:51200
    ds_read_b128 a[204:207], v112 offset:52224
    ds_read_b128 a[208:211], v112 offset:53248
    ds_read_b128 a[212:215], v112 offset:54272
    ds_read_b128 a[216:219], v112 offset:55296
    ds_read_b128 a[220:223], v112 offset:56320
    ds_read_b128 a[224:227], v112 offset:57344
    ds_read_b128 a[228:231], v112 offset:58368
    ds_read_b128 a[232:235], v112 offset:59392
    ds_read_b128 a[236:239], v112 offset:60416
    ds_read_b128 a[240:243], v112 offset:61440
    ds_read_b128 a[244:247], v112 offset:62464
    ds_read_b128 a[248:251], v112 offset:63488
    ds_read_b128 a[252:255], v112 offset:64512
    s_waitcnt lgkmcnt(0)
    s_sub_u32 s71, s71, 500
    s_cmp_gt_i32 s71, 0
    s_nop 11
    s_cbranch_scc1 L_vtry_44
    s_branch L_vok_46

L_code_end:
    s_endpgm
.p2align 8
.type L_table,@object
L_table:
.octa 0x80008000800080003f803f803f803f80,0xbf11becabe54bc493f533f6b3f7a3f80,0xbf6fbf39becfbcc93eb83f313f6a3f80,0xbf79bf70bf16bd17be6d3eb23f4f3f80
.octa 0x3f803f803f803f800000000000000000,0x3f533f6b3f7a3f803f113eca3e543c49,0x3eb83f313f6a3f803f6f3f393ecf3cc9,0xbe6d3eb23f4f3f803f793f703f163d17
.octa 0xbf2cbf80bf3ebd49bf3ebd493f2c3f80,0xbe0abf66bf5dbd7bbf7ebee13f013f80,0x3ee6bf27bf73bd97bf65bf423ea13f7f,0x3f60be9bbf7ebdb0bef7bf743de23f7f
.octa 0xbf3ebd493f2c3f803f2c3f803f3e3d49,0xbf7ebee13f013f803e0a3f663f5d3d7b,0xbf65bf423ea13f7fbee63f273f733d97,0xbef7bf743de23f7fbf603e9b3f7e3db0
.octa 0x80008000800080003f803f803f803f80,0xbf7cbf6ebf57bf373e3b3ebe3f0c3f33,0xbeb8bf31bf6abf80bf6fbf39becfbcc9,0x3f5a3ed5be23bf2ebf06bf69bf7dbf3c
.octa 0x3f803f803f803f800000000000000000,0x3e3b3ebe3f0c3f333f7c3f6e3f573f37,0xbf6fbf39becfbcc93eb83f313f6a3f80,0xbf06bf69bf7dbf3cbf5abed53e233f2e
.octa 0x3f2c3f803f3e3d493f3e3d49bf2cbf80,0xbf1b3ea73f783f403f4c3f723e82bf2a,0xbf65bf423ea13f7fbee63f273f733d97,0x3e8fbf63bf203f25bf76beec3f483f44
.octa 0x3f3e3d49bf2cbf80bf2cbf80bf3ebd49,0x3f4c3f723e82bf2a3f1bbea7bf78bf40,0xbee63f273f733d973f653f42bea1bf7f,0xbf76beec3f483f44be8f3f633f20bf25
.octa 0x80008000800080003f803f803f803f80,0xbf53bf6bbf7abf80bf11becabe54bc49,0x3f6f3f393ecf3cc9beb8bf31bf6abf80,0xbe6d3eb23f4f3f803f793f703f163d17
.octa 0x3f803f803f803f800000000000000000,0xbf11becabe54bc493f533f6b3f7a3f80,0xbeb8bf31bf6abf80bf6fbf39becfbcc9,0x3f793f703f163d173e6dbeb2bf4fbf80
.octa 0xbf2cbf80bf3ebd49bf3ebd493f2c3f80,0x3f7e3ee1bf01bf80be0abf66bf5dbd7b,0xbee63f273f733d973f653f42bea1bf7f,0xbef7bf743de23f7fbf603e9b3f7e3db0
.octa 0xbf3ebd493f2c3f803f2c3f803f3e3d49,0xbe0abf66bf5dbd7bbf7ebee13f013f80,0x3f653f42bea1bf7f3ee6bf27bf73bd97,0xbf603e9b3f7e3db03ef73f74bde2bf7f
.octa 0x80008000800080003f803f803f803f80,0xbe3bbebebf0cbf33bf7cbf6ebf57bf37,0x3eb83f313f6a3f803f6f3f393ecf3cc9,0xbf06bf69bf7dbf3cbf5abed53e233f2e
.octa 0x3f803f803f803f800000000000000000,0xbf7cbf6ebf57bf373e3b3ebe3f0c3f33,0x3f6f3f393ecf3cc9beb8bf31bf6abf80,0xbf5abed53e233f2e3f063f693f7d3f3c
.octa 0x3f2c3f803f3e3d493f3e3d49bf2cbf80,0xbf4cbf72be823f2abf1b3ea73f783f40,0x3f653f42bea1bf7f3ee6bf27bf73bd97,0xbf76beec3f483f44be8f3f633f20bf25
.octa 0x3f3e3d49bf2cbf80bf2cbf80bf3ebd49,0xbf1b3ea73f783f403f4c3f723e82bf2a,0x3ee6bf27bf73bd97bf65bf423ea13f7f,0xbe8f3f633f20bf253f763eecbf48bf44
.octa 0x80008000800080003f803f803f803f80,0xbf13becfbe60bcc93f513f6a3f7a3f80,0xbf71bf3ebedbbd493eac3f2c3f673f80,0xbf77bf73bf1dbd97be893ea13f4a3f7f
.octa 0x3f803f803f803f800000000000000000,0x3f513f6a3f7a3f803f133ecf3e603cc9,0x3eac3f2c3f673f803f713f3e3edb3d49,0xbe893ea13f4a3f7f3f773f733f1d3d97
.octa 0xbf22bf7fbf46bdc9bf46bdc93f223f7f,0xbd97bf5fbf65bdfbbf7fbefc3ee63f7e,0x3f04bf18bf78be16bf5cbf4e3e793f7d,0x3f6abe60bf80be2fbecfbf7a3cc93f7c
.octa 0xbf46bdc93f223f7f3f223f7f3f463dc9,0xbf7fbefc3ee63f7e3d973f5f3f653dfb,0xbf5cbf4e3e793f7dbf043f183f783e16,0xbecfbf7a3cc93f7cbf6a3e603f803e2f
.octa 0x80008000800080003f803f803f803f80,0xbf7cbf6fbf58bf393e2f3eb83f093f31,0xbeacbf2cbf67bf80bf71bf3ebedbbd49,0x3f5f3ee6bdfbbf27befcbf65bf7ebf42
.octa 0x3f803f803f803f800000000000000000,0x3e2f3eb83f093f313f7c3f6f3f583f39,0xbf71bf3ebedbbd493eac3f2c3f673f80,0xbefcbf65bf7ebf42bf5fbee63dfb3f27
.octa 0x3f223f7f3f463dc93f463dc9bf22bf7f,0xbf273e893f733f4a3f423f773ea1bf1d,0xbf5cbf4e3e793f7dbf043f183f783e16,0x3eb8bf58bf313f13bf6fbf093f393f51
.octa 0x3f463dc9bf22bf7fbf22bf7fbf46bdc9,0x3f423f773ea1bf1d3f27be89bf73bf4a,0xbf043f183f783e163f5c3f4ebe79bf7d,0xbf6fbf093f393f51beb83f583f31bf13
.octa 0x80008000800080003f803f803f803f80,0xbf51bf6abf7abf80bf13becfbe60bcc9,0x3f713f3e3edb3d49beacbf2cbf67bf80,0xbe893ea13f4a3f7f3f773f733f1d3d97
.octa 0x3f803f803f803f800000000000000000,0xbf13becfbe60bcc93f513f6a3f7a3f80,0xbeacbf2cbf67bf80bf71bf3ebedbbd49,0x3f773f733f1d3d973e89bea1bf4abf7f
.octa 0xbf22bf7fbf46bdc9bf46bdc93f223f7f,0x3f7f3efcbee6bf7ebd97bf5fbf65bdfb,0xbf043f183f783e163f5c3f4ebe79bf7d,0xbecfbf7a3cc93f7cbf6a3e603f803e2f
.octa 0xbf46bdc93f223f7f3f223f7f3f463dc9,0xbd97bf5fbf65bdfbbf7fbefc3ee63f7e,0x3f5c3f4ebe79bf7d3f04bf18bf78be16,0xbf6a3e603f803e2f3ecf3f7abcc9bf7c
.octa 0x80008000800080003f803f803f803f80,0xbe2fbeb8bf09bf31bf7cbf6fbf58bf39,0x3eac3f2c3f673f803f713f3e3edb3d49,0xbefcbf65bf7ebf42bf5fbee63dfb3f27
.octa 0x3f803f803f803f800000000000000000,0xbf7cbf6fbf58bf393e2f3eb83f093f31,0x3f713f3e3edb3d49beacbf2cbf67bf80,0xbf5fbee63dfb3f273efc3f653f7e3f42
.octa 0x3f223f7f3f463dc93f463dc9bf22bf7f,0xbf42bf77bea13f1dbf273e893f733f4a,0x3f5c3f4ebe79bf7d3f04bf18bf78be16,0xbf6fbf093f393f51beb83f583f31bf13
.octa 0x3f463dc9bf22bf7fbf22bf7fbf46bdc9,0xbf273e893f733f4a3f423f773ea1bf1d,0x3f04bf18bf78be16bf5cbf4e3e793f7d,0xbeb83f583f31bf133f6f3f09bf39bf51
.octa 0x80008000800080003f803f803f803f80,0xbf16bed5be6dbd173f4f3f693f793f80,0xbf73bf42bee6bd973ea13f273f653f7f,0xbf74bf76bf25bde2be9b3e8f3f443f7e
.octa 0x3f803f803f803f800000000000000000,0x3f4f3f693f793f803f163ed53e6d3d17,0x3ea13f273f653f7f3f733f423ee63d97,0xbe9b3e8f3f443f7e3f743f763f253de2
.octa 0xbf18bf7dbf4ebe16bf4ebe163f183f7d,0xbc49bf57bf6bbe3bbf80bf0c3eca3f7c,0x3f13bf09bf7cbe60bf51bf583e2f3f7a,0x3f72be0abf80be82bea7bf7ebd7b3f78
.octa 0xbf4ebe163f183f7d3f183f7d3f4e3e16,0xbf80bf0c3eca3f7c3c493f573f6b3e3b,0xbf51bf583e2f3f7abf133f093f7c3e60,0xbea7bf7ebd7b3f78bf723e0a3f803e82
.octa 0x80008000800080003f803f803f803f80,0xbf7dbf70bf5abf3c3e233eb23f063f2e,0xbea1bf27bf65bf7fbf73bf42bee6bd97,0x3f633ef7bdb0bf20beecbf60bf7fbf48
.octa 0x3f803f803f803f800000000000000000,0x3e233eb23f063f2e3f7d3f703f5a3f3c,0xbf73bf42bee6bd973ea13f273f653f7f,0xbeecbf60bf7fbf48bf63bef73db03f20
.octa 0x3f183f7d3f4e3e163f4e3e16bf18bf7d,0xbf333e543f6e3f533f373f7a3ebebf11,0xbf51bf583e2f3f7abf133f093f7c3e60,0x3ee1bf4cbf403f01bf66bf1b3f2a3f5d
.octa 0x3f4e3e16bf18bf7dbf18bf7dbf4ebe16,0x3f373f7a3ebebf113f33be54bf6ebf53,0xbf133f093f7c3e603f513f58be2fbf7a,0xbf66bf1b3f2a3f5dbee13f4c3f40bf01
.octa 0x80008000800080003f803f803f803f80,0xbf4fbf69bf79bf80bf16bed5be6dbd17,0x3f733f423ee63d97bea1bf27bf65bf7f,0xbe9b3e8f3f443f7e3f743f763f253de2
.octa 0x3f803f803f803f800000000000000000,0xbf16bed5be6dbd173f4f3f693f793f80,0xbea1bf27bf65bf7fbf73bf42bee6bd97,0x3f743f763f253de23e9bbe8fbf44bf7e
.octa 0xbf18bf7dbf4ebe16bf4ebe163f183f7d,0x3f803f0cbecabf7cbc49bf57bf6bbe3b,0xbf133f093f7c3e603f513f58be2fbf7a,0xbea7bf7ebd7b3f78bf723e0a3f803e82
.octa 0xbf4ebe163f183f7d3f183f7d3f4e3e16,0xbc49bf57bf6bbe3bbf80bf0c3eca3f7c,0x3f513f58be2fbf7a3f13bf09bf7cbe60,0xbf723e0a3f803e823ea73f7e3d7bbf78
.octa 0x80008000800080003f803f803f803f80,0xbe23beb2bf06bf2ebf7dbf70bf5abf3c,0x3ea13f273f653f7f3f733f423ee63d97,0xbeecbf60bf7fbf48bf63bef73db03f20
.octa 0x3f803f803f803f800000000000000000,0xbf7dbf70bf5abf3c3e233eb23f063f2e,0x3f733f423ee63d97bea1bf27bf65bf7f,0xbf63bef73db03f203eec3f603f7f3f48
.octa 0x3f183f7d3f4e3e163f4e3e16bf18bf7d,0xbf37bf7abebe3f11bf333e543f6e3f53,0x3f513f58be2fbf7a3f13bf09bf7cbe60,0xbf66bf1b3f2a3f5dbee13f4c3f40bf01
.octa 0x3f4e3e16bf18bf7dbf18bf7dbf4ebe16,0xbf333e543f6e3f533f373f7a3ebebf11,0x3f13bf09bf7cbe60bf51bf583e2f3f7a,0xbee13f4c3f40bf013f663f1bbf2abf5d
.octa 0x80008000800080003f803f803f803f80,0xbf18bedbbe79bd493f4e3f673f783f80,0xbf75bf46bef1bdc93e953f223f623f7f,0xbf71bf78bf2cbe16beac3e793f3e3f7d
.octa 0x3f803f803f803f800000000000000000,0x3f4e3f673f783f803f183edb3e793d49,0x3e953f223f623f7f3f753f463ef13dc9,0xbeac3e793f3e3f7d3f713f783f2c3e16
.octa 0xbf0ebf7bbf55be48bf55be483f0e3f7b,0x3d49bf4ebf71be79bf80bf183eac3f78,0x3f22bef1bf7fbe95bf46bf623dc93f75,0x3f78bd49bf7dbeacbe79bf80be163f71
.octa 0xbf55be483f0e3f7b3f0e3f7b3f553e48,0xbf80bf183eac3f78bd493f4e3f713e79,0xbf46bf623dc93f75bf223ef13f7f3e95,0xbe79bf80be163f71bf783d493f7d3eac
.octa 0x80008000800080003f803f803f803f80,0xbf7dbf71bf5cbf3e3e163eac3f043f2c,0xbe95bf22bf62bf7fbf75bf46bef1bdc9,0x3f673f04bd49bf18bedbbf5cbf80bf4e
.octa 0x3f803f803f803f800000000000000000,0x3e163eac3f043f2c3f7d3f713f5c3f3e,0xbf75bf46bef1bdc93e953f223f623f7f,0xbedbbf5cbf80bf4ebf67bf043d493f18
.octa 0x3f0e3f7b3f553e483f553e48bf0ebf7b,0xbf3e3e163f673f5c3f2c3f7d3edbbf04,0xbf46bf623dc93f75bf223ef13f7f3e95,0x3f04bf3ebf4e3edbbf5cbf2c3f183f67
.octa 0x3f553e48bf0ebf7bbf0ebf7bbf55be48,0x3f2c3f7d3edbbf043f3ebe16bf67bf5c,0xbf223ef13f7f3e953f463f62bdc9bf75,0xbf5cbf2c3f183f67bf043f3e3f4ebedb
.octa 0x80008000800080003f803f803f803f80,0xbf4ebf67bf78bf80bf18bedbbe79bd49,0x3f753f463ef13dc9be95bf22bf62bf7f,0xbeac3e793f3e3f7d3f713f783f2c3e16
.octa 0x3f803f803f803f800000000000000000,0xbf18bedbbe79bd493f4e3f673f783f80,0xbe95bf22bf62bf7fbf75bf46bef1bdc9,0x3f713f783f2c3e163eacbe79bf3ebf7d
.octa 0xbf0ebf7bbf55be48bf55be483f0e3f7b,0x3f803f18beacbf783d49bf4ebf71be79,0xbf223ef13f7f3e953f463f62bdc9bf75,0xbe79bf80be163f71bf783d493f7d3eac
.octa 0xbf55be483f0e3f7b3f0e3f7b3f553e48,0x3d49bf4ebf71be79bf80bf183eac3f78,0x3f463f62bdc9bf753f22bef1bf7fbe95,0xbf783d493f7d3eac3e793f803e16bf71
.octa 0x80008000800080003f803f803f803f80,0xbe16beacbf04bf2cbf7dbf71bf5cbf3e,0x3e953f223f623f7f3f753f463ef13dc9,0xbedbbf5cbf80bf4ebf67bf043d493f18
.octa 0x3f803f803f803f800000000000000000,0xbf7dbf71bf5cbf3e3e163eac3f043f2c,0x3f753f463ef13dc9be95bf22bf62bf7f,0xbf67bf043d493f183edb3f5c3f803f4e
.octa 0x3f0e3f7b3f553e483f553e48bf0ebf7b,0xbf2cbf7dbedb3f04bf3e3e163f673f5c,0x3f463f62bdc9bf753f22bef1bf7fbe95,0xbf5cbf2c3f183f67bf043f3e3f4ebedb
.octa 0x3f553e48bf0ebf7bbf0ebf7bbf55be48,0xbf3e3e163f673f5c3f2c3f7d3edbbf04,0x3f22bef1bf7fbe95bf46bf623dc93f75,0xbf043f3e3f4ebedb3f5c3f2cbf18bf67
.octa 0x80008000800080003f803f803f803f80,0xbf1bbee1be82bd7b3f4c3f663f783f80,0xbf77bf4abefcbdfb3e893f1d3f5f3f7e,0xbf6ebf7abf33be3bbebe3e543f373f7c
.octa 0x3f803f803f803f800000000000000000,0x3f4c3f663f783f803f1b3ee13e823d7b,0x3e893f1d3f5f3f7e3f773f4a3efc3dfb,0xbebe3e543f373f7c3f6e3f7a3f333e3b
.octa 0xbf04bf78bf5cbe79bf5cbe793f043f78,0x3de2bf44bf76be9bbf7ebf253e8f3f74,0x3f31becfbf80beb8bf39bf6a3cc93f6f,0x3f7d3d17bf79bed5be23bf80be6d3f69
.octa 0xbf5cbe793f043f783f043f783f5c3e79,0xbf7ebf253e8f3f74bde23f443f763e9b,0xbf39bf6a3cc93f6fbf313ecf3f803eb8,0xbe23bf80be6d3f69bf7dbd173f793ed5
.octa 0x80008000800080003f803f803f803f80,0xbf7ebf72bf5dbf403e0a3ea73f013f2a,0xbe89bf1dbf5fbf7ebf77bf4abefcbdfb,0x3f6b3f0cbc49bf11becabf57bf80bf53
.octa 0x3f803f803f803f800000000000000000,0x3e0a3ea73f013f2a3f7e3f723f5d3f40,0xbf77bf4abefcbdfb3e893f1d3f5f3f7e,0xbecabf57bf80bf53bf6bbf0c3c493f11
.octa 0x3f043f783f5c3e793f5c3e79bf04bf78,0xbf483db03f603f633f203f7f3ef7beec,0xbf39bf6a3cc93f6fbf313ecf3f803eb8,0x3f16bf2ebf5a3eb2bf4fbf3c3f063f70
.octa 0x3f5c3e79bf04bf78bf04bf78bf5cbe79,0x3f203f7f3ef7beec3f48bdb0bf60bf63,0xbf313ecf3f803eb83f393f6abcc9bf6f,0xbf4fbf3c3f063f70bf163f2e3f5abeb2
.octa 0x80008000800080003f803f803f803f80,0xbf4cbf66bf78bf80bf1bbee1be82bd7b,0x3f773f4a3efc3dfbbe89bf1dbf5fbf7e,0xbebe3e543f373f7c3f6e3f7a3f333e3b
.octa 0x3f803f803f803f800000000000000000,0xbf1bbee1be82bd7b3f4c3f663f783f80,0xbe89bf1dbf5fbf7ebf77bf4abefcbdfb,0x3f6e3f7a3f333e3b3ebebe54bf37bf7c
.octa 0xbf04bf78bf5cbe79bf5cbe793f043f78,0x3f7e3f25be8fbf743de2bf44bf76be9b,0xbf313ecf3f803eb83f393f6abcc9bf6f,0xbe23bf80be6d3f69bf7dbd173f793ed5
.octa 0xbf5cbe793f043f783f043f783f5c3e79,0x3de2bf44bf76be9bbf7ebf253e8f3f74,0x3f393f6abcc9bf6f3f31becfbf80beb8,0xbf7dbd173f793ed53e233f803e6dbf69
.octa 0x80008000800080003f803f803f803f80,0xbe0abea7bf01bf2abf7ebf72bf5dbf40,0x3e893f1d3f5f3f7e3f773f4a3efc3dfb,0xbecabf57bf80bf53bf6bbf0c3c493f11
.octa 0x3f803f803f803f800000000000000000,0xbf7ebf72bf5dbf403e0a3ea73f013f2a,0x3f773f4a3efc3dfbbe89bf1dbf5fbf7e,0xbf6bbf0c3c493f113eca3f573f803f53
.octa 0x3f043f783f5c3e793f5c3e79bf04bf78,0xbf20bf7fbef73eecbf483db03f603f63,0x3f393f6abcc9bf6f3f31becfbf80beb8,0xbf4fbf3c3f063f70bf163f2e3f5abeb2
.octa 0x3f5c3e79bf04bf78bf04bf78bf5cbe79,0xbf483db03f603f633f203f7f3ef7beec,0x3f31becfbf80beb8bf39bf6a3cc93f6f,0xbf163f2e3f5abeb23f4f3f3cbf06bf70
.octa 0x80008000800080003f803f803f803f80,0xbf1dbee6be89bd973f4a3f653f773f7f,0xbf78bf4ebf04be163e793f183f5c3f7d,0xbf6abf7cbf39be60becf3e2f3f313f7a
.octa 0x3f803f803f803f800000000000000000,0x3f4a3f653f773f7f3f1d3ee63e893d97,0x3e793f183f5c3f7d3f783f4e3f043e16,0xbecf3e2f3f313f7a3f6a3f7c3f393e60
.octa 0xbef1bf75bf62be95bf62be953ef13f75,0x3e2fbf39bf7abeb8bf7cbf313e603f6f,0x3f3ebeacbf80bedbbf2cbf71bd493f67,0x3f7f3dfbbf73befcbd97bf7ebea13f5f
.octa 0xbf62be953ef13f753ef13f753f623e95,0xbf7cbf313e603f6fbe2f3f393f7a3eb8,0xbf2cbf71bd493f67bf3e3eac3f803edb,0xbd97bf7ebea13f5fbf7fbdfb3f733efc
.octa 0x80008000800080003f803f803f803f80,0xbf7ebf73bf5fbf423dfb3ea13efc3f27,0xbe79bf18bf5cbf7dbf78bf4ebf04be16,0x3f6f3f133cc9bf09beb8bf51bf80bf58
.octa 0x3f803f803f803f800000000000000000,0x3dfb3ea13efc3f273f7e3f733f5f3f42,0xbf78bf4ebf04be163e793f183f5c3f7d,0xbeb8bf51bf80bf58bf6fbf13bcc93f09
.octa 0x3ef13f753f623e953f623e95bef1bf75,0xbf513cc93f583f6a3f133f803f09becf,0xbf2cbf71bd493f67bf3e3eac3f803edb,0x3f27bf1dbf653e89bf42bf4a3ee63f77
.octa 0x3f623e95bef1bf75bef1bf75bf62be95,0x3f133f803f09becf3f51bcc9bf58bf6a,0xbf3e3eac3f803edb3f2c3f713d49bf67,0xbf42bf4a3ee63f77bf273f1d3f65be89
.octa 0x80008000800080003f803f803f803f80,0xbf4abf65bf77bf7fbf1dbee6be89bd97,0x3f783f4e3f043e16be79bf18bf5cbf7d,0xbecf3e2f3f313f7a3f6a3f7c3f393e60
.octa 0x3f803f803f803f800000000000000000,0xbf1dbee6be89bd973f4a3f653f773f7f,0xbe79bf18bf5cbf7dbf78bf4ebf04be16,0x3f6a3f7c3f393e603ecfbe2fbf31bf7a
.octa 0xbef1bf75bf62be95bf62be953ef13f75,0x3f7c3f31be60bf6f3e2fbf39bf7abeb8,0xbf3e3eac3f803edb3f2c3f713d49bf67,0xbd97bf7ebea13f5fbf7fbdfb3f733efc
.octa 0xbf62be953ef13f753ef13f753f623e95,0x3e2fbf39bf7abeb8bf7cbf313e603f6f,0x3f2c3f713d49bf673f3ebeacbf80bedb,0xbf7fbdfb3f733efc3d973f7e3ea1bf5f
.octa 0x80008000800080003f803f803f803f80,0xbdfbbea1befcbf27bf7ebf73bf5fbf42,0x3e793f183f5c3f7d3f783f4e3f043e16,0xbeb8bf51bf80bf58bf6fbf13bcc93f09
.octa 0x3f803f803f803f800000000000000000,0xbf7ebf73bf5fbf423dfb3ea13efc3f27,0x3f783f4e3f043e16be79bf18bf5cbf7d,0xbf6fbf13bcc93f093eb83f513f803f58
.octa 0x3ef13f753f623e953f623e95bef1bf75,0xbf13bf80bf093ecfbf513cc93f583f6a,0x3f2c3f713d49bf673f3ebeacbf80bedb,0xbf42bf4a3ee63f77bf273f1d3f65be89
.octa 0x3f623e95bef1bf75bef1bf75bf62be95,0xbf513cc93f583f6a3f133f803f09becf,0x3f3ebeacbf80bedbbf2cbf71bd493f67,0xbf273f1d3f65be893f423f4abee6bf77
.octa 0x80008000800080003f803f803f803f80,0xbf20beecbe8fbdb03f483f633f763f7f,0xbf7abf51bf09be2f3e603f133f583f7c,0xbf66bf7ebf40be82bee13e0a3f2a3f78
.octa 0x3f803f803f803f800000000000000000,0x3f483f633f763f7f3f203eec3e8f3db0,0x3e603f133f583f7c3f7a3f513f093e2f,0xbee13e0a3f2a3f783f663f7e3f403e82
.octa 0xbedbbf71bf67beacbf67beac3edb3f71,0x3e6dbf2ebf7dbed5bf79bf3c3e233f69,0x3f4abe89bf7ebefcbf1dbf77bdfb3f5f,0x3f803e54bf6bbf113c49bf7abeca3f53
.octa 0xbf67beac3edb3f713edb3f713f673eac,0xbf79bf3c3e233f69be6d3f2e3f7d3ed5,0xbf1dbf77bdfb3f5fbf4a3e893f7e3efc,0x3c49bf7abeca3f53bf80be543f6b3f11
.octa 0x80008000800080003f803f803f803f80,0xbf7ebf74bf60bf443de23e9b3ef73f25,0xbe60bf13bf58bf7cbf7abf51bf09be2f,0x3f723f1b3d7bbf01bea7bf4cbf80bf5d
.octa 0x3f803f803f803f800000000000000000,0x3de23e9b3ef73f253f7e3f743f603f44,0xbf7abf51bf09be2f3e603f133f583f7c,0xbea7bf4cbf80bf5dbf72bf1bbd7b3f01
.octa 0x3edb3f713f673eac3f673eacbedbbf71,0xbf5abd173f4f3f703f063f803f16beb2,0xbf1dbf77bdfb3f5fbf4a3e893f7e3efc,0x3f37bf0cbf6e3e3bbf33bf573ebe3f7c
.octa 0x3f673eacbedbbf71bedbbf71bf67beac,0x3f063f803f16beb23f5a3d17bf4fbf70,0xbf4a3e893f7e3efc3f1d3f773dfbbf5f,0xbf33bf573ebe3f7cbf373f0c3f6ebe3b
.octa 0x80008000800080003f803f803f803f80,0xbf48bf63bf76bf7fbf20beecbe8fbdb0,0x3f7a3f513f093e2fbe60bf13bf58bf7c,0xbee13e0a3f2a3f783f663f7e3f403e82
.octa 0x3f803f803f803f800000000000000000,0xbf20beecbe8fbdb03f483f633f763f7f,0xbe60bf13bf58bf7cbf7abf51bf09be2f,0x3f663f7e3f403e823ee1be0abf2abf78
.octa 0xbedbbf71bf67beacbf67beac3edb3f71,0x3f793f3cbe23bf693e6dbf2ebf7dbed5,0xbf4a3e893f7e3efc3f1d3f773dfbbf5f,0x3c49bf7abeca3f53bf80be543f6b3f11
.octa 0xbf67beac3edb3f713edb3f713f673eac,0x3e6dbf2ebf7dbed5bf79bf3c3e233f69,0x3f1d3f773dfbbf5f3f4abe89bf7ebefc,0xbf80be543f6b3f11bc493f7a3ecabf53
.octa 0x80008000800080003f803f803f803f80,0xbde2be9bbef7bf25bf7ebf74bf60bf44,0x3e603f133f583f7c3f7a3f513f093e2f,0xbea7bf4cbf80bf5dbf72bf1bbd7b3f01
.octa 0x3f803f803f803f800000000000000000,0xbf7ebf74bf60bf443de23e9b3ef73f25,0x3f7a3f513f093e2fbe60bf13bf58bf7c,0xbf72bf1bbd7b3f013ea73f4c3f803f5d
.octa 0x3edb3f713f673eac3f673eacbedbbf71,0xbf06bf80bf163eb2bf5abd173f4f3f70,0x3f1d3f773dfbbf5f3f4abe89bf7ebefc,0xbf33bf573ebe3f7cbf373f0c3f6ebe3b
.octa 0x3f673eacbedbbf71bedbbf71bf67beac,0xbf5abd173f4f3f703f063f803f16beb2,0x3f4abe89bf7ebefcbf1dbf77bdfb3f5f,0xbf373f0c3f6ebe3b3f333f57bebebf7c
.octa 0x80008000800080003f803f803f803f80,0xbf22bef1be95bdc93f463f623f753f7f,0xbf7bbf55bf0ebe483e483f0e3f553f7b,0xbf62bf7fbf46be95bef13dc93f223f75
.octa 0x00000000000000000000000000000000,0x00000000000000000000000000000000,0x00000000000000000000000000000000,0x00000000000000000000000000000000
.octa 0xbec4bf6dbf6dbec4bf6dbec43ec43f6d,0x3e95bf22bf7fbef1bf75bf463dc93f62,0x3f55be48bf7bbf0ebf0ebf7bbe483f55,0x3f7f3e95bf62bf223dc9bf75bef13f46
.octa 0x00000000000000000000000000000000,0x00000000000000000000000000000000,0x00000000000000000000000000000000,0x00000000000000000000000000000000
.octa 0x80008000800080003f803f803f803f80,0xbf7fbf75bf62bf463dc93e953ef13f22,0xbe48bf0ebf55bf7bbf7bbf55bf0ebe48,0x3f753f223dc9bef1be95bf46bf7fbf62
.octa 0x00000000000000000000000000000000,0x00000000000000000000000000000000,0x00000000000000000000000000000000,0x00000000000000000000000000000000
.octa 0x3ec43f6d3f6d3ec43f6d3ec4bec4bf6d,0xbf62bdc93f463f753ef13f7f3f22be95,0xbf0ebf7bbe483f55bf553e483f7b3f0e,0x3f46bef1bf753dc9bf22bf623e953f7f
.octa 0x00000000000000000000000000000000,0x00000000000000000000000000000000,0x00000000000000000000000000000000,0x00000000000000000000000000000000
.octa 0x80008000800080003f803f803f803f80,0xbf46bf62bf75bf7fbf22bef1be95bdc9,0x3f7b3f553f0e3e48be48bf0ebf55bf7b,0xbef13dc93f223f753f623f7f3f463e95
.octa 0x00000000000000000000000000000000,0x00000000000000000000000000000000,0x00000000000000000000000000000000,0x00000000000000000000000000000000
.octa 0xbec4bf6dbf6dbec4bf6dbec43ec43f6d,0x3f753f46bdc9bf623e95bf22bf7fbef1,0xbf553e483f7b3f0e3f0e3f7b3e48bf55,0x3dc9bf75bef13f46bf7fbe953f623f22
.octa 0x00000000000000000000000000000000,0x00000000000000000000000000000000,0x00000000000000000000000000000000,0x00000000000000000000000000000000
.octa 0x80008000800080003f803f803f803f80,0xbdc9be95bef1bf22bf7fbf75bf62bf46,0x3e483f0e3f553f7b3f7b3f553f0e3e48,0xbe95bf46bf7fbf62bf75bf22bdc93ef1
.octa 0x00000000000000000000000000000000,0x00000000000000000000000000000000,0x00000000000000000000000000000000,0x00000000000000000000000000000000
.octa 0x3ec43f6d3f6d3ec43f6d3ec4bec4bf6d,0xbef1bf7fbf223e95bf62bdc93f463f75,0x3f0e3f7b3e48bf553f55be48bf7bbf0e,0xbf22bf623e953f7fbf463ef13f75bdc9
.octa 0x00000000000000000000000000000000,0x00000000000000000000000000000000,0x00000000000000000000000000000000,0x00000000000000000000000000000000
.octa 0x80008000800080003f803f803f803f80,0xbf25bef7be9bbde23f443f603f743f7e,0xbf7cbf58bf13be603e2f3f093f513f7a,0xbf5dbf80bf4cbea7bf013d7b3f1b3f72
.octa 0xbf80bf80bf80bf800000000000000000,0xbf44bf60bf74bf7ebf25bef7be9bbde2,0xbe2fbf09bf51bf7abf7cbf58bf13be60,0x3f01bd7bbf1bbf72bf5dbf80bf4cbea7
.octa 0xbeacbf67bf71bedbbf71bedb3eac3f67,0x3eb2bf16bf80bf06bf70bf4f3d173f5a,0x3f5fbdfbbf77bf1dbefcbf7ebe893f4a,0x3f7c3ebebf57bf333e3bbf6ebf0c3f37
.octa 0x3f713edbbeacbf67beacbf67bf71bedb,0x3f703f4fbd17bf5a3eb2bf16bf80bf06,0x3efc3f7e3e89bf4a3f5fbdfbbf77bf1d,0xbe3b3f6e3f0cbf373f7c3ebebf57bf33
.octa 0x80008000800080003f803f803f803f80,0xbf7fbf76bf63bf483db03e8f3eec3f20,0xbe2fbf09bf51bf7abf7cbf58bf13be60,0x3f783f2a3e0abee1be82bf40bf7ebf66
.octa 0xbf80bf80bf80bf800000000000000000,0xbdb0be8fbeecbf20bf7fbf76bf63bf48,0x3f7c3f583f133e60be2fbf09bf51bf7a,0x3e823f403f7e3f663f783f2a3e0abee1
.octa 0x3eac3f673f713edb3f713edbbeacbf67,0xbf69be233f3c3f793ed53f7d3f2ebe6d,0xbefcbf7ebe893f4abf5f3dfb3f773f1d,0x3f53becabf7a3c49bf11bf6b3e543f80
.octa 0xbf71bedb3eac3f673eac3f673f713edb,0xbed5bf7dbf2e3e6dbf69be233f3c3f79,0x3f5fbdfbbf77bf1dbefcbf7ebe893f4a,0x3f113f6bbe54bf803f53becabf7a3c49
.octa 0x80008000800080003f803f803f803f80,0xbf44bf60bf74bf7ebf25bef7be9bbde2,0x3f7c3f583f133e60be2fbf09bf51bf7a,0xbf013d7b3f1b3f723f5d3f803f4c3ea7
.octa 0xbf80bf80bf80bf800000000000000000,0x3f253ef73e9b3de2bf44bf60bf74bf7e,0x3e2f3f093f513f7a3f7c3f583f133e60,0xbf5dbf80bf4cbea7bf013d7b3f1b3f72
.octa 0xbeacbf67bf71bedbbf71bedb3eac3f67,0x3f703f4fbd17bf5a3eb2bf16bf80bf06,0xbf5f3dfb3f773f1d3efc3f7e3e89bf4a,0x3e3bbf6ebf0c3f37bf7cbebe3f573f33
.octa 0x3f713edbbeacbf67beacbf67bf71bedb,0xbeb23f163f803f063f703f4fbd17bf5a,0xbefcbf7ebe893f4abf5f3dfb3f773f1d,0x3f7c3ebebf57bf333e3bbf6ebf0c3f37
.octa 0x80008000800080003f803f803f803f80,0xbdb0be8fbeecbf20bf7fbf76bf63bf48,0x3e2f3f093f513f7a3f7c3f583f133e60,0xbe82bf40bf7ebf66bf78bf2abe0a3ee1
.octa 0xbf80bf80bf80bf800000000000000000,0x3f7f3f763f633f48bdb0be8fbeecbf20,0xbf7cbf58bf13be603e2f3f093f513f7a,0x3f783f2a3e0abee1be82bf40bf7ebf66
.octa 0x3eac3f673f713edb3f713edbbeacbf67,0xbed5bf7dbf2e3e6dbf69be233f3c3f79,0x3efc3f7e3e89bf4a3f5fbdfbbf77bf1d,0xbf11bf6b3e543f80bf533eca3f7abc49
.octa 0xbf71bedb3eac3f673eac3f673f713edb,0x3f693e23bf3cbf79bed5bf7dbf2e3e6d,0xbf5f3dfb3f773f1d3efc3f7e3e89bf4a,0x3f53becabf7a3c49bf11bf6b3e543f80
.octa 0x80008000800080003f803f803f803f80,0xbf27befcbea1bdfb3f423f5f3f733f7e,0xbf7dbf5cbf18be793e163f043f4e3f78,0xbf58bf80bf51beb8bf093cc93f133f6f
.octa 0xbf80bf80bf80bf800000000000000000,0xbf42bf5fbf73bf7ebf27befcbea1bdfb,0xbe16bf04bf4ebf78bf7dbf5cbf18be79,0x3f09bcc9bf13bf6fbf58bf80bf51beb8
.octa 0xbe95bf62bf75bef1bf75bef13e953f62,0x3ecfbf09bf80bf13bf6abf58bcc93f51,0x3f67bd49bf71bf2cbedbbf80beac3f3e,0x3f773ee6bf4abf423e89bf65bf1d3f27
.octa 0x3f753ef1be95bf62be95bf62bf75bef1,0x3f6a3f583cc9bf513ecfbf09bf80bf13,0x3edb3f803eacbf3e3f67bd49bf71bf2c,0xbe893f653f1dbf273f773ee6bf4abf42
.octa 0x80008000800080003f803f803f803f80,0xbf7fbf77bf65bf4a3d973e893ee63f1d,0xbe16bf04bf4ebf78bf7dbf5cbf18be79,0x3f7a3f313e2fbecfbe60bf39bf7cbf6a
.octa 0xbf80bf80bf80bf800000000000000000,0xbd97be89bee6bf1dbf7fbf77bf65bf4a,0x3f7d3f5c3f183e79be16bf04bf4ebf78,0x3e603f393f7c3f6a3f7a3f313e2fbecf
.octa 0x3e953f623f753ef13f753ef1be95bf62,0xbf6fbe603f313f7c3eb83f7a3f39be2f,0xbedbbf80beac3f3ebf673d493f713f2c,0x3f5fbea1bf7ebd97befcbf733dfb3f7f
.octa 0xbf75bef13e953f623e953f623f753ef1,0xbeb8bf7abf393e2fbf6fbe603f313f7c,0x3f67bd49bf71bf2cbedbbf80beac3f3e,0x3efc3f73bdfbbf7f3f5fbea1bf7ebd97
.octa 0x80008000800080003f803f803f803f80,0xbf42bf5fbf73bf7ebf27befcbea1bdfb,0x3f7d3f5c3f183e79be16bf04bf4ebf78,0xbf093cc93f133f6f3f583f803f513eb8
.octa 0xbf80bf80bf80bf800000000000000000,0x3f273efc3ea13dfbbf42bf5fbf73bf7e,0x3e163f043f4e3f783f7d3f5c3f183e79,0xbf58bf80bf51beb8bf093cc93f133f6f
.octa 0xbe95bf62bf75bef1bf75bef13e953f62,0x3f6a3f583cc9bf513ecfbf09bf80bf13,0xbf673d493f713f2c3edb3f803eacbf3e,0x3e89bf65bf1d3f27bf77bee63f4a3f42
.octa 0x3f753ef1be95bf62be95bf62bf75bef1,0xbecf3f093f803f133f6a3f583cc9bf51,0xbedbbf80beac3f3ebf673d493f713f2c,0x3f773ee6bf4abf423e89bf65bf1d3f27
.octa 0x80008000800080003f803f803f803f80,0xbd97be89bee6bf1dbf7fbf77bf65bf4a,0x3e163f043f4e3f783f7d3f5c3f183e79,0xbe60bf39bf7cbf6abf7abf31be2f3ecf
.octa 0xbf80bf80bf80bf800000000000000000,0x3f7f3f773f653f4abd97be89bee6bf1d,0xbf7dbf5cbf18be793e163f043f4e3f78,0x3f7a3f313e2fbecfbe60bf39bf7cbf6a
.octa 0x3e953f623f753ef13f753ef1be95bf62,0xbeb8bf7abf393e2fbf6fbe603f313f7c,0x3edb3f803eacbf3e3f67bd49bf71bf2c,0xbefcbf733dfb3f7fbf5f3ea13f7e3d97
.octa 0xbf75bef13e953f623e953f623f753ef1,0x3f6f3e60bf31bf7cbeb8bf7abf393e2f,0xbf673d493f713f2c3edb3f803eacbf3e,0x3f5fbea1bf7ebd97befcbf733dfb3f7f
.octa 0x80008000800080003f803f803f803f80,0xbf2abf01bea7be0a3f403f5d3f723f7e,0xbf7ebf5fbf1dbe893dfb3efc3f4a3f77,0xbf53bf80bf57becabf11bc493f0c3f6b
.octa 0xbf80bf80bf80bf800000000000000000,0xbf40bf5dbf72bf7ebf2abf01bea7be0a,0xbdfbbefcbf4abf77bf7ebf5fbf1dbe89,0x3f113c49bf0cbf6bbf53bf80bf57beca
.octa 0xbe79bf5cbf78bf04bf78bf043e793f5c,0x3eecbef7bf7fbf20bf63bf60bdb03f48,0x3f6f3cc9bf6abf39beb8bf80becf3f31,0x3f703f06bf3cbf4f3eb2bf5abf2e3f16
.octa 0x3f783f04be79bf5cbe79bf5cbf78bf04,0x3f633f603db0bf483eecbef7bf7fbf20,0x3eb83f803ecfbf313f6f3cc9bf6abf39,0xbeb23f5a3f2ebf163f703f06bf3cbf4f
.octa 0x80008000800080003f803f803f803f80,0xbf80bf78bf66bf4c3d7b3e823ee13f1b,0xbdfbbefcbf4abf77bf7ebf5fbf1dbe89,0x3f7c3f373e54bebebe3bbf33bf7abf6e
.octa 0xbf80bf80bf80bf800000000000000000,0xbd7bbe82bee1bf1bbf80bf78bf66bf4c,0x3f7e3f5f3f1d3e89bdfbbefcbf4abf77,0x3e3b3f333f7a3f6e3f7c3f373e54bebe
.octa 0x3e793f5c3f783f043f783f04be79bf5c,0xbf74be8f3f253f7e3e9b3f763f44bde2,0xbeb8bf80becf3f31bf6fbcc93f6a3f39,0x3f69be6dbf80be23bed5bf793d173f7d
.octa 0xbf78bf043e793f5c3e793f5c3f783f04,0xbe9bbf76bf443de2bf74be8f3f253f7e,0x3f6f3cc9bf6abf39beb8bf80becf3f31,0x3ed53f79bd17bf7d3f69be6dbf80be23
.octa 0x80008000800080003f803f803f803f80,0xbf40bf5dbf72bf7ebf2abf01bea7be0a,0x3f7e3f5f3f1d3e89bdfbbefcbf4abf77,0xbf11bc493f0c3f6b3f533f803f573eca
.octa 0xbf80bf80bf80bf800000000000000000,0x3f2a3f013ea73e0abf40bf5dbf72bf7e,0x3dfb3efc3f4a3f773f7e3f5f3f1d3e89,0xbf53bf80bf57becabf11bc493f0c3f6b
.octa 0xbe79bf5cbf78bf04bf78bf043e793f5c,0x3f633f603db0bf483eecbef7bf7fbf20,0xbf6fbcc93f6a3f393eb83f803ecfbf31,0x3eb2bf5abf2e3f16bf70bf063f3c3f4f
.octa 0x3f783f04be79bf5cbe79bf5cbf78bf04,0xbeec3ef73f7f3f203f633f603db0bf48,0xbeb8bf80becf3f31bf6fbcc93f6a3f39,0x3f703f06bf3cbf4f3eb2bf5abf2e3f16
.octa 0x80008000800080003f803f803f803f80,0xbd7bbe82bee1bf1bbf80bf78bf66bf4c,0x3dfb3efc3f4a3f773f7e3f5f3f1d3e89,0xbe3bbf33bf7abf6ebf7cbf37be543ebe
.octa 0xbf80bf80bf80bf800000000000000000,0x3f803f783f663f4cbd7bbe82bee1bf1b,0xbf7ebf5fbf1dbe893dfb3efc3f4a3f77,0x3f7c3f373e54bebebe3bbf33bf7abf6e
.octa 0x3e793f5c3f783f043f783f04be79bf5c,0xbe9bbf76bf443de2bf74be8f3f253f7e,0x3eb83f803ecfbf313f6f3cc9bf6abf39,0xbed5bf793d173f7dbf693e6d3f803e23
.octa 0xbf78bf043e793f5c3e793f5c3f783f04,0x3f743e8fbf25bf7ebe9bbf76bf443de2,0xbf6fbcc93f6a3f393eb83f803ecfbf31,0x3f69be6dbf80be23bed5bf793d173f7d
.octa 0x80008000800080003f803f803f803f80,0xbf2cbf04beacbe163f3e3f5c3f713f7d,0xbf7fbf62bf22be953dc93ef13f463f75,0xbf4ebf80bf5cbedbbf18bd493f043f67
.octa 0xbf80bf80bf80bf800000000000000000,0xbf3ebf5cbf71bf7dbf2cbf04beacbe16,0xbdc9bef1bf46bf75bf7fbf62bf22be95,0x3f183d49bf04bf67bf4ebf80bf5cbedb
.octa 0xbe48bf55bf7bbf0ebf7bbf0e3e483f55,0x3f04bedbbf7dbf2cbf5cbf67be163f3e,0x3f753dc9bf62bf46be95bf7fbef13f22,0x3f673f18bf2cbf5c3edbbf4ebf3e3f04
.octa 0x3f7b3f0ebe48bf55be48bf55bf7bbf0e,0x3f5c3f673e16bf3e3f04bedbbf7dbf2c,0x3e953f7f3ef1bf223f753dc9bf62bf46,0xbedb3f4e3f3ebf043f673f18bf2cbf5c
.octa 0x80008000800080003f803f803f803f80,0xbf80bf78bf67bf4e3d493e793edb3f18,0xbdc9bef1bf46bf75bf7fbf62bf22be95,0x3f7d3f3e3e79beacbe16bf2cbf78bf71
.octa 0xbf80bf80bf80bf800000000000000000,0xbd49be79bedbbf18bf80bf78bf67bf4e,0x3f7f3f623f223e95bdc9bef1bf46bf75,0x3e163f2c3f783f713f7d3f3e3e79beac
.octa 0x3e483f553f7b3f0e3f7b3f0ebe48bf55,0xbf78beac3f183f803e793f713f4ebd49,0xbe95bf7fbef13f22bf75bdc93f623f46,0x3f71be16bf80be79beacbf7dbd493f78
.octa 0xbf7bbf0e3e483f553e483f553f7b3f0e,0xbe79bf71bf4e3d49bf78beac3f183f80,0x3f753dc9bf62bf46be95bf7fbef13f22,0x3eac3f7d3d49bf783f71be16bf80be79
.octa 0x80008000800080003f803f803f803f80,0xbf3ebf5cbf71bf7dbf2cbf04beacbe16,0x3f7f3f623f223e95bdc9bef1bf46bf75,0xbf18bd493f043f673f4e3f803f5c3edb
.octa 0xbf80bf80bf80bf800000000000000000,0x3f2c3f043eac3e16bf3ebf5cbf71bf7d,0x3dc93ef13f463f753f7f3f623f223e95,0xbf4ebf80bf5cbedbbf18bd493f043f67
.octa 0xbe48bf55bf7bbf0ebf7bbf0e3e483f55,0x3f5c3f673e16bf3e3f04bedbbf7dbf2c,0xbf75bdc93f623f463e953f7f3ef1bf22,0x3edbbf4ebf3e3f04bf67bf183f2c3f5c
.octa 0x3f7b3f0ebe48bf55be48bf55bf7bbf0e,0xbf043edb3f7d3f2c3f5c3f673e16bf3e,0xbe95bf7fbef13f22bf75bdc93f623f46,0x3f673f18bf2cbf5c3edbbf4ebf3e3f04
.octa 0x80008000800080003f803f803f803f80,0xbd49be79bedbbf18bf80bf78bf67bf4e,0x3dc93ef13f463f753f7f3f623f223e95,0xbe16bf2cbf78bf71bf7dbf3ebe793eac
.octa 0xbf80bf80bf80bf800000000000000000,0x3f803f783f673f4ebd49be79bedbbf18,0xbf7fbf62bf22be953dc93ef13f463f75,0x3f7d3f3e3e79beacbe16bf2cbf78bf71
.octa 0x3e483f553f7b3f0e3f7b3f0ebe48bf55,0xbe79bf71bf4e3d49bf78beac3f183f80,0x3e953f7f3ef1bf223f753dc9bf62bf46,0xbeacbf7dbd493f78bf713e163f803e79
.octa 0xbf7bbf0e3e483f553e483f553f7b3f0e,0x3f783eacbf18bf80be79bf71bf4e3d49,0xbf75bdc93f623f463e953f7f3ef1bf22,0x3f71be16bf80be79beacbf7dbd493f78
.octa 0x80008000800080003f803f803f803f80,0xbf2ebf06beb2be233f3c3f5a3f703f7d,0xbf7fbf65bf27bea13d973ee63f423f73,0xbf48bf7fbf60beecbf20bdb03ef73f63
.octa 0xbf80bf80bf80bf800000000000000000,0xbf3cbf5abf70bf7dbf2ebf06beb2be23,0xbd97bee6bf42bf73bf7fbf65bf27bea1,0x3f203db0bef7bf63bf48bf7fbf60beec
.octa 0xbe16bf4ebf7dbf18bf7dbf183e163f4e,0x3f11bebebf7abf37bf53bf6ebe543f33,0x3f7a3e2fbf58bf51be60bf7cbf093f13,0x3f5d3f2abf1bbf663f01bf40bf4c3ee1
.octa 0x3f7d3f18be16bf4ebe16bf4ebf7dbf18,0x3f533f6e3e54bf333f11bebebf7abf37,0x3e603f7c3f09bf133f7a3e2fbf58bf51,0xbf013f403f4cbee13f5d3f2abf1bbf66
.octa 0x80008000800080003f803f803f803f80,0xbf80bf79bf69bf4f3d173e6d3ed53f16,0xbd97bee6bf42bf73bf7fbf65bf27bea1,0x3f7e3f443e8fbe9bbde2bf25bf76bf74
.octa 0xbf80bf80bf80bf800000000000000000,0xbd17be6dbed5bf16bf80bf79bf69bf4f,0x3f7f3f653f273ea1bd97bee6bf42bf73,0x3de23f253f763f743f7e3f443e8fbe9b
.octa 0x3e163f4e3f7d3f183f7d3f18be16bf4e,0xbf7cbeca3f0c3f803e3b3f6b3f573c49,0xbe60bf7cbf093f13bf7abe2f3f583f51,0x3f78bd7bbf7ebea7be82bf80be0a3f72
.octa 0xbf7dbf183e163f4e3e163f4e3f7d3f18,0xbe3bbf6bbf57bc49bf7cbeca3f0c3f80,0x3f7a3e2fbf58bf51be60bf7cbf093f13,0x3e823f803e0abf723f78bd7bbf7ebea7
.octa 0x80008000800080003f803f803f803f80,0xbf3cbf5abf70bf7dbf2ebf06beb2be23,0x3f7f3f653f273ea1bd97bee6bf42bf73,0xbf20bdb03ef73f633f483f7f3f603eec
.octa 0xbf80bf80bf80bf800000000000000000,0x3f2e3f063eb23e23bf3cbf5abf70bf7d,0x3d973ee63f423f733f7f3f653f273ea1,0xbf48bf7fbf60beecbf20bdb03ef73f63
.octa 0xbe16bf4ebf7dbf18bf7dbf183e163f4e,0x3f533f6e3e54bf333f11bebebf7abf37,0xbf7abe2f3f583f513e603f7c3f09bf13,0x3f01bf40bf4c3ee1bf5dbf2a3f1b3f66
.octa 0x3f7d3f18be16bf4ebe16bf4ebf7dbf18,0xbf113ebe3f7a3f373f533f6e3e54bf33,0xbe60bf7cbf093f13bf7abe2f3f583f51,0x3f5d3f2abf1bbf663f01bf40bf4c3ee1
.octa 0x80008000800080003f803f803f803f80,0xbd17be6dbed5bf16bf80bf79bf69bf4f,0x3d973ee63f423f733f7f3f653f273ea1,0xbde2bf25bf76bf74bf7ebf44be8f3e9b
.octa 0xbf80bf80bf80bf800000000000000000,0x3f803f793f693f4fbd17be6dbed5bf16,0xbf7fbf65bf27bea13d973ee63f423f73,0x3f7e3f443e8fbe9bbde2bf25bf76bf74
.octa 0x3e163f4e3f7d3f183f7d3f18be16bf4e,0xbe3bbf6bbf57bc49bf7cbeca3f0c3f80,0x3e603f7c3f09bf133f7a3e2fbf58bf51,0xbe82bf80be0a3f72bf783d7b3f7e3ea7
.octa 0xbf7dbf183e163f4e3e163f4e3f7d3f18,0x3f7c3ecabf0cbf80be3bbf6bbf57bc49,0xbf7abe2f3f583f513e603f7c3f09bf13,0x3f78bd7bbf7ebea7be82bf80be0a3f72
.octa 0x80008000800080003f803f803f803f80,0xbf31bf09beb8be2f3f393f583f6f3f7c,0xbf80bf67bf2cbeac3d493edb3f3e3f71,0xbf42bf7ebf65befcbf27bdfb3ee63f5f
.octa 0xbf80bf80bf80bf800000000000000000,0xbf39bf58bf6fbf7cbf31bf09beb8be2f,0xbd49bedbbf3ebf71bf80bf67bf2cbeac,0x3f273dfbbee6bf5fbf42bf7ebf65befc
.octa 0xbdc9bf46bf7fbf22bf7fbf223dc93f46,0x3f1dbea1bf77bf42bf4abf73be893f27,0x3f7d3e79bf4ebf5cbe16bf78bf183f04,0x3f513f39bf09bf6f3f13bf31bf583eb8
.octa 0x3f7f3f22bdc9bf46bdc9bf46bf7fbf22,0x3f4a3f733e89bf273f1dbea1bf77bf42,0x3e163f783f18bf043f7d3e79bf4ebf5c,0xbf133f313f58beb83f513f39bf09bf6f
.octa 0x80008000800080003f803f803f803f80,0xbf80bf7abf6abf513cc93e603ecf3f13,0xbd49bedbbf3ebf71bf80bf67bf2cbeac,0x3f7f3f4a3ea1be89bd97bf1dbf73bf77
.octa 0xbf80bf80bf80bf800000000000000000,0xbcc9be60becfbf13bf80bf7abf6abf51,0x3f803f673f2c3eacbd49bedbbf3ebf71,0x3d973f1d3f733f773f7f3f4a3ea1be89
.octa 0x3dc93f463f7f3f223f7f3f22bdc9bf46,0xbf7ebee63efc3f7f3dfb3f653f5f3d97,0xbe16bf78bf183f04bf7dbe793f4e3f5c,0x3f7c3cc9bf7abecfbe2fbf80be603f6a
.octa 0xbf7fbf223dc93f463dc93f463f7f3f22,0xbdfbbf65bf5fbd97bf7ebee63efc3f7f,0x3f7d3e79bf4ebf5cbe16bf78bf183f04,0x3e2f3f803e60bf6a3f7c3cc9bf7abecf
.octa 0x80008000800080003f803f803f803f80,0xbf39bf58bf6fbf7cbf31bf09beb8be2f,0x3f803f673f2c3eacbd49bedbbf3ebf71,0xbf27bdfb3ee63f5f3f423f7e3f653efc
.octa 0xbf80bf80bf80bf800000000000000000,0x3f313f093eb83e2fbf39bf58bf6fbf7c,0x3d493edb3f3e3f713f803f673f2c3eac,0xbf42bf7ebf65befcbf27bdfb3ee63f5f
.octa 0xbdc9bf46bf7fbf22bf7fbf223dc93f46,0x3f4a3f733e89bf273f1dbea1bf77bf42,0xbf7dbe793f4e3f5c3e163f783f18bf04,0x3f13bf31bf583eb8bf51bf393f093f6f
.octa 0x3f7f3f22bdc9bf46bdc9bf46bf7fbf22,0xbf1d3ea13f773f423f4a3f733e89bf27,0xbe16bf78bf183f04bf7dbe793f4e3f5c,0x3f513f39bf09bf6f3f13bf31bf583eb8
.octa 0x80008000800080003f803f803f803f80,0xbcc9be60becfbf13bf80bf7abf6abf51,0x3d493edb3f3e3f713f803f673f2c3eac,0xbd97bf1dbf73bf77bf7fbf4abea13e89
.octa 0xbf80bf80bf80bf800000000000000000,0x3f803f7a3f6a3f51bcc9be60becfbf13,0xbf80bf67bf2cbeac3d493edb3f3e3f71,0x3f7f3f4a3ea1be89bd97bf1dbf73bf77
.octa 0x3dc93f463f7f3f223f7f3f22bdc9bf46,0xbdfbbf65bf5fbd97bf7ebee63efc3f7f,0x3e163f783f18bf043f7d3e79bf4ebf5c,0xbe2fbf80be603f6abf7cbcc93f7a3ecf
.octa 0xbf7fbf223dc93f463dc93f463f7f3f22,0x3f7e3ee6befcbf7fbdfbbf65bf5fbd97,0xbf7dbe793f4e3f5c3e163f783f18bf04,0x3f7c3cc9bf7abecfbe2fbf80be603f6a
.octa 0x80008000800080003f803f803f803f80,0xbf33bf0cbebebe3b3f373f573f6e3f7c,0xbf80bf6abf31beb83cc93ecf3f393f6f,0xbf3cbf7dbf69bf06bf2ebe233ed53f5a
.octa 0xbf80bf80bf80bf800000000000000000,0xbf37bf57bf6ebf7cbf33bf0cbebebe3b,0xbcc9becfbf39bf6fbf80bf6abf31beb8,0x3f2e3e23bed5bf5abf3cbf7dbf69bf06
.octa 0xbd49bf3ebf80bf2cbf80bf2c3d493f3e,0x3f2abe82bf72bf4cbf40bf78bea73f1b,0x3f7f3ea1bf42bf65bd97bf73bf273ee6,0x3f443f48beecbf763f25bf20bf633e8f
.octa 0x3f803f2cbd49bf3ebd49bf3ebf80bf2c,0x3f403f783ea7bf1b3f2abe82bf72bf4c,0x3d973f733f27bee63f7f3ea1bf42bf65,0xbf253f203f63be8f3f443f48beecbf76
.octa 0x80008000800080003f803f803f803f80,0xbf80bf7abf6bbf533c493e543eca3f11,0xbcc9becfbf39bf6fbf80bf6abf31beb8,0x3f803f4f3eb2be6dbd17bf16bf70bf79
.octa 0xbf80bf80bf80bf800000000000000000,0xbc49be54becabf11bf80bf7abf6bbf53,0x3f803f6a3f313eb8bcc9becfbf39bf6f,0x3d173f163f703f793f803f4f3eb2be6d
.octa 0x3d493f3e3f803f2c3f803f2cbd49bf3e,0xbf80bf013ee13f7e3d7b3f5d3f663e0a,0xbd97bf73bf273ee6bf7fbea13f423f65,0x3f7f3de2bf74bef7bdb0bf7ebe9b3f60
.octa 0xbf80bf2c3d493f3e3d493f3e3f803f2c,0xbd7bbf5dbf66be0abf80bf013ee13f7e,0x3f7f3ea1bf42bf65bd97bf73bf273ee6,0x3db03f7e3e9bbf603f7f3de2bf74bef7
.octa 0x80008000800080003f803f803f803f80,0xbf37bf57bf6ebf7cbf33bf0cbebebe3b,0x3f803f6a3f313eb8bcc9becfbf39bf6f,0xbf2ebe233ed53f5a3f3c3f7d3f693f06
.octa 0xbf80bf80bf80bf800000000000000000,0x3f333f0c3ebe3e3bbf37bf57bf6ebf7c,0x3cc93ecf3f393f6f3f803f6a3f313eb8,0xbf3cbf7dbf69bf06bf2ebe233ed53f5a
.octa 0xbd49bf3ebf80bf2cbf80bf2c3d493f3e,0x3f403f783ea7bf1b3f2abe82bf72bf4c,0xbf7fbea13f423f653d973f733f27bee6,0x3f25bf20bf633e8fbf44bf483eec3f76
.octa 0x3f803f2cbd49bf3ebd49bf3ebf80bf2c,0xbf2a3e823f723f4c3f403f783ea7bf1b,0xbd97bf73bf273ee6bf7fbea13f423f65,0x3f443f48beecbf763f25bf20bf633e8f
.octa 0x80008000800080003f803f803f803f80,0xbc49be54becabf11bf80bf7abf6bbf53,0x3cc93ecf3f393f6f3f803f6a3f313eb8,0xbd17bf16bf70bf79bf80bf4fbeb23e6d
.octa 0xbf80bf80bf80bf800000000000000000,0x3f803f7a3f6b3f53bc49be54becabf11,0xbf80bf6abf31beb83cc93ecf3f393f6f,0x3f803f4f3eb2be6dbd17bf16bf70bf79
.octa 0x3d493f3e3f803f2c3f803f2cbd49bf3e,0xbd7bbf5dbf66be0abf80bf013ee13f7e,0x3d973f733f27bee63f7f3ea1bf42bf65,0xbdb0bf7ebe9b3f60bf7fbde23f743ef7
.octa 0xbf80bf2c3d493f3e3d493f3e3f803f2c,0x3f803f01bee1bf7ebd7bbf5dbf66be0a,0xbf7fbea13f423f653d973f733f27bee6,0x3f7f3de2bf74bef7bdb0bf7ebe9b3f60
.octa 0x00000000000000000000000000000000,0x00000000000000000000000000000000,0x00000000000000000000000000000000,0x00000000000000000000000000000000
.octa 0x80008000800080003f803f803f803f80,0xbf35bf0ebec4be483f353f553f6d3f7b,0xbf80bf6dbf35bec400003ec43f353f6d,0xbf35bf7bbf6dbf0ebf35be483ec43f55
.octa 0x00000000000000000000000000000000,0x00000000000000000000000000000000,0x00000000000000000000000000000000,0x00000000000000000000000000000000
.octa 0x8000bf35bf80bf35bf80bf3500003f35,0x3f35be48bf6dbf55bf35bf7bbec43f0e,0x3f803ec4bf35bf6d0000bf6dbf353ec4,0x3f353f55bec4bf7b3f35bf0ebf6d3e48
.octa 0x00000000000000000000000000000000,0x00000000000000000000000000000000,0x00000000000000000000000000000000,0x00000000000000000000000000000000
.octa 0x80008000800080003f803f803f803f80,0xbf80bf7bbf6dbf5500003e483ec43f0e,0x8000bec4bf35bf6dbf80bf6dbf35bec4,0x3f803f553ec4be480000bf0ebf6dbf7b
.octa 0x00000000000000000000000000000000,0x00000000000000000000000000000000,0x00000000000000000000000000000000,0x00000000000000000000000000000000
.octa 0x80003f353f803f353f803f350000bf35,0xbf80bf0e3ec43f7b00003f553f6d3e48,0x8000bf6dbf353ec4bf80bec43f353f6d,0x3f803e48bf6dbf0e0000bf7bbec43f55
.octa 0x00000000000000000000000000000000,0x00000000000000000000000000000000,0x00000000000000000000000000000000,0x00000000000000000000000000000000
.octa 0x80008000800080003f803f803f803f80,0xbf35bf55bf6dbf7bbf35bf0ebec4be48,0x3f803f6d3f353ec40000bec4bf35bf6d,0xbf35be483ec43f553f353f7b3f6d3f0e
.octa 0x00000000000000000000000000000000,0x00000000000000000000000000000000,0x00000000000000000000000000000000,0x00000000000000000000000000000000
.octa 0x8000bf35bf80bf35bf80bf3500003f35,0x3f353f7b3ec4bf0e3f35be48bf6dbf55,0xbf80bec43f353f6d00003f6d3f35bec4,0x3f35bf0ebf6d3e48bf35bf553ec43f7b
.octa 0x00000000000000000000000000000000,0x00000000000000000000000000000000,0x00000000000000000000000000000000,0x00000000000000000000000000000000
.octa 0x80008000800080003f803f803f803f80,0x8000be48bec4bf0ebf80bf7bbf6dbf55,0x80003ec43f353f6d3f803f6d3f353ec4,0x8000bf0ebf6dbf7bbf80bf55bec43e48
.octa 0x00000000000000000000000000000000,0x00000000000000000000000000000000,0x00000000000000000000000000000000,0x00000000000000000000000000000000
.octa 0x80003f353f803f353f803f350000bf35,0x8000bf55bf6dbe48bf80bf0e3ec43f7b,0x80003f6d3f35bec43f803ec4bf35bf6d,0x8000bf7bbec43f55bf80be483f6d3f0e
.octa 0x3f7f3dc9bf7fbdc93dc9bf7fbdc93f7f,0x3f443ef7bf74bde23f25bf60be9b3f7e,0x3e893f4abf5fbdfb3f77bf1dbefc3f7e,0xbea73f78bf40be0a3f72be82bf2a3f7e
.octa 0x3dc9bf7fbdc93f7fbf7fbdc93f7f3dc9,0x3f25bf60be9b3f7ebf44bef73f743de2,0x3f77bf1dbefc3f7ebe89bf4a3f5f3dfb,0x3f72be82bf2a3f7e3ea7bf783f403e0a
.octa 0xbf4e3f7dbf18be163f183e16bf4e3f7d,0xbf803f5abed5be233d173f06bf693f7d,0xbf583f13be60be2fbf093f51bf7a3f7c,0xbeca3e54bc49be3bbf6b3f7abf803f7c
.octa 0x3f183e16bf4e3f7d3f4ebf7d3f183e16,0x3d173f06bf693f7d3f80bf5a3ed53e23,0xbf093f51bf7a3f7c3f58bf133e603e2f,0xbf6b3f7abf803f7c3ecabe543c493e3b
.octa 0x3f7f3dc9bf7fbdc93dc9bf7fbdc93f7f,0x3db03f76beecbf483f7fbe8fbf633f20,0xbf773f1d3efcbf7e3e893f4abf5fbdfb,0xbee1bf013f80bf1bbf663f5dbd7bbf4c
.octa 0x3dc9bf7fbdc93f7fbf7fbdc93f7f3dc9,0x3f7fbe8fbf633f20bdb0bf763eec3f48,0x3e893f4abf5fbdfb3f77bf1dbefc3f7e,0xbf663f5dbd7bbf4c3ee13f01bf803f1b
.octa 0x3f4ebf7d3f183e16bf18be163f4ebf7d,0x3f3cbe6dbeb23f4f3f2ebf793f70bf16,0xbf093f51bf7a3f7c3f58bf133e603e2f,0xbf6e3f57bf373f11bebe3f0cbf333f53
.octa 0xbf18be163f4ebf7dbf4e3f7dbf18be16,0x3f2ebf793f70bf16bf3c3e6d3eb2bf4f,0x3f58bf133e603e2f3f09bf513f7abf7c,0xbebe3f0cbf333f533f6ebf573f37bf11
.octa 0x3f7f3dc9bf7fbdc93dc9bf7fbdc93f7f,0xbf253f603e9bbf7e3f443ef7bf74bde2,0xbe89bf4a3f5f3dfbbf773f1d3efcbf7e,0x3f72be82bf2a3f7e3ea7bf783f403e0a
.octa 0x3dc9bf7fbdc93f7fbf7fbdc93f7f3dc9,0x3f443ef7bf74bde23f25bf60be9b3f7e,0xbf773f1d3efcbf7e3e893f4abf5fbdfb,0x3ea7bf783f403e0abf723e823f2abf7e
.octa 0xbf4e3f7dbf18be163f183e16bf4e3f7d,0xbd17bf063f69bf7dbf803f5abed5be23,0x3f58bf133e603e2f3f09bf513f7abf7c,0xbf6b3f7abf803f7c3ecabe543c493e3b
.octa 0x3f183e16bf4e3f7d3f4ebf7d3f183e16,0xbf803f5abed5be233d173f06bf693f7d,0x3f09bf513f7abf7cbf583f13be60be2f,0x3ecabe543c493e3b3f6bbf7a3f80bf7c
.octa 0x3f7f3dc9bf7fbdc93dc9bf7fbdc93f7f,0xbf7f3e8f3f63bf203db03f76beecbf48,0x3f77bf1dbefc3f7ebe89bf4a3f5f3dfb,0xbf663f5dbd7bbf4c3ee13f01bf803f1b
.octa 0x3dc9bf7fbdc93f7fbf7fbdc93f7f3dc9,0x3db03f76beecbf483f7fbe8fbf633f20,0xbe89bf4a3f5f3dfbbf773f1d3efcbf7e,0x3ee13f01bf803f1b3f66bf5d3d7b3f4c
.octa 0x3f4ebf7d3f183e16bf18be163f4ebf7d,0xbf2e3f79bf703f163f3cbe6dbeb23f4f,0x3f09bf513f7abf7cbf583f13be60be2f,0xbebe3f0cbf333f533f6ebf573f37bf11
.octa 0xbf18be163f4ebf7dbf4e3f7dbf18be16,0x3f3cbe6dbeb23f4f3f2ebf793f70bf16,0xbf583f13be60be2fbf093f51bf7a3f7c,0x3f6ebf573f37bf113ebebf0c3f33bf53
.octa 0x3f7b3e48bf7bbe483e48bf7bbe483f7b,0x3f313f13bf6abe603f39bf51becf3f7a,0x3e163f5cbf4ebe793f7dbf04bf183f78,0xbee63f7ebf27be893f65bdfbbf423f77
.octa 0x3e48bf7bbe483f7bbf7bbe483f7b3e48,0x3f39bf51becf3f7abf31bf133f6a3e60,0x3f7dbf04bf183f78be16bf5c3f4e3e79,0x3f65bdfbbf423f773ee6bf7e3f273e89
.octa 0xbf623f75bef1be953ef13e95bf623f75,0xbf7e3f42be89bea1bdfb3f27bf773f73,0xbf3e3edbbd49beacbf2c3f67bf803f71,0xbe603cc93e2fbeb8bf7a3f80bf7c3f6f
.octa 0x3ef13e95bf623f753f62bf753ef13e95,0xbdfb3f27bf773f733f7ebf423e893ea1,0xbf2c3f67bf803f713f3ebedb3d493eac,0xbf7a3f80bf7c3f6f3e60bcc9be2f3eb8
.octa 0x3f7b3e48bf7bbe483e48bf7bbe483f7b,0xbcc93f7cbeb8bf583f80be2fbf6f3f09,0xbf7d3f043f18bf783e163f5cbf4ebe79,0xbea1bf1d3f7fbefcbf733f4a3d97bf5f
.octa 0x3e48bf7bbe483f7bbf7bbe483f7b3e48,0x3f80be2fbf6f3f093cc9bf7c3eb83f58,0x3e163f5cbf4ebe793f7dbf04bf183f78,0xbf733f4a3d97bf5f3ea13f1dbf7f3efc
.octa 0x3f62bf753ef13e95bef1be953f62bf75,0x3f1dbd97befc3f653f4abf7f3f5fbee6,0xbf2c3f67bf803f713f3ebedb3d493eac,0xbf583f39bf133ecfbf093f31bf513f6a
.octa 0xbef1be953f62bf75bf623f75bef1be95,0x3f4abf7f3f5fbee6bf1d3d973efcbf65,0x3f3ebedb3d493eac3f2cbf673f80bf71,0xbf093f31bf513f6a3f58bf393f13becf
.octa 0x3f7b3e48bf7bbe483e48bf7bbe483f7b,0xbf393f513ecfbf7a3f313f13bf6abe60,0xbe16bf5c3f4e3e79bf7d3f043f18bf78,0x3f65bdfbbf423f773ee6bf7e3f273e89
.octa 0x3e48bf7bbe483f7bbf7bbe483f7b3e48,0x3f313f13bf6abe603f39bf51becf3f7a,0xbf7d3f043f18bf783e163f5cbf4ebe79,0x3ee6bf7e3f273e89bf653dfb3f42bf77
.octa 0xbf623f75bef1be953ef13e95bf623f75,0x3dfbbf273f77bf73bf7e3f42be89bea1,0x3f3ebedb3d493eac3f2cbf673f80bf71,0xbf7a3f80bf7c3f6f3e60bcc9be2f3eb8
.octa 0x3ef13e95bf623f753f62bf753ef13e95,0xbf7e3f42be89bea1bdfb3f27bf773f73,0x3f2cbf673f80bf71bf3e3edbbd49beac,0x3e60bcc9be2f3eb83f7abf803f7cbf6f
.octa 0x3f7b3e48bf7bbe483e48bf7bbe483f7b,0xbf803e2f3f6fbf09bcc93f7cbeb8bf58,0x3f7dbf04bf183f78be16bf5c3f4e3e79,0xbf733f4a3d97bf5f3ea13f1dbf7f3efc
.octa 0x3e48bf7bbe483f7bbf7bbe483f7b3e48,0xbcc93f7cbeb8bf583f80be2fbf6f3f09,0xbe16bf5c3f4e3e79bf7d3f043f18bf78,0x3ea13f1dbf7f3efc3f73bf4abd973f5f
.octa 0x3f62bf753ef13e95bef1be953f62bf75,0xbf4a3f7fbf5f3ee63f1dbd97befc3f65,0x3f2cbf673f80bf71bf3e3edbbd49beac,0xbf093f31bf513f6a3f58bf393f13becf
.octa 0xbef1be953f62bf75bf623f75bef1be95,0x3f1dbd97befc3f653f4abf7f3f5fbee6,0xbf3e3edbbd49beacbf2c3f67bf803f71,0x3f58bf393f13becf3f09bf313f51bf6a
.octa 0x3f753e95bf75be953e95bf75be953f75,0x3f1b3f2abf5dbea73f4cbf40bf013f72,0x3cc93f6abf39beb83f80becfbf313f6f,0xbf113f80bf0cbeca3f533c49bf573f6b
.octa 0x3e95bf75be953f75bf75be953f753e95,0x3f4cbf40bf013f72bf1bbf2a3f5d3ea7,0x3f80becfbf313f6fbcc9bf6a3f393eb8,0x3f533c49bf573f6b3f11bf803f0c3eca
.octa 0xbf713f67beacbedb3eac3edbbf713f67,0xbf763f25bde2beecbe8f3f44bf7e3f63,0xbf1d3e893dfbbefcbf4a3f77bf7e3f5f,0xbd17be233eb2bf06bf803f7dbf703f5a
.octa 0x3eac3edbbf713f673f71bf673eac3edb,0xbe8f3f44bf7e3f633f76bf253de23eec,0xbf4a3f77bf7e3f5f3f1dbe89bdfb3efc,0xbf803f7dbf703f5a3d173e23beb23f06
.octa 0x3f753e95bf75be953e95bf75be953f75,0xbe0a3f80be82bf663f7ebd7bbf783ee1,0xbf803ecf3f31bf6f3cc93f6abf39beb8,0xbe3bbf373f7abebebf7c3f333e54bf6e
.octa 0x3e95bf75be953f75bf75be953f753e95,0x3f7ebd7bbf783ee13e0abf803e823f66,0x3cc93f6abf39beb83f80becfbf313f6f,0xbf7c3f333e54bf6e3e3b3f37bf7a3ebe
.octa 0x3f71bf673eac3edbbeacbedb3f71bf67,0x3ef73db0bf203f743f60bf7f3f48be9b,0xbf4a3f77bf7e3f5f3f1dbe89bdfb3efc,0xbf3c3f16bed53e6dbf2e3f4fbf693f79
.octa 0xbeacbedb3f71bf67bf713f67beacbedb,0x3f60bf7f3f48be9bbef7bdb03f20bf74,0x3f1dbe89bdfb3efc3f4abf773f7ebf5f,0xbf2e3f4fbf693f793f3cbf163ed5be6d
.octa 0x3f753e95bf75be953e95bf75be953f75,0xbf4c3f403f01bf723f1b3f2abf5dbea7,0xbcc9bf6a3f393eb8bf803ecf3f31bf6f,0x3f533c49bf573f6b3f11bf803f0c3eca
.octa 0x3e95bf75be953f75bf75be953f753e95,0x3f1b3f2abf5dbea73f4cbf40bf013f72,0xbf803ecf3f31bf6f3cc93f6abf39beb8,0x3f11bf803f0c3ecabf53bc493f57bf6b
.octa 0xbf713f67beacbedb3eac3edbbf713f67,0x3e8fbf443f7ebf63bf763f25bde2beec,0x3f1dbe89bdfb3efc3f4abf773f7ebf5f,0xbf803f7dbf703f5a3d173e23beb23f06
.octa 0x3eac3edbbf713f673f71bf673eac3edb,0xbf763f25bde2beecbe8f3f44bf7e3f63,0x3f4abf773f7ebf5fbf1d3e893dfbbefc,0x3d173e23beb23f063f80bf7d3f70bf5a
.octa 0x3f753e95bf75be953e95bf75be953f75,0xbf7e3d7b3f78bee1be0a3f80be82bf66,0x3f80becfbf313f6fbcc9bf6a3f393eb8,0xbf7c3f333e54bf6e3e3b3f37bf7a3ebe
.octa 0x3e95bf75be953f75bf75be953f753e95,0xbe0a3f80be82bf663f7ebd7bbf783ee1,0xbcc9bf6a3f393eb8bf803ecf3f31bf6f,0x3e3b3f37bf7a3ebe3f7cbf33be543f6e
.octa 0x3f71bf673eac3edbbeacbedb3f71bf67,0xbf603f7fbf483e9b3ef73db0bf203f74,0x3f4abf773f7ebf5fbf1d3e893dfbbefc,0xbf2e3f4fbf693f793f3cbf163ed5be6d
.octa 0xbeacbedb3f71bf67bf713f67beacbedb,0x3ef73db0bf203f743f60bf7f3f48be9b,0xbf1d3e893dfbbefcbf4a3f77bf7e3f5f,0x3f3cbf163ed5be6d3f2ebf4f3f69bf79
.octa 0x3f6d3ec4bf6dbec43ec4bf6dbec43f6d,0x3f043f3ebf4ebedb3f5cbf2cbf183f67,0xbdc93f75bf22bef13f7fbe95bf463f62,0xbf2c3f7dbedbbf043f3e3e16bf673f5c
.octa 0x3ec4bf6dbec43f6dbf6dbec43f6d3ec4,0x3f5cbf2cbf183f67bf04bf3e3f4e3edb,0x3f7fbe95bf463f623dc9bf753f223ef1,0x3f3e3e16bf673f5c3f2cbf7d3edb3f04
.octa 0xbf7b3f55be48bf0e3e483f0ebf7b3f55,0xbf673f043d49bf18bedb3f5cbf803f4e,0xbef13dc93e95bf22bf623f7fbf753f46,0x3e16beac3f04bf2cbf7d3f71bf5c3f3e
.octa 0x3e483f0ebf7b3f553f7bbf553e483f0e,0xbedb3f5cbf803f4e3f67bf04bd493f18,0xbf623f7fbf753f463ef1bdc9be953f22,0xbf7d3f71bf5c3f3ebe163eacbf043f2c
.octa 0x3f6d3ec4bf6dbec43ec4bf6dbec43f6d,0xbe793f80be16bf713f783d49bf7d3eac,0xbf7f3e953f46bf62bdc93f75bf22bef1,0xbd49bf4e3f71be79bf803f183eacbf78
.octa 0x3ec4bf6dbec43f6dbf6dbec43f6d3ec4,0x3f783d49bf7d3eac3e79bf803e163f71,0xbdc93f75bf22bef13f7fbe95bf463f62,0xbf803f183eacbf783d493f4ebf713e79
.octa 0x3f7bbf553e483f0ebe48bf0e3f7bbf55,0x3eac3e79bf3e3f7d3f71bf783f2cbe16,0xbf623f7fbf753f463ef1bdc9be953f22,0xbf183edbbe793d49bf4e3f67bf783f80
.octa 0xbe48bf0e3f7bbf55bf7b3f55be48bf0e,0x3f71bf783f2cbe16beacbe793f3ebf7d,0x3ef1bdc9be953f223f62bf7f3f75bf46,0xbf4e3f67bf783f803f18bedb3e79bd49
.octa 0x3f6d3ec4bf6dbec43ec4bf6dbec43f6d,0xbf5c3f2c3f18bf673f043f3ebf4ebedb,0x3dc9bf753f223ef1bf7f3e953f46bf62,0x3f3e3e16bf673f5c3f2cbf7d3edb3f04
.octa 0x3ec4bf6dbec43f6dbf6dbec43f6d3ec4,0x3f043f3ebf4ebedb3f5cbf2cbf183f67,0xbf7f3e953f46bf62bdc93f75bf22bef1,0x3f2cbf7d3edb3f04bf3ebe163f67bf5c
.octa 0xbf7b3f55be48bf0e3e483f0ebf7b3f55,0x3edbbf5c3f80bf4ebf673f043d49bf18,0x3ef1bdc9be953f223f62bf7f3f75bf46,0xbf7d3f71bf5c3f3ebe163eacbf043f2c
.octa 0x3e483f0ebf7b3f553f7bbf553e483f0e,0xbf673f043d49bf18bedb3f5cbf803f4e,0x3f62bf7f3f75bf46bef13dc93e95bf22,0xbe163eacbf043f2c3f7dbf713f5cbf3e
.octa 0x3f6d3ec4bf6dbec43ec4bf6dbec43f6d,0xbf78bd493f7dbeacbe793f80be16bf71,0x3f7fbe95bf463f623dc9bf753f223ef1,0xbf803f183eacbf783d493f4ebf713e79
.octa 0x3ec4bf6dbec43f6dbf6dbec43f6d3ec4,0xbe793f80be16bf713f783d49bf7d3eac,0x3dc9bf753f223ef1bf7f3e953f46bf62,0x3d493f4ebf713e793f80bf18beac3f78
.octa 0x3f7bbf553e483f0ebe48bf0e3f7bbf55,0xbf713f78bf2c3e163eac3e79bf3e3f7d,0x3f62bf7f3f75bf46bef13dc93e95bf22,0xbf4e3f67bf783f803f18bedb3e79bd49
.octa 0xbe48bf0e3f7bbf55bf7b3f55be48bf0e,0x3eac3e79bf3e3f7d3f71bf783f2cbe16,0xbef13dc93e95bf22bf623f7fbf753f46,0x3f18bedb3e79bd493f4ebf673f78bf80
.octa 0x3f623ef1bf62bef13ef1bf62bef13f62,0x3ed53f4fbf3cbf063f69bf16bf2e3f5a,0xbe603f7cbf09bf133f7abe2fbf583f51,0xbf443f76be9bbf203f253e8fbf743f48
.octa 0x3ef1bf62bef13f62bf62bef13f623ef1,0x3f69bf16bf2e3f5abed5bf4f3f3c3f06,0x3f7abe2fbf583f513e60bf7c3f093f13,0x3f253e8fbf743f483f44bf763e9b3f20
.octa 0xbf803f3ebd49bf2c3d493f2cbf803f3e,0xbf533ebe3e54bf37bf113f6ebf7a3f33,0xbea1bd973ee6bf42bf733f7fbf653f27,0x3ea7bf013f2abf4cbf723f5dbf403f1b
.octa 0x3d493f2cbf803f3e3f80bf3e3d493f2c,0xbf113f6ebf7a3f333f53bebebe543f37,0xbf733f7fbf653f273ea13d97bee63f42,0xbf723f5dbf403f1bbea73f01bf2a3f4c
.octa 0x3f623ef1bf62bef13ef1bf62bef13f62,0xbeb23f7dbd17bf793f703e23bf803e6d,0xbf7a3e2f3f58bf51be603f7cbf09bf13,0x3db0bf603f63bde2bf7f3ef73eecbf7e
.octa 0x3ef1bf62bef13f62bf62bef13f623ef1,0x3f703e23bf803e6d3eb2bf7d3d173f79,0xbe603f7cbf09bf133f7abe2fbf583f51,0xbf7f3ef73eecbf7ebdb03f60bf633de2
.octa 0x3f80bf3e3d493f2cbd49bf2c3f80bf3e,0x3e3b3ecabf573f803f7cbf6b3f0c3c49,0xbf733f7fbf653f273ea13d97bee63f42,0xbee13e82bd7bbe0abf663f78bf803f7e
.octa 0xbd49bf2c3f80bf3ebf803f3ebd49bf2c,0x3f7cbf6b3f0c3c49be3bbeca3f57bf80,0x3ea13d97bee63f423f73bf7f3f65bf27,0xbf663f78bf803f7e3ee1be823d7b3e0a
.octa 0x3f623ef1bf62bef13ef1bf62bef13f62,0xbf693f163f2ebf5a3ed53f4fbf3cbf06,0x3e60bf7c3f093f13bf7a3e2f3f58bf51,0x3f253e8fbf743f483f44bf763e9b3f20
.octa 0x3ef1bf62bef13f62bf62bef13f623ef1,0x3ed53f4fbf3cbf063f69bf16bf2e3f5a,0xbf7a3e2f3f58bf51be603f7cbf09bf13,0x3f44bf763e9b3f20bf25be8f3f74bf48
.octa 0xbf803f3ebd49bf2c3d493f2cbf803f3e,0x3f11bf6e3f7abf33bf533ebe3e54bf37,0x3ea13d97bee63f423f73bf7f3f65bf27,0xbf723f5dbf403f1bbea73f01bf2a3f4c
.octa 0x3d493f2cbf803f3e3f80bf3e3d493f2c,0xbf533ebe3e54bf37bf113f6ebf7a3f33,0x3f73bf7f3f65bf27bea1bd973ee6bf42,0xbea73f01bf2a3f4c3f72bf5d3f40bf1b
.octa 0x3f623ef1bf62bef13ef1bf62bef13f62,0xbf70be233f80be6dbeb23f7dbd17bf79,0x3f7abe2fbf583f513e60bf7c3f093f13,0xbf7f3ef73eecbf7ebdb03f60bf633de2
.octa 0x3ef1bf62bef13f62bf62bef13f623ef1,0xbeb23f7dbd17bf793f703e23bf803e6d,0x3e60bf7c3f093f13bf7a3e2f3f58bf51,0xbdb03f60bf633de23f7fbef7beec3f7e
.octa 0x3f80bf3e3d493f2cbd49bf2c3f80bf3e,0xbf7c3f6bbf0cbc493e3b3ecabf573f80,0x3f73bf7f3f65bf27bea1bd973ee6bf42,0xbf663f78bf803f7e3ee1be823d7b3e0a
.octa 0xbd49bf2c3f80bf3ebf803f3ebd49bf2c,0x3e3b3ecabf573f803f7cbf6b3f0c3c49,0xbea1bd973ee6bf42bf733f7fbf653f27,0x3ee1be823d7b3e0a3f66bf783f80bf7e
.octa 0x3f553f0ebf55bf0e3f0ebf55bf0e3f55,0x3ea13f5fbf27bf1d3f73befcbf423f4a,0xbeac3f80bedbbf2c3f71bd49bf673f3e,0xbf583f6abe2fbf393f093ecfbf7c3f31
.octa 0x3f0ebf55bf0e3f55bf55bf0e3f553f0e,0x3f73befcbf423f4abea1bf5f3f273f1d,0x3f71bd49bf673f3e3eacbf803edb3f2c,0x3f093ecfbf7c3f313f58bf6a3e2f3f39
.octa 0xbf7f3f223dc9bf46bdc93f46bf7f3f22,0xbf393e603eb8bf51bf313f7abf6f3f13,0xbe16be793f18bf5cbf7d3f78bf4e3f04,0x3efcbf273f4abf65bf5f3f42bf1d3ee6
.octa 0xbdc93f46bf7f3f223f7fbf22bdc93f46,0xbf313f7abf6f3f133f39be60beb83f51,0xbf7d3f78bf4e3f043e163e79bf183f5c,0xbf5f3f42bf1d3ee6befc3f27bf4a3f65
.octa 0x3f553f0ebf55bf0e3f0ebf55bf0e3f55,0xbee63f773d97bf7e3f653e89bf7f3dfb,0xbf713d493f67bf3ebeac3f80bedbbf2c,0x3e60bf6f3f513cc9bf7a3eb83f13bf80
.octa 0x3f0ebf55bf0e3f55bf55bf0e3f553f0e,0x3f653e89bf7f3dfb3ee6bf77bd973f7e,0xbeac3f80bedbbf2c3f71bd49bf673f3e,0xbf7a3eb83f13bf80be603f6fbf51bcc9
.octa 0x3f7fbf22bdc93f463dc9bf463f7fbf22,0x3cc93f09bf6a3f7c3f80bf583ecf3e2f,0xbf7d3f78bf4e3f043e163e79bf183f5c,0xbe893d973dfbbea1bf773f7fbf7e3f73
.octa 0x3dc9bf463f7fbf22bf7f3f223dc9bf46,0x3f80bf583ecf3e2fbcc9bf093f6abf7c,0x3e163e79bf183f5c3f7dbf783f4ebf04,0xbf773f7fbf7e3f733e89bd97bdfb3ea1
.octa 0x3f553f0ebf55bf0e3f0ebf55bf0e3f55,0xbf733efc3f42bf4a3ea13f5fbf27bf1d,0x3eacbf803edb3f2cbf713d493f67bf3e,0x3f093ecfbf7c3f313f58bf6a3e2f3f39
.octa 0x3f0ebf55bf0e3f55bf55bf0e3f553f0e,0x3ea13f5fbf27bf1d3f73befcbf423f4a,0xbf713d493f67bf3ebeac3f80bedbbf2c,0x3f58bf6a3e2f3f39bf09becf3f7cbf31
.octa 0xbf7f3f223dc9bf46bdc93f46bf7f3f22,0x3f31bf7a3f6fbf13bf393e603eb8bf51,0x3e163e79bf183f5c3f7dbf783f4ebf04,0xbf5f3f42bf1d3ee6befc3f27bf4a3f65
.octa 0xbdc93f46bf7f3f223f7fbf22bdc93f46,0xbf393e603eb8bf51bf313f7abf6f3f13,0x3f7dbf783f4ebf04be16be793f18bf5c,0xbefc3f27bf4a3f653f5fbf423f1dbee6
.octa 0x3f553f0ebf55bf0e3f0ebf55bf0e3f55,0xbf65be893f7fbdfbbee63f773d97bf7e,0x3f71bd49bf673f3e3eacbf803edb3f2c,0xbf7a3eb83f13bf80be603f6fbf51bcc9
.octa 0x3f0ebf55bf0e3f55bf55bf0e3f553f0e,0xbee63f773d97bf7e3f653e89bf7f3dfb,0x3eacbf803edb3f2cbf713d493f67bf3e,0xbe603f6fbf51bcc93f7abeb8bf133f80
.octa 0x3f7fbf22bdc93f463dc9bf463f7fbf22,0xbf803f58becfbe2f3cc93f09bf6a3f7c,0x3f7dbf783f4ebf04be16be793f18bf5c,0xbf773f7fbf7e3f733e89bd97bdfb3ea1
.octa 0x3dc9bf463f7fbf22bf7f3f223dc9bf46,0x3cc93f09bf6a3f7c3f80bf583ecf3e2f,0xbe16be793f18bf5cbf7d3f78bf4e3f04,0x3e89bd97bdfb3ea13f77bf7f3f7ebf73
.octa 0x3f463f22bf46bf223f22bf46bf223f46,0x3e543f6bbf11bf333f7abecabf533f37,0xbee63f7fbea1bf423f653d97bf733f27,0xbf693f5abd17bf4f3ed53f06bf803f16
.octa 0x3f22bf46bf223f46bf46bf223f463f22,0x3f7abecabf533f37be54bf6b3f113f33,0x3f653d97bf733f273ee6bf7f3ea13f42,0x3ed53f06bf803f163f69bf5a3d173f4f
.octa 0xbf783f043e79bf5cbe793f5cbf783f04,0xbf1b3d7b3f01bf66bf4c3f80bf5d3ee1,0x3cc9becf3f39bf6fbf803f6abf313eb8,0x3f25bf483f63bf76bf443f20beec3e8f
.octa 0xbe793f5cbf783f043f78bf04be793f5c,0xbf4c3f80bf5d3ee13f1bbd7bbf013f66,0xbf803f6abf313eb8bcc93ecfbf393f6f,0xbf443f20beec3e8fbf253f48bf633f76
.octa 0x3f463f22bf46bf223f22bf46bf223f46,0xbf0c3f6e3e3bbf803f573ebebf7c3c49,0xbf65bd973f73bf27bee63f7fbea1bf42,0x3eb2bf793f3c3e23bf703e6d3f2ebf7d
.octa 0x3f22bf46bf223f46bf46bf223f463f22,0x3f573ebebf7c3c493f0cbf6ebe3b3f80,0xbee63f7fbea1bf423f653d97bf733f27,0xbf703e6d3f2ebf7dbeb23f79bf3cbe23
.octa 0x3f78bf04be793f5c3e79bf5c3f78bf04,0xbe0a3f2abf783f723f7ebf403e823ea7,0xbf803f6abf313eb8bcc93ecfbf393f6f,0xbdb0bde23e9bbef7bf7f3f7ebf743f60
.octa 0x3e79bf5c3f78bf04bf783f043e79bf5c,0x3f7ebf403e823ea73e0abf2a3f78bf72,0xbcc93ecfbf393f6f3f80bf6a3f31beb8,0xbf7f3f7ebf743f603db03de2be9b3ef7
.octa 0x3f463f22bf46bf223f22bf46bf223f46,0xbf7a3eca3f53bf373e543f6bbf11bf33,0x3ee6bf7f3ea13f42bf65bd973f73bf27,0x3ed53f06bf803f163f69bf5a3d173f4f
.octa 0x3f22bf46bf223f46bf46bf223f463f22,0x3e543f6bbf11bf333f7abecabf533f37,0xbf65bd973f73bf27bee63f7fbea1bf42,0x3f69bf5a3d173f4fbed5bf063f80bf16
.octa 0xbf783f043e79bf5cbe793f5cbf783f04,0x3f4cbf803f5dbee1bf1b3d7b3f01bf66,0xbcc93ecfbf393f6f3f80bf6a3f31beb8,0xbf443f20beec3e8fbf253f48bf633f76
.octa 0xbe793f5cbf783f043f78bf04be793f5c,0xbf1b3d7b3f01bf66bf4c3f80bf5d3ee1,0x3f80bf6a3f31beb83cc9becf3f39bf6f,0xbf253f48bf633f763f44bf203eecbe8f
.octa 0x3f463f22bf46bf223f22bf46bf223f46,0xbf57bebe3f7cbc49bf0c3f6e3e3bbf80,0x3f653d97bf733f273ee6bf7f3ea13f42,0xbf703e6d3f2ebf7dbeb23f79bf3cbe23
.octa 0x3f22bf46bf223f46bf46bf223f463f22,0xbf0c3f6e3e3bbf803f573ebebf7c3c49,0x3ee6bf7f3ea13f42bf65bd973f73bf27,0xbeb23f79bf3cbe233f70be6dbf2e3f7d
.octa 0x3f78bf04be793f5c3e79bf5c3f78bf04,0xbf7e3f40be82bea7be0a3f2abf783f72,0x3f80bf6a3f31beb83cc9becf3f39bf6f,0xbf7f3f7ebf743f603db03de2be9b3ef7
.octa 0x3e79bf5c3f78bf04bf783f043e79bf5c,0xbe0a3f2abf783f723f7ebf403e823ea7,0x3cc9becf3f39bf6fbf803f6abf313eb8,0x3db03de2be9b3ef73f7fbf7e3f74bf60
.octa 0x3f353f35bf35bf353f35bf35bf353f35,0x3dc93f75bef1bf463f7fbe95bf623f22,0xbf0e3f7bbe48bf553f553e48bf7b3f0e,0xbf753f463dc9bf623e953f22bf7f3ef1
.octa 0x00000000000000000000000000000000,0x00000000000000000000000000000000,0x00000000000000000000000000000000,0x00000000000000000000000000000000
.octa 0xbf6d3ec43ec4bf6dbec43f6dbf6d3ec4,0xbef1bdc93f22bf75bf623f7fbf463e95,0x3e48bf0e3f55bf7bbf7b3f55bf0e3e48,0x3f46bf623f75bf7fbf223ef1be953dc9
.octa 0x00000000000000000000000000000000,0x00000000000000000000000000000000,0x00000000000000000000000000000000,0x00000000000000000000000000000000
.octa 0x3f353f35bf35bf353f35bf35bf353f35,0xbf223f623e95bf7f3f463ef1bf75bdc9,0xbf55be483f7bbf0ebf0e3f7bbe48bf55,0x3ef1bf7f3f223e95bf623dc93f46bf75
.octa 0x00000000000000000000000000000000,0x00000000000000000000000000000000,0x00000000000000000000000000000000,0x00000000000000000000000000000000
.octa 0x3f6dbec4bec43f6d3ec4bf6d3f6dbec4,0xbe953f46bf7f3f623f75bf223dc93ef1,0xbf7b3f55bf0e3e48be483f0ebf553f7b,0x3dc9be953ef1bf22bf7f3f75bf623f46
.octa 0x00000000000000000000000000000000,0x00000000000000000000000000000000,0x00000000000000000000000000000000,0x00000000000000000000000000000000
.octa 0x3f353f35bf35bf353f35bf35bf353f35,0xbf7f3e953f62bf223dc93f75bef1bf46,0x3f0ebf7b3e483f55bf55be483f7bbf0e,0x3e953f22bf7f3ef13f75bf46bdc93f62
.octa 0x00000000000000000000000000000000,0x00000000000000000000000000000000,0x00000000000000000000000000000000,0x00000000000000000000000000000000
.octa 0xbf6d3ec43ec4bf6dbec43f6dbf6d3ec4,0x3f62bf7f3f46be95bef1bdc93f22bf75,0xbe483f0ebf553f7b3f7bbf553f0ebe48,0xbf223ef1be953dc9bf463f62bf753f7f
.octa 0x00000000000000000000000000000000,0x00000000000000000000000000000000,0x00000000000000000000000000000000,0x00000000000000000000000000000000
.octa 0x3f353f35bf35bf353f35bf35bf353f35,0xbf46bef13f753dc9bf223f623e95bf7f,0x3f553e48bf7b3f0e3f0ebf7b3e483f55,0xbf623dc93f46bf75bef13f7fbf22be95
.octa 0x00000000000000000000000000000000,0x00000000000000000000000000000000,0x00000000000000000000000000000000,0x00000000000000000000000000000000
.octa 0x3f6dbec4bec43f6d3ec4bf6d3f6dbec4,0xbf753f22bdc9bef1be953f46bf7f3f62,0x3f7bbf553f0ebe483e48bf0e3f55bf7b,0xbf7f3f75bf623f46bdc93e95bef13f22
.octa 0x00000000000000000000000000000000,0x00000000000000000000000000000000,0x00000000000000000000000000000000,0x00000000000000000000000000000000
.octa 0x3f223f46bf22bf463f46bf22bf463f22,0xbc493f7cbebebf573f80be3bbf6e3f0c,0xbf273f73bd97bf653f423ea1bf7f3ee6,0xbf7d3f2e3e6dbf703e233f3cbf793eb2
.octa 0xbf463f223f46bf223f223f46bf22bf46,0xbf803e3b3f6ebf0cbc493f7cbebebf57,0xbf42bea13f7fbee6bf273f73bd97bf65,0xbe23bf3c3f79beb2bf7d3f2e3e6dbf70
.octa 0xbf5c3e793f04bf78bf043f78bf5c3e79,0xbea7be823f40bf7ebf723f78bf2a3e0a,0x3eb8bf313f6abf80bf6f3f39becf3cc9,0x3f60bf743f7ebf7fbef73e9bbde2bdb0
.octa 0x3f04bf783f5cbe79bf5c3e793f04bf78,0x3f72bf783f2abe0abea7be823f40bf7e,0x3f6fbf393ecfbcc93eb8bf313f6abf80,0x3ef7be9b3de23db03f60bf743f7ebf7f
.octa 0x3f223f46bf22bf463f46bf22bf463f22,0xbf373f533ecabf7a3f333f11bf6bbe54,0xbf42bea13f7fbee6bf273f73bd97bf65,0x3f16bf803f063ed5bf4fbd173f5abf69
.octa 0xbf463f223f46bf223f223f46bf22bf46,0xbf33bf113f6b3e54bf373f533ecabf7a,0x3f27bf733d973f65bf42bea13f7fbee6,0x3f4f3d17bf5a3f693f16bf803f063ed5
.octa 0x3f5cbe79bf043f783f04bf783f5cbe79,0xbee13f5dbf803f4c3f66bf01bd7b3f1b,0xbf6f3f39becf3cc9beb83f31bf6a3f80,0x3e8fbeec3f20bf44bf763f63bf483f25
.octa 0xbf043f78bf5c3e793f5cbe79bf043f78,0xbf663f013d7bbf1bbee13f5dbf803f4c,0x3eb8bf313f6abf80bf6f3f39becf3cc9,0x3f76bf633f48bf253e8fbeec3f20bf44
.octa 0x3f223f46bf22bf463f46bf22bf463f22,0xbf803e3b3f6ebf0cbc493f7cbebebf57,0x3f27bf733d973f65bf42bea13f7fbee6,0x3e233f3cbf793eb23f7dbf2ebe6d3f70
.octa 0xbf463f223f46bf223f223f46bf22bf46,0x3c49bf7c3ebe3f57bf803e3b3f6ebf0c,0x3f423ea1bf7f3ee63f27bf733d973f65,0xbf7d3f2e3e6dbf703e233f3cbf793eb2
.octa 0xbf5c3e793f04bf78bf043f78bf5c3e79,0x3f72bf783f2abe0abea7be823f40bf7e,0xbeb83f31bf6a3f803f6fbf393ecfbcc9,0xbef73e9bbde2bdb0bf603f74bf7e3f7f
.octa 0x3f04bf783f5cbe79bf5c3e793f04bf78,0x3ea73e82bf403f7e3f72bf783f2abe0a,0xbf6f3f39becf3cc9beb83f31bf6a3f80,0x3f60bf743f7ebf7fbef73e9bbde2bdb0
.octa 0x3f223f46bf22bf463f46bf22bf463f22,0xbf33bf113f6b3e54bf373f533ecabf7a,0x3f423ea1bf7f3ee63f27bf733d973f65,0xbf4fbd173f5abf69bf163f80bf06bed5
.octa 0xbf463f223f46bf223f223f46bf22bf46,0x3f37bf53beca3f7abf33bf113f6b3e54,0xbf273f73bd97bf653f423ea1bf7f3ee6,0x3f16bf803f063ed5bf4fbd173f5abf69
.octa 0x3f5cbe79bf043f783f04bf783f5cbe79,0xbf663f013d7bbf1bbee13f5dbf803f4c,0x3f6fbf393ecfbcc93eb8bf313f6abf80,0xbf763f63bf483f25be8f3eecbf203f44
.octa 0xbf043f78bf5c3e793f5cbe79bf043f78,0x3ee1bf5d3f80bf4cbf663f013d7bbf1b,0xbeb83f31bf6a3f803f6fbf393ecfbcc9,0x3e8fbeec3f20bf44bf763f63bf483f25
.octa 0x3f0e3f55bf0ebf553f55bf0ebf553f0e,0xbdfb3f7fbe89bf653f7ebd97bf773ee6,0xbf3e3f673d49bf713f2c3edbbf803eac,0xbf803f133eb8bf7a3cc93f51bf6f3e60
.octa 0xbf553f0e3f55bf0e3f0e3f55bf0ebf55,0xbf7e3d973f77bee6bdfb3f7fbe89bf65,0xbf2cbedb3f80beacbf3e3f673d49bf71,0xbcc9bf513f6fbe60bf803f133eb8bf7a
.octa 0xbf463dc93f22bf7fbf223f7fbf463dc9,0xbe2fbecf3f58bf80bf7c3f6abf09bcc9,0x3f04bf4e3f78bf7dbf5c3f18be79be16,0x3f73bf7e3f7fbf77bea13dfb3d97be89
.octa 0x3f22bf7f3f46bdc9bf463dc93f22bf7f,0x3f7cbf6a3f093cc9be2fbecf3f58bf80,0x3f5cbf183e793e163f04bf4e3f78bf7d,0x3ea1bdfbbd973e893f73bf7e3f7fbf77
.octa 0x3f0e3f55bf0ebf553f55bf0ebf553f0e,0xbf4a3f423efcbf733f1d3f27bf5fbea1,0xbf2cbedb3f80beacbf3e3f673d49bf71,0x3f31bf7c3ecf3f09bf39be2f3f6abf58
.octa 0xbf553f0e3f55bf0e3f0e3f55bf0ebf55,0xbf1dbf273f5f3ea1bf4a3f423efcbf73,0x3f3ebf67bd493f71bf2cbedb3f80beac,0x3f393e2fbf6a3f583f31bf7c3ecf3f09
.octa 0x3f46bdc9bf223f7f3f22bf7f3f46bdc9,0xbf133f6fbf7a3f313f51beb8be603f39,0xbf5c3f18be79be16bf043f4ebf783f7d,0x3ee6bf1d3f42bf5fbf653f4abf273efc
.octa 0xbf223f7fbf463dc93f46bdc9bf223f7f,0xbf513eb83e60bf39bf133f6fbf7a3f31,0x3f04bf4e3f78bf7dbf5c3f18be79be16,0x3f65bf4a3f27befc3ee6bf1d3f42bf5f
.octa 0x3f0e3f55bf0ebf553f55bf0ebf553f0e,0xbf7e3d973f77bee6bdfb3f7fbe89bf65,0x3f3ebf67bd493f71bf2cbedb3f80beac,0x3cc93f51bf6f3e603f80bf13beb83f7a
.octa 0xbf553f0e3f55bf0e3f0e3f55bf0ebf55,0x3dfbbf7f3e893f65bf7e3d973f77bee6,0x3f2c3edbbf803eac3f3ebf67bd493f71,0xbf803f133eb8bf7a3cc93f51bf6f3e60
.octa 0xbf463dc93f22bf7fbf223f7fbf463dc9,0x3f7cbf6a3f093cc9be2fbecf3f58bf80,0xbf043f4ebf783f7d3f5cbf183e793e16,0xbea13dfb3d97be89bf733f7ebf7f3f77
.octa 0x3f22bf7f3f46bdc9bf463dc93f22bf7f,0x3e2f3ecfbf583f803f7cbf6a3f093cc9,0xbf5c3f18be79be16bf043f4ebf783f7d,0x3f73bf7e3f7fbf77bea13dfb3d97be89
.octa 0x3f0e3f55bf0ebf553f55bf0ebf553f0e,0xbf1dbf273f5f3ea1bf4a3f423efcbf73,0x3f2c3edbbf803eac3f3ebf67bd493f71,0xbf39be2f3f6abf58bf313f7cbecfbf09
.octa 0xbf553f0e3f55bf0e3f0e3f55bf0ebf55,0x3f4abf42befc3f73bf1dbf273f5f3ea1,0xbf3e3f673d49bf713f2c3edbbf803eac,0x3f31bf7c3ecf3f09bf39be2f3f6abf58
.octa 0x3f46bdc9bf223f7f3f22bf7f3f46bdc9,0xbf513eb83e60bf39bf133f6fbf7a3f31,0x3f5cbf183e793e163f04bf4e3f78bf7d,0xbf653f4abf273efcbee63f1dbf423f5f
.octa 0xbf223f7fbf463dc93f46bdc9bf223f7f,0x3f13bf6f3f7abf31bf513eb83e60bf39,0xbf043f4ebf783f7d3f5cbf183e793e16,0x3ee6bf1d3f42bf5fbf653f4abf273efc
.octa 0x3ef13f62bef1bf623f62bef1bf623ef1,0xbe6d3f80be23bf703f793d17bf7d3eb2,0xbf513f583e2fbf7a3f133f09bf7c3e60,0xbf7e3eec3ef7bf7fbde23f63bf603db0
.octa 0xbf623ef13f62bef13ef13f62bef1bf62,0xbf79bd173f7dbeb2be6d3f80be23bf70,0xbf13bf093f7cbe60bf513f583e2fbf7a,0x3de2bf633f60bdb0bf7e3eec3ef7bf7f
.octa 0xbf2cbd493f3ebf80bf3e3f80bf2cbd49,0xbc49bf0c3f6bbf7cbf803f57becabe3b,0x3f27bf653f7fbf73bf423ee6bd97bea1,0x3f7ebf803f78bf66be0abd7b3e82bee1
.octa 0x3f3ebf803f2c3d49bf2cbd493f3ebf80,0x3f80bf573eca3e3bbc49bf0c3f6bbf7c,0x3f42bee63d973ea13f27bf653f7fbf73,0x3e0a3d7bbe823ee13f7ebf803f78bf66
.octa 0x3ef13f62bef1bf623f62bef1bf623ef1,0xbf5a3f2e3f16bf693f063f3cbf4fbed5,0xbf13bf093f7cbe60bf513f583e2fbf7a,0x3f48bf743e8f3f25bf20be9b3f76bf44
.octa 0xbf623ef13f62bef13ef13f62bef1bf62,0xbf06bf3c3f4f3ed5bf5a3f2e3f16bf69,0x3f51bf58be2f3f7abf13bf093f7cbe60,0x3f203e9bbf763f443f48bf743e8f3f25
.octa 0x3f2c3d49bf3e3f803f3ebf803f2c3d49,0xbf333f7abf6e3f113f37be54bebe3f53,0xbf423ee6bd97bea1bf273f65bf7f3f73,0x3f1bbf403f5dbf72bf4c3f2abf013ea7
.octa 0xbf3e3f80bf2cbd493f2c3d49bf3e3f80,0xbf373e543ebebf53bf333f7abf6e3f11,0x3f27bf653f7fbf73bf423ee6bd97bea1,0x3f4cbf2a3f01bea73f1bbf403f5dbf72
.octa 0x3ef13f62bef1bf623f62bef1bf623ef1,0xbf79bd173f7dbeb2be6d3f80be23bf70,0x3f51bf58be2f3f7abf13bf093f7cbe60,0xbde23f63bf603db03f7ebeecbef73f7f
.octa 0xbf623ef13f62bef13ef13f62bef1bf62,0x3e6dbf803e233f70bf79bd173f7dbeb2,0x3f133f09bf7c3e603f51bf58be2f3f7a,0xbf7e3eec3ef7bf7fbde23f63bf603db0
.octa 0xbf2cbd493f3ebf80bf3e3f80bf2cbd49,0x3f80bf573eca3e3bbc49bf0c3f6bbf7c,0xbf273f65bf7f3f733f42bee63d973ea1,0xbe0abd7b3e82bee1bf7e3f80bf783f66
.octa 0x3f3ebf803f2c3d49bf2cbd493f3ebf80,0x3c493f0cbf6b3f7c3f80bf573eca3e3b,0xbf423ee6bd97bea1bf273f65bf7f3f73,0x3f7ebf803f78bf66be0abd7b3e82bee1
.octa 0x3ef13f62bef1bf623f62bef1bf623ef1,0xbf06bf3c3f4f3ed5bf5a3f2e3f16bf69,0x3f133f09bf7c3e603f51bf58be2f3f7a,0xbf20be9b3f76bf44bf483f74be8fbf25
.octa 0xbf623ef13f62bef13ef13f62bef1bf62,0x3f5abf2ebf163f69bf06bf3c3f4f3ed5,0xbf513f583e2fbf7a3f133f09bf7c3e60,0x3f48bf743e8f3f25bf20be9b3f76bf44
.octa 0x3f2c3d49bf3e3f803f3ebf803f2c3d49,0xbf373e543ebebf53bf333f7abf6e3f11,0x3f42bee63d973ea13f27bf653f7fbf73,0xbf4c3f2abf013ea7bf1b3f40bf5d3f72
.octa 0xbf3e3f80bf2cbd493f2c3d49bf3e3f80,0x3f33bf7a3f6ebf11bf373e543ebebf53,0xbf273f65bf7f3f733f42bee63d973ea1,0x3f1bbf403f5dbf72bf4c3f2abf013ea7
.octa 0x3ec43f6dbec4bf6d3f6dbec4bf6d3ec4,0xbeac3f7dbd49bf783f713e16bf803e79,0xbf623f463e95bf7f3ef13f22bf753dc9,0xbf783eac3f18bf80be793f71bf4ebd49
.octa 0xbf6d3ec43f6dbec43ec43f6dbec4bf6d,0xbf71be163f80be79beac3f7dbd49bf78,0xbef1bf223f75bdc9bf623f463e95bf7f,0x3e79bf713f4e3d49bf783eac3f18bf80
.octa 0xbf0ebe483f55bf7bbf553f7bbf0ebe48,0x3e16bf2c3f78bf71bf7d3f3ebe79beac,0x3f46bf753f7fbf62bf223e953dc9bef1,0x3f80bf783f67bf4e3d49be793edbbf18
.octa 0x3f55bf7b3f0e3e48bf0ebe483f55bf7b,0x3f7dbf3e3e793eac3e16bf2c3f78bf71,0x3f22be95bdc93ef13f46bf753f7fbf62,0xbd493e79bedb3f183f80bf783f67bf4e
.octa 0x3ec43f6dbec4bf6d3f6dbec4bf6d3ec4,0xbf673f183f2cbf5c3edb3f4ebf3ebf04,0xbef1bf223f75bdc9bf623f463e95bf7f,0x3f5cbf673e163f3ebf04bedb3f7dbf2c
.octa 0xbf6d3ec43f6dbec43ec43f6dbec4bf6d,0xbedbbf4e3f3e3f04bf673f183f2cbf5c,0x3f62bf46be953f7fbef1bf223f75bdc9,0x3f043edbbf7d3f2c3f5cbf673e163f3e
.octa 0x3f0e3e48bf553f7b3f55bf7b3f0e3e48,0xbf4e3f80bf5c3edb3f18bd49bf043f67,0xbf223e953dc9bef1bf463f75bf7f3f62,0x3f3ebf5c3f71bf7dbf2c3f04beac3e16
.octa 0xbf553f7bbf0ebe483f0e3e48bf553f7b,0xbf183d493f04bf67bf4e3f80bf5c3edb,0x3f46bf753f7fbf62bf223e953dc9bef1,0x3f2cbf043eacbe163f3ebf5c3f71bf7d
.octa 0x3ec43f6dbec4bf6d3f6dbec4bf6d3ec4,0xbf71be163f80be79beac3f7dbd49bf78,0x3f62bf46be953f7fbef1bf223f75bdc9,0xbe793f71bf4ebd493f78beacbf183f80
.octa 0xbf6d3ec43f6dbec43ec43f6dbec4bf6d,0x3eacbf7d3d493f78bf71be163f80be79,0x3ef13f22bf753dc93f62bf46be953f7f,0xbf783eac3f18bf80be793f71bf4ebd49
.octa 0xbf0ebe483f55bf7bbf553f7bbf0ebe48,0x3f7dbf3e3e793eac3e16bf2c3f78bf71,0xbf463f75bf7f3f623f22be95bdc93ef1,0x3d49be793edbbf18bf803f78bf673f4e
.octa 0x3f55bf7b3f0e3e48bf0ebe483f55bf7b,0xbe163f2cbf783f713f7dbf3e3e793eac,0xbf223e953dc9bef1bf463f75bf7f3f62,0x3f80bf783f67bf4e3d49be793edbbf18
.octa 0x3ec43f6dbec4bf6d3f6dbec4bf6d3ec4,0xbedbbf4e3f3e3f04bf673f183f2cbf5c,0x3ef13f22bf753dc93f62bf46be953f7f,0xbf04bedb3f7dbf2cbf5c3f67be16bf3e
.octa 0xbf6d3ec43f6dbec43ec43f6dbec4bf6d,0x3f67bf18bf2c3f5cbedbbf4e3f3e3f04,0xbf623f463e95bf7f3ef13f22bf753dc9,0x3f5cbf673e163f3ebf04bedb3f7dbf2c
.octa 0x3f0e3e48bf553f7b3f55bf7b3f0e3e48,0xbf183d493f04bf67bf4e3f80bf5c3edb,0x3f22be95bdc93ef13f46bf753f7fbf62,0xbf2c3f04beac3e16bf3e3f5cbf713f7d
.octa 0xbf553f7bbf0ebe483f0e3e48bf553f7b,0x3f4ebf803f5cbedbbf183d493f04bf67,0xbf463f75bf7f3f623f22be95bdc93ef1,0x3f3ebf5c3f71bf7dbf2c3f04beac3e16
.octa 0x3e953f75be95bf753f75be95bf753e95,0xbee13f783d7bbf7e3f663e82bf803e0a,0xbf6f3f313ecfbf803eb83f39bf6abcc9,0xbf6e3e543f33bf7cbebe3f7abf37be3b
.octa 0xbf753e953f75be953e953f75be95bf75,0xbf66be823f80be0abee13f783d7bbf7e,0xbeb8bf393f6a3cc9bf6f3f313ecfbf80,0x3ebebf7a3f373e3bbf6e3e543f33bf7c
.octa 0xbedbbeac3f67bf71bf673f71bedbbeac,0x3e9bbf483f7fbf60bf743f20bdb0bef7,0x3f5fbf7e3f77bf4abefc3dfb3e89bf1d,0x3f79bf693f4fbf2e3e6dbed53f16bf3c
.octa 0x3f67bf713edb3eacbedbbeac3f67bf71,0x3f74bf203db03ef73e9bbf483f7fbf60,0x3efcbdfbbe893f1d3f5fbf7e3f77bf4a,0xbe6d3ed5bf163f3c3f79bf693f4fbf2e
.octa 0x3e953f75be95bf753f75be95bf753e95,0xbf723f013f40bf4c3ea73f5dbf2abf1b,0xbeb8bf393f6a3cc9bf6f3f313ecfbf80,0x3f6bbf573c493f53becabf0c3f80bf11
.octa 0xbf753e953f75be953e953f75be95bf75,0xbea7bf5d3f2a3f1bbf723f013f40bf4c,0x3f6fbf31becf3f80beb8bf393f6a3cc9,0x3eca3f0cbf803f113f6bbf573c493f53
.octa 0x3edb3eacbf673f713f67bf713edb3eac,0xbf633f7ebf443e8f3eec3de2bf253f76,0xbefc3dfb3e89bf1dbf5f3f7ebf773f4a,0x3f5abf703f7dbf80bf063eb2be23bd17
.octa 0xbf673f71bedbbeac3edb3eacbf673f71,0xbeecbde23f25bf76bf633f7ebf443e8f,0x3f5fbf7e3f77bf4abefc3dfb3e89bf1d,0x3f06beb23e233d173f5abf703f7dbf80
.octa 0x3e953f75be95bf753f75be95bf753e95,0xbf66be823f80be0abee13f783d7bbf7e,0x3f6fbf31becf3f80beb8bf393f6a3cc9,0xbebe3f7abf37be3b3f6ebe54bf333f7c
.octa 0xbf753e953f75be953e953f75be95bf75,0x3ee1bf78bd7b3f7ebf66be823f80be0a,0x3eb83f39bf6abcc93f6fbf31becf3f80,0xbf6e3e543f33bf7cbebe3f7abf37be3b
.octa 0xbedbbeac3f67bf71bf673f71bedbbeac,0x3f74bf203db03ef73e9bbf483f7fbf60,0xbf5f3f7ebf773f4a3efcbdfbbe893f1d,0x3e6dbed53f16bf3cbf793f69bf4f3f2e
.octa 0x3f67bf713edb3eacbedbbeac3f67bf71,0xbe9b3f48bf7f3f603f74bf203db03ef7,0xbefc3dfb3e89bf1dbf5f3f7ebf773f4a,0x3f79bf693f4fbf2e3e6dbed53f16bf3c
.octa 0x3e953f75be95bf753f75be95bf753e95,0xbea7bf5d3f2a3f1bbf723f013f40bf4c,0x3eb83f39bf6abcc93f6fbf31becf3f80,0xbecabf0c3f80bf11bf6b3f57bc49bf53
.octa 0xbf753e953f75be953e953f75be95bf75,0x3f72bf01bf403f4cbea7bf5d3f2a3f1b,0xbf6f3f313ecfbf803eb83f39bf6abcc9,0x3f6bbf573c493f53becabf0c3f80bf11
.octa 0x3edb3eacbf673f713f67bf713edb3eac,0xbeecbde23f25bf76bf633f7ebf443e8f,0x3efcbdfbbe893f1d3f5fbf7e3f77bf4a,0xbf063eb2be23bd17bf5a3f70bf7d3f80
.octa 0xbf673f71bedbbeac3edb3eacbf673f71,0x3f63bf7e3f44be8fbeecbde23f25bf76,0xbf5f3f7ebf773f4a3efcbdfbbe893f1d,0x3f5abf703f7dbf80bf063eb2be23bd17
.octa 0x3e483f7bbe48bf7b3f7bbe48bf7b3e48,0xbf093f6f3e2fbf803f583eb8bf7c3cc9,0xbf783f183f04bf7d3e793f4ebf5cbe16,0xbf5f3d973f4abf73befc3f7fbf1dbea1
.octa 0xbf7b3e483f7bbe483e483f7bbe48bf7b,0xbf58beb83f7cbcc9bf093f6f3e2fbf80,0xbe79bf4e3f5c3e16bf783f183f04bf7d,0x3efcbf7f3f1d3ea1bf5f3d973f4abf73
.octa 0xbe95bef13f75bf62bf753f62be95bef1,0x3ee6bf5f3f7fbf4abf653efc3d97bf1d,0x3f71bf803f67bf2cbeacbd493edbbf3e,0x3f6abf513f31bf093ecfbf133f39bf58
.octa 0x3f75bf623e953ef1be95bef13f75bf62,0x3f65befcbd973f1d3ee6bf5f3f7fbf4a,0x3eac3d49bedb3f3e3f71bf803f67bf2c,0xbecf3f13bf393f583f6abf513f31bf09
.octa 0x3e483f7bbe48bf7b3f7bbe48bf7b3e48,0xbf7a3ecf3f51bf393e603f6abf13bf31,0xbe79bf4e3f5c3e16bf783f183f04bf7d,0x3f77bf42bdfb3f65be89bf273f7ebee6
.octa 0xbf7b3e483f7bbe483e483f7bbe48bf7b,0xbe60bf6a3f133f31bf7a3ecf3f51bf39,0x3f78bf18bf043f7dbe79bf4e3f5c3e16,0x3e893f27bf7e3ee63f77bf42bdfb3f65
.octa 0x3e953ef1bf753f623f75bf623e953ef1,0xbf733f77bf273dfb3ea13e89bf423f7e,0xbeacbd493edbbf3ebf713f80bf673f2c,0x3f6fbf7c3f80bf7abeb83e2f3cc9be60
.octa 0xbf753f62be95bef13e953ef1bf753f62,0xbea1be893f42bf7ebf733f77bf273dfb,0x3f71bf803f67bf2cbeacbd493edbbf3e,0x3eb8be2fbcc93e603f6fbf7c3f80bf7a
.octa 0x3e483f7bbe48bf7b3f7bbe48bf7b3e48,0xbf58beb83f7cbcc9bf093f6f3e2fbf80,0x3f78bf18bf043f7dbe79bf4e3f5c3e16,0xbefc3f7fbf1dbea13f5fbd97bf4a3f73
.octa 0xbf7b3e483f7bbe483e483f7bbe48bf7b,0x3f09bf6fbe2f3f80bf58beb83f7cbcc9,0x3e793f4ebf5cbe163f78bf18bf043f7d,0xbf5f3d973f4abf73befc3f7fbf1dbea1
.octa 0xbe95bef13f75bf62bf753f62be95bef1,0x3f65befcbd973f1d3ee6bf5f3f7fbf4a,0xbf713f80bf673f2c3eac3d49bedb3f3e,0x3ecfbf133f39bf58bf6a3f51bf313f09
.octa 0x3f75bf623e953ef1be95bef13f75bf62,0xbee63f5fbf7f3f4a3f65befcbd973f1d,0xbeacbd493edbbf3ebf713f80bf673f2c,0x3f6abf513f31bf093ecfbf133f39bf58
.octa 0x3e483f7bbe48bf7b3f7bbe48bf7b3e48,0xbe60bf6a3f133f31bf7a3ecf3f51bf39,0x3e793f4ebf5cbe163f78bf18bf043f7d,0xbe89bf273f7ebee6bf773f423dfbbf65
.octa 0xbf7b3e483f7bbe483e483f7bbe48bf7b,0x3f7abecfbf513f39be60bf6a3f133f31,0xbf783f183f04bf7d3e793f4ebf5cbe16,0x3f77bf42bdfb3f65be89bf273f7ebee6
.octa 0x3e953ef1bf753f623f75bf623e953ef1,0xbea1be893f42bf7ebf733f77bf273dfb,0x3eac3d49bedb3f3e3f71bf803f67bf2c,0xbeb83e2f3cc9be60bf6f3f7cbf803f7a
.octa 0xbf753f62be95bef13e953ef1bf753f62,0x3f73bf773f27bdfbbea1be893f42bf7e,0xbf713f80bf673f2c3eac3d49bedb3f3e,0x3f6fbf7c3f80bf7abeb83e2f3cc9be60
.octa 0x3dc93f7fbdc9bf7f3f7fbdc9bf7f3dc9,0xbf203f633e8fbf7f3f483eecbf76bdb0,0xbf7e3efc3f1dbf773dfb3f5fbf4abe89,0xbf4cbd7b3f5dbf66bf1b3f80bf01bee1
.octa 0xbf7f3dc93f7fbdc93dc93f7fbdc9bf7f,0xbf48beec3f763db0bf203f633e8fbf7f,0xbdfbbf5f3f4a3e89bf7e3efc3f1dbf77,0x3f1bbf803f013ee1bf4cbd7b3f5dbf66
.octa 0xbe16bf183f7dbf4ebf7d3f4ebe16bf18,0x3f16bf703f79bf2ebf4f3eb23e6dbf3c,0x3f7cbf7a3f51bf09be2fbe603f13bf58,0x3f53bf333f0cbebe3f11bf373f57bf6e
.octa 0x3f7dbf4e3e163f18be16bf183f7dbf4e,0x3f4fbeb2be6d3f3c3f16bf703f79bf2e,0x3e2f3e60bf133f583f7cbf7a3f51bf09,0xbf113f37bf573f6e3f53bf333f0cbebe
.octa 0x3dc93f7fbdc9bf7f3f7fbdc9bf7f3dc9,0xbf7e3e9b3f60bf253de23f74bef7bf44,0xbdfbbf5f3f4a3e89bf7e3efc3f1dbf77,0x3f7ebf2abe823f72be0abf403f78bea7
.octa 0xbf7f3dc93f7fbdc93dc93f7fbdc9bf7f,0xbde2bf743ef73f44bf7e3e9b3f60bf25,0x3f7ebefcbf1d3f77bdfbbf5f3f4a3e89,0x3e0a3f40bf783ea73f7ebf2abe823f72
.octa 0x3e163f18bf7d3f4e3f7dbf4e3e163f18,0xbf7d3f69bf06bd173e233ed5bf5a3f80,0xbe2fbe603f13bf58bf7c3f7abf513f09,0x3f7cbf803f7abf6bbe3bbc493e54beca
.octa 0xbf7d3f4ebe16bf183e163f18bf7d3f4e,0xbe23bed53f5abf80bf7d3f69bf06bd17,0x3f7cbf7a3f51bf09be2fbe603f13bf58,0x3e3b3c49be543eca3f7cbf803f7abf6b
.octa 0x3dc93f7fbdc9bf7f3f7fbdc9bf7f3dc9,0xbf48beec3f763db0bf203f633e8fbf7f,0x3f7ebefcbf1d3f77bdfbbf5f3f4a3e89,0xbf1b3f80bf01bee13f4c3d7bbf5d3f66
.octa 0xbf7f3dc93f7fbdc93dc93f7fbdc9bf7f,0x3f20bf63be8f3f7fbf48beec3f763db0,0x3dfb3f5fbf4abe893f7ebefcbf1d3f77,0xbf4cbd7b3f5dbf66bf1b3f80bf01bee1
.octa 0xbe16bf183f7dbf4ebf7d3f4ebe16bf18,0x3f4fbeb2be6d3f3c3f16bf703f79bf2e,0xbf7c3f7abf513f093e2f3e60bf133f58,0x3f11bf373f57bf6ebf533f33bf0c3ebe
.octa 0x3f7dbf4e3e163f18be16bf183f7dbf4e,0xbf163f70bf793f2e3f4fbeb2be6d3f3c,0xbe2fbe603f13bf58bf7c3f7abf513f09,0x3f53bf333f0cbebe3f11bf373f57bf6e
.octa 0x3dc93f7fbdc9bf7f3f7fbdc9bf7f3dc9,0xbde2bf743ef73f44bf7e3e9b3f60bf25,0x3dfb3f5fbf4abe893f7ebefcbf1d3f77,0xbe0abf403f78bea7bf7e3f2a3e82bf72
.octa 0xbf7f3dc93f7fbdc93dc93f7fbdc9bf7f,0x3f7ebe9bbf603f25bde2bf743ef73f44,0xbf7e3efc3f1dbf773dfb3f5fbf4abe89,0x3f7ebf2abe823f72be0abf403f78bea7
.octa 0x3e163f18bf7d3f4e3f7dbf4e3e163f18,0xbe23bed53f5abf80bf7d3f69bf06bd17,0x3e2f3e60bf133f583f7cbf7a3f51bf09,0xbe3bbc493e54becabf7c3f80bf7a3f6b
.octa 0xbf7d3f4ebe16bf183e163f18bf7d3f4e,0x3f7dbf693f063d17be23bed53f5abf80,0xbf7c3f7abf513f093e2f3e60bf133f58,0x3f7cbf803f7abf6bbe3bbc493e54beca
.octa 0x00000000000000000000000000000000,0x00000000000000000000000000000000,0x00000000000000000000000000000000,0x00000000000000000000000000000000
.octa 0x80003f808000bf803f800000bf800000,0xbf353f553ec4bf7b3f353f0ebf6dbe48,0xbf803ec43f35bf6d00003f6dbf35bec4,0xbf35be483f6dbf55bf353f7bbec4bf0e
.octa 0x00000000000000000000000000000000,0x00000000000000000000000000000000,0x00000000000000000000000000000000,0x00000000000000000000000000000000
.octa 0x8000bf353f80bf35bf803f350000bf35,0x3f35bf7b3f6dbf0ebf353e483ec4bf55,0x3f80bf6d3f35bec40000bec43f35bf6d,0x3f35bf0e3ec4be483f35bf553f6dbf7b
.octa 0x00000000000000000000000000000000,0x00000000000000000000000000000000,0x00000000000000000000000000000000,0x00000000000000000000000000000000
.octa 0x80003f808000bf803f800000bf800000,0xbf803e483f6dbf0e00003f7bbec4bf55,0x8000bf6d3f353ec4bf803ec43f35bf6d,0x3f80bf0ebec43f7b0000bf553f6dbe48
.octa 0x00000000000000000000000000000000,0x00000000000000000000000000000000,0x00000000000000000000000000000000,0x00000000000000000000000000000000
.octa 0x80003f35bf803f353f80bf3500003f35,0xbf803f55bec4be4800003f0ebf6d3f7b,0x8000bec43f35bf6dbf803f6dbf353ec4,0x3f80bf7b3f6dbf550000be483ec4bf0e
.octa 0x00000000000000000000000000000000,0x00000000000000000000000000000000,0x00000000000000000000000000000000,0x00000000000000000000000000000000
.octa 0x80003f808000bf803f800000bf800000,0xbf35bf0e3f6d3e48bf353f553ec4bf7b,0x3f80bec4bf353f6d0000bf6d3f353ec4,0xbf353f7bbec4bf0e3f353e48bf6d3f55
.octa 0x00000000000000000000000000000000,0x00000000000000000000000000000000,0x00000000000000000000000000000000,0x00000000000000000000000000000000
.octa 0x8000bf353f80bf35bf803f350000bf35,0x3f35be48bec43f553f35bf7b3f6dbf0e,0xbf803f6dbf353ec400003ec4bf353f6d,0x3f35bf553f6dbf7bbf353f0ebec43e48
.octa 0x00000000000000000000000000000000,0x00000000000000000000000000000000,0x00000000000000000000000000000000,0x00000000000000000000000000000000
.octa 0x80003f808000bf803f800000bf800000,0x8000bf7b3ec43f55bf803e483f6dbf0e,0x80003f6dbf35bec43f80bec4bf353f6d,0x8000bf553f6dbe48bf803f0e3ec4bf7b
.octa 0x00000000000000000000000000000000,0x00000000000000000000000000000000,0x00000000000000000000000000000000,0x00000000000000000000000000000000
.octa 0x80003f35bf803f353f80bf3500003f35,0x8000bf0e3f6dbf7bbf803f55bec4be48,0x80003ec4bf353f6d3f80bf6d3f35bec4,0x8000be483ec4bf0ebf803f7bbf6d3f55
.octa 0x3e48be483e48be48bf7b3f7bbf7b3f7b,0x3f37bf113ecabe54bf333f53bf6b3f7a,0x3f7cbf583f13be60be2f3f09bf513f7a,0x3f69bf7d3f3cbe6d3ed53e23bf2e3f79
.octa 0xbf7b3f7bbf7b3f7bbe483e48be483e48,0xbf333f53bf6b3f7abf373f11beca3e54,0xbe2f3f09bf513f7abf7c3f58bf133e60,0x3ed53e23bf2e3f79bf693f7dbf3c3e6d
.octa 0x3f04bf783f5cbe793f5cbe79bf043f78,0xbd7bbf4c3f72be823f80bf1bbea73f78,0xbf1dbefc3f7ebe893f4abf5fbdfb3f77,0xbf74bde23f7fbe8f3e9bbf7e3db03f76
.octa 0x3f5cbe79bf043f78bf043f78bf5c3e79,0x3f80bf1bbea73f783d7b3f4cbf723e82,0x3f4abf5fbdfb3f773f1d3efcbf7e3e89,0x3e9bbf7e3db03f763f743de2bf7f3e8f
.octa 0x3e48be483e48be48bf7b3f7bbf7b3f7b,0x3f80bf7c3f6ebf573c493e3bbebe3f0c,0x3e2fbf093f51bf7a3f7cbf583f13be60,0xbf703f16bd17bf063eb2bf4f3f80bf5a
.octa 0xbf7b3f7bbf7b3f7bbe483e48be483e48,0x3c493e3bbebe3f0cbf803f7cbf6e3f57,0x3f7cbf583f13be60be2f3f09bf513f7a,0x3eb2bf4f3f80bf5a3f70bf163d173f06
.octa 0xbf043f78bf5c3e79bf5c3e793f04bf78,0x3f403e0abf663f5dbf2a3f7ebee1bf01,0x3f4abf5fbdfb3f773f1d3efcbf7e3e89,0xbeecbf483f443ef73f63bf20bf253f60
.octa 0xbf5c3e793f04bf783f04bf783f5cbe79,0xbf2a3f7ebee1bf01bf40be0a3f66bf5d,0x3f1d3efcbf7e3e89bf4a3f5f3dfbbf77,0x3f63bf20bf253f603eec3f48bf44bef7
.octa 0x3e48be483e48be48bf7b3f7bbf7b3f7b,0x3f33bf533f6bbf7a3f37bf113ecabe54,0xbf7c3f58bf133e603e2fbf093f51bf7a,0x3ed53e23bf2e3f79bf693f7dbf3c3e6d
.octa 0xbf7b3f7bbf7b3f7bbe483e48be483e48,0x3f37bf113ecabe54bf333f53bf6b3f7a,0x3e2fbf093f51bf7a3f7cbf583f13be60,0xbf693f7dbf3c3e6dbed5be233f2ebf79
.octa 0x3f04bf783f5cbe793f5cbe79bf043f78,0xbf803f1b3ea7bf78bd7bbf4c3f72be82,0x3f1d3efcbf7e3e89bf4a3f5f3dfbbf77,0x3e9bbf7e3db03f763f743de2bf7f3e8f
.octa 0x3f5cbe79bf043f78bf043f78bf5c3e79,0xbd7bbf4c3f72be823f80bf1bbea73f78,0xbf4a3f5f3dfbbf77bf1dbefc3f7ebe89,0x3f743de2bf7f3e8fbe9b3f7ebdb0bf76
.octa 0x3e48be483e48be48bf7b3f7bbf7b3f7b,0xbc49be3b3ebebf0c3f80bf7c3f6ebf57,0xbe2f3f09bf513f7abf7c3f58bf133e60,0x3eb2bf4f3f80bf5a3f70bf163d173f06
.octa 0xbf7b3f7bbf7b3f7bbe483e48be483e48,0x3f80bf7c3f6ebf573c493e3bbebe3f0c,0xbf7c3f58bf133e603e2fbf093f51bf7a,0x3f70bf163d173f06beb23f4fbf803f5a
.octa 0xbf043f78bf5c3e79bf5c3e793f04bf78,0x3f2abf7e3ee13f013f403e0abf663f5d,0xbf4a3f5f3dfbbf77bf1dbefc3f7ebe89,0x3f63bf20bf253f603eec3f48bf44bef7
.octa 0xbf5c3e793f04bf783f04bf783f5cbe79,0x3f403e0abf663f5dbf2a3f7ebee1bf01,0xbf1dbefc3f7ebe893f4abf5fbdfb3f77,0x3eec3f48bf44bef7bf633f203f25bf60
.octa 0x3ec4bec43ec4bec4bf6d3f6dbf6d3f6d,0x3f58bf393f13becfbf093f31bf513f6a,0x3f80bf713f3ebedb3d493eacbf2c3f67,0x3f4abf7f3f5fbee63f1dbd97befc3f65
.octa 0xbf6d3f6dbf6d3f6dbec43ec4bec43ec4,0xbf093f31bf513f6abf583f39bf133ecf,0x3d493eacbf2c3f67bf803f71bf3e3edb,0x3f1dbd97befc3f65bf4a3f7fbf5f3ee6
.octa 0x3e95bf623f75bef13f75bef1be953f62,0xbea1bf1d3f7fbefc3f73bf4abd973f5f,0xbf4ebe793f7dbf043f18bf783e163f5c,0xbf803e2f3f6fbf093cc9bf7c3eb83f58
.octa 0x3f75bef1be953f62be953f62bf753ef1,0x3f73bf4abd973f5f3ea13f1dbf7f3efc,0x3f18bf783e163f5c3f4e3e79bf7d3f04,0x3cc9bf7c3eb83f583f80be2fbf6f3f09
.octa 0x3ec4bec43ec4bec4bf6d3f6dbf6d3f6d,0x3f7abf803f7cbf6f3e60bcc9be2f3eb8,0xbd49beac3f2cbf673f80bf713f3ebedb,0xbf7e3f42be89bea13dfbbf273f77bf73
.octa 0xbf6d3f6dbf6d3f6dbec43ec4bec43ec4,0x3e60bcc9be2f3eb8bf7a3f80bf7c3f6f,0x3f80bf713f3ebedb3d493eacbf2c3f67,0x3dfbbf273f77bf733f7ebf423e893ea1
.octa 0xbe953f62bf753ef1bf753ef13e95bf62,0x3f65bdfbbf423f77bee63f7ebf27be89,0x3f18bf783e163f5c3f4e3e79bf7d3f04,0xbf31bf133f6a3e603f39bf51becf3f7a
.octa 0xbf753ef13e95bf623e95bf623f75bef1,0xbee63f7ebf27be89bf653dfb3f42bf77,0x3f4e3e79bf7d3f04bf183f78be16bf5c,0x3f39bf51becf3f7a3f313f13bf6abe60
.octa 0x3ec4bec43ec4bec4bf6d3f6dbf6d3f6d,0x3f09bf313f51bf6a3f58bf393f13becf,0xbf803f71bf3e3edbbd49beac3f2cbf67,0x3f1dbd97befc3f65bf4a3f7fbf5f3ee6
.octa 0xbf6d3f6dbf6d3f6dbec43ec4bec43ec4,0x3f58bf393f13becfbf093f31bf513f6a,0xbd49beac3f2cbf673f80bf713f3ebedb,0xbf4a3f7fbf5f3ee6bf1d3d973efcbf65
.octa 0x3e95bf623f75bef13f75bef1be953f62,0xbf733f4a3d97bf5fbea1bf1d3f7fbefc,0x3f4e3e79bf7d3f04bf183f78be16bf5c,0x3cc9bf7c3eb83f583f80be2fbf6f3f09
.octa 0x3f75bef1be953f62be953f62bf753ef1,0xbea1bf1d3f7fbefc3f73bf4abd973f5f,0xbf183f78be16bf5cbf4ebe793f7dbf04,0x3f80be2fbf6f3f09bcc93f7cbeb8bf58
.octa 0x3ec4bec43ec4bec4bf6d3f6dbf6d3f6d,0xbe603cc93e2fbeb83f7abf803f7cbf6f,0x3d493eacbf2c3f67bf803f71bf3e3edb,0x3dfbbf273f77bf733f7ebf423e893ea1
.octa 0xbf6d3f6dbf6d3f6dbec43ec4bec43ec4,0x3f7abf803f7cbf6f3e60bcc9be2f3eb8,0xbf803f71bf3e3edbbd49beac3f2cbf67,0x3f7ebf423e893ea1bdfb3f27bf773f73
.octa 0xbe953f62bf753ef1bf753ef13e95bf62,0x3ee6bf7e3f273e893f65bdfbbf423f77,0xbf183f78be16bf5cbf4ebe793f7dbf04,0x3f39bf51becf3f7a3f313f13bf6abe60
.octa 0xbf753ef13e95bf623e95bf623f75bef1,0x3f65bdfbbf423f77bee63f7ebf27be89,0xbf4ebe793f7dbf043f18bf783e163f5c,0x3f313f13bf6abe60bf393f513ecfbf7a
.octa 0x3f0ebf0e3f0ebf0ebf553f55bf553f55,0x3f70bf5a3f3cbf16beb23f06bf2e3f4f,0x3f77bf7e3f5fbf1d3e893dfbbefc3f4a,0x3f20bf743f76bf253f48be9bbe8f3f44
.octa 0xbf553f55bf553f55bf0e3f0ebf0e3f0e,0xbeb23f06bf2e3f4fbf703f5abf3c3f16,0x3e893dfbbefc3f4abf773f7ebf5f3f1d,0x3f48be9bbe8f3f44bf203f74bf763f25
.octa 0x3d49bf3e3f80bf2c3f80bf2cbd493f3e,0xbf0cbeca3f7cbf333f57bf6b3e3b3f37,0xbf6f3cc93f6abf393eb8bf803ecf3f31,0xbf783ee13f4cbf40be82bf663f1b3f2a
.octa 0x3f80bf2cbd493f3ebd493f3ebf803f2c,0x3f57bf6b3e3b3f373f0c3ecabf7c3f33,0x3eb8bf803ecf3f313f6fbcc9bf6a3f39,0xbe82bf663f1b3f2a3f78bee1bf4c3f40
.octa 0x3f0ebf0e3f0ebf0ebf553f55bf553f55,0x3f69bf793f80bf7d3ed5be6d3d173e23,0xbe89bdfb3efcbf4a3f77bf7e3f5fbf1d,0xbf7e3f63bef7bdb0bde2beec3f60bf7f
.octa 0xbf553f55bf553f55bf0e3f0ebf0e3f0e,0x3ed5be6d3d173e23bf693f79bf803f7d,0x3f77bf7e3f5fbf1d3e893dfbbefc3f4a,0xbde2beec3f60bf7f3f7ebf633ef73db0
.octa 0xbd493f3ebf803f2cbf803f2c3d49bf3e,0x3f7abebebf113f80be543f6ebf53bc49,0x3eb8bf803ecf3f313f6fbcc9bf6a3f39,0xbf5dbea73f7ebd7b3f01bf72be0a3f80
.octa 0xbf803f2c3d49bf3e3d49bf3e3f80bf2c,0xbe543f6ebf53bc49bf7a3ebe3f11bf80,0x3f6fbcc9bf6a3f39beb83f80becfbf31,0x3f01bf72be0a3f803f5d3ea7bf7e3d7b
.octa 0x3f0ebf0e3f0ebf0ebf553f55bf553f55,0x3eb2bf063f2ebf4f3f70bf5a3f3cbf16,0xbf773f7ebf5f3f1dbe89bdfb3efcbf4a,0x3f48be9bbe8f3f44bf203f74bf763f25
.octa 0xbf553f55bf553f55bf0e3f0ebf0e3f0e,0x3f70bf5a3f3cbf16beb23f06bf2e3f4f,0xbe89bdfb3efcbf4a3f77bf7e3f5fbf1d,0xbf203f74bf763f25bf483e9b3e8fbf44
.octa 0x3d49bf3e3f80bf2c3f80bf2cbd493f3e,0xbf573f6bbe3bbf37bf0cbeca3f7cbf33,0x3f6fbcc9bf6a3f39beb83f80becfbf31,0xbe82bf663f1b3f2a3f78bee1bf4c3f40
.octa 0x3f80bf2cbd493f3ebd493f3ebf803f2c,0xbf0cbeca3f7cbf333f57bf6b3e3b3f37,0xbeb83f80becfbf31bf6f3cc93f6abf39,0x3f78bee1bf4c3f403e823f66bf1bbf2a
.octa 0x3f0ebf0e3f0ebf0ebf553f55bf553f55,0xbed53e6dbd17be233f69bf793f80bf7d,0x3e893dfbbefc3f4abf773f7ebf5f3f1d,0xbde2beec3f60bf7f3f7ebf633ef73db0
.octa 0xbf553f55bf553f55bf0e3f0ebf0e3f0e,0x3f69bf793f80bf7d3ed5be6d3d173e23,0xbf773f7ebf5f3f1dbe89bdfb3efcbf4a,0x3f7ebf633ef73db03de23eecbf603f7f
.octa 0xbd493f3ebf803f2cbf803f2c3d49bf3e,0x3e54bf6e3f533c493f7abebebf113f80,0xbeb83f80becfbf31bf6f3cc93f6abf39,0x3f01bf72be0a3f803f5d3ea7bf7e3d7b
.octa 0xbf803f2c3d49bf3e3d49bf3e3f80bf2c,0x3f7abebebf113f80be543f6ebf53bc49,0xbf6f3cc93f6abf393eb8bf803ecf3f31,0x3f5d3ea7bf7e3d7bbf013f723e0abf80
.octa 0x3f35bf353f35bf35bf353f35bf353f35,0x3f7dbf713f5cbf3ebe163eacbf043f2c,0x3f62bf7f3f75bf463ef1bdc9be953f22,0x3edbbf5c3f80bf4e3f67bf04bd493f18
.octa 0xbf353f35bf353f35bf353f35bf353f35,0xbe163eacbf043f2cbf7d3f71bf5c3f3e,0x3ef1bdc9be953f22bf623f7fbf753f46,0x3f67bf04bd493f18bedb3f5cbf803f4e
.octa 0xbe48bf0e3f7bbf553f7bbf553e483f0e,0xbf3ebe163f67bf5c3f2cbf7d3edb3f04,0xbf7f3e953f46bf623dc9bf753f223ef1,0xbf5c3f2c3f18bf67bf04bf3e3f4e3edb
.octa 0x3f7bbf553e483f0e3e483f0ebf7b3f55,0x3f2cbf7d3edb3f043f3e3e16bf673f5c,0x3dc9bf753f223ef13f7fbe95bf463f62,0xbf04bf3e3f4e3edb3f5cbf2cbf183f67
.octa 0x3f35bf353f35bf35bf353f35bf353f35,0x3f4ebf673f78bf803f18bedb3e79bd49,0xbef13dc93e95bf223f62bf7f3f75bf46,0xbf713f78bf2c3e16beacbe793f3ebf7d
.octa 0xbf353f35bf353f35bf353f35bf353f35,0x3f18bedb3e79bd49bf4e3f67bf783f80,0x3f62bf7f3f75bf463ef1bdc9be953f22,0xbeacbe793f3ebf7d3f71bf783f2cbe16
.octa 0x3e483f0ebf7b3f55bf7b3f55be48bf0e,0x3f80bf18beac3f783d493f4ebf713e79,0x3dc9bf753f223ef13f7fbe95bf463f62,0xbf78bd493f7dbeac3e79bf803e163f71
.octa 0xbf7b3f55be48bf0ebe48bf0e3f7bbf55,0x3d493f4ebf713e79bf803f183eacbf78,0x3f7fbe95bf463f62bdc93f75bf22bef1,0x3e79bf803e163f713f783d49bf7d3eac
.octa 0x3f35bf353f35bf35bf353f35bf353f35,0x3e16beac3f04bf2c3f7dbf713f5cbf3e,0xbf623f7fbf753f46bef13dc93e95bf22,0x3f67bf04bd493f18bedb3f5cbf803f4e
.octa 0xbf353f35bf353f35bf353f35bf353f35,0x3f7dbf713f5cbf3ebe163eacbf043f2c,0xbef13dc93e95bf223f62bf7f3f75bf46,0xbedb3f5cbf803f4ebf673f043d49bf18
.octa 0xbe48bf0e3f7bbf553f7bbf553e483f0e,0xbf2c3f7dbedbbf04bf3ebe163f67bf5c,0x3f7fbe95bf463f62bdc93f75bf22bef1,0xbf04bf3e3f4e3edb3f5cbf2cbf183f67
.octa 0x3f7bbf553e483f0e3e483f0ebf7b3f55,0xbf3ebe163f67bf5c3f2cbf7d3edb3f04,0xbdc93f75bf22bef1bf7f3e953f46bf62,0x3f5cbf2cbf183f673f043f3ebf4ebedb
.octa 0x3f35bf353f35bf35bf353f35bf353f35,0xbf183edbbe793d493f4ebf673f78bf80,0x3ef1bdc9be953f22bf623f7fbf753f46,0xbeacbe793f3ebf7d3f71bf783f2cbe16
.octa 0xbf353f35bf353f35bf353f35bf353f35,0x3f4ebf673f78bf803f18bedb3e79bd49,0xbf623f7fbf753f46bef13dc93e95bf22,0x3f71bf783f2cbe163eac3e79bf3e3f7d
.octa 0x3e483f0ebf7b3f55bf7b3f55be48bf0e,0xbd49bf4e3f71be793f80bf18beac3f78,0xbdc93f75bf22bef1bf7f3e953f46bf62,0x3e79bf803e163f713f783d49bf7d3eac
.octa 0xbf7b3f55be48bf0ebe48bf0e3f7bbf55,0x3f80bf18beac3f783d493f4ebf713e79,0xbf7f3e953f46bf623dc9bf753f223ef1,0x3f783d49bf7d3eacbe793f80be16bf71
.octa 0x3f55bf553f55bf55bf0e3f0ebf0e3f0e,0x3f80bf7e3f72bf5d3d7b3e0abea73f01,0x3f42bf733f7fbf653f27bea1bd973ee6,0x3e54bf373f7cbf6b3f7abf333e3b3eca
.octa 0xbf0e3f0ebf0e3f0ebf553f55bf553f55,0x3d7b3e0abea73f01bf803f7ebf723f5d,0x3f27bea1bd973ee6bf423f73bf7f3f65,0x3f7abf333e3b3ecabe543f37bf7c3f6b
.octa 0xbedbbeac3f67bf713f67bf713edb3eac,0xbf633de23f44bf763eecbf7e3f253e8f,0xbf7c3f093f13bf7abe2fbf583f513e60,0xbf2e3f5a3eb2bf7dbf3cbf063f703e23
.octa 0x3f67bf713edb3eac3edb3eacbf673f71,0x3eecbf7e3f253e8f3f63bde2bf443f76,0xbe2fbf583f513e603f7cbf09bf133f7a,0xbf3cbf063f703e233f2ebf5abeb23f7d
.octa 0x3f55bf553f55bf55bf0e3f0ebf0e3f0e,0x3f2abf4c3f66bf783f40bf1b3ee1be82,0xbf273ea13d97bee63f42bf733f7fbf65,0xbf573f80bf533ebebf0cbc493f11bf6e
.octa 0xbf0e3f0ebf0e3f0ebf553f55bf553f55,0x3f40bf1b3ee1be82bf2a3f4cbf663f78,0x3f42bf733f7fbf653f27bea1bd973ee6,0xbf0cbc493f11bf6e3f57bf803f53bebe
.octa 0x3edb3eacbf673f71bf673f71bedbbeac,0x3f74bf48bdb03f603e9b3f20bf7f3ef7,0xbe2fbf583f513e603f7cbf09bf133f7a,0xbf803e6d3f69bf16bd17bf793ed53f4f
.octa 0xbf673f71bedbbeacbedbbeac3f67bf71,0x3e9b3f20bf7f3ef7bf743f483db0bf60,0x3f7cbf09bf133f7a3e2f3f58bf51be60,0xbd17bf793ed53f4f3f80be6dbf693f16
.octa 0x3f55bf553f55bf55bf0e3f0ebf0e3f0e,0xbd7bbe0a3ea7bf013f80bf7e3f72bf5d,0xbf423f73bf7f3f65bf273ea13d97bee6,0x3f7abf333e3b3ecabe543f37bf7c3f6b
.octa 0xbf0e3f0ebf0e3f0ebf553f55bf553f55,0x3f80bf7e3f72bf5d3d7b3e0abea73f01,0xbf273ea13d97bee63f42bf733f7fbf65,0xbe543f37bf7c3f6bbf7a3f33be3bbeca
.octa 0xbedbbeac3f67bf713f67bf713edb3eac,0xbeec3f7ebf25be8fbf633de23f44bf76,0x3f7cbf09bf133f7a3e2f3f58bf51be60,0xbf3cbf063f703e233f2ebf5abeb23f7d
.octa 0x3f67bf713edb3eac3edb3eacbf673f71,0xbf633de23f44bf763eecbf7e3f253e8f,0x3e2f3f58bf51be60bf7c3f093f13bf7a,0x3f2ebf5abeb23f7d3f3c3f06bf70be23
.octa 0x3f55bf553f55bf55bf0e3f0ebf0e3f0e,0xbf403f1bbee13e823f2abf4c3f66bf78,0x3f27bea1bd973ee6bf423f73bf7f3f65,0xbf0cbc493f11bf6e3f57bf803f53bebe
.octa 0xbf0e3f0ebf0e3f0ebf553f55bf553f55,0x3f2abf4c3f66bf783f40bf1b3ee1be82,0xbf423f73bf7f3f65bf273ea13d97bee6,0x3f57bf803f53bebe3f0c3c49bf113f6e
.octa 0x3edb3eacbf673f71bf673f71bedbbeac,0xbe9bbf203f7fbef73f74bf48bdb03f60,0x3e2f3f58bf51be60bf7c3f093f13bf7a,0xbd17bf793ed53f4f3f80be6dbf693f16
.octa 0xbf673f71bedbbeacbedbbeac3f67bf71,0x3f74bf48bdb03f603e9b3f20bf7f3ef7,0xbf7c3f093f13bf7abe2fbf583f513e60,0x3f80be6dbf693f163d173f79bed5bf4f
.octa 0x3f6dbf6d3f6dbf6dbec43ec4bec43ec4,0x3f77bf7f3f7ebf733e89bd97bdfb3ea1,0x3f18bf5c3f7dbf783f4ebf043e163e79,0xbcc9bf093f6abf7c3f80bf583ecf3e2f
.octa 0xbec43ec4bec43ec4bf6d3f6dbf6d3f6d,0x3e89bd97bdfb3ea1bf773f7fbf7e3f73,0x3f4ebf043e163e79bf183f5cbf7d3f78,0x3f80bf583ecf3e2f3cc93f09bf6a3f7c
.octa 0xbf22bdc93f46bf7f3f46bf7f3f223dc9,0xbf7a3eb83f13bf803e60bf6f3f513cc9,0xbf673f3e3eacbf80bedbbf2c3f71bd49,0xbee63f773d97bf7ebf65be893f7fbdfb
.octa 0x3f46bf7f3f223dc93f223dc9bf463f7f,0x3e60bf6f3f513cc93f7abeb8bf133f80,0xbedbbf2c3f71bd493f67bf3ebeac3f80,0xbf65be893f7fbdfb3ee6bf77bd973f7e
.octa 0x3f6dbf6d3f6dbf6dbec43ec4bec43ec4,0x3efcbf273f4abf653f5fbf423f1dbee6,0xbf4e3f04be16be793f18bf5c3f7dbf78,0xbf313f7abf6f3f13bf393e603eb8bf51
.octa 0xbec43ec4bec43ec4bf6d3f6dbf6d3f6d,0x3f5fbf423f1dbee6befc3f27bf4a3f65,0x3f18bf5c3f7dbf783f4ebf043e163e79,0xbf393e603eb8bf513f31bf7a3f6fbf13
.octa 0x3f223dc9bf463f7fbf463f7fbf22bdc9,0x3f58bf6a3e2f3f393f093ecfbf7c3f31,0xbedbbf2c3f71bd493f67bf3ebeac3f80,0xbf733efc3f42bf4abea1bf5f3f273f1d
.octa 0xbf463f7fbf22bdc9bf22bdc93f46bf7f,0x3f093ecfbf7c3f31bf583f6abe2fbf39,0x3f67bf3ebeac3f803edb3f2cbf713d49,0xbea1bf5f3f273f1d3f73befcbf423f4a
.octa 0x3f6dbf6d3f6dbf6dbec43ec4bec43ec4,0xbe893d973dfbbea13f77bf7f3f7ebf73,0xbf183f5cbf7d3f78bf4e3f04be16be79,0x3f80bf583ecf3e2f3cc93f09bf6a3f7c
.octa 0xbec43ec4bec43ec4bf6d3f6dbf6d3f6d,0x3f77bf7f3f7ebf733e89bd97bdfb3ea1,0xbf4e3f04be16be793f18bf5c3f7dbf78,0x3cc93f09bf6a3f7cbf803f58becfbe2f
.octa 0xbf22bdc93f46bf7f3f46bf7f3f223dc9,0xbe603f6fbf51bcc9bf7a3eb83f13bf80,0x3f67bf3ebeac3f803edb3f2cbf713d49,0xbf65be893f7fbdfb3ee6bf77bd973f7e
.octa 0x3f46bf7f3f223dc93f223dc9bf463f7f,0xbf7a3eb83f13bf803e60bf6f3f513cc9,0x3edb3f2cbf713d49bf673f3e3eacbf80,0x3ee6bf77bd973f7e3f653e89bf7f3dfb
.octa 0x3f6dbf6d3f6dbf6dbec43ec4bec43ec4,0xbf5f3f42bf1d3ee63efcbf273f4abf65,0x3f4ebf043e163e79bf183f5cbf7d3f78,0xbf393e603eb8bf513f31bf7a3f6fbf13
.octa 0xbec43ec4bec43ec4bf6d3f6dbf6d3f6d,0x3efcbf273f4abf653f5fbf423f1dbee6,0xbf183f5cbf7d3f78bf4e3f04be16be79,0x3f31bf7a3f6fbf133f39be60beb83f51
.octa 0x3f223dc9bf463f7fbf463f7fbf22bdc9,0xbf09becf3f7cbf313f58bf6a3e2f3f39,0x3edb3f2cbf713d49bf673f3e3eacbf80,0xbea1bf5f3f273f1d3f73befcbf423f4a
.octa 0xbf463f7fbf22bdc9bf22bdc93f46bf7f,0x3f58bf6a3e2f3f393f093ecfbf7c3f31,0xbf673f3e3eacbf80bedbbf2c3f71bd49,0x3f73befcbf423f4a3ea13f5fbf27bf1d
.octa 0x3f7bbf7b3f7bbf7bbe483e48be483e48,0x3f63bf763f7fbf7e3eecbe8f3db03de2,0x3ecfbf393f6fbf803f6abf313eb83cc9,0xbe82bea73f4cbf803f78bf723f1bbd7b
.octa 0xbe483e48be483e48bf7b3f7bbf7b3f7b,0x3eecbe8f3db03de2bf633f76bf7f3f7e,0x3f6abf313eb83cc9becf3f39bf6f3f80,0x3f78bf723f1bbd7b3e823ea7bf4c3f80
.octa 0xbf4e3e163f18bf7d3f18bf7d3f4ebe16,0xbf803f163eb2bf79bd17bf4f3f70be6d,0xbf423f653d97bf73bf27bee63f7fbea1,0xbe3b3f80be54bf6bbf7c3c493f7abeca
.octa 0x3f18bf7d3f4ebe163f4ebe16bf183f7d,0xbd17bf4f3f70be6d3f80bf16beb23f79,0xbf27bee63f7fbea13f42bf65bd973f73,0xbf7c3c493f7abeca3e3bbf803e543f6b
.octa 0x3f7bbf7b3f7bbf7bbe483e48be483e48,0x3e9bbef73f25bf483f74bf603f44bf20,0xbf6a3f31beb8bcc93ecfbf393f6fbf80,0xbf013f66bf7e3f40bf5d3ee13e0abf2a
.octa 0xbe483e48be483e48bf7b3f7bbf7b3f7b,0x3f74bf603f44bf20be9b3ef7bf253f48,0x3ecfbf393f6fbf803f6abf313eb83cc9,0xbf5d3ee13e0abf2a3f01bf663f7ebf40
.octa 0x3f4ebe16bf183f7dbf183f7dbf4e3e16,0x3f2ebf7d3ed53f063f3c3e23bf693f5a,0xbf27bee63f7fbea13f42bf65bd973f73,0xbf533f373f0cbf6ebf11bf333f573ebe
.octa 0xbf183f7dbf4e3e16bf4e3e163f18bf7d,0x3f3c3e23bf693f5abf2e3f7dbed5bf06,0x3f42bf65bd973f733f273ee6bf7f3ea1,0xbf11bf333f573ebe3f53bf37bf0c3f6e
.octa 0x3f7bbf7b3f7bbf7bbe483e48be483e48,0xbeec3e8fbdb0bde23f63bf763f7fbf7e,0xbecf3f39bf6f3f80bf6a3f31beb8bcc9,0x3f78bf723f1bbd7b3e823ea7bf4c3f80
.octa 0xbe483e48be483e48bf7b3f7bbf7b3f7b,0x3f63bf763f7fbf7e3eecbe8f3db03de2,0xbf6a3f31beb8bcc93ecfbf393f6fbf80,0x3e823ea7bf4c3f80bf783f72bf1b3d7b
.octa 0xbf4e3e163f18bf7d3f18bf7d3f4ebe16,0x3d173f4fbf703e6dbf803f163eb2bf79,0x3f42bf65bd973f733f273ee6bf7f3ea1,0xbf7c3c493f7abeca3e3bbf803e543f6b
.octa 0x3f18bf7d3f4ebe163f4ebe16bf183f7d,0xbf803f163eb2bf79bd17bf4f3f70be6d,0x3f273ee6bf7f3ea1bf423f653d97bf73,0x3e3bbf803e543f6b3f7cbc49bf7a3eca
.octa 0x3f7bbf7b3f7bbf7bbe483e48be483e48,0xbf743f60bf443f203e9bbef73f25bf48,0x3f6abf313eb83cc9becf3f39bf6f3f80,0xbf5d3ee13e0abf2a3f01bf663f7ebf40
.octa 0xbe483e48be483e48bf7b3f7bbf7b3f7b,0x3e9bbef73f25bf483f74bf603f44bf20,0xbecf3f39bf6f3f80bf6a3f31beb8bcc9,0x3f01bf663f7ebf403f5dbee1be0a3f2a
.octa 0x3f4ebe16bf183f7dbf183f7dbf4e3e16,0xbf3cbe233f69bf5a3f2ebf7d3ed53f06,0x3f273ee6bf7f3ea1bf423f653d97bf73,0xbf11bf333f573ebe3f53bf37bf0c3f6e
.octa 0xbf183f7dbf4e3e16bf4e3e163f18bf7d,0x3f2ebf7d3ed53f063f3c3e23bf693f5a,0xbf423f653d97bf73bf27bee63f7fbea1,0x3f53bf37bf0c3f6e3f113f33bf57bebe
.octa 0x3f80bf803f80bf800000000000000000,0x3f46bf623f75bf7f3f22bef13e95bdc9,0x3e48bf0e3f55bf7b3f7bbf553f0ebe48,0xbef1bdc93f22bf753f62bf7f3f46be95
.octa 0x00000000000000000000000000000000,0x00000000000000000000000000000000,0x00000000000000000000000000000000,0x00000000000000000000000000000000
.octa 0xbf6d3ec43ec4bf6d3ec4bf6d3f6dbec4,0xbf753f463dc9bf62be95bf223f7fbef1,0xbf0e3f7bbe48bf55bf55be483f7bbf0e,0x3dc93f75bef1bf46bf7f3e953f62bf22
.octa 0x00000000000000000000000000000000,0x00000000000000000000000000000000,0x00000000000000000000000000000000,0x00000000000000000000000000000000
.octa 0x3f80bf803f80bf800000000000000000,0x3dc9be953ef1bf223f7fbf753f62bf46,0xbf7b3f55bf0e3e483e48bf0e3f55bf7b,0xbe953f46bf7f3f62bf753f22bdc9bef1
.octa 0x00000000000000000000000000000000,0x00000000000000000000000000000000,0x00000000000000000000000000000000,0x00000000000000000000000000000000
.octa 0x3f6dbec4bec43f6dbec43f6dbf6d3ec4,0x3ef1bf7f3f223e953f62bdc9bf463f75,0xbf55be483f7bbf0e3f0ebf7b3e483f55,0xbf223f623e95bf7fbf46bef13f753dc9
.octa 0x00000000000000000000000000000000,0x00000000000000000000000000000000,0x00000000000000000000000000000000,0x00000000000000000000000000000000
.octa 0x3f80bf803f80bf800000000000000000,0xbf223ef1be953dc93f46bf623f75bf7f,0xbe483f0ebf553f7bbf7b3f55bf0e3e48,0x3f62bf7f3f46be953ef13dc9bf223f75
.octa 0x00000000000000000000000000000000,0x00000000000000000000000000000000,0x00000000000000000000000000000000,0x00000000000000000000000000000000
.octa 0xbf6d3ec43ec4bf6d3ec4bf6d3f6dbec4,0x3e953f22bf7f3ef1bf753f463dc9bf62,0x3f0ebf7b3e483f553f553e48bf7b3f0e,0xbf7f3e953f62bf22bdc9bf753ef13f46
.octa 0x00000000000000000000000000000000,0x00000000000000000000000000000000,0x00000000000000000000000000000000,0x00000000000000000000000000000000
.octa 0x3f80bf803f80bf800000000000000000,0xbf7f3f75bf623f463dc9be953ef1bf22,0x3f7bbf553f0ebe48be483f0ebf553f7b,0xbf753f22bdc9bef13e95bf463f7fbf62
.octa 0x00000000000000000000000000000000,0x00000000000000000000000000000000,0x00000000000000000000000000000000,0x00000000000000000000000000000000
.octa 0x3f6dbec4bec43f6dbec43f6dbf6d3ec4,0xbf623dc93f46bf753ef1bf7f3f223e95,0x3f553e48bf7b3f0ebf0e3f7bbe48bf55,0xbf46bef13f753dc93f22bf62be953f7f
.octa 0x00000000000000000000000000000000,0x00000000000000000000000000000000,0x00000000000000000000000000000000,0x00000000000000000000000000000000
.octa 0x3f7bbf7b3f7bbf7b3e48be483e48be48,0x3f20bf443f60bf743f48bf253ef7be9b,0xbcc9beb83f31bf6a3f80bf6f3f39becf,0xbf2a3e0a3ee1bf5d3f40bf7e3f66bf01
.octa 0xbe483e48be483e483f7bbf7b3f7bbf7b,0xbf483f25bef73e9b3f20bf443f60bf74,0xbf803f6fbf393ecfbcc9beb83f31bf6a,0xbf403f7ebf663f01bf2a3e0a3ee1bf5d
.octa 0xbf7d3f183e16bf4e3e16bf4e3f7dbf18,0xbf5a3f69be23bf3cbf06bed53f7dbf2e,0xbea13f7fbee6bf27bf733d973f65bf42,0x3ebe3f57bf33bf11bf6e3f0c3f37bf53
.octa 0xbe163f4ebf7d3f18bf7d3f183e16bf4e,0x3f063ed5bf7d3f2ebf5a3f69be23bf3c,0x3f73bd97bf653f42bea13f7fbee6bf27,0x3f6ebf0cbf373f533ebe3f57bf33bf11
.octa 0x3f7bbf7b3f7bbf7b3e48be483e48be48,0xbde2bdb03e8fbeec3f7ebf7f3f76bf63,0xbf803f6fbf393ecfbcc9beb83f31bf6a,0xbd7b3f1bbf723f78bf803f4cbea7be82
.octa 0xbe483e48be483e483f7bbf7b3f7bbf7b,0xbf7e3f7fbf763f63bde2bdb03e8fbeec,0x3cc93eb8bf313f6abf803f6fbf393ecf,0x3f80bf4c3ea73e82bd7b3f1bbf723f78
.octa 0x3f7dbf18be163f4ebe163f4ebf7d3f18,0x3e6dbf703f4f3d173f79beb2bf163f80,0xbf733d973f65bf423ea1bf7f3ee63f27,0xbeca3f7a3c49bf7cbf6bbe543f80be3b
.octa 0x3e16bf4e3f7dbf183f7dbf18be163f4e,0xbf793eb23f16bf803e6dbf703f4f3d17,0xbea13f7fbee6bf27bf733d973f65bf42,0x3f6b3e54bf803e3bbeca3f7a3c49bf7c
.octa 0x3f7bbf7b3f7bbf7b3e48be483e48be48,0xbf483f25bef73e9b3f20bf443f60bf74,0x3cc93eb8bf313f6abf803f6fbf393ecf,0x3f40bf7e3f66bf013f2abe0abee13f5d
.octa 0xbe483e48be483e483f7bbf7b3f7bbf7b,0xbf203f44bf603f74bf483f25bef73e9b,0x3f80bf6f3f39becf3cc93eb8bf313f6a,0xbf2a3e0a3ee1bf5d3f40bf7e3f66bf01
.octa 0xbf7d3f183e16bf4e3e16bf4e3f7dbf18,0x3f063ed5bf7d3f2ebf5a3f69be23bf3c,0x3ea1bf7f3ee63f273f73bd97bf653f42,0xbf6e3f0c3f37bf53bebebf573f333f11
.octa 0xbe163f4ebf7d3f18bf7d3f183e16bf4e,0x3f5abf693e233f3c3f063ed5bf7d3f2e,0xbf733d973f65bf423ea1bf7f3ee63f27,0x3ebe3f57bf33bf11bf6e3f0c3f37bf53
.octa 0x3f7bbf7b3f7bbf7b3e48be483e48be48,0xbf7e3f7fbf763f63bde2bdb03e8fbeec,0x3f80bf6f3f39becf3cc93eb8bf313f6a,0xbf803f4cbea7be823d7bbf1b3f72bf78
.octa 0xbe483e48be483e483f7bbf7b3f7bbf7b,0x3de23db0be8f3eecbf7e3f7fbf763f63,0xbcc9beb83f31bf6a3f80bf6f3f39becf,0xbd7b3f1bbf723f78bf803f4cbea7be82
.octa 0x3f7dbf18be163f4ebe163f4ebf7d3f18,0xbf793eb23f16bf803e6dbf703f4f3d17,0x3f73bd97bf653f42bea13f7fbee6bf27,0xbf6bbe543f80be3b3ecabf7abc493f7c
.octa 0x3e16bf4e3f7dbf183f7dbf18be163f4e,0xbe6d3f70bf4fbd17bf793eb23f16bf80,0x3ea1bf7f3ee63f273f73bd97bf653f42,0xbeca3f7a3c49bf7cbf6bbe543f80be3b
.octa 0x3f6dbf6d3f6dbf6d3ec4bec43ec4bec4,0x3ee6bf1d3f42bf5f3f65bf4a3f27befc,0xbe79be163f04bf4e3f78bf7d3f5cbf18,0xbf513eb83e60bf393f13bf6f3f7abf31
.octa 0xbec43ec4bec43ec43f6dbf6d3f6dbf6d,0xbf653f4abf273efc3ee6bf1d3f42bf5f,0xbf783f7dbf5c3f18be79be163f04bf4e,0xbf133f6fbf7a3f31bf513eb83e60bf39
.octa 0xbf7f3f46bdc9bf22bdc9bf223f7fbf46,0xbf313f7cbecfbf09bf39be2f3f6abf58,0xbd493f71bf2cbedbbf803eac3f3ebf67,0x3f1d3f27bf5fbea1bf4a3f423efcbf73
.octa 0x3dc93f22bf7f3f46bf7f3f46bdc9bf22,0x3f393e2fbf6a3f58bf313f7cbecfbf09,0x3f80beacbf3e3f67bd493f71bf2cbedb,0x3f4abf42befc3f733f1d3f27bf5fbea1
.octa 0x3f6dbf6d3f6dbf6d3ec4bec43ec4bec4,0xbea13dfb3d97be893f73bf7e3f7fbf77,0xbf783f7dbf5c3f18be79be163f04bf4e,0x3e2f3ecfbf583f80bf7c3f6abf09bcc9
.octa 0xbec43ec4bec43ec43f6dbf6d3f6dbf6d,0xbf733f7ebf7f3f77bea13dfb3d97be89,0x3e793e16bf043f4ebf783f7dbf5c3f18,0x3f7cbf6a3f093cc93e2f3ecfbf583f80
.octa 0x3f7fbf463dc93f223dc93f22bf7f3f46,0xbcc9bf513f6fbe603f80bf13beb83f7a,0xbf803eac3f3ebf673d49bf713f2c3edb,0xbdfb3f7fbe89bf65bf7e3d973f77bee6
.octa 0xbdc9bf223f7fbf463f7fbf463dc93f22,0xbf803f133eb8bf7abcc9bf513f6fbe60,0xbd493f71bf2cbedbbf803eac3f3ebf67,0x3f7ebd97bf773ee6bdfb3f7fbe89bf65
.octa 0x3f6dbf6d3f6dbf6d3ec4bec43ec4bec4,0xbf653f4abf273efc3ee6bf1d3f42bf5f,0x3e793e16bf043f4ebf783f7dbf5c3f18,0x3f13bf6f3f7abf313f51beb8be603f39
.octa 0xbec43ec4bec43ec43f6dbf6d3f6dbf6d,0xbee63f1dbf423f5fbf653f4abf273efc,0x3f78bf7d3f5cbf183e793e16bf043f4e,0xbf513eb83e60bf393f13bf6f3f7abf31
.octa 0xbf7f3f46bdc9bf22bdc9bf223f7fbf46,0x3f393e2fbf6a3f58bf313f7cbecfbf09,0x3d49bf713f2c3edb3f80beacbf3e3f67,0xbf4a3f423efcbf73bf1dbf273f5f3ea1
.octa 0x3dc93f22bf7f3f46bf7f3f46bdc9bf22,0x3f31bf7c3ecf3f093f393e2fbf6a3f58,0xbf803eac3f3ebf673d49bf713f2c3edb,0x3f1d3f27bf5fbea1bf4a3f423efcbf73
.octa 0x3f6dbf6d3f6dbf6d3ec4bec43ec4bec4,0xbf733f7ebf7f3f77bea13dfb3d97be89,0x3f78bf7d3f5cbf183e793e16bf043f4e,0xbf7c3f6abf09bcc9be2fbecf3f58bf80
.octa 0xbec43ec4bec43ec43f6dbf6d3f6dbf6d,0x3ea1bdfbbd973e89bf733f7ebf7f3f77,0xbe79be163f04bf4e3f78bf7d3f5cbf18,0x3e2f3ecfbf583f80bf7c3f6abf09bcc9
.octa 0x3f7fbf463dc93f223dc93f22bf7f3f46,0xbf803f133eb8bf7abcc9bf513f6fbe60,0x3f80beacbf3e3f67bd493f71bf2cbedb,0xbf7e3d973f77bee63dfbbf7f3e893f65
.octa 0xbdc9bf223f7fbf463f7fbf463dc93f22,0x3cc93f51bf6f3e60bf803f133eb8bf7a,0x3d49bf713f2c3edb3f80beacbf3e3f67,0xbdfb3f7fbe89bf65bf7e3d973f77bee6
.octa 0x3f55bf553f55bf553f0ebf0e3f0ebf0e,0x3e82bee13f1bbf403f78bf663f4cbf2a,0xbee63d973ea1bf273f65bf7f3f73bf42,0xbf6e3f11bc49bf0c3ebebf533f80bf57
.octa 0xbf0e3f0ebf0e3f0e3f55bf553f55bf55,0xbf783f66bf4c3f2a3e82bee13f1bbf40,0xbf653f7fbf733f42bee63d973ea1bf27,0xbebe3f53bf803f57bf6e3f11bc49bf0c
.octa 0xbf713f67beacbedbbeacbedb3f71bf67,0xbef73f7fbf20be9bbf603db03f48bf74,0x3e603f51bf58be2fbf7a3f133f09bf7c,0x3f4f3ed5bf79bd17bf163f693e6dbf80
.octa 0x3eac3edbbf713f67bf713f67beacbedb,0x3f60bdb0bf483f74bef73f7fbf20be9b,0x3f7abf13bf093f7c3e603f51bf58be2f,0x3f16bf69be6d3f803f4f3ed5bf79bd17
.octa 0x3f55bf553f55bf553f0ebf0e3f0ebf0e,0xbf013ea7be0abd7b3f5dbf723f7ebf80,0xbf653f7fbf733f42bee63d973ea1bf27,0x3eca3e3bbf333f7abf6b3f7cbf373e54
.octa 0xbf0e3f0ebf0e3f0e3f55bf553f55bf55,0xbf5d3f72bf7e3f80bf013ea7be0abd7b,0x3ee6bd97bea13f27bf653f7fbf733f42,0x3f6bbf7c3f37be543eca3e3bbf333f7a
.octa 0x3f71bf673eac3edb3eac3edbbf713f67,0xbe8fbf253f7ebeec3f76bf44bde23f63,0xbf7a3f133f09bf7cbe60bf513f583e2f,0x3e233f70bf06bf3cbf7d3eb23f5abf2e
.octa 0xbeacbedb3f71bf673f71bf673eac3edb,0xbf763f443de2bf63be8fbf253f7ebeec,0x3e603f51bf58be2fbf7a3f133f09bf7c,0x3f7dbeb2bf5a3f2e3e233f70bf06bf3c
.octa 0x3f55bf553f55bf553f0ebf0e3f0ebf0e,0xbf783f66bf4c3f2a3e82bee13f1bbf40,0x3ee6bd97bea13f27bf653f7fbf733f42,0x3ebebf533f80bf573f6ebf113c493f0c
.octa 0xbf0e3f0ebf0e3f0e3f55bf553f55bf55,0xbe823ee1bf1b3f40bf783f66bf4c3f2a,0x3f65bf7f3f73bf423ee6bd97bea13f27,0xbf6e3f11bc49bf0c3ebebf533f80bf57
.octa 0xbf713f67beacbedbbeacbedb3f71bf67,0x3f60bdb0bf483f74bef73f7fbf20be9b,0xbe60bf513f583e2f3f7abf13bf093f7c,0xbf163f693e6dbf80bf4fbed53f793d17
.octa 0x3eac3edbbf713f67bf713f67beacbedb,0x3ef7bf7f3f203e9b3f60bdb0bf483f74,0xbf7a3f133f09bf7cbe60bf513f583e2f,0x3f4f3ed5bf79bd17bf163f693e6dbf80
.octa 0x3f55bf553f55bf553f0ebf0e3f0ebf0e,0xbf5d3f72bf7e3f80bf013ea7be0abd7b,0x3f65bf7f3f73bf423ee6bd97bea13f27,0xbf6b3f7cbf373e54becabe3b3f33bf7a
.octa 0xbf0e3f0ebf0e3f0e3f55bf553f55bf55,0x3f01bea73e0a3d7bbf5d3f72bf7e3f80,0xbee63d973ea1bf273f65bf7f3f73bf42,0x3eca3e3bbf333f7abf6b3f7cbf373e54
.octa 0x3f71bf673eac3edb3eac3edbbf713f67,0xbf763f443de2bf63be8fbf253f7ebeec,0x3f7abf13bf093f7c3e603f51bf58be2f,0xbf7d3eb23f5abf2ebe23bf703f063f3c
.octa 0xbeacbedb3f71bf673f71bf673eac3edb,0x3e8f3f25bf7e3eecbf763f443de2bf63,0xbe60bf513f583e2f3f7abf13bf093f7c,0x3e233f70bf06bf3cbf7d3eb23f5abf2e
.octa 0x3f35bf353f35bf353f35bf353f35bf35,0x3d49be793edbbf183f80bf783f67bf4e,0xbf223e953dc9bef13f46bf753f7fbf62,0xbf7d3f3ebe79beac3e16bf2c3f78bf71
.octa 0xbf353f35bf353f353f35bf353f35bf35,0xbf803f78bf673f4e3d49be793edbbf18,0xbf463f75bf7f3f62bf223e953dc9bef1,0xbe163f2cbf783f71bf7d3f3ebe79beac
.octa 0xbf553f7bbf0ebe48bf0ebe483f55bf7b,0xbe793f71bf4ebd49bf783eac3f18bf80,0x3ef13f22bf753dc9bf623f463e95bf7f,0x3f713e16bf803e79beac3f7dbd49bf78
.octa 0x3f0e3e48bf553f7bbf553f7bbf0ebe48,0x3f78beacbf183f80be793f71bf4ebd49,0x3f62bf46be953f7f3ef13f22bf753dc9,0x3eacbf7d3d493f783f713e16bf803e79
.octa 0x3f35bf353f35bf353f35bf353f35bf35,0xbf2c3f04beac3e163f3ebf5c3f71bf7d,0xbf463f75bf7f3f62bf223e953dc9bef1,0x3f18bd49bf043f67bf4e3f80bf5c3edb
.octa 0xbf353f35bf353f353f35bf353f35bf35,0xbf3e3f5cbf713f7dbf2c3f04beac3e16,0x3f22be95bdc93ef1bf463f75bf7f3f62,0x3f4ebf803f5cbedb3f18bd49bf043f67
.octa 0x3f55bf7b3f0e3e483f0e3e48bf553f7b,0xbf04bedb3f7dbf2c3f5cbf673e163f3e,0xbf623f463e95bf7fbef1bf223f75bdc9,0x3edb3f4ebf3ebf04bf673f183f2cbf5c
.octa 0xbf0ebe483f55bf7b3f55bf7b3f0e3e48,0xbf5c3f67be16bf3ebf04bedb3f7dbf2c,0x3ef13f22bf753dc9bf623f463e95bf7f,0x3f67bf18bf2c3f5c3edb3f4ebf3ebf04
.octa 0x3f35bf353f35bf353f35bf353f35bf35,0xbf803f78bf673f4e3d49be793edbbf18,0x3f22be95bdc93ef1bf463f75bf7f3f62,0x3e16bf2c3f78bf713f7dbf3e3e793eac
.octa 0xbf353f35bf353f353f35bf353f35bf35,0xbd493e79bedb3f18bf803f78bf673f4e,0x3f46bf753f7fbf623f22be95bdc93ef1,0xbf7d3f3ebe79beac3e16bf2c3f78bf71
.octa 0xbf553f7bbf0ebe48bf0ebe483f55bf7b,0x3f78beacbf183f80be793f71bf4ebd49,0xbef1bf223f75bdc93f62bf46be953f7f,0xbeac3f7dbd49bf78bf71be163f80be79
.octa 0x3f0e3e48bf553f7bbf553f7bbf0ebe48,0x3e79bf713f4e3d493f78beacbf183f80,0xbf623f463e95bf7fbef1bf223f75bdc9,0x3f713e16bf803e79beac3f7dbd49bf78
.octa 0x3f35bf353f35bf353f35bf353f35bf35,0xbf3e3f5cbf713f7dbf2c3f04beac3e16,0x3f46bf753f7fbf623f22be95bdc93ef1,0xbf4e3f80bf5c3edbbf183d493f04bf67
.octa 0xbf353f35bf353f353f35bf353f35bf35,0x3f2cbf043eacbe16bf3e3f5cbf713f7d,0xbf223e953dc9bef13f46bf753f7fbf62,0x3f18bd49bf043f67bf4e3f80bf5c3edb
.octa 0x3f55bf7b3f0e3e483f0e3e48bf553f7b,0xbf5c3f67be16bf3ebf04bedb3f7dbf2c,0x3f62bf46be953f7f3ef13f22bf753dc9,0xbf673f183f2cbf5cbedbbf4e3f3e3f04
.octa 0xbf0ebe483f55bf7b3f55bf7b3f0e3e48,0x3f043edbbf7d3f2cbf5c3f67be16bf3e,0xbef1bf223f75bdc93f62bf46be953f7f,0x3edb3f4ebf3ebf04bf673f183f2cbf5c
.octa 0x3f0ebf0e3f0ebf0e3f55bf553f55bf55,0xbe23bd173e6dbed53f7dbf803f79bf69,0xbf4a3efcbdfbbe893f1dbf5f3f7ebf77,0xbf7f3f60beecbde2bdb0bef73f63bf7e
.octa 0xbf553f55bf553f553f0ebf0e3f0ebf0e,0xbf7d3f80bf793f69be23bd173e6dbed5,0xbf1d3f5fbf7e3f77bf4a3efcbdfbbe89,0x3db03ef7bf633f7ebf7f3f60beecbde2
.octa 0xbf2c3f80bf3e3d49bf3e3d493f2cbf80,0x3c493f53bf6e3e54bf803f113ebebf7a,0x3f313ecfbf803eb8bf393f6a3cc9bf6f,0x3f80be0abf723f01bd7b3f7ebea7bf5d
.octa 0x3f3ebd49bf2c3f80bf2c3f80bf3e3d49,0x3f80bf11bebe3f7a3c493f53bf6e3e54,0x3f39bf6abcc93f6f3f313ecfbf803eb8,0x3d7bbf7e3ea73f5d3f80be0abf723f01
.octa 0x3f0ebf0e3f0ebf0e3f55bf553f55bf55,0xbf4f3f2ebf063eb23f16bf3c3f5abf70,0xbf1d3f5fbf7e3f77bf4a3efcbdfbbe89,0x3f44be8fbe9b3f48bf253f76bf743f20
.octa 0xbf553f55bf553f553f0ebf0e3f0ebf0e,0xbf163f3cbf5a3f70bf4f3f2ebf063eb2,0x3f4abefc3dfb3e89bf1d3f5fbf7e3f77,0x3f25bf763f74bf203f44be8fbe9b3f48
.octa 0x3f2cbf803f3ebd493f3ebd49bf2c3f80,0xbf37be3b3f6bbf573f33bf7c3eca3f0c,0xbf393f6a3cc9bf6fbf31becf3f80beb8,0x3f2a3f1bbf66be82bf403f4c3ee1bf78
.octa 0xbf3e3d493f2cbf803f2cbf803f3ebd49,0xbf333f7cbecabf0cbf37be3b3f6bbf57,0x3f313ecfbf803eb8bf393f6a3cc9bf6f,0x3f40bf4cbee13f783f2a3f1bbf66be82
.octa 0x3f0ebf0e3f0ebf0e3f55bf553f55bf55,0xbf7d3f80bf793f69be23bd173e6dbed5,0x3f4abefc3dfb3e89bf1d3f5fbf7e3f77,0xbdb0bef73f63bf7e3f7fbf603eec3de2
.octa 0xbf553f55bf553f553f0ebf0e3f0ebf0e,0x3e233d17be6d3ed5bf7d3f80bf793f69,0x3f1dbf5f3f7ebf773f4abefc3dfb3e89,0xbf7f3f60beecbde2bdb0bef73f63bf7e
.octa 0xbf2c3f80bf3e3d49bf3e3d493f2cbf80,0x3f80bf11bebe3f7a3c493f53bf6e3e54,0xbf31becf3f80beb83f39bf6abcc93f6f,0xbd7b3f7ebea7bf5dbf803e0a3f72bf01
.octa 0x3f3ebd49bf2c3f80bf2c3f80bf3e3d49,0xbc49bf533f6ebe543f80bf11bebe3f7a,0xbf393f6a3cc9bf6fbf31becf3f80beb8,0x3f80be0abf723f01bd7b3f7ebea7bf5d
.octa 0x3f0ebf0e3f0ebf0e3f55bf553f55bf55,0xbf163f3cbf5a3f70bf4f3f2ebf063eb2,0x3f1dbf5f3f7ebf773f4abefc3dfb3e89,0xbf253f76bf743f20bf443e8f3e9bbf48
.octa 0xbf553f55bf553f553f0ebf0e3f0ebf0e,0x3f4fbf2e3f06beb2bf163f3cbf5a3f70,0xbf4a3efcbdfbbe893f1dbf5f3f7ebf77,0x3f44be8fbe9b3f48bf253f76bf743f20
.octa 0x3f2cbf803f3ebd493f3ebd49bf2c3f80,0xbf333f7cbecabf0cbf37be3b3f6bbf57,0x3f39bf6abcc93f6f3f313ecfbf803eb8,0xbf403f4c3ee1bf78bf2abf1b3f663e82
.octa 0xbf3e3d493f2cbf803f2cbf803f3ebd49,0x3f373e3bbf6b3f57bf333f7cbecabf0c,0xbf31becf3f80beb83f39bf6abcc93f6f,0x3f2a3f1bbf66be82bf403f4c3ee1bf78
.octa 0x3ec4bec43ec4bec43f6dbf6d3f6dbf6d,0xbeb83e2f3cc9be603f6fbf7c3f80bf7a,0xbf673f2cbeacbd493edbbf3e3f71bf80,0xbf733f77bf273dfbbea1be893f42bf7e
.octa 0xbf6d3f6dbf6d3f6d3ec4bec43ec4bec4,0xbf6f3f7cbf803f7abeb83e2f3cc9be60,0xbedb3f3ebf713f80bf673f2cbeacbd49,0x3ea13e89bf423f7ebf733f77bf273dfb
.octa 0xbef13f75bf623e95bf623e953ef1bf75,0x3e893f27bf7e3ee6bf773f423dfbbf65,0x3f5c3e16bf783f18bf043f7dbe79bf4e,0x3f7abecfbf513f393e603f6abf13bf31
.octa 0x3f62be95bef13f75bef13f75bf623e95,0x3f77bf42bdfb3f653e893f27bf7e3ee6,0x3f04bf7d3e793f4e3f5c3e16bf783f18,0xbe60bf6a3f133f313f7abecfbf513f39
.octa 0x3ec4bec43ec4bec43f6dbf6d3f6dbf6d,0xbf6a3f51bf313f093ecfbf133f39bf58,0xbedb3f3ebf713f80bf673f2cbeacbd49,0x3f65befcbd973f1dbee63f5fbf7f3f4a
.octa 0xbf6d3f6dbf6d3f6d3ec4bec43ec4bec4,0xbecf3f13bf393f58bf6a3f51bf313f09,0x3f67bf2c3eac3d49bedb3f3ebf713f80,0x3ee6bf5f3f7fbf4a3f65befcbd973f1d
.octa 0x3ef1bf753f62be953f62be95bef13f75,0xbf5f3d973f4abf733efcbf7f3f1d3ea1,0xbf043f7dbe79bf4ebf5cbe163f78bf18,0x3f583eb8bf7c3cc9bf093f6f3e2fbf80
.octa 0xbf623e953ef1bf753ef1bf753f62be95,0xbefc3f7fbf1dbea1bf5f3d973f4abf73,0x3f5c3e16bf783f18bf043f7dbe79bf4e,0x3f09bf6fbe2f3f803f583eb8bf7c3cc9
.octa 0x3ec4bec43ec4bec43f6dbf6d3f6dbf6d,0xbf6f3f7cbf803f7abeb83e2f3cc9be60,0x3f67bf2c3eac3d49bedb3f3ebf713f80,0xbea1be893f42bf7e3f73bf773f27bdfb
.octa 0xbf6d3f6dbf6d3f6d3ec4bec43ec4bec4,0x3eb8be2fbcc93e60bf6f3f7cbf803f7a,0x3edbbf3e3f71bf803f67bf2c3eac3d49,0xbf733f77bf273dfbbea1be893f42bf7e
.octa 0xbef13f75bf623e95bf623e953ef1bf75,0x3f77bf42bdfb3f653e893f27bf7e3ee6,0xbf5cbe163f78bf183f04bf7d3e793f4e,0x3e603f6abf13bf31bf7a3ecf3f51bf39
.octa 0x3f62be95bef13f75bef13f75bf623e95,0xbe89bf273f7ebee63f77bf42bdfb3f65,0xbf043f7dbe79bf4ebf5cbe163f78bf18,0x3f7abecfbf513f393e603f6abf13bf31
.octa 0x3ec4bec43ec4bec43f6dbf6d3f6dbf6d,0xbecf3f13bf393f58bf6a3f51bf313f09,0x3edbbf3e3f71bf803f67bf2c3eac3d49,0xbee63f5fbf7f3f4abf653efc3d97bf1d
.octa 0xbf6d3f6dbf6d3f6d3ec4bec43ec4bec4,0x3f6abf513f31bf09becf3f13bf393f58,0xbf673f2cbeacbd493edbbf3e3f71bf80,0x3f65befcbd973f1dbee63f5fbf7f3f4a
.octa 0x3ef1bf753f62be953f62be95bef13f75,0xbefc3f7fbf1dbea1bf5f3d973f4abf73,0x3f04bf7d3e793f4e3f5c3e16bf783f18,0xbf093f6f3e2fbf80bf58beb83f7cbcc9
.octa 0xbf623e953ef1bf753ef1bf753f62be95,0x3f5fbd97bf4a3f73befc3f7fbf1dbea1,0xbf5cbe163f78bf183f04bf7d3e793f4e,0x3f583eb8bf7c3cc9bf093f6f3e2fbf80
.octa 0x3e48be483e48be483f7bbf7b3f7bbf7b,0xbf0c3ebebe3bbc493f57bf6e3f7cbf80,0xbf7a3f51bf093e2f3e60bf133f58bf7c,0xbf5a3f80bf4f3eb2bf06bd173f16bf70
.octa 0xbf7b3f7bbf7b3f7b3e48be483e48be48,0xbf573f6ebf7c3f80bf0c3ebebe3bbc49,0xbe603f13bf583f7cbf7a3f51bf093e2f,0x3f063d17bf163f70bf5a3f80bf4f3eb2
.octa 0xbe793f5cbf783f04bf783f043e79bf5c,0x3f013ee1bf7e3f2abf5d3f66be0abf40,0x3f77bdfbbf5f3f4abe893f7ebefcbf1d,0x3f60bf25bf203f633ef73f44bf48beec
.octa 0x3f78bf04be793f5cbe793f5cbf783f04,0x3f5dbf663e0a3f403f013ee1bf7e3f2a,0x3e89bf7e3efc3f1d3f77bdfbbf5f3f4a,0xbef7bf443f483eec3f60bf25bf203f63
.octa 0x3e48be483e48be483f7bbf7b3f7bbf7b,0xbf7a3f6bbf533f333e54beca3f11bf37,0xbe603f13bf583f7cbf7a3f51bf093e2f,0x3f79bf2e3e233ed5be6d3f3cbf7d3f69
.octa 0xbf7b3f7bbf7b3f7b3e48be483e48be48,0xbe543ecabf113f37bf7a3f6bbf533f33,0x3f7abf513f09be2fbe603f13bf583f7c,0x3e6dbf3c3f7dbf693f79bf2e3e233ed5
.octa 0x3e79bf5c3f78bf043f78bf04be793f5c,0xbf783ea73f1bbf803e82bf723f4c3d7b,0xbe893f7ebefcbf1dbf773dfb3f5fbf4a,0x3f763db0bf7e3e9bbe8f3f7fbde2bf74
.octa 0xbf783f043e79bf5c3e79bf5c3f78bf04,0xbe823f72bf4cbd7bbf783ea73f1bbf80,0x3f77bdfbbf5f3f4abe893f7ebefcbf1d,0x3e8fbf7f3de23f743f763db0bf7e3e9b
.octa 0x3e48be483e48be483f7bbf7b3f7bbf7b,0xbf573f6ebf7c3f80bf0c3ebebe3bbc49,0x3f7abf513f09be2fbe603f13bf583f7c,0xbf06bd173f16bf703f5abf803f4fbeb2
.octa 0xbf7b3f7bbf7b3f7b3e48be483e48be48,0x3f0cbebe3e3b3c49bf573f6ebf7c3f80,0x3e60bf133f58bf7c3f7abf513f09be2f,0xbf5a3f80bf4f3eb2bf06bd173f16bf70
.octa 0xbe793f5cbf783f04bf783f043e79bf5c,0x3f5dbf663e0a3f403f013ee1bf7e3f2a,0xbf773dfb3f5fbf4a3e89bf7e3efc3f1d,0x3ef73f44bf48beecbf603f253f20bf63
.octa 0x3f78bf04be793f5cbe793f5cbf783f04,0xbf01bee13f7ebf2a3f5dbf663e0a3f40,0xbe893f7ebefcbf1dbf773dfb3f5fbf4a,0x3f60bf25bf203f633ef73f44bf48beec
.octa 0x3e48be483e48be483f7bbf7b3f7bbf7b,0xbe543ecabf113f37bf7a3f6bbf533f33,0x3e60bf133f58bf7c3f7abf513f09be2f,0xbe6d3f3cbf7d3f69bf793f2ebe23bed5
.octa 0xbf7b3f7bbf7b3f7b3e48be483e48be48,0x3f7abf6b3f53bf33be543ecabf113f37,0xbf7a3f51bf093e2f3e60bf133f58bf7c,0x3f79bf2e3e233ed5be6d3f3cbf7d3f69
.octa 0x3e79bf5c3f78bf043f78bf04be793f5c,0xbe823f72bf4cbd7bbf783ea73f1bbf80,0x3e89bf7e3efc3f1d3f77bdfbbf5f3f4a,0xbe8f3f7fbde2bf74bf76bdb03f7ebe9b
.octa 0xbf783f043e79bf5c3e79bf5c3f78bf04,0x3f78bea7bf1b3f80be823f72bf4cbd7b,0xbf773dfb3f5fbf4a3e89bf7e3efc3f1d,0x3f763db0bf7e3e9bbe8f3f7fbde2bf74
.octa 0x00000000000000000000000000000000,0x00000000000000000000000000000000,0x00000000000000000000000000000000,0x00000000000000000000000000000000
.octa 0x80008000800080003f80bf803f80bf80,0xbf353f0ebec43e483f35bf553f6dbf7b,0xbf803f6dbf353ec40000bec43f35bf6d,0xbf353f7bbf6d3f0ebf353e483ec4bf55
.octa 0x00000000000000000000000000000000,0x00000000000000000000000000000000,0x00000000000000000000000000000000,0x00000000000000000000000000000000
.octa 0x80003f35bf803f35bf803f350000bf35,0x3f353e48bf6d3f55bf353f7bbec4bf0e,0x3f80bec4bf353f6d00003f6dbf35bec4,0x3f35bf55bec43f7b3f353f0ebf6dbe48
.octa 0x00000000000000000000000000000000,0x00000000000000000000000000000000,0x00000000000000000000000000000000,0x00000000000000000000000000000000
.octa 0x80008000800080003f80bf803f80bf80,0xbf803f7bbf6d3f550000be483ec4bf0e,0x80003ec4bf353f6dbf803f6dbf353ec4,0x3f80bf553ec43e4800003f0ebf6d3f7b
.octa 0x00000000000000000000000000000000,0x00000000000000000000000000000000,0x00000000000000000000000000000000,0x00000000000000000000000000000000
.octa 0x8000bf353f80bf353f80bf3500003f35,0xbf803f0e3ec4bf7b0000bf553f6dbe48,0x80003f6dbf35bec4bf803ec43f35bf6d,0x3f80be48bf6d3f0e00003f7bbec4bf55
.octa 0x00000000000000000000000000000000,0x00000000000000000000000000000000,0x00000000000000000000000000000000,0x00000000000000000000000000000000
.octa 0x80008000800080003f80bf803f80bf80,0xbf353f55bf6d3f7bbf353f0ebec43e48,0x3f80bf6d3f35bec400003ec4bf353f6d,0xbf353e483ec4bf553f35bf7b3f6dbf0e
.octa 0x00000000000000000000000000000000,0x00000000000000000000000000000000,0x00000000000000000000000000000000,0x00000000000000000000000000000000
.octa 0x80003f35bf803f35bf803f350000bf35,0x3f35bf7b3ec43f0e3f353e48bf6d3f55,0xbf803ec43f35bf6d0000bf6d3f353ec4,0x3f353f0ebf6dbe48bf353f553ec4bf7b
.octa 0x00000000000000000000000000000000,0x00000000000000000000000000000000,0x00000000000000000000000000000000,0x00000000000000000000000000000000
.octa 0x80008000800080003f80bf803f80bf80,0x80003e48bec43f0ebf803f7bbf6d3f55,0x8000bec43f35bf6d3f80bf6d3f35bec4,0x80003f0ebf6d3f7bbf803f55bec4be48
.octa 0x00000000000000000000000000000000,0x00000000000000000000000000000000,0x00000000000000000000000000000000,0x00000000000000000000000000000000
.octa 0x8000bf353f80bf353f80bf3500003f35,0x80003f55bf6d3e48bf803f0e3ec4bf7b,0x8000bf6d3f353ec43f80bec4bf353f6d,0x80003f7bbec4bf55bf803e483f6dbf0e
.octa 0xbf753e953f75be95be95bf753e953f75,0xbf203f253f60be9bbf48bf443ef73f74,0xbd973f653f42bea1bf7fbee63f273f73,0x3f013f803f1bbea7bf5dbd7b3f4c3f72
.octa 0xbe95bf753e953f753f75be95bf753e95,0xbf48bf443ef73f743f20bf25bf603e9b,0xbf7fbee63f273f733d97bf65bf423ea1,0xbf5dbd7b3f4c3f72bf01bf80bf1b3ea7
.octa 0x3f673f713edbbeacbedb3eac3f673f71,0x3f7d3f3c3e6dbeb23e233f2e3f793f70,0x3f393ecf3cc9beb83f313f6a3f803f6f,0x3e543c49be3bbebe3f7a3f803f7c3f6e
.octa 0xbedb3eac3f673f71bf67bf71bedb3eac,0x3e233f2e3f793f70bf7dbf3cbe6d3eb2,0x3f313f6a3f803f6fbf39becfbcc93eb8,0x3f7a3f803f7c3f6ebe54bc493e3b3ebe
.octa 0xbf753e953f75be95be95bf753e953f75,0x3de23f7f3e8fbf63bf7ebdb03f763eec,0x3f7f3ee6bf27bf73bd973f653f42bea1,0x3e82bf2abf7ebee13f783f40be0abf66
.octa 0xbe95bf753e953f753f75be95bf753e95,0xbf7ebdb03f763eecbde2bf7fbe8f3f63,0xbd973f653f42bea1bf7fbee63f273f73,0x3f783f40be0abf66be823f2a3f7e3ee1
.octa 0xbf67bf71bedb3eac3edbbeacbf67bf71,0xbf16bd173f063f69bf4fbf80bf5abed5,0x3f313f6a3f803f6fbf39becfbcc93eb8,0x3f573f373f113eca3f0c3f333f533f6b
.octa 0x3edbbeacbf67bf713f673f713edbbeac,0xbf4fbf80bf5abed53f163d17bf06bf69,0xbf39becfbcc93eb8bf31bf6abf80bf6f,0x3f0c3f333f533f6bbf57bf37bf11beca
.octa 0xbf753e953f75be95be95bf753e953f75,0x3f483f44bef7bf74bf203f253f60be9b,0x3d97bf65bf423ea13f7f3ee6bf27bf73,0xbf5dbd7b3f4c3f72bf01bf80bf1b3ea7
.octa 0xbe95bf753e953f753f75be95bf753e95,0xbf203f253f60be9bbf48bf443ef73f74,0x3f7f3ee6bf27bf73bd973f653f42bea1,0xbf01bf80bf1b3ea73f5d3d7bbf4cbf72
.octa 0x3f673f713edbbeacbedb3eac3f673f71,0xbe23bf2ebf79bf703f7d3f3c3e6dbeb2,0xbf39becfbcc93eb8bf31bf6abf80bf6f,0x3f7a3f803f7c3f6ebe54bc493e3b3ebe
.octa 0xbedb3eac3f673f71bf67bf71bedb3eac,0x3f7d3f3c3e6dbeb23e233f2e3f793f70,0xbf31bf6abf80bf6f3f393ecf3cc9beb8,0xbe54bc493e3b3ebebf7abf80bf7cbf6e
.octa 0xbf753e953f75be95be95bf753e953f75,0x3f7e3db0bf76beec3de23f7f3e8fbf63,0xbf7fbee63f273f733d97bf65bf423ea1,0x3f783f40be0abf66be823f2a3f7e3ee1
.octa 0xbe95bf753e953f753f75be95bf753e95,0x3de23f7f3e8fbf63bf7ebdb03f763eec,0x3d97bf65bf423ea13f7f3ee6bf27bf73,0xbe823f2a3f7e3ee1bf78bf403e0a3f66
.octa 0xbf67bf71bedb3eac3edbbeacbf67bf71,0x3f4f3f803f5a3ed5bf16bd173f063f69,0xbf31bf6abf80bf6f3f393ecf3cc9beb8,0x3f0c3f333f533f6bbf57bf37bf11beca
.octa 0x3edbbeacbf67bf713f673f713edbbeac,0xbf16bd173f063f69bf4fbf80bf5abed5,0x3f393ecf3cc9beb83f313f6a3f803f6f,0xbf57bf37bf11becabf0cbf33bf53bf6b
.octa 0xbf553f0e3f55bf0ebf0ebf553f0e3f55,0xbeb83f583f31bf13bf6fbf093f393f51,0x3e793f7d3f04bf18bf78be163f5c3f4e,0x3f423f773ea1bf1dbf273e893f733f4a
.octa 0xbf0ebf553f0e3f553f55bf0ebf553f0e,0xbf6fbf093f393f513eb8bf58bf313f13,0xbf78be163f5c3f4ebe79bf7dbf043f18,0xbf273e893f733f4abf42bf77bea13f1d
.octa 0x3f7f3f463dc9bf22bdc93f223f7f3f46,0x3f5f3ee6bdfbbf273efc3f653f7e3f42,0x3edb3d49beacbf2c3f673f803f713f3e,0xbe2fbeb8bf09bf313f7c3f6f3f583f39
.octa 0xbdc93f223f7f3f46bf7fbf46bdc93f22,0x3efc3f653f7e3f42bf5fbee63dfb3f27,0x3f673f803f713f3ebedbbd493eac3f2c,0x3f7c3f6f3f583f393e2f3eb83f093f31
.octa 0xbf553f0e3f55bf0ebf0ebf553f0e3f55,0x3ecf3f7abcc9bf7cbf6a3e603f803e2f,0x3f783e16bf5cbf4e3e793f7d3f04bf18,0xbd97bf5fbf65bdfb3f7f3efcbee6bf7e
.octa 0xbf0ebf553f0e3f553f55bf0ebf553f0e,0xbf6a3e603f803e2fbecfbf7a3cc93f7c,0x3e793f7d3f04bf18bf78be163f5c3f4e,0x3f7f3efcbee6bf7e3d973f5f3f653dfb
.octa 0xbf7fbf46bdc93f223dc9bf22bf7fbf46,0xbe893ea13f4a3f7fbf77bf73bf1dbd97,0x3f673f803f713f3ebedbbd493eac3f2c,0x3f133ecf3e603cc93f513f6a3f7a3f80
.octa 0x3dc9bf22bf7fbf463f7f3f463dc9bf22,0xbf77bf73bf1dbd973e89bea1bf4abf7f,0xbedbbd493eac3f2cbf67bf80bf71bf3e,0x3f513f6a3f7a3f80bf13becfbe60bcc9
.octa 0xbf553f0e3f55bf0ebf0ebf553f0e3f55,0x3f6f3f09bf39bf51beb83f583f31bf13,0xbe79bf7dbf043f183f783e16bf5cbf4e,0xbf273e893f733f4abf42bf77bea13f1d
.octa 0xbf0ebf553f0e3f553f55bf0ebf553f0e,0xbeb83f583f31bf13bf6fbf093f393f51,0x3f783e16bf5cbf4e3e793f7d3f04bf18,0xbf42bf77bea13f1d3f27be89bf73bf4a
.octa 0x3f7f3f463dc9bf22bdc93f223f7f3f46,0xbefcbf65bf7ebf423f5f3ee6bdfbbf27,0xbedbbd493eac3f2cbf67bf80bf71bf3e,0x3f7c3f6f3f583f393e2f3eb83f093f31
.octa 0xbdc93f223f7f3f46bf7fbf46bdc93f22,0x3f5f3ee6bdfbbf273efc3f653f7e3f42,0xbf67bf80bf71bf3e3edb3d49beacbf2c,0x3e2f3eb83f093f31bf7cbf6fbf58bf39
.octa 0xbf553f0e3f55bf0ebf0ebf553f0e3f55,0x3f6abe60bf80be2f3ecf3f7abcc9bf7c,0xbf78be163f5c3f4ebe79bf7dbf043f18,0x3f7f3efcbee6bf7e3d973f5f3f653dfb
.octa 0xbf0ebf553f0e3f553f55bf0ebf553f0e,0x3ecf3f7abcc9bf7cbf6a3e603f803e2f,0xbe79bf7dbf043f183f783e16bf5cbf4e,0x3d973f5f3f653dfbbf7fbefc3ee63f7e
.octa 0xbf7fbf46bdc93f223dc9bf22bf7fbf46,0x3f773f733f1d3d97be893ea13f4a3f7f,0xbf67bf80bf71bf3e3edb3d49beacbf2c,0x3f513f6a3f7a3f80bf13becfbe60bcc9
.octa 0x3dc9bf22bf7fbf463f7f3f463dc9bf22,0xbe893ea13f4a3f7fbf77bf73bf1dbd97,0x3edb3d49beacbf2c3f673f803f713f3e,0xbf13becfbe60bcc9bf51bf6abf7abf80
.octa 0xbf223f463f22bf46bf46bf223f463f22,0xbd7b3f783ee1bf4cbf80be823f663f1b,0x3f093f7c3e60bf51bf583e2f3f7a3f13,0x3f6e3f53bc49bf57bebe3f113f803f0c
.octa 0xbf46bf223f463f223f22bf46bf223f46,0xbf80be823f663f1b3d7bbf78bee13f4c,0xbf583e2f3f7a3f13bf09bf7cbe603f51,0xbebe3f113f803f0cbf6ebf533c493f57
.octa 0x3f783f04be79bf5c3e793f5c3f783f04,0x3f253de2beecbf603f443f7e3f633ef7,0x3d97bea1bf27bf653f7f3f733f423ee6,0xbf06bf2ebf4fbf693f5a3f3c3f163ed5
.octa 0x3e793f5c3f783f04bf78bf043e793f5c,0x3f443f7e3f633ef7bf25bde23eec3f60,0x3f7f3f733f423ee6bd973ea13f273f65,0x3f5a3f3c3f163ed53f063f2e3f4f3f69
.octa 0xbf223f463f22bf46bf46bf223f463f22,0x3f2a3f5dbea7bf7ebf403f013f72be0a,0x3f58be2fbf7abf133f093f7c3e60bf51,0xbecabf7cbf333e543f6b3e3bbf37bf7a
.octa 0xbf46bf223f463f223f22bf46bf223f46,0xbf403f013f72be0abf2abf5d3ea73f7e,0x3f093f7c3e60bf51bf583e2f3f7a3f13,0x3f6b3e3bbf37bf7a3eca3f7c3f33be54
.octa 0xbf78bf043e793f5cbe79bf5cbf78bf04,0x3db03f203f743f76bf7fbf48be9b3e8f,0x3f7f3f733f423ee6bd973ea13f273f65,0x3e6d3d17be23beb23f793f803f7d3f70
.octa 0xbe79bf5cbf78bf043f783f04be79bf5c,0xbf7fbf48be9b3e8fbdb0bf20bf74bf76,0xbd973ea13f273f65bf7fbf73bf42bee6,0x3f793f803f7d3f70be6dbd173e233eb2
.octa 0xbf223f463f22bf46bf46bf223f463f22,0x3f803e82bf66bf1bbd7b3f783ee1bf4c,0xbf09bf7cbe603f513f58be2fbf7abf13,0xbebe3f113f803f0cbf6ebf533c493f57
.octa 0xbf46bf223f463f223f22bf46bf223f46,0xbd7b3f783ee1bf4cbf80be823f663f1b,0x3f58be2fbf7abf133f093f7c3e60bf51,0xbf6ebf533c493f573ebebf11bf80bf0c
.octa 0x3f783f04be79bf5c3e793f5c3f783f04,0xbf44bf7ebf63bef73f253de2beecbf60,0xbd973ea13f273f65bf7fbf73bf42bee6,0x3f5a3f3c3f163ed53f063f2e3f4f3f69
.octa 0x3e793f5c3f783f04bf78bf043e793f5c,0x3f253de2beecbf603f443f7e3f633ef7,0xbf7fbf73bf42bee63d97bea1bf27bf65,0x3f063f2e3f4f3f69bf5abf3cbf16bed5
.octa 0xbf223f463f22bf46bf46bf223f463f22,0x3f40bf01bf723e0a3f2a3f5dbea7bf7e,0xbf583e2f3f7a3f13bf09bf7cbe603f51,0x3f6b3e3bbf37bf7a3eca3f7c3f33be54
.octa 0xbf46bf223f463f223f22bf46bf223f46,0x3f2a3f5dbea7bf7ebf403f013f72be0a,0xbf09bf7cbe603f513f58be2fbf7abf13,0x3eca3f7c3f33be54bf6bbe3b3f373f7a
.octa 0xbf78bf043e793f5cbe79bf5cbf78bf04,0x3f7f3f483e9bbe8f3db03f203f743f76,0xbf7fbf73bf42bee63d97bea1bf27bf65,0x3f793f803f7d3f70be6dbd173e233eb2
.octa 0xbe79bf5cbf78bf043f783f04be79bf5c,0x3db03f203f743f76bf7fbf48be9b3e8f,0x3d97bea1bf27bf653f7f3f733f423ee6,0xbe6dbd173e233eb2bf79bf80bf7dbf70
.octa 0xbec43f6d3ec4bf6dbf6dbec43f6d3ec4,0x3e793f803e16bf71bf783d493f7d3eac,0x3f463f62bdc9bf75bf223ef13f7f3e95,0x3f803f18beacbf78bd493f4e3f713e79
.octa 0xbf6dbec43f6d3ec43ec4bf6dbec43f6d,0xbf783d493f7d3eacbe79bf80be163f71,0xbf223ef13f7f3e95bf46bf623dc93f75,0xbd493f4e3f713e79bf80bf183eac3f78
.octa 0x3f553e48bf0ebf7b3f0e3f7b3f553e48,0x3eacbe79bf3ebf7d3f713f783f2c3e16,0xbe95bf22bf62bf7f3f753f463ef13dc9,0xbf4ebf67bf78bf803f183edb3e793d49
.octa 0x3f0e3f7b3f553e48bf55be483f0e3f7b,0x3f713f783f2c3e16beac3e793f3e3f7d,0x3f753f463ef13dc93e953f223f623f7f,0x3f183edb3e793d493f4e3f673f783f80
.octa 0xbec43f6d3ec4bf6dbf6dbec43f6d3ec4,0x3f5c3f2cbf18bf67bf043f3e3f4ebedb,0x3f22bef1bf7fbe953f463f62bdc9bf75,0xbf2cbf7dbedb3f043f3ebe16bf67bf5c
.octa 0xbf6dbec43f6d3ec43ec4bf6dbec43f6d,0xbf043f3e3f4ebedbbf5cbf2c3f183f67,0x3f463f62bdc9bf75bf223ef13f7f3e95,0x3f3ebe16bf67bf5c3f2c3f7d3edbbf04
.octa 0xbf55be483f0e3f7bbf0ebf7bbf55be48,0x3edb3f5c3f803f4ebf67bf043d493f18,0x3f753f463ef13dc93e953f223f623f7f,0xbe16beacbf04bf2c3f7d3f713f5c3f3e
.octa 0xbf0ebf7bbf55be483f553e48bf0ebf7b,0xbf67bf043d493f18bedbbf5cbf80bf4e,0x3e953f223f623f7fbf75bf46bef1bdc9,0x3f7d3f713f5c3f3e3e163eac3f043f2c
.octa 0xbec43f6d3ec4bf6dbf6dbec43f6d3ec4,0x3f78bd49bf7dbeac3e793f803e16bf71,0xbf46bf623dc93f753f22bef1bf7fbe95,0xbd493f4e3f713e79bf80bf183eac3f78
.octa 0xbf6dbec43f6d3ec43ec4bf6dbec43f6d,0x3e793f803e16bf71bf783d493f7d3eac,0x3f22bef1bf7fbe953f463f62bdc9bf75,0xbf80bf183eac3f783d49bf4ebf71be79
.octa 0x3f553e48bf0ebf7b3f0e3f7b3f553e48,0xbf71bf78bf2cbe163eacbe79bf3ebf7d,0x3e953f223f623f7fbf75bf46bef1bdc9,0x3f183edb3e793d493f4e3f673f783f80
.octa 0x3f0e3f7b3f553e48bf55be483f0e3f7b,0x3eacbe79bf3ebf7d3f713f783f2c3e16,0xbf75bf46bef1bdc9be95bf22bf62bf7f,0x3f4e3f673f783f80bf18bedbbe79bd49
.octa 0xbec43f6d3ec4bf6dbf6dbec43f6d3ec4,0x3f04bf3ebf4e3edb3f5c3f2cbf18bf67,0xbf223ef13f7f3e95bf46bf623dc93f75,0x3f3ebe16bf67bf5c3f2c3f7d3edbbf04
.octa 0xbf6dbec43f6d3ec43ec4bf6dbec43f6d,0x3f5c3f2cbf18bf67bf043f3e3f4ebedb,0xbf46bf623dc93f753f22bef1bf7fbe95,0x3f2c3f7d3edbbf04bf3e3e163f673f5c
.octa 0xbf55be483f0e3f7bbf0ebf7bbf55be48,0x3f673f04bd49bf183edb3f5c3f803f4e,0xbf75bf46bef1bdc9be95bf22bf62bf7f,0x3f7d3f713f5c3f3e3e163eac3f043f2c
.octa 0xbf0ebf7bbf55be483f553e48bf0ebf7b,0x3edb3f5c3f803f4ebf67bf043d493f18,0xbe95bf22bf62bf7f3f753f463ef13dc9,0x3e163eac3f043f2cbf7dbf71bf5cbf3e
.octa 0xbdc93f7f3dc9bf7fbf7fbdc93f7f3dc9,0x3f063f70be23bf80bf5a3eb23f7d3d17,0x3f6f3f31becfbf80beb83f393f6abcc9,0x3f763e9bbf20bf7f3e8f3f743f48bdb0
.octa 0xbf7fbdc93f7f3dc93dc9bf7fbdc93f7f,0xbf5a3eb23f7d3d17bf06bf703e233f80,0xbeb83f393f6abcc9bf6fbf313ecf3f80,0x3e8f3f743f48bdb0bf76be9b3f203f7f
.octa 0x3f18be16bf4ebf7d3f4e3f7d3f18be16,0xbc49bf11bf6ebf7a3f803f533ebebe54,0xbf1dbf5fbf7ebf773f4a3efc3dfbbe89,0xbf78bf80bf7ebf723e823d7bbe0abea7
.octa 0x3f4e3f7d3f18be16bf183e163f4e3f7d,0x3f803f533ebebe543c493f113f6e3f7a,0x3f4a3efc3dfbbe893f1d3f5f3f7e3f77,0x3e823d7bbe0abea73f783f803f7e3f72
.octa 0xbdc93f7f3dc9bf7fbf7fbdc93f7f3dc9,0x3f793ed5bf4fbf3cbe6d3f693f16bf2e,0x3eb8bf39bf6a3cc93f6f3f31becfbf80,0xbf60bf63bde23f443ef7beecbf7ebf25
.octa 0xbf7fbdc93f7f3dc93dc9bf7fbdc93f7f,0xbe6d3f693f16bf2ebf79bed53f4f3f3c,0x3f6f3f31becfbf80beb83f393f6abcc9,0x3ef7beecbf7ebf253f603f633de2bf44
.octa 0xbf183e163f4e3f7dbf4ebf7dbf183e16,0x3f373f7c3f6b3f0cbf33be3b3eca3f57,0x3f4a3efc3dfbbe893f1d3f5f3f7e3f77,0xbf01bf2abf4cbf663f5d3f403f1b3ee1
.octa 0xbf4ebf7dbf183e163f18be16bf4ebf7d,0xbf33be3b3eca3f57bf37bf7cbf6bbf0c,0x3f1d3f5f3f7e3f77bf4abefcbdfb3e89,0x3f5d3f403f1b3ee13f013f2a3f4c3f66
.octa 0xbdc93f7f3dc9bf7fbf7fbdc93f7f3dc9,0x3f5abeb2bf7dbd173f063f70be23bf80,0xbf6fbf313ecf3f803eb8bf39bf6a3cc9,0x3e8f3f743f48bdb0bf76be9b3f203f7f
.octa 0xbf7fbdc93f7f3dc93dc9bf7fbdc93f7f,0x3f063f70be23bf80bf5a3eb23f7d3d17,0x3eb8bf39bf6a3cc93f6f3f31becfbf80,0xbf76be9b3f203f7fbe8fbf74bf483db0
.octa 0x3f18be16bf4ebf7d3f4e3f7d3f18be16,0xbf80bf53bebe3e54bc49bf11bf6ebf7a,0x3f1d3f5f3f7e3f77bf4abefcbdfb3e89,0x3e823d7bbe0abea73f783f803f7e3f72
.octa 0x3f4e3f7d3f18be16bf183e163f4e3f7d,0xbc49bf11bf6ebf7a3f803f533ebebe54,0xbf4abefcbdfb3e89bf1dbf5fbf7ebf77,0x3f783f803f7e3f72be82bd7b3e0a3ea7
.octa 0xbdc93f7f3dc9bf7fbf7fbdc93f7f3dc9,0x3e6dbf69bf163f2e3f793ed5bf4fbf3c,0xbeb83f393f6abcc9bf6fbf313ecf3f80,0x3ef7beecbf7ebf253f603f633de2bf44
.octa 0xbf7fbdc93f7f3dc93dc9bf7fbdc93f7f,0x3f793ed5bf4fbf3cbe6d3f693f16bf2e,0xbf6fbf313ecf3f803eb8bf39bf6a3cc9,0x3f603f633de2bf44bef73eec3f7e3f25
.octa 0xbf183e163f4e3f7dbf4ebf7dbf183e16,0x3f333e3bbecabf573f373f7c3f6b3f0c,0xbf4abefcbdfb3e89bf1dbf5fbf7ebf77,0x3f5d3f403f1b3ee13f013f2a3f4c3f66
.octa 0xbf4ebf7dbf183e163f18be16bf4ebf7d,0x3f373f7c3f6b3f0cbf33be3b3eca3f57,0xbf1dbf5fbf7ebf773f4a3efc3dfbbe89,0x3f013f2a3f4c3f66bf5dbf40bf1bbee1
.octa 0x3e483f7bbe48bf7bbf7b3e483f7bbe48,0x3f423f4abee6bf77bf273f1d3f65be89,0x3f803edbbf2cbf71bd493f673f3ebeac,0x3f51bcc9bf58bf6a3f133f803f09becf
.octa 0xbf7b3e483f7bbe48be48bf7b3e483f7b,0xbf273f1d3f65be89bf42bf4a3ee63f77,0xbd493f673f3ebeacbf80bedb3f2c3f71,0x3f133f803f09becfbf513cc93f583f6a
.octa 0x3e95bef1bf75bf623f753f623e95bef1,0xbeb8bf51bf80bf583f6f3f133cc9bf09,0xbf5cbf7dbf78bf4e3f043e16be79bf18,0xbf7ebf73bf5fbf42bdfbbea1befcbf27
.octa 0x3f753f623e95bef1be953ef13f753f62,0x3f6f3f133cc9bf093eb83f513f803f58,0x3f043e16be79bf183f5c3f7d3f783f4e,0xbdfbbea1befcbf273f7e3f733f5f3f42
.octa 0x3e483f7bbe48bf7bbf7b3e483f7bbe48,0x3f7f3dfbbf73befc3d973f7e3ea1bf5f,0x3d49bf67bf3e3eac3f803edbbf2cbf71,0xbf7cbf313e603f6f3e2fbf39bf7abeb8
.octa 0xbf7b3e483f7bbe48be48bf7b3e483f7b,0x3d973f7e3ea1bf5fbf7fbdfb3f733efc,0x3f803edbbf2cbf71bd493f673f3ebeac,0x3e2fbf39bf7abeb83f7c3f31be60bf6f
.octa 0xbe953ef13f753f62bf75bf62be953ef1,0x3f6a3f7c3f393e60becf3e2f3f313f7a,0x3f043e16be79bf183f5c3f7d3f783f4e,0xbf4abf65bf77bf7f3f1d3ee63e893d97
.octa 0xbf75bf62be953ef13e95bef1bf75bf62,0xbecf3e2f3f313f7abf6abf7cbf39be60,0x3f5c3f7d3f783f4ebf04be163e793f18,0x3f1d3ee63e893d973f4a3f653f773f7f
.octa 0x3e483f7bbe48bf7bbf7b3e483f7bbe48,0x3f27bf1dbf653e893f423f4abee6bf77,0xbf80bedb3f2c3f713d49bf67bf3e3eac,0x3f133f803f09becfbf513cc93f583f6a
.octa 0xbf7b3e483f7bbe48be48bf7b3e483f7b,0x3f423f4abee6bf77bf273f1d3f65be89,0x3d49bf67bf3e3eac3f803edbbf2cbf71,0xbf513cc93f583f6abf13bf80bf093ecf
.octa 0x3e95bef1bf75bf623f753f623e95bef1,0xbf6fbf13bcc93f09beb8bf51bf80bf58,0x3f5c3f7d3f783f4ebf04be163e793f18,0xbdfbbea1befcbf273f7e3f733f5f3f42
.octa 0x3f753f623e95bef1be953ef13f753f62,0xbeb8bf51bf80bf583f6f3f133cc9bf09,0xbf04be163e793f18bf5cbf7dbf78bf4e,0x3f7e3f733f5f3f423dfb3ea13efc3f27
.octa 0x3e483f7bbe48bf7bbf7b3e483f7bbe48,0xbd97bf7ebea13f5f3f7f3dfbbf73befc,0xbd493f673f3ebeacbf80bedb3f2c3f71,0x3e2fbf39bf7abeb83f7c3f31be60bf6f
.octa 0xbf7b3e483f7bbe48be48bf7b3e483f7b,0x3f7f3dfbbf73befc3d973f7e3ea1bf5f,0xbf80bedb3f2c3f713d49bf67bf3e3eac,0x3f7c3f31be60bf6fbe2f3f393f7a3eb8
.octa 0xbe953ef13f753f62bf75bf62be953ef1,0x3ecfbe2fbf31bf7a3f6a3f7c3f393e60,0xbf04be163e793f18bf5cbf7dbf78bf4e,0x3f1d3ee63e893d973f4a3f653f773f7f
.octa 0xbf75bf62be953ef13e95bef1bf75bf62,0x3f6a3f7c3f393e60becf3e2f3f313f7a,0xbf5cbf7dbf78bf4e3f043e16be79bf18,0x3f4a3f653f773f7fbf1dbee6be89bd97
.octa 0x3ef13f62bef1bf62bf623ef13f62bef1,0x3f6b3f11bf33bf57beca3f533f37bf0c,0x3f773dfbbf5fbf4a3e893f7e3efcbf1d,0x3f16beb2bf79bf3c3f4f3f703e6dbf2e
.octa 0xbf623ef13f62bef1bef1bf623ef13f62,0xbeca3f533f37bf0cbf6bbf113f333f57,0x3e893f7e3efcbf1dbf77bdfb3f5f3f4a,0x3f4f3f703e6dbf2ebf163eb23f793f3c
.octa 0xbd49bf3ebf80bf2c3f803f2cbd49bf3e,0xbf2abf78bf72bf1b3f403e82bea7bf4c,0xbf7cbf7abf51bf093e2fbe60bf13bf58,0xbf60bf44bf20beecbef7bf25bf48bf63
.octa 0x3f803f2cbd49bf3e3d493f3e3f803f2c,0x3f403e82bea7bf4c3f2a3f783f723f1b,0x3e2fbe60bf13bf583f7c3f7a3f513f09,0xbef7bf25bf48bf633f603f443f203eec
.octa 0x3ef13f62bef1bf62bf623ef13f62bef1,0x3f6ebe3bbf80be543ebe3f7c3c49bf7a,0xbe89bf7ebefc3f1d3f773dfbbf5fbf4a,0xbf7dbed53f063f80be23bf69bf5abd17
.octa 0xbf623ef13f62bef1bef1bf623ef13f62,0x3ebe3f7c3c49bf7abf6e3e3b3f803e54,0x3f773dfbbf5fbf4a3e893f7e3efcbf1d,0xbe23bf69bf5abd173f7d3ed5bf06bf80
.octa 0x3d493f3e3f803f2cbf80bf2c3d493f3e,0x3f803f5d3ee1be0abd7b3f013f663f7e,0x3e2fbe60bf13bf583f7c3f7a3f513f09,0xbf76bf7fbf7ebf743e8f3db0bde2be9b
.octa 0xbf80bf2c3d493f3ebd49bf3ebf80bf2c,0xbd7b3f013f663f7ebf80bf5dbee13e0a,0x3f7c3f7a3f513f09be2f3e603f133f58,0x3e8f3db0bde2be9b3f763f7f3f7e3f74
.octa 0x3ef13f62bef1bf62bf623ef13f62bef1,0x3ecabf53bf373f0c3f6b3f11bf33bf57,0xbf77bdfb3f5f3f4abe89bf7ebefc3f1d,0x3f4f3f703e6dbf2ebf163eb23f793f3c
.octa 0xbf623ef13f62bef1bef1bf623ef13f62,0x3f6b3f11bf33bf57beca3f533f37bf0c,0xbe89bf7ebefc3f1d3f773dfbbf5fbf4a,0xbf163eb23f793f3cbf4fbf70be6d3f2e
.octa 0xbd49bf3ebf80bf2c3f803f2cbd49bf3e,0xbf40be823ea73f4cbf2abf78bf72bf1b,0x3f7c3f7a3f513f09be2f3e603f133f58,0xbef7bf25bf48bf633f603f443f203eec
.octa 0x3f803f2cbd49bf3e3d493f3e3f803f2c,0xbf2abf78bf72bf1b3f403e82bea7bf4c,0xbe2f3e603f133f58bf7cbf7abf51bf09,0x3f603f443f203eec3ef73f253f483f63
.octa 0x3ef13f62bef1bf62bf623ef13f62bef1,0xbebebf7cbc493f7a3f6ebe3bbf80be54,0x3e893f7e3efcbf1dbf77bdfb3f5f3f4a,0xbe23bf69bf5abd173f7d3ed5bf06bf80
.octa 0xbf623ef13f62bef1bef1bf623ef13f62,0x3f6ebe3bbf80be543ebe3f7c3c49bf7a,0xbf77bdfb3f5f3f4abe89bf7ebefc3f1d,0x3f7d3ed5bf06bf803e233f693f5a3d17
.octa 0x3d493f3e3f803f2cbf80bf2c3d493f3e,0x3d7bbf01bf66bf7e3f803f5d3ee1be0a,0xbe2f3e603f133f58bf7cbf7abf51bf09,0x3e8f3db0bde2be9b3f763f7f3f7e3f74
.octa 0xbf80bf2c3d493f3ebd49bf3ebf80bf2c,0x3f803f5d3ee1be0abd7b3f013f663f7e,0xbf7cbf7abf51bf093e2fbe60bf13bf58,0x3f763f7f3f7e3f74be8fbdb03de23e9b
.octa 0x3f353f35bf35bf35bf353f353f35bf35,0x3f7f3e95bf62bf22bdc93f753ef1bf46,0x3f55be48bf7bbf0e3f0e3f7b3e48bf55,0x3e95bf22bf7fbef13f753f46bdc9bf62
.octa 0x00000000000000000000000000000000,0x00000000000000000000000000000000,0x00000000000000000000000000000000,0x00000000000000000000000000000000
.octa 0xbec4bf6dbf6dbec43f6d3ec4bec4bf6d,0xbf62bf7fbf46be953ef1bdc9bf22bf75,0xbf7bbf55bf0ebe48be48bf0ebf55bf7b,0xbf22bef1be95bdc9bf46bf62bf75bf7f
.octa 0x00000000000000000000000000000000,0x00000000000000000000000000000000,0x00000000000000000000000000000000,0x00000000000000000000000000000000
.octa 0x3f353f35bf35bf35bf353f353f35bf35,0x3f46bef1bf753dc93f223f62be95bf7f,0xbf0ebf7bbe483f553f55be48bf7bbf0e,0xbf62bdc93f463f75bef1bf7fbf223e95
.octa 0x00000000000000000000000000000000,0x00000000000000000000000000000000,0x00000000000000000000000000000000,0x00000000000000000000000000000000
.octa 0x3ec43f6d3f6d3ec4bf6dbec43ec43f6d,0x3f753f223dc9bef13e953f463f7f3f62,0xbe48bf0ebf55bf7b3f7b3f553f0e3e48,0xbf7fbf75bf62bf46bdc9be95bef1bf22
.octa 0x00000000000000000000000000000000,0x00000000000000000000000000000000,0x00000000000000000000000000000000,0x00000000000000000000000000000000
.octa 0x3f353f35bf35bf35bf353f353f35bf35,0x3dc9bf75bef13f463f7f3e95bf62bf22,0xbf553e483f7b3f0ebf0ebf7bbe483f55,0x3f753f46bdc9bf62be953f223f7f3ef1
.octa 0x00000000000000000000000000000000,0x00000000000000000000000000000000,0x00000000000000000000000000000000,0x00000000000000000000000000000000
.octa 0xbec4bf6dbf6dbec43f6d3ec4bec4bf6d,0xbef13dc93f223f75bf62bf7fbf46be95,0x3f7b3f553f0e3e483e483f0e3f553f7b,0xbf46bf62bf75bf7f3f223ef13e953dc9
.octa 0x00000000000000000000000000000000,0x00000000000000000000000000000000,0x00000000000000000000000000000000,0x00000000000000000000000000000000
.octa 0x3f353f35bf35bf35bf353f353f35bf35,0xbf22bf623e953f7f3f46bef1bf753dc9,0x3f0e3f7b3e48bf55bf553e483f7b3f0e,0xbef1bf7fbf223e953f623dc9bf46bf75
.octa 0x00000000000000000000000000000000,0x00000000000000000000000000000000,0x00000000000000000000000000000000,0x00000000000000000000000000000000
.octa 0x3ec43f6d3f6d3ec4bf6dbec43ec43f6d,0xbe95bf46bf7fbf623f753f223dc9bef1,0x3e483f0e3f553f7bbf7bbf55bf0ebe48,0xbdc9be95bef1bf223f7f3f753f623f46
.octa 0x00000000000000000000000000000000,0x00000000000000000000000000000000,0x00000000000000000000000000000000,0x00000000000000000000000000000000
.octa 0x3f623ef1bf62bef1bef13f623ef1bf62,0x3f7abc49bf7cbebe3e543f803e3bbf6e,0x3f1dbefcbf7ebe893f4a3f5fbdfbbf77,0xbd17bf5abf69be233f803f06bed5bf7d
.octa 0x3ef1bf62bef13f623f623ef1bf62bef1,0xbe54bf80be3b3f6e3f7abc49bf7cbebe,0xbf4abf5f3dfb3f773f1dbefcbf7ebe89,0xbf80bf063ed53f7dbd17bf5abf69be23
.octa 0xbf2cbf80bf3ebd493f3e3d49bf2cbf80,0xbf7ebf66bf013d7b3e0abee1bf5dbf80,0xbf58bf13be603e2fbf09bf51bf7abf7c,0xbe9bbde23db03e8fbf74bf7ebf7fbf76
.octa 0xbf3ebd493f2c3f80bf2cbf80bf3ebd49,0xbe0a3ee13f5d3f80bf7ebf66bf013d7b,0x3f093f513f7a3f7cbf58bf13be603e2f,0x3f743f7e3f7f3f76be9bbde23db03e8f
.octa 0x3f623ef1bf62bef1bef13f623ef1bf62,0x3f0cbf37bf533eca3f573f33bf11bf6b,0xbf4abf5f3dfb3f773f1dbefcbf7ebe89,0xbf2e3e6d3f703f4fbf3cbf79beb23f16
.octa 0x3ef1bf62bef13f623f623ef1bf62bef1,0xbf57bf333f113f6b3f0cbf37bf533eca,0xbf1d3efc3f7e3e89bf4abf5f3dfb3f77,0x3f3c3f793eb2bf16bf2e3e6d3f703f4f
.octa 0x3f2c3f803f3e3d49bf3ebd493f2c3f80,0x3f4c3ea7be82bf403f1b3f723f783f2a,0xbf09bf51bf7abf7c3f583f133e60be2f,0xbf63bf48bf25bef7beecbf20bf44bf60
.octa 0x3f3e3d49bf2cbf803f2c3f803f3e3d49,0xbf1bbf72bf78bf2a3f4c3ea7be82bf40,0xbf58bf13be603e2fbf09bf51bf7abf7c,0x3eec3f203f443f60bf63bf48bf25bef7
.octa 0x3f623ef1bf62bef1bef13f623ef1bf62,0xbe54bf80be3b3f6e3f7abc49bf7cbebe,0xbf1d3efc3f7e3e89bf4abf5f3dfb3f77,0x3f803f06bed5bf7d3d173f5a3f693e23
.octa 0x3ef1bf62bef13f623f623ef1bf62bef1,0xbf7a3c493f7c3ebebe54bf80be3b3f6e,0x3f4a3f5fbdfbbf77bf1d3efc3f7e3e89,0xbd17bf5abf69be233f803f06bed5bf7d
.octa 0xbf2cbf80bf3ebd493f3e3d49bf2cbf80,0xbe0a3ee13f5d3f80bf7ebf66bf013d7b,0x3f583f133e60be2f3f093f513f7a3f7c,0xbf74bf7ebf7fbf763e9b3de2bdb0be8f
.octa 0xbf3ebd493f2c3f80bf2cbf80bf3ebd49,0x3f7e3f663f01bd7bbe0a3ee13f5d3f80,0xbf09bf51bf7abf7c3f583f133e60be2f,0xbe9bbde23db03e8fbf74bf7ebf7fbf76
.octa 0x3f623ef1bf62bef1bef13f623ef1bf62,0xbf57bf333f113f6b3f0cbf37bf533eca,0x3f4a3f5fbdfbbf77bf1d3efc3f7e3e89,0xbf3cbf79beb23f163f2ebe6dbf70bf4f
.octa 0x3ef1bf62bef13f623f623ef1bf62bef1,0xbf0c3f373f53becabf57bf333f113f6b,0x3f1dbefcbf7ebe893f4a3f5fbdfbbf77,0xbf2e3e6d3f703f4fbf3cbf79beb23f16
.octa 0x3f2c3f803f3e3d49bf3ebd493f2c3f80,0xbf1bbf72bf78bf2a3f4c3ea7be82bf40,0x3f093f513f7a3f7cbf58bf13be603e2f,0xbeecbf20bf44bf603f633f483f253ef7
.octa 0x3f3e3d49bf2cbf803f2c3f803f3e3d49,0xbf4cbea73e823f40bf1bbf72bf78bf2a,0x3f583f133e60be2f3f093f513f7a3f7c,0xbf63bf48bf25bef7beecbf20bf44bf60
.octa 0x3f7b3e48bf7bbe48be483f7b3e48bf7b,0x3f5fbea1bf7ebd973efc3f73bdfbbf7f,0x3eacbf3ebf673d493f713f2cbedbbf80,0xbeb8bf7abf393e2f3f6f3e60bf31bf7c
.octa 0x3e48bf7bbe483f7b3f7b3e48bf7bbe48,0xbefcbf733dfb3f7f3f5fbea1bf7ebd97,0xbf71bf2c3edb3f803eacbf3ebf673d49,0xbf6fbe603f313f7cbeb8bf7abf393e2f
.octa 0xbf62bf75bef13e953ef1be95bf62bf75,0xbf7abf31be2f3ecfbe60bf39bf7cbf6a,0xbf18be793e163f04bf4ebf78bf7dbf5c,0x3d973e893ee63f1dbf7fbf77bf65bf4a
.octa 0xbef13e953f623f75bf62bf75bef13e95,0x3e603f393f7c3f6abf7abf31be2f3ecf,0x3f4e3f783f7d3f5cbf18be793e163f04,0x3f7f3f773f653f4a3d973e893ee63f1d
.octa 0x3f7b3e48bf7bbe48be483f7b3e48bf7b,0x3e89bf65bf1d3f273f773ee6bf4abf42,0xbf71bf2c3edb3f803eacbf3ebf673d49,0xbecf3f093f803f13bf6abf58bcc93f51
.octa 0x3e48bf7bbe483f7b3f7b3e48bf7bbe48,0xbf77bee63f4a3f423e89bf65bf1d3f27,0xbeac3f3e3f67bd49bf71bf2c3edb3f80,0x3f6a3f583cc9bf51becf3f093f803f13
.octa 0x3f623f753ef1be95bef13e953f623f75,0x3f09bcc9bf13bf6f3f583f803f513eb8,0xbf4ebf78bf7dbf5c3f183e79be16bf04,0xbf27befcbea1bdfbbf42bf5fbf73bf7e
.octa 0x3ef1be95bf62bf753f623f753ef1be95,0xbf58bf80bf51beb83f09bcc9bf13bf6f,0xbf18be793e163f04bf4ebf78bf7dbf5c,0x3f423f5f3f733f7ebf27befcbea1bdfb
.octa 0x3f7b3e48bf7bbe48be483f7b3e48bf7b,0xbefcbf733dfb3f7f3f5fbea1bf7ebd97,0xbeac3f3e3f67bd49bf71bf2c3edb3f80,0x3f6f3e60bf31bf7c3eb83f7a3f39be2f
.octa 0x3e48bf7bbe483f7b3f7b3e48bf7bbe48,0xbf5f3ea13f7e3d97befcbf733dfb3f7f,0x3f713f2cbedbbf80beac3f3e3f67bd49,0xbeb8bf7abf393e2f3f6f3e60bf31bf7c
.octa 0xbf62bf75bef13e953ef1be95bf62bf75,0x3e603f393f7c3f6abf7abf31be2f3ecf,0x3f183e79be16bf043f4e3f783f7d3f5c,0xbf7fbf77bf65bf4abd97be89bee6bf1d
.octa 0xbef13e953f623f75bf62bf75bef13e95,0x3f7a3f313e2fbecf3e603f393f7c3f6a,0xbf4ebf78bf7dbf5c3f183e79be16bf04,0x3d973e893ee63f1dbf7fbf77bf65bf4a
.octa 0x3f7b3e48bf7bbe48be483f7b3e48bf7b,0xbf77bee63f4a3f423e89bf65bf1d3f27,0x3f713f2cbedbbf80beac3f3e3f67bd49,0xbf6abf58bcc93f513ecfbf09bf80bf13
.octa 0x3e48bf7bbe483f7b3f7b3e48bf7bbe48,0xbe893f653f1dbf27bf77bee63f4a3f42,0x3eacbf3ebf673d493f713f2cbedbbf80,0xbecf3f093f803f13bf6abf58bcc93f51
.octa 0x3f623f753ef1be95bef13e953f623f75,0xbf58bf80bf51beb83f09bcc9bf13bf6f,0x3f4e3f783f7d3f5cbf18be793e163f04,0xbf42bf5fbf73bf7e3f273efc3ea13dfb
.octa 0x3ef1be95bf62bf753f623f753ef1be95,0xbf093cc93f133f6fbf58bf80bf51beb8,0x3f183e79be16bf043f4e3f783f7d3f5c,0xbf27befcbea1bdfbbf42bf5fbf73bf7e
.octa 0x3f7fbdc9bf7f3dc93dc93f7fbdc9bf7f,0x3f2ebf16bf693e6d3f3c3f4fbed5bf79,0x3cc9bf6abf393eb83f803ecfbf31bf6f,0xbf25bf7ebeec3ef73f44bde2bf63bf60
.octa 0xbdc9bf7f3dc93f7f3f7fbdc9bf7f3dc9,0xbf3cbf4f3ed53f793f2ebf16bf693e6d,0xbf80becf3f313f6f3cc9bf6abf393eb8,0xbf443de23f633f60bf25bf7ebeec3ef7
.octa 0xbf7dbf4ebe163f183e16bf18bf7dbf4e,0xbf57beca3e3b3f33bf0cbf6bbf7cbf37,0xbe893dfb3efc3f4abf77bf7ebf5fbf1d,0x3ee13f1b3f403f5dbf66bf4cbf2abf01
.octa 0xbe163f183f7d3f4ebf7dbf4ebe163f18,0x3f0c3f6b3f7c3f37bf57beca3e3b3f33,0x3f773f7e3f5f3f1dbe893dfb3efc3f4a,0x3f663f4c3f2a3f013ee13f1b3f403f5d
.octa 0x3f7fbdc9bf7f3dc93dc93f7fbdc9bf7f,0xbd17bf7dbeb23f5a3f803e23bf70bf06,0xbf80becf3f313f6f3cc9bf6abf393eb8,0xbdb03f483f743e8fbf7fbf203e9b3f76
.octa 0xbdc9bf7f3dc93f7f3f7fbdc9bf7f3dc9,0xbf80be233f703f06bd17bf7dbeb23f5a,0xbcc93f6a3f39beb8bf80becf3f313f6f,0x3f7f3f20be9bbf76bdb03f483f743e8f
.octa 0x3f7d3f4e3e16bf18be163f183f7d3f4e,0x3e54bebebf53bf803f7a3f6e3f113c49,0xbf77bf7ebf5fbf1d3e89bdfbbefcbf4a,0xbea7be0a3d7b3e82bf72bf7ebf80bf78
.octa 0x3e16bf18bf7dbf4e3f7d3f4e3e16bf18,0xbf7abf6ebf11bc493e54bebebf53bf80,0xbe893dfb3efc3f4abf77bf7ebf5fbf1d,0x3f723f7e3f803f78bea7be0a3d7b3e82
.octa 0x3f7fbdc9bf7f3dc93dc93f7fbdc9bf7f,0xbf3cbf4f3ed53f793f2ebf16bf693e6d,0xbcc93f6a3f39beb8bf80becf3f313f6f,0x3f44bde2bf63bf603f253f7e3eecbef7
.octa 0xbdc9bf7f3dc93f7f3f7fbdc9bf7f3dc9,0xbf2e3f163f69be6dbf3cbf4f3ed53f79,0x3f803ecfbf31bf6fbcc93f6a3f39beb8,0xbf25bf7ebeec3ef73f44bde2bf63bf60
.octa 0xbf7dbf4ebe163f183e16bf18bf7dbf4e,0x3f0c3f6b3f7c3f37bf57beca3e3b3f33,0x3e89bdfbbefcbf4a3f773f7e3f5f3f1d,0xbf66bf4cbf2abf01bee1bf1bbf40bf5d
.octa 0xbe163f183f7d3f4ebf7dbf4ebe163f18,0x3f573ecabe3bbf333f0c3f6b3f7c3f37,0xbf77bf7ebf5fbf1d3e89bdfbbefcbf4a,0x3ee13f1b3f403f5dbf66bf4cbf2abf01
.octa 0x3f7fbdc9bf7f3dc93dc93f7fbdc9bf7f,0xbf80be233f703f06bd17bf7dbeb23f5a,0x3f803ecfbf31bf6fbcc93f6a3f39beb8,0xbf7fbf203e9b3f763db0bf48bf74be8f
.octa 0xbdc9bf7f3dc93f7f3f7fbdc9bf7f3dc9,0x3d173f7d3eb2bf5abf80be233f703f06,0x3cc9bf6abf393eb83f803ecfbf31bf6f,0xbdb03f483f743e8fbf7fbf203e9b3f76
.octa 0x3f7d3f4e3e16bf18be163f183f7d3f4e,0xbf7abf6ebf11bc493e54bebebf53bf80,0x3f773f7e3f5f3f1dbe893dfb3efc3f4a,0xbf72bf7ebf80bf783ea73e0abd7bbe82
.octa 0x3e16bf18bf7dbf4e3f7d3f4e3e16bf18,0xbe543ebe3f533f80bf7abf6ebf11bc49,0x3e89bdfbbefcbf4a3f773f7e3f5f3f1d,0xbea7be0a3d7b3e82bf72bf7ebf80bf78
.octa 0x3f6dbec4bf6d3ec43ec43f6dbec4bf6d,0x3edbbf4ebf3e3f043f673f18bf2cbf5c,0xbe95bf7fbef13f223f753dc9bf62bf46,0xbf5cbf67be163f3e3f04bedbbf7dbf2c
.octa 0xbec4bf6d3ec43f6d3f6dbec4bf6d3ec4,0xbf67bf183f2c3f5c3edbbf4ebf3e3f04,0xbf75bdc93f623f46be95bf7fbef13f22,0xbf043edb3f7d3f2cbf5cbf67be163f3e
.octa 0xbf7bbf0e3e483f55be48bf55bf7bbf0e,0xbf18bd493f043f67bf4ebf80bf5cbedb,0x3dc93ef13f463f75bf7fbf62bf22be95,0x3f3e3f5c3f713f7dbf2cbf04beacbe16
.octa 0x3e483f553f7b3f0ebf7bbf0e3e483f55,0x3f4e3f803f5c3edbbf18bd493f043f67,0x3f7f3f623f223e953dc93ef13f463f75,0x3f2c3f043eac3e163f3e3f5c3f713f7d
.octa 0x3f6dbec4bf6d3ec43ec43f6dbec4bf6d,0xbeacbf7dbd493f783f71be16bf80be79,0xbf75bdc93f623f46be95bf7fbef13f22,0x3e793f713f4ebd49bf78beac3f183f80
.octa 0xbec4bf6d3ec43f6d3f6dbec4bf6d3ec4,0xbf713e163f803e79beacbf7dbd493f78,0x3e953f7f3ef1bf22bf75bdc93f623f46,0x3f783eacbf18bf803e793f713f4ebd49
.octa 0x3f7b3f0ebe48bf553e483f553f7b3f0e,0xbe16bf2cbf78bf713f7d3f3e3e79beac,0xbf7fbf62bf22be95bdc9bef1bf46bf75,0x3d493e793edb3f18bf80bf78bf67bf4e
.octa 0xbe48bf55bf7bbf0e3f7b3f0ebe48bf55,0xbf7dbf3ebe793eacbe16bf2cbf78bf71,0x3dc93ef13f463f75bf7fbf62bf22be95,0x3f803f783f673f4e3d493e793edb3f18
.octa 0x3f6dbec4bf6d3ec43ec43f6dbec4bf6d,0xbf67bf183f2c3f5c3edbbf4ebf3e3f04,0x3e953f7f3ef1bf22bf75bdc93f623f46,0x3f04bedbbf7dbf2c3f5c3f673e16bf3e
.octa 0xbec4bf6d3ec43f6d3f6dbec4bf6d3ec4,0xbedb3f4e3f3ebf04bf67bf183f2c3f5c,0x3f753dc9bf62bf463e953f7f3ef1bf22,0xbf5cbf67be163f3e3f04bedbbf7dbf2c
.octa 0xbf7bbf0e3e483f55be48bf55bf7bbf0e,0x3f4e3f803f5c3edbbf18bd493f043f67,0xbdc9bef1bf46bf753f7f3f623f223e95,0xbf2cbf04beacbe16bf3ebf5cbf71bf7d
.octa 0x3e483f553f7b3f0ebf7bbf0e3e483f55,0x3f183d49bf04bf673f4e3f803f5c3edb,0xbf7fbf62bf22be95bdc9bef1bf46bf75,0x3f3e3f5c3f713f7dbf2cbf04beacbe16
.octa 0x3f6dbec4bf6d3ec43ec43f6dbec4bf6d,0xbf713e163f803e79beacbf7dbd493f78,0x3f753dc9bf62bf463e953f7f3ef1bf22,0xbf78beac3f183f80be79bf71bf4e3d49
.octa 0xbec4bf6d3ec43f6d3f6dbec4bf6d3ec4,0x3eac3f7d3d49bf78bf713e163f803e79,0xbe95bf7fbef13f223f753dc9bf62bf46,0x3e793f713f4ebd49bf78beac3f183f80
.octa 0x3f7b3f0ebe48bf553e483f553f7b3f0e,0xbf7dbf3ebe793eacbe16bf2cbf78bf71,0x3f7f3f623f223e953dc93ef13f463f75,0xbf80bf78bf67bf4ebd49be79bedbbf18
.octa 0xbe48bf55bf7bbf0e3f7b3f0ebe48bf55,0x3e163f2c3f783f71bf7dbf3ebe793eac,0xbdc9bef1bf46bf753f7f3f623f223e95,0x3d493e793edb3f18bf80bf78bf67bf4e
.octa 0x3f46bf22bf463f223f223f46bf22bf46,0x3e0abf72bf013f403f7e3ea7bf5dbf2a,0xbf13bf7abe2f3f583f51be60bf7cbf09,0xbf7abf373e3b3f6b3e54bf33bf7cbeca
.octa 0xbf22bf463f223f463f46bf22bf463f22,0xbf7ebea73f5d3f2a3e0abf72bf013f40,0xbf513e603f7c3f09bf13bf7abe2f3f58,0xbe543f333f7c3ecabf7abf373e3b3f6b
.octa 0xbf5cbe793f043f78bf04bf78bf5cbe79,0xbe8f3e9b3f483f7fbf76bf74bf20bdb0,0x3ee63f423f733f7fbf65bf27bea13d97,0x3f703f7d3f803f79beb2be233d173e6d
.octa 0x3f043f783f5c3e79bf5cbe793f043f78,0x3f763f743f203db0be8f3e9b3f483f7f,0x3f653f273ea1bd973ee63f423f733f7f,0x3eb23e23bd17be6d3f703f7d3f803f79
.octa 0x3f46bf22bf463f223f223f46bf22bf46,0xbf1bbf663e823f803f4cbee1bf783d7b,0xbf513e603f7c3f09bf13bf7abe2f3f58,0x3f0c3f803f11bebebf57bc493f533f6e
.octa 0xbf22bf463f223f463f46bf22bf463f22,0xbf4c3ee13f78bd7bbf1bbf663e823f80,0x3f133f7a3e2fbf58bf513e603f7c3f09,0x3f573c49bf53bf6e3f0c3f803f11bebe
.octa 0x3f5c3e79bf04bf783f043f783f5c3e79,0xbef7bf63bf7ebf443f603eecbde2bf25,0xbf65bf27bea13d97bee6bf42bf73bf7f,0x3ed53f163f3c3f5abf69bf4fbf2ebf06
.octa 0xbf04bf78bf5cbe793f5c3e79bf04bf78,0xbf60beec3de23f25bef7bf63bf7ebf44,0x3ee63f423f733f7fbf65bf27bea13d97,0x3f693f4f3f2e3f063ed53f163f3c3f5a
.octa 0x3f46bf22bf463f223f223f46bf22bf46,0xbf7ebea73f5d3f2a3e0abf72bf013f40,0x3f133f7a3e2fbf58bf513e603f7c3f09,0x3e54bf33bf7cbeca3f7a3f37be3bbf6b
.octa 0xbf22bf463f223f463f46bf22bf463f22,0xbe0a3f723f01bf40bf7ebea73f5d3f2a,0x3f51be60bf7cbf093f133f7a3e2fbf58,0xbf7abf373e3b3f6b3e54bf33bf7cbeca
.octa 0xbf5cbe793f043f78bf04bf78bf5cbe79,0x3f763f743f203db0be8f3e9b3f483f7f,0xbee6bf42bf73bf7f3f653f273ea1bd97,0xbeb2be233d173e6dbf70bf7dbf80bf79
.octa 0x3f043f783f5c3e79bf5cbe793f043f78,0x3e8fbe9bbf48bf7f3f763f743f203db0,0xbf65bf27bea13d97bee6bf42bf73bf7f,0x3f703f7d3f803f79beb2be233d173e6d
.octa 0x3f46bf22bf463f223f223f46bf22bf46,0xbf4c3ee13f78bd7bbf1bbf663e823f80,0x3f51be60bf7cbf093f133f7a3e2fbf58,0xbf57bc493f533f6ebf0cbf80bf113ebe
.octa 0xbf22bf463f223f463f46bf22bf463f22,0x3f1b3f66be82bf80bf4c3ee13f78bd7b,0xbf13bf7abe2f3f583f51be60bf7cbf09,0x3f0c3f803f11bebebf57bc493f533f6e
.octa 0x3f5c3e79bf04bf783f043f783f5c3e79,0xbf60beec3de23f25bef7bf63bf7ebf44,0x3f653f273ea1bd973ee63f423f733f7f,0xbf69bf4fbf2ebf06bed5bf16bf3cbf5a
.octa 0xbf04bf78bf5cbe793f5c3e79bf04bf78,0x3ef73f633f7e3f44bf60beec3de23f25,0xbee6bf42bf73bf7f3f653f273ea1bd97,0x3ed53f163f3c3f5abf69bf4fbf2ebf06
.octa 0x3f0ebf55bf0e3f553f553f0ebf55bf0e,0xbe2fbf80be603f6a3f7c3cc9bf7abecf,0xbf4ebf5c3e163f783f18bf04bf7dbe79,0xbf7ebee63efc3f7fbdfbbf65bf5fbd97
.octa 0xbf55bf0e3f553f0e3f0ebf55bf0e3f55,0xbf7cbcc93f7a3ecfbe2fbf80be603f6a,0xbf183f043f7d3e79bf4ebf5c3e163f78,0x3dfb3f653f5f3d97bf7ebee63efc3f7f
.octa 0xbf223dc93f463f7fbf46bf7fbf223dc9,0x3d973f1d3f733f77bf7fbf4abea13e89,0x3f3e3f713f803f67bf2cbeac3d493edb,0x3f803f7a3f6a3f513cc93e603ecf3f13
.octa 0x3f463f7f3f22bdc9bf223dc93f463f7f,0x3f7f3f4a3ea1be893d973f1d3f733f77,0x3f2c3eacbd49bedb3f3e3f713f803f67,0xbcc9be60becfbf133f803f7a3f6a3f51
.octa 0x3f0ebf55bf0e3f553f553f0ebf55bf0e,0xbf51bf393f093f6f3f13bf31bf583eb8,0xbf183f043f7d3e79bf4ebf5c3e163f78,0x3f4a3f733e89bf27bf1d3ea13f773f42
.octa 0xbf55bf0e3f553f0e3f0ebf55bf0e3f55,0xbf133f313f58beb8bf51bf393f093f6f,0x3f4e3f5cbe16bf78bf183f043f7d3e79,0x3f1dbea1bf77bf423f4a3f733e89bf27
.octa 0x3f22bdc9bf46bf7f3f463f7f3f22bdc9,0xbf42bf7ebf65befc3f273dfbbee6bf5f,0xbf2cbeac3d493edbbf3ebf71bf80bf67,0x3f393f583f6f3f7cbf31bf09beb8be2f
.octa 0xbf46bf7fbf223dc93f22bdc9bf46bf7f,0xbf27bdfb3ee63f5fbf42bf7ebf65befc,0x3f3e3f713f803f67bf2cbeac3d493edb,0x3f313f093eb83e2f3f393f583f6f3f7c
.octa 0x3f0ebf55bf0e3f553f553f0ebf55bf0e,0xbf7cbcc93f7a3ecfbe2fbf80be603f6a,0x3f4e3f5cbe16bf78bf183f043f7d3e79,0xbdfbbf65bf5fbd973f7e3ee6befcbf7f
.octa 0xbf55bf0e3f553f0e3f0ebf55bf0e3f55,0x3e2f3f803e60bf6abf7cbcc93f7a3ecf,0x3f18bf04bf7dbe793f4e3f5cbe16bf78,0xbf7ebee63efc3f7fbdfbbf65bf5fbd97
.octa 0xbf223dc93f463f7fbf46bf7fbf223dc9,0x3f7f3f4a3ea1be893d973f1d3f733f77,0xbf3ebf71bf80bf673f2c3eacbd49bedb,0x3cc93e603ecf3f13bf80bf7abf6abf51
.octa 0x3f463f7f3f22bdc9bf223dc93f463f7f,0xbd97bf1dbf73bf773f7f3f4a3ea1be89,0xbf2cbeac3d493edbbf3ebf71bf80bf67,0x3f803f7a3f6a3f513cc93e603ecf3f13
.octa 0x3f0ebf55bf0e3f553f553f0ebf55bf0e,0xbf133f313f58beb8bf51bf393f093f6f,0x3f18bf04bf7dbe793f4e3f5cbe16bf78,0xbf1d3ea13f773f42bf4abf73be893f27
.octa 0xbf55bf0e3f553f0e3f0ebf55bf0e3f55,0x3f513f39bf09bf6fbf133f313f58beb8,0xbf4ebf5c3e163f783f18bf04bf7dbe79,0x3f4a3f733e89bf27bf1d3ea13f773f42
.octa 0x3f22bdc9bf46bf7f3f463f7f3f22bdc9,0xbf27bdfb3ee63f5fbf42bf7ebf65befc,0x3f2c3eacbd49bedb3f3e3f713f803f67,0xbf31bf09beb8be2fbf39bf58bf6fbf7c
.octa 0xbf46bf7fbf223dc93f22bdc9bf46bf7f,0x3f423f7e3f653efcbf27bdfb3ee63f5f,0xbf3ebf71bf80bf673f2c3eacbd49bedb,0x3f393f583f6f3f7cbf31bf09beb8be2f
.octa 0x3e95bf75be953f753f753e95bf75be95,0xbeecbf763db03f7e3f63be8fbf7fbde2,0xbf73bf273ee63f7f3ea1bf42bf653d97,0xbf66be0a3f403f78bee1bf7ebf2a3e82
.octa 0xbf75be953f753e953e95bf75be953f75,0xbf633e8f3f7f3de2beecbf763db03f7e,0xbea13f423f65bd97bf73bf273ee63f7f,0x3ee13f7e3f2abe82bf66be0a3f403f78
.octa 0xbeac3edb3f713f67bf71bf67beac3edb,0x3ed53f5a3f803f4fbf69bf063d173f16,0x3f6f3f803f6a3f31beb83cc93ecf3f39,0x3f6b3f533f333f0c3eca3f113f373f57
.octa 0x3f713f673eacbedbbeac3edb3f713f67,0x3f693f06bd17bf163ed53f5a3f803f4f,0x3eb8bcc9becfbf393f6f3f803f6a3f31,0xbecabf11bf37bf573f6b3f533f333f0c
.octa 0x3e95bf75be953f753f753e95bf75be95,0xbf74bef73f443f483e9bbf60bf253f20,0xbea13f423f65bd97bf73bf273ee63f7f,0x3f723f4cbd7bbf5dbea73f1b3f803f01
.octa 0xbf75be953f753e953e95bf75be953f75,0xbe9b3f603f25bf20bf74bef73f443f48,0x3f733f27bee6bf7fbea13f423f65bd97,0x3ea7bf1bbf80bf013f723f4cbd7bbf5d
.octa 0x3eacbedbbf71bf673f713f673eacbedb,0xbf70bf79bf2ebe233eb2be6dbf3cbf7d,0xbeb83cc93ecf3f39bf6fbf80bf6abf31,0x3f6e3f7c3f803f7abebebe3b3c493e54
.octa 0xbf71bf67beac3edb3eacbedbbf71bf67,0xbeb23e6d3f3c3f7dbf70bf79bf2ebe23,0x3f6f3f803f6a3f31beb83cc93ecf3f39,0x3ebe3e3bbc49be543f6e3f7c3f803f7a
.octa 0x3e95bf75be953f753f753e95bf75be95,0xbf633e8f3f7f3de2beecbf763db03f7e,0x3f733f27bee6bf7fbea13f423f65bd97,0xbee1bf7ebf2a3e823f663e0abf40bf78
.octa 0xbf75be953f753e953e95bf75be953f75,0x3eec3f76bdb0bf7ebf633e8f3f7f3de2,0x3ea1bf42bf653d973f733f27bee6bf7f,0xbf66be0a3f403f78bee1bf7ebf2a3e82
.octa 0xbeac3edb3f713f67bf71bf67beac3edb,0x3f693f06bd17bf163ed53f5a3f803f4f,0xbf6fbf80bf6abf313eb8bcc9becfbf39,0x3eca3f113f373f57bf6bbf53bf33bf0c
.octa 0x3f713f673eacbedbbeac3edb3f713f67,0xbed5bf5abf80bf4f3f693f06bd17bf16,0xbeb83cc93ecf3f39bf6fbf80bf6abf31,0x3f6b3f533f333f0c3eca3f113f373f57
.octa 0x3e95bf75be953f753f753e95bf75be95,0xbe9b3f603f25bf20bf74bef73f443f48,0x3ea1bf42bf653d973f733f27bee6bf7f,0xbea73f1b3f803f01bf72bf4c3d7b3f5d
.octa 0xbf75be953f753e953e95bf75be953f75,0x3f743ef7bf44bf48be9b3f603f25bf20,0xbf73bf273ee63f7f3ea1bf42bf653d97,0x3f723f4cbd7bbf5dbea73f1b3f803f01
.octa 0x3eacbedbbf71bf673f713f673eacbedb,0xbeb23e6d3f3c3f7dbf70bf79bf2ebe23,0x3eb8bcc9becfbf393f6f3f803f6a3f31,0xbebebe3b3c493e54bf6ebf7cbf80bf7a
.octa 0xbf71bf67beac3edb3eacbedbbf71bf67,0x3f703f793f2e3e23beb23e6d3f3c3f7d,0xbf6fbf80bf6abf313eb8bcc9becfbf39,0x3f6e3f7c3f803f7abebebe3b3c493e54
.octa 0x00000000000000000000000000000000,0x00000000000000000000000000000000,0x00000000000000000000000000000000,0x00000000000000000000000000000000
.octa 0x8000bf8080003f803f800000bf800000,0xbf35bf553ec43f7b3f35bf0ebf6d3e48,0xbf80bec43f353f6d0000bf6dbf353ec4,0xbf353e483f6d3f55bf35bf7bbec43f0e
.octa 0x00000000000000000000000000000000,0x00000000000000000000000000000000,0x00000000000000000000000000000000,0x00000000000000000000000000000000
.octa 0x80003f353f803f35bf80bf3500003f35,0x3f353f7b3f6d3f0ebf35be483ec43f55,0x3f803f6d3f353ec400003ec43f353f6d,0x3f353f0e3ec43e483f353f553f6d3f7b
.octa 0x00000000000000000000000000000000,0x00000000000000000000000000000000,0x00000000000000000000000000000000,0x00000000000000000000000000000000
.octa 0x8000bf8080003f803f800000bf800000,0xbf80be483f6d3f0e0000bf7bbec43f55,0x80003f6d3f35bec4bf80bec43f353f6d,0x3f803f0ebec4bf7b00003f553f6d3e48
.octa 0x00000000000000000000000000000000,0x00000000000000000000000000000000,0x00000000000000000000000000000000,0x00000000000000000000000000000000
.octa 0x8000bf35bf80bf353f803f350000bf35,0xbf80bf55bec43e480000bf0ebf6dbf7b,0x80003ec43f353f6dbf80bf6dbf35bec4,0x3f803f7b3f6d3f5500003e483ec43f0e
.octa 0x00000000000000000000000000000000,0x00000000000000000000000000000000,0x00000000000000000000000000000000,0x00000000000000000000000000000000
.octa 0x8000bf8080003f803f800000bf800000,0xbf353f0e3f6dbe48bf35bf553ec43f7b,0x3f803ec4bf35bf6d00003f6d3f35bec4,0xbf35bf7bbec43f0e3f35be48bf6dbf55
.octa 0x00000000000000000000000000000000,0x00000000000000000000000000000000,0x00000000000000000000000000000000,0x00000000000000000000000000000000
.octa 0x80003f353f803f35bf80bf3500003f35,0x3f353e48bec4bf553f353f7b3f6d3f0e,0xbf80bf6dbf35bec40000bec4bf35bf6d,0x3f353f553f6d3f7bbf35bf0ebec4be48
.octa 0x00000000000000000000000000000000,0x00000000000000000000000000000000,0x00000000000000000000000000000000,0x00000000000000000000000000000000
.octa 0x8000bf8080003f803f800000bf800000,0x80003f7b3ec4bf55bf80be483f6d3f0e,0x8000bf6dbf353ec43f803ec4bf35bf6d,0x80003f553f6d3e48bf80bf0e3ec43f7b
.octa 0x00000000000000000000000000000000,0x00000000000000000000000000000000,0x00000000000000000000000000000000,0x00000000000000000000000000000000
.octa 0x8000bf35bf80bf353f803f350000bf35,0x80003f0e3f6d3f7bbf80bf55bec43e48,0x8000bec4bf35bf6d3f803f6d3f353ec4,0x80003e483ec43f0ebf80bf7bbf6dbf55
.octa 0x0000000000003f803f803f803f803f80,0x000000003f80000000003ec43f353f6d,0x00003f8000000000bf80bf3500003f35,0x3f800000000000000000bf6dbf353ec4
.octa 0x00000000000000003f800000bf800000,0x000000000000000000003f6dbf35bec4,0x0000000000000000bf803f350000bf35,0x00000000000000000000bec43f35bf6d
.octa 0x00000000000000003f80bf803f80bf80,0x00000000000000000000bec43f35bf6d,0x0000000000000000bf803f350000bf35,0x000000000000000000003f6dbf35bec4
.octa 0x00000000000000003f800000bf800000,0x00000000000000000000bf6dbf353ec4,0x0000000000000000bf80bf3500003f35,0x000000000000000000003ec43f353f6d
.octa 0x00000000000000008000800080008000,0x0000000000000000bf80bf6dbf35bec4,0x00000000000000008000bf35bf80bf35,0x00000000000000003f803ec4bf35bf6d
.octa 0x0000000000003f8080003f808000bf80,0x000000003f800000bf803ec43f35bf6d,0x00003f80000000008000bf353f80bf35,0x3f800000000000003f80bf6d3f35bec4
.octa 0x00000000000000008000800080008000,0x0000000000000000bf803f6dbf353ec4,0x000000000000000080003f35bf803f35,0x00000000000000003f80bec4bf353f6d
.octa 0x00000000000000008000bf8080003f80,0x0000000000000000bf80bec43f353f6d,0x000000000000000080003f353f803f35,0x00000000000000003f803f6d3f353ec4
.octa 0x00000000000000003f803f803f803f80,0x0000000000000000bf80bf6dbf35bec4,0x00000000000000003f803f350000bf35,0x0000000000000000bf80bec43f353f6d
.octa 0x00000000000000003f800000bf800000,0x0000000000000000bf803ec43f35bf6d,0x00000000000000003f80bf3500003f35,0x0000000000000000bf803f6dbf353ec4
.octa 0x0000000000003f803f80bf803f80bf80,0x000000003f800000bf803f6dbf353ec4,0x00003f80000000003f80bf3500003f35,0x3f80000000000000bf803ec43f35bf6d
.octa 0x00000000000000003f800000bf800000,0x0000000000000000bf80bec43f353f6d,0x00000000000000003f803f350000bf35,0x0000000000000000bf80bf6dbf35bec4
.octa 0x00000000000000003f80800080008000,0x00000000000000003f80bec4bf35bf6d,0x00000000000000003f803f353f803f35,0x00000000000000003f80bf6dbf353ec4
.octa 0x00000000000000003f803f808000bf80,0x00000000000000003f80bf6d3f353ec4,0x00000000000000003f803f35bf803f35,0x00000000000000003f80bec43f35bf6d
.octa 0x00000000000000003f80800080008000,0x00000000000000003f803ec4bf353f6d,0x00000000000000003f80bf353f80bf35,0x00000000000000003f803f6dbf35bec4
.octa 0x0000000000003f803f80bf8080003f80,0x000000003f8000003f803f6d3f35bec4,0x00003f80000000003f80bf35bf80bf35,0x3f800000000000003f803ec43f353f6d
.octa 0x00003f8000003f8000003f8000003f80,0x3f8000003f8000003f8000003f800000,0x3f6d3ec43f353f353ec43f6d00003f80,0x3ec4bf6d3f35bf353f6dbec43f800000
.octa 0x3f35bf353f8000003f353f3500003f80,0xbf35bf350000bf803f35bf353f800000,0xbec4bf6d3f35bf353f6d3ec400003f80,0xbf6d3ec4bf35bf353ec4bf6d3f800000
.octa 0xbf8000000000bf803f80000000003f80,0x00003f80bf8000000000bf803f800000,0xbec43f6dbf35bf353f6dbec400003f80,0x3f6d3ec4bf353f35bec4bf6d3f800000
.octa 0x3f353f35bf8000003f35bf3500003f80,0x3f35bf3500003f80bf35bf353f800000,0x3f6dbec4bf353f353ec4bf6d00003f80,0xbec4bf6d3f353f35bf6dbec43f800000
.octa 0x00003f8000003f8000003f8000003f80,0x3f8000003f8000003f8000003f800000,0x3ec4bf6d3f35bf353f6dbec43f800000,0xbf6dbec4bf35bf35bec4bf6d0000bf80
.octa 0xbf353f35bf800000bf35bf350000bf80,0x3f353f3500003f80bf353f35bf800000,0x3f6dbec43f353f35bec43f6dbf800000,0xbec4bf6d3f35bf353f6d3ec400003f80
.octa 0xbf8000000000bf803f80000000003f80,0x00003f80bf8000000000bf803f800000,0x3f6d3ec4bf353f35bec4bf6d3f800000,0x3ec4bf6d3f353f35bf6d3ec40000bf80
.octa 0xbf35bf353f800000bf353f350000bf80,0xbf353f350000bf803f353f35bf800000,0x3ec43f6dbf35bf353f6d3ec4bf800000,0x3f6dbec4bf353f353ec4bf6d00003f80
.octa 0x00003f8000003f8000003f8000003f80,0x3f8000003f8000003f8000003f800000,0xbf6dbec4bf35bf35bec4bf6d0000bf80,0xbec43f6dbf353f35bf6d3ec4bf800000
.octa 0x3f35bf353f8000003f353f3500003f80,0xbf35bf350000bf803f35bf353f800000,0x3ec43f6dbf353f35bf6dbec40000bf80,0x3f6dbec43f353f35bec43f6dbf800000
.octa 0xbf8000000000bf803f80000000003f80,0x00003f80bf8000000000bf803f800000,0x3ec4bf6d3f353f35bf6d3ec40000bf80,0xbf6dbec43f35bf353ec43f6dbf800000
.octa 0x3f353f35bf8000003f35bf3500003f80,0x3f35bf3500003f80bf35bf353f800000,0xbf6d3ec43f35bf35bec43f6d0000bf80,0x3ec43f6dbf35bf353f6d3ec4bf800000
.octa 0x00003f8000003f8000003f8000003f80,0x3f8000003f8000003f8000003f800000,0xbec43f6dbf353f35bf6d3ec4bf800000,0x3f6d3ec43f353f353ec43f6d00003f80
.octa 0xbf353f35bf800000bf35bf350000bf80,0x3f353f3500003f80bf353f35bf800000,0xbf6d3ec4bf35bf353ec4bf6d3f800000,0x3ec43f6dbf353f35bf6dbec40000bf80
.octa 0xbf8000000000bf803f80000000003f80,0x00003f80bf8000000000bf803f800000,0xbf6dbec43f35bf353ec43f6dbf800000,0xbec43f6dbf35bf353f6dbec400003f80
.octa 0xbf35bf353f800000bf353f350000bf80,0xbf353f350000bf803f353f35bf800000,0xbec4bf6d3f353f35bf6dbec43f800000,0xbf6d3ec43f35bf35bec43f6d0000bf80
.octa 0xbf55bf6dbf7bbf803f553f6d3f7b3f80,0x3ec43f353f6d3f803ec43f353f6d3f80,0x3e48bec4bf55bf80be483ec43f553f80,0xbf3500003f353f80bf3500003f353f80
.octa 0x3f7b3ec4bf0ebf80bf7bbec43f0e3f80,0xbf6dbf353ec43f80bf6dbf353ec43f80,0x3f0e3f6dbe48bf80bf0ebf6d3e483f80,0x0000bf8000003f800000bf8000003f80
.octa 0xbf0e3f6d3e48bf803f0ebf6dbe483f80,0x3f6dbf35bec43f803f6dbf35bec43f80,0xbf7b3ec43f0ebf803f7bbec4bf0e3f80,0x3f350000bf353f803f350000bf353f80
.octa 0xbe48bec43f55bf803e483ec4bf553f80,0xbec43f35bf6d3f80bec43f35bf6d3f80,0x3f55bf6d3f7bbf80bf553f6dbf7b3f80,0xbf803f80bf803f80bf803f80bf803f80
.octa 0xbe48bec4bf0ebf353e483ec43f0e3f35,0xbf6dbf35bec40000bf6dbf35bec40000,0x3f0e3f6d3f7b3f35bf0ebf6dbf7bbf35,0x3f350000bf35bf803f350000bf35bf80
.octa 0xbf55bf6dbe483f353f553f6d3e48bf35,0xbec43f353f6d0000bec43f353f6d0000,0x3f7b3ec4bf55bf35bf7bbec43f553f35,0x0000bf8000003f800000bf8000003f80
.octa 0xbf7b3ec43f55bf353f7bbec4bf553f35,0x3ec43f35bf6d00003ec43f35bf6d0000,0x3f55bf6d3e483f35bf553f6dbe48bf35,0xbf3500003f35bf80bf3500003f35bf80
.octa 0xbf0e3f6dbf7b3f353f0ebf6d3f7bbf35,0x3f6dbf353ec400003f6dbf353ec40000,0x3e48bec43f0ebf35be483ec4bf0e3f35,0xbf803f80bf803f80bf803f80bf803f80
.octa 0x3f0e3ec43e480000bf0ebec4be480000,0xbec4bf35bf6dbf80bec4bf35bf6dbf80,0xbf7bbf6dbf0e00003f7b3f6d3f0e0000,0xbf3500003f353f80bf3500003f353f80
.octa 0x3e483f6d3f550000be48bf6dbf550000,0x3f6d3f35bec4bf803f6d3f35bec4bf80,0x3f55bec4bf7b0000bf553ec43f7b0000,0x0000bf8000003f800000bf8000003f80
.octa 0xbf55bec43f7b00003f553ec4bf7b0000,0xbf6d3f353ec4bf80bf6d3f353ec4bf80,0xbe483f6dbf5500003e48bf6d3f550000,0x3f350000bf353f803f350000bf353f80
.octa 0x3f7bbf6d3f0e0000bf7b3f6dbf0e0000,0x3ec4bf353f6dbf803ec4bf353f6dbf80,0xbf0e3ec4be4800003f0ebec43e480000,0xbf803f80bf803f80bf803f80bf803f80
.octa 0x3f7b3f6d3f553f35bf7bbf6dbf55bf35,0x3f6d3f353ec400003f6d3f353ec40000,0x3f553ec4be48bf35bf55bec43e483f35,0x3f350000bf35bf803f350000bf35bf80
.octa 0x3f0ebec4bf7bbf35bf0e3ec43f7b3f35,0x3ec4bf35bf6d00003ec4bf35bf6d0000,0x3e48bf6dbf0e3f35be483f6d3f0ebf35,0x0000bf8000003f800000bf8000003f80
.octa 0xbe48bf6d3f0e3f353e483f6dbf0ebf35,0xbec4bf353f6d0000bec4bf353f6d0000,0xbf0ebec43f7bbf353f0e3ec4bf7b3f35,0xbf3500003f35bf80bf3500003f35bf80
.octa 0xbf553ec43e48bf353f55bec4be483f35,0xbf6d3f35bec40000bf6d3f35bec40000,0xbf7b3f6dbf553f353f7bbf6d3f55bf35,0xbf803f80bf803f80bf803f80bf803f80
.octa 0x3f0e3ec43e488000bf0ebec4be488000,0xbf6dbf35bec48000bf6dbf35bec48000,0x3f7b3f6d3f0e8000bf7bbf6dbf0e8000,0xbf35bf80bf358000bf35bf80bf358000
.octa 0x3e483f6d3f558000be48bf6dbf558000,0x3ec4bf35bf6d80003ec4bf35bf6d8000,0xbf553ec43f7b80003f55bec4bf7b8000,0x3f808000bf8080003f808000bf808000
.octa 0xbf55bec43f7b80003f553ec4bf7b8000,0x3ec43f35bf6d80003ec43f35bf6d8000,0x3e48bf6d3f558000be483f6dbf558000,0xbf353f80bf358000bf353f80bf358000
.octa 0x3f7bbf6d3f0e8000bf7b3f6dbf0e8000,0xbf6d3f35bec48000bf6d3f35bec48000,0x3f0ebec43e488000bf0e3ec4be488000,0x80008000800080008000800080008000
.octa 0x3f7b3f6d3f553f35bf7bbf6dbf55bf35,0xbec4bf35bf6dbf80bec4bf35bf6dbf80,0xbf55bec43e483f353f553ec4be48bf35,0x3f353f803f3580003f353f803f358000
.octa 0x3f0ebec4bf7bbf35bf0e3ec43f7b3f35,0xbf6dbf353ec43f80bf6dbf353ec43f80,0xbe483f6d3f0ebf353e48bf6dbf0e3f35,0x3f808000bf8080003f808000bf808000
.octa 0xbe48bf6d3f0e3f353e483f6dbf0ebf35,0xbf6d3f353ec4bf80bf6d3f353ec4bf80,0x3f0e3ec4bf7b3f35bf0ebec43f7bbf35,0x3f35bf803f3580003f35bf803f358000
.octa 0xbf553ec43e48bf353f55bec4be483f35,0xbec43f35bf6d3f80bec43f35bf6d3f80,0x3f7bbf6d3f55bf35bf7b3f6dbf553f35,0x80008000800080008000800080008000
.octa 0x3f553f6d3f7b3f80bf55bf6dbf7bbf80,0x3f6d3f353ec480003f6d3f353ec48000,0x3e48bec4bf55bf80be483ec43f553f80,0xbf35bf80bf358000bf35bf80bf358000
.octa 0xbf7bbec43f0e3f803f7b3ec4bf0ebf80,0xbec43f353f6d8000bec43f353f6d8000,0x3f0e3f6dbe48bf80bf0ebf6d3e483f80,0x3f808000bf8080003f808000bf808000
.octa 0x3f0ebf6dbe483f80bf0e3f6d3e48bf80,0xbec4bf353f6d8000bec4bf353f6d8000,0xbf7b3ec43f0ebf803f7bbec4bf0e3f80,0xbf353f80bf358000bf353f80bf358000
.octa 0x3e483ec4bf553f80be48bec43f55bf80,0x3f6dbf353ec480003f6dbf353ec48000,0x3f55bf6d3f7bbf80bf553f6dbf7b3f80,0x80008000800080008000800080008000
.octa 0x3e483ec43f0e3f35be48bec4bf0ebf35,0x3ec43f353f6d3f803ec43f353f6d3f80,0x3f0e3f6d3f7b3f35bf0ebf6dbf7bbf35,0x3f353f803f3580003f353f803f358000
.octa 0x3f553f6d3e48bf35bf55bf6dbe483f35,0x3f6d3f35bec4bf803f6d3f35bec4bf80,0x3f7b3ec4bf55bf35bf7bbec43f553f35,0x3f808000bf8080003f808000bf808000
.octa 0x3f7bbec4bf553f35bf7b3ec43f55bf35,0x3f6dbf35bec43f803f6dbf35bec43f80,0x3f55bf6d3e483f35bf553f6dbe48bf35,0x3f35bf803f3580003f35bf803f358000
.octa 0x3f0ebf6d3f7bbf35bf0e3f6dbf7b3f35,0x3ec4bf353f6dbf803ec4bf353f6dbf80,0x3e48bec43f0ebf35be483ec4bf0e3f35,0x80008000800080008000800080008000
.octa 0x3f7fd3973f7fec433f7ffb113f800000,0x3f7f4e6d3f7fb10f3f7fec433f800000,0x3f7e70b03f7f4e6d3f7fd3973f800000,0x3f7d3aac3f7ec46d3f7fb10f3f800000
.octa 0x3f7baccd3f7e13243f7f84ab3f800000,0x3f79c79d3f7d3aac3f7f4e6d3f800000,0x3f778bc53f7c3b283f7f0e583f800000,0x3f74fa0b3f7b14be3f7ec46d3f800000
.octa 0x3f7213523f79c79d3f7e70b03f800000,0x3f6ed89e3f7853f83f7e13243f800000,0x3f6b4b0c3f76ba073f7dabcc3f800000,0x3f676bd83f74fa0b3f7d3aac3f800000
.octa 0x3f633c5a3f7314473f7cbfc93f800000,0x3f5ebe053f7109083f7c3b283f800000,0x3f59f26a3f6ed89e3f7baccd3f800000,0x3f54db313f6c835e3f7b14be3f800000
.octa 0x3f7f0e583f7f4e6d3f7f84ab3f7fb10f,0x3f7c3b283f7d3aac3f7e13243f7ec46d,0x3f778bc53f79c79d3f7baccd3f7d3aac,0x3f7109083f74fa0b3f7853f83f7b14be
.octa 0x3f68bf3c3f6ed89e3f740bdd3f7853f8,0x3f5ebe053f676bd83f6ed89e3f74fa0b,0x3f5318493f5ebe053f68bf3c3f710908,0x3f45e4033f54db313f61c5983f6c835e
.octa 0x3f373a233f49d1123f59f26a3f676bd8,0x3f2736563f3daef93f514d3d3f61c598,0x3f15f6d93f3085bb3f47de653f5b941a,0x3f039c3d3f2267993f3daef93f54db31
.octa 0x3ee0924f3f13682a3f32c8c93f4d9f02,0x3eb8442a3f039c3d3f2736563f45e403,0x3e8e9a223ee633753f1b02c63f3daef9,0x3e47c5c23ec3ef153f0e39da3f3504f3
.octa 0x3f7dabcc3f7e13243f7e70b03f7ec46d,0x3f76ba073f7853f83f79c79d3f7b14be,0x3f6b4b0c3f6ed89e3f7213523f74fa0b,0x3f5b941a3f61c5983f676bd83f6c835e
.octa 0x3f47de653f514d3d3f59f26a3f61c598,0x3f3085bb3f3daef93f49d1123f54db31,0x3f15f6d93f2736563f373a233f45e403,0x3ef15aea3f0e39da3f2267993f3504f3
.octa 0x3eb263ef3ee633753f0b9a6b3f226799,0x3e605c133eac7cd43ee633753f0e39da,0x3dafb6803e605c133eb263ef3ef15aea,0xbd48fb303dc8bd363e78cfcc3ec3ef15
.octa 0xbe3b6ecfbcc90ab03e09cf863e94a031,0xbea09ae5be1640833cc90ab03e47c5c2,0xbee0924fbe888e93bdafb6803dc8bd36,0xbf0e39dabec3ef15be47c5c200000000
.octa 0x3f7baccd3f7c3b283f7cbfc93f7d3aac,0x3f6ed89e3f7109083f7314473f74fa0b,0x3f59f26a3f5ebe053f633c5a3f676bd8,0x3f3daef93f45e4033f4d9f023f54db31
.octa 0x3f1b02c63f2736563f32c8c93f3daef9,0x3ee633753f039c3d3f13682a3f226799,0x3e8e9a223eb8442a3ee0924f3f039c3d,0x3dc8bd363e47c5c23e94a0313ec3ef15
.octa 0xbdafb6803cc90ab03e09cf863e78cfcc,0xbe888e93be164083bcc90ab03dc8bd36,0xbee0924fbea09ae5be3b6ecfbd48fb30,0xbf187fc0bef15aeabeac7cd4be47c5c2
.octa 0xbf3b8f3bbf1d7fd1bef6e0cbbeac7cd4,0xbf584853bf3daef9bf1d7fd1bef15aea,0xbf6db293bf584853bf3b8f3bbf187fc0,0xbf7b14bebf6c835ebf54db31bf3504f3
.octa 0xbd16c32cbcc90ab0bc490e9000000000,0xbd96a905bd48fb30bcc90ab000000000,0xbde1bc2ebd96a905bd16c32c00000000,0xbe164083bdc8bd36bd48fb3000000000
.octa 0xbe3b6ecfbdfab273bd7b2b7400000000,0xbe605c13be164083bd96a90500000000,0xbe827dc0be2f10a2bdafb68000000000,0xbe94a031be47c5c2bdc8bd3600000000
.octa 0xbea68f12be605c13bde1bc2e00000000,0xbeb8442abe78cfccbdfab27300000000,0xbec9b953be888e93be09cf8600000000,0xbedae880be94a031be16408300000000
.octa 0xbeebcbbbbea09ae5be22abb600000000,0xbefc5d27beac7cd4be2f10a200000000,0xbf064b82beb8442abe3b6ecf00000000,0xbf0e39dabec3ef15be47c5c200000000
.octa 0xbdafb680bd96a905bd7b2b74bd48fb30,0xbe2f10a2be164083bdfab273bdc8bd36,0xbe827dc0be605c13be3b6ecfbe164083,0xbeac7cd4be94a031be78cfccbe47c5c2
.octa 0xbed53641beb8442abe9aa086be78cfcc,0xbefc5d27bedae880beb8442abe94a031,0xbf10d3cdbefc5d27bed53641beac7cd4,0xbf226799bf0e39dabef15aeabec3ef15
.octa 0xbf32c8c9bf1d7fd1bf064b82bedae880,0xbf41d870bf2beb4abf13682abef15aea,0xbf4f7a1fbf396842bf1ff6cbbf039c3d,0xbf5b941abf45e403bf2beb4abf0e39da
.octa 0xbf660f88bf514d3dbf373a23bf187fc0,0xbf6ed89ebf5b941abf41d870bf226799,0xbf75dec6bf64aa59bf4bbbf8bf2beb4a,0xbf7b14bebf6c835ebf54db31bf3504f3
.octa 0xbe09cf86bdfab273bde1bc2ebdc8bd36,0xbe888e93be78cfccbe605c13be47c5c2,0xbec9b953beb8442abea68f12be94a031,0xbf039c3dbef15aeabedae880bec3ef15
.octa 0xbf1ff6cbbf13682abf064b82bef15aea,0xbf396842bf2beb4abf1d7fd1bf0e39da,0xbf4f7a1fbf41d870bf32c8c9bf226799,0xbf61c598bf54db31bf45e403bf3504f3
.octa 0xbf6ff573bf64aa59bf5695e5bf45e403,0xbf79c79dbf710908bf64aa59bf54db31,0xbf7f0e58bf79c79dbf6ff573bf61c598,0xbf7fb10fbf7ec46dbf7853f8bf6c835e
.octa 0xbf7baccdbf7fec43bf7dabccbf74fa0b,0xbf731447bf7d3aacbf7fec43bf7b14be,0xbf660f88bf76ba07bf7f0e58bf7ec46d,0xbf54db31bf6c835ebf7b14bebf800000
.octa 0xbe3b6ecfbe2f10a2be22abb6be164083,0xbeb8442abeac7cd4bea09ae5be94a031,0xbf064b82befc5d27beebcbbbbedae880,0xbf2beb4abf226799bf187fc0bf0e39da
.octa 0xbf4bbbf8bf41d870bf373a23bf2beb4a,0xbf64aa59bf5b941abf514d3dbf45e403,0xbf75dec6bf6ed89ebf660f88bf5b941a,0xbf7ec46dbf7b14bebf74fa0bbf6c835e
.octa 0xbf7f0e58bf7fec43bf7dabccbf7853f8,0xbf76ba07bf7d3aacbf7fec43bf7ec46d,0xbf660f88bf731447bf7baccdbf7fb10f,0xbf4d9f02bf61c598bf710908bf7b14be
.octa 0xbf2e3bdebf49d112bf604621bf710908,0xbf08f59bbf2beb4abf49d112bf61c598,0xbebe1d4abf08f59bbf2e3bdebf4d9f02,0xbe47c5c2bec3ef15bf0e39dabf3504f3
.octa 0x3f55bf6d3f7bbf80bf553f6dbf7b3f80,0xbec43f35bf6d3f80bec43f35bf6d3f80,0xbe48bec43f55bf803e483ec4bf553f80,0x3f350000bf353f803f350000bf353f80
.octa 0xbf7b3ec43f0ebf803f7bbec4bf0e3f80,0x3f6dbf35bec43f803f6dbf35bec43f80,0xbf0e3f6d3e48bf803f0ebf6dbe483f80,0x0000bf8000003f800000bf8000003f80
.octa 0x3f0e3f6dbe48bf80bf0ebf6d3e483f80,0xbf6dbf353ec43f80bf6dbf353ec43f80,0x3f7b3ec4bf0ebf80bf7bbec43f0e3f80,0xbf3500003f353f80bf3500003f353f80
.octa 0x3e48bec4bf55bf80be483ec43f553f80,0x3ec43f353f6d3f803ec43f353f6d3f80,0xbf55bf6dbf7bbf803f553f6d3f7b3f80,0x3f803f803f803f803f803f803f803f80
.octa 0x3e48bec43f0ebf35be483ec4bf0e3f35,0x3f6dbf353ec400003f6dbf353ec40000,0xbf0e3f6dbf7b3f353f0ebf6d3f7bbf35,0xbf3500003f35bf80bf3500003f35bf80
.octa 0x3f55bf6d3e483f35bf553f6dbe48bf35,0x3ec43f35bf6d00003ec43f35bf6d0000,0xbf7b3ec43f55bf353f7bbec4bf553f35,0x0000bf8000003f800000bf8000003f80
.octa 0x3f7b3ec4bf55bf35bf7bbec43f553f35,0xbec43f353f6d0000bec43f353f6d0000,0xbf55bf6dbe483f353f553f6d3e48bf35,0x3f350000bf35bf803f350000bf35bf80
.octa 0x3f0e3f6d3f7b3f35bf0ebf6dbf7bbf35,0xbf6dbf35bec40000bf6dbf35bec40000,0xbe48bec4bf0ebf353e483ec43f0e3f35,0x3f803f803f803f803f803f803f803f80
.octa 0xbf0e3ec4be4800003f0ebec43e480000,0x3ec4bf353f6dbf803ec4bf353f6dbf80,0x3f7bbf6d3f0e0000bf7b3f6dbf0e0000,0x3f350000bf353f803f350000bf353f80
.octa 0xbe483f6dbf5500003e48bf6d3f550000,0xbf6d3f353ec4bf80bf6d3f353ec4bf80,0xbf55bec43f7b00003f553ec4bf7b0000,0x0000bf8000003f800000bf8000003f80
.octa 0x3f55bec4bf7b0000bf553ec43f7b0000,0x3f6d3f35bec4bf803f6d3f35bec4bf80,0x3e483f6d3f550000be48bf6dbf550000,0xbf3500003f353f80bf3500003f353f80
.octa 0xbf7bbf6dbf0e00003f7b3f6d3f0e0000,0xbec4bf35bf6dbf80bec4bf35bf6dbf80,0x3f0e3ec43e480000bf0ebec4be480000,0x3f803f803f803f803f803f803f803f80
.octa 0xbf7b3f6dbf553f353f7bbf6d3f55bf35,0xbf6d3f35bec40000bf6d3f35bec40000,0xbf553ec43e48bf353f55bec4be483f35,0xbf3500003f35bf80bf3500003f35bf80
.octa 0xbf0ebec43f7bbf353f0e3ec4bf7b3f35,0xbec4bf353f6d0000bec4bf353f6d0000,0xbe48bf6d3f0e3f353e483f6dbf0ebf35,0x0000bf8000003f800000bf8000003f80
.octa 0x3e48bf6dbf0e3f35be483f6d3f0ebf35,0x3ec4bf35bf6d00003ec4bf35bf6d0000,0x3f0ebec4bf7bbf35bf0e3ec43f7b3f35,0x3f350000bf35bf803f350000bf35bf80
.octa 0x3f553ec4be48bf35bf55bec43e483f35,0x3f6d3f353ec400003f6d3f353ec40000,0x3f7b3f6d3f553f35bf7bbf6dbf55bf35,0x3f803f803f803f803f803f803f803f80
.octa 0xbf0e3ec4be4880003f0ebec43e488000,0x3f6dbf353ec480003f6dbf353ec48000,0xbf7b3f6dbf0e80003f7bbf6d3f0e8000,0x3f35bf803f3580003f35bf803f358000
.octa 0xbe483f6dbf5580003e48bf6d3f558000,0xbec4bf353f6d8000bec4bf353f6d8000,0x3f553ec4bf7b8000bf55bec43f7b8000,0xbf8080003f808000bf8080003f808000
.octa 0x3f55bec4bf7b8000bf553ec43f7b8000,0xbec43f353f6d8000bec43f353f6d8000,0xbe48bf6dbf5580003e483f6d3f558000,0x3f353f803f3580003f353f803f358000
.octa 0xbf7bbf6dbf0e80003f7b3f6d3f0e8000,0x3f6d3f353ec480003f6d3f353ec48000,0xbf0ebec4be4880003f0e3ec43e488000,0x80008000800080008000800080008000
.octa 0xbf7b3f6dbf553f353f7bbf6d3f55bf35,0x3ec4bf353f6dbf803ec4bf353f6dbf80,0x3f55bec4be483f35bf553ec43e48bf35,0xbf353f80bf358000bf353f80bf358000
.octa 0xbf0ebec43f7bbf353f0e3ec4bf7b3f35,0x3f6dbf35bec43f803f6dbf35bec43f80,0x3e483f6dbf0ebf35be48bf6d3f0e3f35,0xbf8080003f808000bf8080003f808000
.octa 0x3e48bf6dbf0e3f35be483f6d3f0ebf35,0x3f6d3f35bec4bf803f6d3f35bec4bf80,0xbf0e3ec43f7b3f353f0ebec4bf7bbf35,0xbf35bf80bf358000bf35bf80bf358000
.octa 0x3f553ec4be48bf35bf55bec43e483f35,0x3ec43f353f6d3f803ec43f353f6d3f80,0xbf7bbf6dbf55bf353f7b3f6d3f553f35,0x80008000800080008000800080008000
.octa 0xbf553f6dbf7b3f803f55bf6d3f7bbf80,0xbf6d3f35bec48000bf6d3f35bec48000,0xbe48bec43f55bf803e483ec4bf553f80,0x3f35bf803f3580003f35bf803f358000
.octa 0x3f7bbec4bf0e3f80bf7b3ec43f0ebf80,0x3ec43f35bf6d80003ec43f35bf6d8000,0xbf0e3f6d3e48bf803f0ebf6dbe483f80,0xbf8080003f808000bf8080003f808000
.octa 0xbf0ebf6d3e483f803f0e3f6dbe48bf80,0x3ec4bf35bf6d80003ec4bf35bf6d8000,0x3f7b3ec4bf0ebf80bf7bbec43f0e3f80,0x3f353f803f3580003f353f803f358000
.octa 0xbe483ec43f553f803e48bec4bf55bf80,0xbf6dbf35bec48000bf6dbf35bec48000,0xbf55bf6dbf7bbf803f553f6d3f7b3f80,0x80008000800080008000800080008000
.octa 0xbe483ec4bf0e3f353e48bec43f0ebf35,0xbec43f35bf6d3f80bec43f35bf6d3f80,0xbf0e3f6dbf7b3f353f0ebf6d3f7bbf35,0xbf353f80bf358000bf353f80bf358000
.octa 0xbf553f6dbe48bf353f55bf6d3e483f35,0xbf6d3f353ec4bf80bf6d3f353ec4bf80,0xbf7b3ec43f55bf353f7bbec4bf553f35,0xbf8080003f808000bf8080003f808000
.octa 0xbf7bbec43f553f353f7b3ec4bf55bf35,0xbf6dbf353ec43f80bf6dbf353ec43f80,0xbf55bf6dbe483f353f553f6d3e48bf35,0xbf35bf80bf358000bf35bf80bf358000
.octa 0xbf0ebf6dbf7bbf353f0e3f6d3f7b3f35,0xbec4bf35bf6dbf80bec4bf35bf6dbf80,0xbe48bec4bf0ebf353e483ec43f0e3f35,0x80008000800080008000800080008000
.octa 0x3f4f7a1f3f6a09a73f7a73023f800000,0x3f49d1123f676bd83f79c79d3f800000,0x3f43e2003f64aa593f7912983f800000,0x3f3daef93f61c5983f7853f83f800000
.octa 0x3f373a233f5ebe053f778bc53f800000,0x3f3085bb3f5b941a3f76ba073f800000,0x3f2994153f5848533f75dec63f800000,0x3f2267993f54db313f74fa0b3f800000
.octa 0x3f1b02c63f514d3d3f740bdd3f800000,0x3f13682a3f4d9f023f7314473f800000,0x3f0b9a6b3f49d1123f7213523f800000,0x3f039c3d3f45e4033f7109083f800000
.octa 0x3ef6e0cb3f41d8703f6ff5733f800000,0x3ee633753f3daef93f6ed89e3f800000,0x3ed536413f3968423f6db2933f800000,0x3ec3ef153f3504f33f6c835e3f800000
.octa 0x3de1bc2e3ea09ae53f00e7e43f2beb4a,0x3cc90ab03e78cfcc3ee633753f226799,0xbd7b2b743e2f10a23ec9b9533f187fc0,0xbe1640833dc8bd363eac7cd43f0e39da
.octa 0xbe6c9a7f3cc90ab03e8e9a223f039c3d,0xbea09ae5bd48fb303e605c133ef15aea,0xbec9b953bdfab2733e22abb63edae880,0xbef15aeabe47c5c23dc8bd363ec3ef15
.octa 0xbf0b9a6bbe888e933d16c32c3eac7cd4,0xbf1d7fd1beac7cd4bcc90ab03e94a031,0xbf2e3bdebecf7bcabdafb6803e78cfcc,0xbf3daef9bef15aeabe1640833e47c5c2
.octa 0xbf4bbbf8bf08f59bbe5415013e164083,0xbf584853bf187fc0be888e933dc8bd36,0xbf633c5abf273656bea68f123d48fb30,0xbf6c835ebf3504f3bec3ef1500000000
.octa 0xbf299415befc5d27be9aa086bdc8bd36,0xbf41d870bf187fc0becf7bcabe47c5c2,0xbf5695e5bf3085bbbf00e7e4be94a031,0xbf676bd8bf45e403bf187fc0bec3ef15
.octa 0xbf740bddbf584853bf2e3bdebef15aea,0xbf7c3b28bf676bd8bf41d870bf0e39da,0xbf7fd397bf731447bf531849bf226799,0xbf7ec46dbf7b14bebf61c598bf3504f3
.octa 0xbf791298bf7f4e6dbf6db293bf45e403,0xbf6ed89ebf7fb10fbf76ba07bf54db31,0xbf604621bf7c3b28bf7cbfc9bf61c598,0xbf4d9f02bf74fa0bbf7fb10fbf6c835e
.octa 0xbf373a23bf6a09a7bf7f84abbf74fa0b,0xbf1d7fd1bf5b941abf7c3b28bf7b14be,0xbf00e7e4bf49d112bf75dec6bf7ec46d,0xbec3ef15bf3504f3bf6c835ebf800000
.octa 0xbf7ffb11bf79c79dbf68bf3cbf4d9f02,0xbf7c3b28bf7fb10fbf76ba07bf61c598,0xbf6ff573bf7e1324bf7e70b0bf710908,0xbf5b941abf74fa0bbf7fb10fbf7b14be
.octa 0xbf3fc767bf64aa59bf7a7302bf7fb10f,0xbf1d7fd1bf4d9f02bf6ed89ebf7ec46d,0xbeebcbbbbf3085bbbf5d2d53bf7853f8,0xbe94a031bf0e39dabf45e403bf6c835e
.octa 0xbde1bc2ebecf7bcabf299415bf5b941a,0x3d96a905be78cfccbf08f59bbf45e403,0x3e827dc0bd96a905bec9b953bf2beb4a,0x3edae8803dc8bd36be78cfccbf0e39da
.octa 0x3f15f6d93e888e93bdafb680bedae880,0x3f3968423edae8803d96a905be94a031,0x3f5695e53f13682a3e6c9a7fbe164083,0x3f6c835e3f3504f33ec3ef1500000000
.octa 0xbf15f6d9becf7bcabe54150100000000,0xbf1d7fd1bedae880be605c1300000000,0xbf24d225bee63375be6c9a7f00000000,0xbf2beb4abef15aeabe78cfcc00000000
.octa 0xbf32c8c9befc5d27be827dc000000000,0xbf396842bf039c3dbe888e9300000000,0xbf3fc767bf08f59bbe8e9a2200000000,0xbf45e403bf0e39dabe94a03100000000
.octa 0xbf4bbbf8bf13682abe9aa08600000000,0xbf514d3dbf187fc0bea09ae500000000,0xbf5695e5bf1d7fd1bea68f1200000000,0xbf5b941abf226799beac7cd400000000
.octa 0xbf604621bf273656beb263ef00000000,0xbf64aa59bf2beb4abeb8442a00000000,0xbf68bf3cbf3085bbbebe1d4a00000000,0xbf6c835ebf3504f3bec3ef1500000000
.octa 0xbf7e70b0bf731447bf5d2d53bf3daef9,0xbf7fec43bf7853f8bf64aa59bf45e403,0xbf7f84abbf7c3b28bf6b4b0cbf4d9f02,0xbf7d3aacbf7ec46dbf710908bf54db31
.octa 0xbf791298bf7fec43bf75dec6bf5b941a,0xbf731447bf7fb10fbf79c79dbf61c598,0xbf6b4b0cbf7e1324bf7cbfc9bf676bd8,0xbf61c598bf7b14bebf7ec46dbf6c835e
.octa 0xbf5695e5bf76ba07bf7fd397bf710908,0xbf49d112bf710908bf7fec43bf74fa0b,0xbf3b8f3bbf6a09a7bf7f0e58bf7853f8,0xbf2beb4abf61c598bf7d3aacbf7b14be
.octa 0xbf1b02c6bf584853bf7a7302bf7d3aac,0xbf08f59bbf4d9f02bf76ba07bf7ec46d,0xbeebcbbbbf41d870bf721352bf7fb10f,0xbec3ef15bf3504f3bf6c835ebf800000
.octa 0xbf3fc767bf5ebe05bf740bddbf7ec46d,0xbf273656bf4d9f02bf6a09a7bf7b14be,0xbf0b9a6bbf396842bf5d2d53bf74fa0b,0xbedae880bf226799bf4d9f02bf6c835e
.octa 0xbe9aa086bf08f59bbf3b8f3bbf61c598,0xbe2f10a2bedae880bf273656bf54db31,0xbd16c32cbea09ae5bf10d3cdbf45e403,0x3dc8bd36be47c5c2bef15aeabf3504f3
.octa 0x3e6c9a7fbd96a905bebe1d4abf226799,0x3eb8442a3d48fb30be888e93bf0e39da,0x3ef6e0cb3e2f10a2be22abb6bef15aea,0x3f187fc03e94a031bd48fb30bec3ef15
.octa 0x3f32c8c93ecf7bca3d7b2b74be94a031,0x3f49d1123f039c3d3e2f10a2be47c5c2,0x3f5d2d533f1d7fd13e8e9a22bdc8bd36,0x3f6c835e3f3504f33ec3ef1500000000
.octa 0xbc490e90be605c13bed53641bf187fc0,0x3e2f10a2bd48fb30be888e93bef15aea,0x3eb263ef3dfab273bde1bc2ebeac7cd4,0x3f039c3d3e94a0313d48fb30be47c5c2
.octa 0x3f2994153ee633753e541501bd48fb30,0x3f49d1123f187fc03eb8442a3dc8bd36,0x3f633c5a3f3968423f00e7e43e78cfcc,0x3f74fa0b3f54db313f2267993ec3ef15
.octa 0x3f7e70b03f6a09a73f3fc7673f039c3d,0x3f7f4e6d3f7853f83f5848533f226799,0x3f778bc53f7f4e6d3f6b4b0c3f3daef9,0x3f676bd83f7ec46d3f7853f83f54db31
.octa 0x3f4f7a1f3f76ba073f7f0e583f676bd8,0x3f3085bb3f676bd83f7f4e6d3f74fa0b,0x3f0b9a6b3f514d3d3f7912983f7d3aac,0x3ec3ef153f3504f33f6c835e3f800000
.size L_table, .-L_table
.section .rodata,"a"
.p2align 6
.amdhsa_kernel sequential_preLN__spectral_gfnet__mixer_gmlp__prompt_kernel
  .amdhsa_next_free_vgpr 512
  .amdhsa_next_free_sgpr 102
  .amdhsa_accum_offset 256
  .amdhsa_group_segment_fixed_size 0
  .amdhsa_kernarg_size 88
  .amdhsa_user_sgpr_count 2
  .amdhsa_user_sgpr_kernarg_segment_ptr 1
  .amdhsa_system_sgpr_workgroup_id_x 1
.end_amdhsa_kernel
```
